```python
import torch

def _softmax(x, axis=-1):
    return torch.softmax(x, dim=axis)
def _gelu(x):
    return torch.nn.functional.gelu(x, approximate="tanh")
def _silu(x):
    return torch.nn.functional.silu(x)
def _sigmoid(x):
    return torch.sigmoid(x)
def _layernorm(x, axis=-1, eps=1e-5):
    m = x.mean(dim=axis, keepdim=True)
    v = x.var(dim=axis, keepdim=True, unbiased=False)
    return (x - m) / torch.sqrt(v + eps)
def _scatter_add(tgt, idx, src, axis=0):
    return tgt.clone().index_add_(axis, idx, src)
def _segment_sum(src, seg, n):
    out = torch.zeros((n,) + src.shape[1:], dtype=src.dtype)
    return out.index_add_(0, seg, src)
def _pad(x, pw):
    flat = tuple(v for pair in reversed(pw) for v in pair)
    return torch.nn.functional.pad(x, flat)

kernel_name = 'interleave_layers__gqa_block_cached__glu_gated_bilinear__decode'

def setup_inputs():

    _w = (lambda a: (lambda t: t.to(torch.bfloat16) if t.is_floating_point() else t)(torch.as_tensor(a)))
    def _A_setup():
        B, Sq, D = 2, 1, 512
        Hq, Hkv, Sk, Dh = 32, 32, 16384, 128
        assert Hq % Hkv == 0, (Hq, Hkv)
        return {
            "x": _w((lambda *s: torch.randn(*s, dtype=torch.bfloat16) * 0.05)(B, Sq, D)),
            "k_cache": _w((lambda *s: torch.randn(*s, dtype=torch.bfloat16) * 0.8)(B, Hkv, Sk, Dh)),
            "v_cache": _w((lambda *s: torch.randn(*s, dtype=torch.bfloat16) * 1.6)(B, Hkv, Sk, Dh)),
            "wq": _w((lambda *s: torch.randn(*s, dtype=torch.bfloat16) * 0.8)(D, Hq * Dh) * (D ** -0.5)),
            "wo": _w((lambda *s: torch.randn(*s, dtype=torch.bfloat16) * 1.6)(Hq * Dh, D) * ((Hq * Dh) ** -0.5)),
        }
    _A_in = _A_setup()

    def _B_setup():
        B, S, D, F = 2, 1, 512, 1376
        return {
            "x": _w((lambda *s: torch.randn(*s, dtype=torch.bfloat16) * 0.05)(B, S, D)),
            "w_gate": _w((lambda *s: torch.randn(*s, dtype=torch.bfloat16) * 0.4)(D, F) * (D ** -0.5)),
            "w_up": _w((lambda *s: torch.randn(*s, dtype=torch.bfloat16) * 0.4)(D, F) * (D ** -0.5)),
            "w_down": _w((lambda *s: torch.randn(*s, dtype=torch.bfloat16) * 0.4)(F, D) * (F ** -0.5)),
        }
    _B_in = _B_setup()

    return {
        "A_x": _A_in["x"],
        "A_k_cache": _A_in["k_cache"],
        "A_v_cache": _A_in["v_cache"],
        "A_wq": _A_in["wq"],
        "A_wo": _A_in["wo"],
        "B_x": _B_in["x"],
        "B_w_gate": _B_in["w_gate"],
        "B_w_up": _B_in["w_up"],
        "B_w_down": _B_in["w_down"],
    }

def reference(A_x, A_k_cache, A_v_cache, A_wq, A_wo, B_x, B_w_gate, B_w_up, B_w_down):
    def _A_ref(x, k_cache, v_cache, wq, wo):
        B, Sq, D = x.shape
        Hq, Dh = 32, 128
        Hkv = k_cache.shape[1]
        rep = Hq // Hkv
        q = (lambda x, *d: x.permute(*d))((x @ wq).reshape(B, Sq, Hq, Dh), 0, 2, 1, 3)
        k = (lambda x, n, axis: torch.repeat_interleave(x, n, dim=axis))(k_cache, rep, axis=1)
        v = (lambda x, n, axis: torch.repeat_interleave(x, n, dim=axis))(v_cache, rep, axis=1)
        scores = torch.einsum("bhqd,bhkd->bhqk", q, k) * (Dh ** -0.5)
        p = _softmax(scores, axis=-1)
        o = torch.einsum("bhqk,bhkd->bhqd", p, v)
        return (lambda x, *d: x.permute(*d))(o, 0, 2, 1, 3).reshape(B, Sq, Hq * Dh) @ wo

    def _B_ref(x, w_gate, w_up, w_down):
        g = torch.einsum("bsd,df->bsf", x, w_gate)
        u = torch.einsum("bsd,df->bsf", x, w_up)
        h = g * u
        return torch.einsum("bsf,fd->bsd", h, w_down)

    x = A_x
    x = x + _A_ref(_layernorm(x, axis=-1), A_k_cache, A_v_cache, A_wq, A_wo)
    x = x + _B_ref(_layernorm(x, axis=-1), B_w_gate, B_w_up, B_w_down)
    x = x + _A_ref(_layernorm(x, axis=-1), A_k_cache, A_v_cache, A_wq, A_wo)
    x = x + _B_ref(_layernorm(x, axis=-1), B_w_gate, B_w_up, B_w_down)
    return x
```

```asm
; @launch grid=(256,1,1) block=(256,1,1) lds=161792
.amdgcn_target "amdgcn-amd-amdhsa--gfx950"
.text
.globl interleave_layers__gqa_block_cached__glu_gated_bilinear__decode_kernel
.p2align 8
.type interleave_layers__gqa_block_cached__glu_gated_bilinear__decode_kernel,@function
interleave_layers__gqa_block_cached__glu_gated_bilinear__decode_kernel:
  s_cmp_ge_u32 s2, 256
  s_cbranch_scc1 L_end
  s_load_dwordx16 s[64:79], s[0:1], 0
  s_load_dwordx8 s[80:87], s[0:1], 64
  v_lshrrev_b32 v1, 6, v0
  v_and_b32 v0, 63, v0
  v_readfirstlane_b32 s24, v1
  s_mov_b32 s27, s2
  s_and_b32 s46, s2, 7
  s_lshr_b32 s47, s2, 3
  s_mov_b32 s39, 200000
  s_waitcnt lgkmcnt(0)
  s_mov_b32 s4, s66
  s_and_b32 s5, s67, 0xffff
  s_mov_b32 s6, 0x10000000
  s_mov_b32 s7, 0x20000
  s_mov_b32 s8, s68
  s_and_b32 s9, s69, 0xffff
  s_mov_b32 s10, 0x10000000
  s_mov_b32 s11, 0x20000
  s_mov_b32 s12, s86
  s_and_b32 s13, s87, 0xffff
  s_mov_b32 s14, 0x330000
  s_mov_b32 s15, 0x20000
  s_mov_b32 s16, s82
  s_and_b32 s17, s83, 0xffff
  s_mov_b32 s18, 0x800
  s_mov_b32 s19, 0x20000
  s_mov_b32 s20, s70
  s_and_b32 s21, s71, 0xffff
  s_mov_b32 s22, 0x400000
  s_mov_b32 s23, 0x20000
  s_and_b32 s65, s65, 0xffff
  s_mov_b32 s66, 2048
  s_mov_b32 s67, 0x20000
  s_cmp_lt_u32 s47, 4
  s_cbranch_scc1 L_service
  s_sub_u32 s47, s47, 4
  s_mul_i32 s48, s47, 37
  s_lshr_b32 s48, s48, 8
  s_lshl_b32 s25, s46, 2
  s_add_u32 s25, s25, s48
  s_mul_i32 s48, s48, 7
  s_sub_u32 s26, s47, s48
  v_mov_b32 v48, v0
  s_mul_i32 s46, s26, 292
  s_min_u32 s47, s26, 4
  s_add_u32 s46, s46, s47
  s_lshl_b32 s46, s46, 11
  s_lshl_b32 s47, s25, 22
  s_add_u32 s46, s46, s47
  s_lshl_b32 s47, s24, 14
  s_add_u32 s28, s46, s47
  s_add_u32 s29, s28, 0x8000000
  s_lshl_b32 s47, s24, 12
  s_add_u32 s30, s46, s47
  s_add_u32 s30, s30, 589824
  s_add_u32 s31, s30, 0x8000000
  s_cmp_lt_u32 s26, 4
  s_cselect_b32 s46, 5, 4
  s_lshl_b32 s47, s24, 1
  s_sub_i32 s46, s46, s47
  s_max_i32 s46, s46, 0
  s_min_i32 s46, s46, 2
  s_lshl_b32 s38, s46, 3
  s_cmp_gt_u32 s38, 0
  s_cselect_b64 s[42:43], -1, 0
  s_cmp_gt_u32 s38, 8
  s_cselect_b64 s[44:45], -1, 0
  s_lshl_b32 s40, s26, 2
  s_add_u32 s40, s40, s24
  s_mul_i32 s34, s24, 39936
  s_add_u32 s34, s34, 2048
  s_lshl_b32 s35, s24, 9
  v_lshlrev_b32 v3, 4, v48
  v_add_u32 v4, s34, v3
  s_sub_u32 s34, s34, 4096
  v_and_b32 v40, 7, v48
  v_lshlrev_b32 v0, 8, v40
  v_bfe_u32 v40, v48, 3, 1
  v_lshl_add_u32 v0, v40, 6, v0
  v_lshrrev_b32 v41, 4, v48
  v_lshl_add_u32 v0, v41, 4, v0
  v_and_b32 v40, 15, v48
  v_lshlrev_b32 v1, 4, v40
  v_lshl_add_u32 v2, v41, 11, v1
  v_lshl_add_u32 v1, v41, 12, v1
  v_lshl_add_u32 v42, v40, 2, v41
  v_cmp_gt_u32 vcc, s38, v42
  s_nop 1
  v_cndmask_b32 v42, 16, v42, vcc
  v_lshlrev_b32 v5, 2, v42
  v_and_b32 v42, 1, v48
  v_lshlrev_b32 v42, 4, v42
  v_mov_b32 v43, 0xffff
  v_lshlrev_b32 v43, v42, v43
  v_lshrrev_b32 v44, 1, v40
  v_cmp_eq_u32 vcc, 0, v44
  s_nop 1
  v_cndmask_b32 v6, 0, v43, vcc
  v_cmp_eq_u32 vcc, 1, v44
  s_nop 1
  v_cndmask_b32 v7, 0, v43, vcc
  v_cmp_eq_u32 vcc, 2, v44
  s_nop 1
  v_cndmask_b32 v8, 0, v43, vcc
  v_cmp_eq_u32 vcc, 3, v44
  s_nop 1
  v_cndmask_b32 v9, 0, v43, vcc
  s_mov_b32 s32, s28
  buffer_load_dwordx4 a[0:3], v0, s[4:7], s32 offen offset:0 nt
  buffer_load_dwordx4 a[4:7], v0, s[4:7], s32 offen offset:128 nt
  buffer_load_dwordx4 a[8:11], v0, s[4:7], s32 offen offset:2048 nt
  buffer_load_dwordx4 a[12:15], v0, s[4:7], s32 offen offset:2176 nt
  s_add_u32 s32, s28, 4096
  buffer_load_dwordx4 a[16:19], v0, s[4:7], s32 offen offset:0 nt
  buffer_load_dwordx4 a[20:23], v0, s[4:7], s32 offen offset:128 nt
  buffer_load_dwordx4 a[24:27], v0, s[4:7], s32 offen offset:2048 nt
  buffer_load_dwordx4 a[28:31], v0, s[4:7], s32 offen offset:2176 nt
  s_waitcnt vmcnt(6)
  v_mov_b32 v52, -1
  v_mov_b32 v53, -1
  v_mov_b32 v54, -1
  v_mov_b32 v55, -1
  s_sub_u32 s41, s27, 32
  s_lshl_b32 s41, s41, 2
  s_add_u32 s41, s41, s24
  s_mul_i32 s41, s41, 3072
  buffer_store_dwordx4 v[52:55], v3, s[12:15], s41 offen offset:0 sc1
  s_waitcnt vmcnt(6)
  buffer_store_dwordx4 v[52:55], v3, s[12:15], s41 offen offset:1024 sc1
  s_waitcnt vmcnt(6)
  buffer_store_dwordx4 v[52:55], v3, s[12:15], s41 offen offset:2048 sc1
  s_waitcnt vmcnt(6)
  s_add_u32 s32, s28, 8192
  buffer_load_dwordx4 a[32:35], v0, s[4:7], s32 offen offset:0 nt
  s_waitcnt vmcnt(6)
  buffer_load_dwordx4 a[36:39], v0, s[4:7], s32 offen offset:128 nt
  s_waitcnt vmcnt(6)
  buffer_load_dwordx4 a[40:43], v0, s[4:7], s32 offen offset:2048 nt
  s_waitcnt vmcnt(6)
  buffer_load_dwordx4 a[44:47], v0, s[4:7], s32 offen offset:2176 nt
  s_waitcnt vmcnt(6)
  s_add_u32 s32, s28, 12288
  buffer_load_dwordx4 a[48:51], v0, s[4:7], s32 offen offset:0 nt
  s_waitcnt vmcnt(6)
  buffer_load_dwordx4 a[52:55], v0, s[4:7], s32 offen offset:128 nt
  s_waitcnt vmcnt(6)
  buffer_load_dwordx4 a[56:59], v0, s[4:7], s32 offen offset:2048 nt
  s_waitcnt vmcnt(6)
  buffer_load_dwordx4 a[60:63], v0, s[4:7], s32 offen offset:2176 nt
  s_waitcnt vmcnt(6)
  s_add_u32 s32, s28, 65536
  buffer_load_dwordx4 a[64:67], v0, s[4:7], s32 offen offset:0 nt
  s_waitcnt vmcnt(6)
  buffer_load_dwordx4 a[68:71], v0, s[4:7], s32 offen offset:128 nt
  s_waitcnt vmcnt(6)
  buffer_load_dwordx4 a[72:75], v0, s[4:7], s32 offen offset:2048 nt
  s_waitcnt vmcnt(6)
  buffer_load_dwordx4 a[76:79], v0, s[4:7], s32 offen offset:2176 nt
  s_barrier
  s_cmp_eq_u32 s24, 0
  s_cbranch_scc0 b1_1
  v_mov_b32 v40, 0
  v_mov_b32 v41, 1
  s_mov_b64 exec, 1
  global_atomic_add v40, v41, s[84:85]
  s_mov_b64 exec, -1
b1_1:
  s_waitcnt vmcnt(6)
  s_add_u32 s32, s28, 69632
  buffer_load_dwordx4 a[80:83], v0, s[4:7], s32 offen offset:0 nt
  s_waitcnt vmcnt(6)
  buffer_load_dwordx4 a[84:87], v0, s[4:7], s32 offen offset:128 nt
  s_waitcnt vmcnt(6)
  buffer_load_dwordx4 a[88:91], v0, s[4:7], s32 offen offset:2048 nt
  s_waitcnt vmcnt(6)
  buffer_load_dwordx4 a[92:95], v0, s[4:7], s32 offen offset:2176 nt
  s_waitcnt vmcnt(6)
  s_add_u32 s32, s28, 73728
  buffer_load_dwordx4 a[96:99], v0, s[4:7], s32 offen offset:0 nt
  s_waitcnt vmcnt(6)
  buffer_load_dwordx4 a[100:103], v0, s[4:7], s32 offen offset:128 nt
  s_waitcnt vmcnt(6)
  buffer_load_dwordx4 a[104:107], v0, s[4:7], s32 offen offset:2048 nt
  s_waitcnt vmcnt(6)
  buffer_load_dwordx4 a[108:111], v0, s[4:7], s32 offen offset:2176 nt
  s_waitcnt vmcnt(6)
  s_add_u32 s32, s28, 77824
  buffer_load_dwordx4 a[112:115], v0, s[4:7], s32 offen offset:0 nt
  s_waitcnt vmcnt(6)
  buffer_load_dwordx4 a[116:119], v0, s[4:7], s32 offen offset:128 nt
  s_waitcnt vmcnt(6)
  buffer_load_dwordx4 a[120:123], v0, s[4:7], s32 offen offset:2048 nt
  s_waitcnt vmcnt(6)
  buffer_load_dwordx4 a[124:127], v0, s[4:7], s32 offen offset:2176 nt
  s_waitcnt vmcnt(6)
  s_add_u32 s32, s28, 131072
  buffer_load_dwordx4 a[128:131], v0, s[4:7], s32 offen offset:0 nt
  s_waitcnt vmcnt(6)
  buffer_load_dwordx4 a[132:135], v0, s[4:7], s32 offen offset:128 nt
  s_waitcnt vmcnt(6)
  buffer_load_dwordx4 a[136:139], v0, s[4:7], s32 offen offset:2048 nt
  s_waitcnt vmcnt(6)
  buffer_load_dwordx4 a[140:143], v0, s[4:7], s32 offen offset:2176 nt
  s_waitcnt vmcnt(6)
  s_add_u32 s32, s28, 135168
  buffer_load_dwordx4 a[144:147], v0, s[4:7], s32 offen offset:0 nt
  s_waitcnt vmcnt(6)
  buffer_load_dwordx4 a[148:151], v0, s[4:7], s32 offen offset:128 nt
  s_waitcnt vmcnt(6)
  buffer_load_dwordx4 a[152:155], v0, s[4:7], s32 offen offset:2048 nt
  s_waitcnt vmcnt(6)
  buffer_load_dwordx4 a[156:159], v0, s[4:7], s32 offen offset:2176 nt
  s_waitcnt vmcnt(6)
  s_add_u32 s32, s28, 139264
  buffer_load_dwordx4 a[160:163], v0, s[4:7], s32 offen offset:0 nt
  s_waitcnt vmcnt(6)
  buffer_load_dwordx4 a[164:167], v0, s[4:7], s32 offen offset:128 nt
  s_waitcnt vmcnt(6)
  buffer_load_dwordx4 a[168:171], v0, s[4:7], s32 offen offset:2048 nt
  s_waitcnt vmcnt(6)
  buffer_load_dwordx4 a[172:175], v0, s[4:7], s32 offen offset:2176 nt
  s_waitcnt vmcnt(6)
  s_add_u32 s32, s28, 143360
  buffer_load_dwordx4 a[176:179], v0, s[4:7], s32 offen offset:0 nt
  s_waitcnt vmcnt(6)
  buffer_load_dwordx4 a[180:183], v0, s[4:7], s32 offen offset:128 nt
  s_waitcnt vmcnt(6)
  buffer_load_dwordx4 a[184:187], v0, s[4:7], s32 offen offset:2048 nt
  s_waitcnt vmcnt(6)
  buffer_load_dwordx4 a[188:191], v0, s[4:7], s32 offen offset:2176 nt
  s_waitcnt vmcnt(6)
  s_add_u32 s32, s28, 196608
  buffer_load_dwordx4 a[192:195], v0, s[4:7], s32 offen offset:0 nt
  s_waitcnt vmcnt(6)
  buffer_load_dwordx4 a[196:199], v0, s[4:7], s32 offen offset:128 nt
  s_waitcnt vmcnt(6)
  buffer_load_dwordx4 a[200:203], v0, s[4:7], s32 offen offset:2048 nt
  s_waitcnt vmcnt(6)
  buffer_load_dwordx4 a[204:207], v0, s[4:7], s32 offen offset:2176 nt
  s_waitcnt vmcnt(6)
  s_add_u32 s32, s28, 200704
  buffer_load_dwordx4 a[208:211], v0, s[4:7], s32 offen offset:0 nt
  s_waitcnt vmcnt(6)
  buffer_load_dwordx4 a[212:215], v0, s[4:7], s32 offen offset:128 nt
  s_waitcnt vmcnt(6)
  buffer_load_dwordx4 a[216:219], v0, s[4:7], s32 offen offset:2048 nt
  s_waitcnt vmcnt(6)
  buffer_load_dwordx4 a[220:223], v0, s[4:7], s32 offen offset:2176 nt
  s_waitcnt vmcnt(6)
  s_add_u32 s32, s28, 204800
  buffer_load_dwordx4 a[224:227], v0, s[4:7], s32 offen offset:0 nt
  s_waitcnt vmcnt(6)
  buffer_load_dwordx4 a[228:231], v0, s[4:7], s32 offen offset:128 nt
  s_waitcnt vmcnt(6)
  buffer_load_dwordx4 a[232:235], v0, s[4:7], s32 offen offset:2048 nt
  s_waitcnt vmcnt(6)
  buffer_load_dwordx4 a[236:239], v0, s[4:7], s32 offen offset:2176 nt
  s_waitcnt vmcnt(6)
  s_add_u32 s32, s28, 208896
  buffer_load_dwordx4 a[240:243], v0, s[4:7], s32 offen offset:0 nt
  s_waitcnt vmcnt(6)
  v_mov_b32 v58, 0
  global_load_dword v59, v58, s[84:85] sc1
  s_waitcnt vmcnt(6)
  buffer_load_dwordx4 a[244:247], v0, s[4:7], s32 offen offset:128 nt
  s_waitcnt vmcnt(6)
  buffer_load_dwordx4 a[248:251], v0, s[4:7], s32 offen offset:2048 nt
  s_waitcnt vmcnt(6)
  buffer_load_dwordx4 a[252:255], v0, s[4:7], s32 offen offset:2176 nt
  s_waitcnt vmcnt(6)
  s_add_u32 s32, s28, 524288
  buffer_load_dwordx4 v[92:95], v0, s[4:7], s32 offen offset:0 nt
  s_waitcnt vmcnt(6)
  buffer_load_dwordx4 v[96:99], v0, s[4:7], s32 offen offset:128 nt
  s_waitcnt vmcnt(6)
  buffer_load_dwordx4 v[100:103], v0, s[4:7], s32 offen offset:2048 nt
  s_waitcnt vmcnt(6)
  buffer_load_dwordx4 v[104:107], v0, s[4:7], s32 offen offset:2176 nt
  v_readfirstlane_b32 s46, v59
  s_nop 0
  s_cmp_ge_u32 s46, 224
  s_nop 2
  s_cbranch_scc1 clok_2
clp_3:
  global_load_dword v59, v58, s[84:85] sc1
  s_waitcnt vmcnt(0)
  v_readfirstlane_b32 s46, v59
  s_nop 0
  s_cmp_ge_u32 s46, 224
  s_cbranch_scc1 clok_2
  s_sub_u32 s39, s39, 1
  s_cmp_gt_i32 s39, 0
  s_cbranch_scc1 clp_3
clok_2:
  s_waitcnt vmcnt(6)
  s_add_u32 s32, s28, 528384
  buffer_load_dwordx4 v[108:111], v0, s[4:7], s32 offen offset:0 nt
  s_waitcnt vmcnt(6)
  buffer_load_dwordx4 v[112:115], v0, s[4:7], s32 offen offset:128 nt
  s_waitcnt vmcnt(6)
  buffer_load_dwordx4 v[116:119], v0, s[4:7], s32 offen offset:2048 nt
  s_waitcnt vmcnt(6)
  buffer_load_dwordx4 v[120:123], v0, s[4:7], s32 offen offset:2176 nt
  s_waitcnt vmcnt(6)
  s_mov_b32 s33, s28
  buffer_load_dwordx4 v[124:127], v1, s[8:11], s33 offen offset:0 nt
  s_waitcnt vmcnt(6)
  buffer_load_dwordx4 v[128:131], v1, s[8:11], s33 offen offset:256 nt
  s_waitcnt vmcnt(6)
  buffer_load_dwordx4 v[132:135], v1, s[8:11], s33 offen offset:512 nt
  s_waitcnt vmcnt(6)
  buffer_load_dwordx4 v[136:139], v1, s[8:11], s33 offen offset:768 nt
  s_waitcnt vmcnt(6)
  buffer_load_dwordx4 v[140:143], v1, s[8:11], s33 offen offset:1024 nt
  s_waitcnt vmcnt(6)
  buffer_load_dwordx4 v[144:147], v1, s[8:11], s33 offen offset:1280 nt
  s_waitcnt vmcnt(6)
  buffer_load_dwordx4 v[148:151], v1, s[8:11], s33 offen offset:1536 nt
  s_waitcnt vmcnt(6)
  buffer_load_dwordx4 v[152:155], v1, s[8:11], s33 offen offset:1792 nt
  s_waitcnt vmcnt(6)
  buffer_load_dwordx4 v[156:159], v1, s[8:11], s33 offen offset:2048 nt
  s_waitcnt vmcnt(6)
  buffer_load_dwordx4 v[160:163], v1, s[8:11], s33 offen offset:2304 nt
  s_waitcnt vmcnt(6)
  buffer_load_dwordx4 v[164:167], v1, s[8:11], s33 offen offset:2560 nt
  s_waitcnt vmcnt(6)
  buffer_load_dwordx4 v[168:171], v1, s[8:11], s33 offen offset:2816 nt
  s_waitcnt vmcnt(6)
  buffer_load_dwordx4 v[172:175], v1, s[8:11], s33 offen offset:3072 nt
  s_waitcnt vmcnt(6)
  buffer_load_dwordx4 v[176:179], v1, s[8:11], s33 offen offset:3328 nt
  s_waitcnt vmcnt(6)
  buffer_load_dwordx4 v[180:183], v1, s[8:11], s33 offen offset:3584 nt
  s_waitcnt vmcnt(6)
  buffer_load_dwordx4 v[184:187], v1, s[8:11], s33 offen offset:3840 nt
  s_waitcnt vmcnt(6)
  s_add_u32 s33, s28, 65536
  buffer_load_dwordx4 v[188:191], v1, s[8:11], s33 offen offset:0 nt
  s_waitcnt vmcnt(6)
  buffer_load_dwordx4 v[192:195], v1, s[8:11], s33 offen offset:256 nt
  s_waitcnt vmcnt(6)
  buffer_load_dwordx4 v[196:199], v1, s[8:11], s33 offen offset:512 nt
  s_waitcnt vmcnt(6)
  buffer_load_dwordx4 v[200:203], v1, s[8:11], s33 offen offset:768 nt
  s_waitcnt vmcnt(6)
  buffer_load_dwordx4 v[204:207], v1, s[8:11], s33 offen offset:1024 nt
  s_waitcnt vmcnt(6)
  buffer_load_dwordx4 v[208:211], v1, s[8:11], s33 offen offset:1280 nt
  s_waitcnt vmcnt(6)
  buffer_load_dwordx4 v[212:215], v1, s[8:11], s33 offen offset:1536 nt
  s_waitcnt vmcnt(6)
  buffer_load_dwordx4 v[216:219], v1, s[8:11], s33 offen offset:1792 nt
  s_waitcnt vmcnt(6)
  buffer_load_dwordx4 v[220:223], v1, s[8:11], s33 offen offset:2048 nt
  s_waitcnt vmcnt(6)
  buffer_load_dwordx4 v[224:227], v1, s[8:11], s33 offen offset:2304 nt
  s_waitcnt vmcnt(6)
  buffer_load_dwordx4 v[228:231], v1, s[8:11], s33 offen offset:2560 nt
  s_waitcnt vmcnt(6)
  buffer_load_dwordx4 v[232:235], v1, s[8:11], s33 offen offset:2816 nt
  s_waitcnt vmcnt(6)
  buffer_load_dwordx4 v[236:239], v1, s[8:11], s33 offen offset:3072 nt
  s_waitcnt vmcnt(6)
  buffer_load_dwordx4 v[240:243], v1, s[8:11], s33 offen offset:3328 nt
  s_waitcnt vmcnt(6)
  buffer_load_dwordx4 v[244:247], v1, s[8:11], s33 offen offset:3584 nt
  s_waitcnt vmcnt(6)
  buffer_load_dwordx4 v[248:251], v1, s[8:11], s33 offen offset:3840 nt
  s_waitcnt vmcnt(6)
  s_add_u32 s33, s28, 131072
  buffer_load_dwordx4 v[252:255], v1, s[8:11], s33 offen offset:0 nt
  s_waitcnt vmcnt(6)
  s_add_u32 m0, s34, 3840
  s_nop 0
  buffer_load_dwordx4 v1, s[8:11], s33 offen offset:256 nt lds
  s_waitcnt vmcnt(6)
  s_add_u32 m0, s34, 4608
  s_nop 0
  buffer_load_dwordx4 v1, s[8:11], s33 offen offset:512 nt lds
  s_waitcnt vmcnt(6)
  s_add_u32 m0, s34, 5376
  s_nop 0
  buffer_load_dwordx4 v1, s[8:11], s33 offen offset:768 nt lds
  s_waitcnt vmcnt(6)
  s_add_u32 m0, s34, 6144
  s_nop 0
  buffer_load_dwordx4 v1, s[8:11], s33 offen offset:1024 nt lds
  s_waitcnt vmcnt(6)
  s_add_u32 m0, s34, 6912
  s_nop 0
  buffer_load_dwordx4 v1, s[8:11], s33 offen offset:1280 nt lds
  s_waitcnt vmcnt(6)
  s_add_u32 m0, s34, 7680
  s_nop 0
  buffer_load_dwordx4 v1, s[8:11], s33 offen offset:1536 nt lds
  s_waitcnt vmcnt(6)
  s_add_u32 m0, s34, 8448
  s_nop 0
  buffer_load_dwordx4 v1, s[8:11], s33 offen offset:1792 nt lds
  s_waitcnt vmcnt(6)
  s_add_u32 m0, s34, 9216
  s_nop 0
  buffer_load_dwordx4 v1, s[8:11], s33 offen offset:2048 nt lds
  s_waitcnt vmcnt(6)
  s_add_u32 m0, s34, 9984
  s_nop 0
  buffer_load_dwordx4 v1, s[8:11], s33 offen offset:2304 nt lds
  s_waitcnt vmcnt(6)
  s_add_u32 m0, s34, 10752
  s_nop 0
  buffer_load_dwordx4 v1, s[8:11], s33 offen offset:2560 nt lds
  s_waitcnt vmcnt(6)
  s_add_u32 m0, s34, 11520
  s_nop 0
  buffer_load_dwordx4 v1, s[8:11], s33 offen offset:2816 nt lds
  s_waitcnt vmcnt(6)
  s_add_u32 m0, s34, 12288
  s_nop 0
  buffer_load_dwordx4 v1, s[8:11], s33 offen offset:3072 nt lds
  s_waitcnt vmcnt(6)
  s_add_u32 m0, s34, 13056
  s_nop 0
  buffer_load_dwordx4 v1, s[8:11], s33 offen offset:3328 nt lds
  s_waitcnt vmcnt(6)
  s_add_u32 m0, s34, 13824
  s_nop 0
  buffer_load_dwordx4 v1, s[8:11], s33 offen offset:3584 nt lds
  s_waitcnt vmcnt(6)
  s_add_u32 m0, s34, 14592
  s_nop 0
  buffer_load_dwordx4 v1, s[8:11], s33 offen offset:3840 nt lds
  s_waitcnt vmcnt(6)
  s_add_u32 s33, s28, 196608
  s_add_u32 m0, s34, 19456
  s_nop 0
  buffer_load_dwordx4 v1, s[8:11], s33 offen offset:0 nt lds
  s_waitcnt vmcnt(6)
  s_add_u32 m0, s34, 20224
  s_nop 0
  buffer_load_dwordx4 v1, s[8:11], s33 offen offset:256 nt lds
  s_waitcnt vmcnt(6)
  s_add_u32 m0, s34, 20992
  s_nop 0
  buffer_load_dwordx4 v1, s[8:11], s33 offen offset:512 nt lds
  s_waitcnt vmcnt(6)
  s_add_u32 m0, s34, 21760
  s_nop 0
  buffer_load_dwordx4 v1, s[8:11], s33 offen offset:768 nt lds
  s_waitcnt vmcnt(6)
  s_add_u32 m0, s34, 22528
  s_nop 0
  buffer_load_dwordx4 v1, s[8:11], s33 offen offset:1024 nt lds
  s_waitcnt vmcnt(6)
  s_add_u32 m0, s34, 23296
  s_nop 0
  buffer_load_dwordx4 v1, s[8:11], s33 offen offset:1280 nt lds
  s_waitcnt vmcnt(6)
  s_add_u32 m0, s34, 24064
  s_nop 0
  buffer_load_dwordx4 v1, s[8:11], s33 offen offset:1536 nt lds
  s_waitcnt vmcnt(6)
  s_add_u32 m0, s34, 24832
  s_nop 0
  buffer_load_dwordx4 v1, s[8:11], s33 offen offset:1792 nt lds
  s_waitcnt vmcnt(6)
  s_add_u32 m0, s34, 25600
  s_nop 0
  buffer_load_dwordx4 v1, s[8:11], s33 offen offset:2048 nt lds
  s_waitcnt vmcnt(6)
  s_add_u32 m0, s34, 26368
  s_nop 0
  buffer_load_dwordx4 v1, s[8:11], s33 offen offset:2304 nt lds
  s_waitcnt vmcnt(6)
  s_add_u32 m0, s34, 27136
  s_nop 0
  buffer_load_dwordx4 v1, s[8:11], s33 offen offset:2560 nt lds
  s_waitcnt vmcnt(6)
  s_add_u32 m0, s34, 27904
  s_nop 0
  buffer_load_dwordx4 v1, s[8:11], s33 offen offset:2816 nt lds
  s_waitcnt vmcnt(6)
  s_add_u32 m0, s34, 28672
  s_nop 0
  buffer_load_dwordx4 v1, s[8:11], s33 offen offset:3072 nt lds
  s_waitcnt vmcnt(6)
  s_add_u32 m0, s34, 29440
  s_nop 0
  buffer_load_dwordx4 v1, s[8:11], s33 offen offset:3328 nt lds
  s_waitcnt vmcnt(6)
  s_add_u32 m0, s34, 30208
  s_nop 0
  buffer_load_dwordx4 v1, s[8:11], s33 offen offset:3584 nt lds
  s_waitcnt vmcnt(6)
  s_add_u32 m0, s34, 30976
  s_nop 0
  buffer_load_dwordx4 v1, s[8:11], s33 offen offset:3840 nt lds
  s_waitcnt vmcnt(6)
  s_lshl_b32 s46, s25, 8
  s_add_u32 s46, s46, 2400256
  s_add_u32 m0, s35, 0
  v_lshrrev_b32 v59, 2, v3
  buffer_load_dword v59, s[12:15], s46 offen sc1 lds
  s_waitcnt vmcnt(6)
  s_add_u32 s33, s28, 524288
  s_add_u32 m0, s34, 35840
  s_nop 0
  buffer_load_dwordx4 v2, s[8:11], s33 offen offset:0 nt lds
  s_waitcnt vmcnt(6)
  s_add_u32 m0, s34, 36608
  s_nop 0
  buffer_load_dwordx4 v2, s[8:11], s33 offen offset:256 nt lds
  s_waitcnt vmcnt(6)
  s_add_u32 m0, s34, 37376
  s_nop 0
  buffer_load_dwordx4 v2, s[8:11], s33 offen offset:512 nt lds
  s_waitcnt vmcnt(6)
  s_add_u32 m0, s34, 38144
  s_nop 0
  buffer_load_dwordx4 v2, s[8:11], s33 offen offset:768 nt lds
  s_waitcnt vmcnt(6)
  s_add_u32 m0, s34, 38912
  s_nop 0
  buffer_load_dwordx4 v2, s[8:11], s33 offen offset:1024 nt lds
  s_waitcnt vmcnt(6)
  s_add_u32 m0, s34, 39680
  s_nop 0
  buffer_load_dwordx4 v2, s[8:11], s33 offen offset:1280 nt lds
  s_waitcnt vmcnt(6)
  s_add_u32 m0, s34, 40448
  s_nop 0
  buffer_load_dwordx4 v2, s[8:11], s33 offen offset:1536 nt lds
  v_lshrrev_b32 v41, 4, v3
  v_and_b32 v40, 1, v41
  v_lshlrev_b32 v40, 6, v40
  v_lshrrev_b32 v41, 4, v41
  v_lshl_add_u32 v40, v41, 4, v40
  v_add_u32 v40, s35, v40
  ds_read_b128 v[12:15], v40 offset:0
  ds_read_b128 v[16:19], v40 offset:128
  s_waitcnt lgkmcnt(0)
  v_max3_u32 v42, v12, v13, v14
  v_max3_u32 v42, v42, v15, v16
  v_max3_u32 v42, v42, v17, v18
  v_max_u32 v42, v42, v19
  v_cmp_eq_u32 vcc, -1, v42
  s_nop 0
  s_cmp_lg_u64 vcc, 0
  s_nop 2
  s_cbranch_scc0 qok_4
qretry_5:
  s_sleep 2
  s_lshl_b32 s46, s25, 8
  s_add_u32 s46, s46, 2400256
  s_add_u32 m0, s35, 0
  v_lshrrev_b32 v59, 2, v3
  buffer_load_dword v59, s[12:15], s46 offen sc1 lds
  s_waitcnt vmcnt(0)
  v_lshrrev_b32 v41, 4, v3
  v_and_b32 v40, 1, v41
  v_lshlrev_b32 v40, 6, v40
  v_lshrrev_b32 v41, 4, v41
  v_lshl_add_u32 v40, v41, 4, v40
  v_add_u32 v40, s35, v40
  ds_read_b128 v[12:15], v40 offset:0
  ds_read_b128 v[16:19], v40 offset:128
  s_waitcnt lgkmcnt(0)
  v_max3_u32 v42, v12, v13, v14
  v_max3_u32 v42, v42, v15, v16
  v_max3_u32 v42, v42, v17, v18
  v_max_u32 v42, v42, v19
  v_cmp_eq_u32 vcc, -1, v42
  s_nop 0
  s_cmp_lg_u64 vcc, 0
  s_cbranch_scc0 qok_4
  s_sub_u32 s39, s39, 1
  s_cmp_gt_i32 s39, 0
  s_cbranch_scc1 qretry_5
qok_4:
  v_mfma_f32_16x16x32_bf16 v[40:43], v[12:15], a[0:3], 0
  v_mfma_f32_16x16x32_bf16 v[40:43], v[16:19], a[4:7], v[40:43]
  v_mfma_f32_16x16x32_bf16 v[44:47], v[12:15], a[8:11], 0
  v_mfma_f32_16x16x32_bf16 v[44:47], v[16:19], a[12:15], v[44:47]
  s_nop 5
  v_add_f32_dpp v20, v41, v40 row_ror:8 row_mask:0x1 bank_mask:0x3
  v_mfma_f32_16x16x32_bf16 v[40:43], v[12:15], a[16:19], 0
  v_mfma_f32_16x16x32_bf16 v[40:43], v[16:19], a[20:23], v[40:43]
  s_waitcnt vmcnt(6)
  s_add_u32 m0, s34, 41216
  s_nop 0
  buffer_load_dwordx4 v2, s[8:11], s33 offen offset:1792 nt lds
  v_add_f32_dpp v20, v44, v45 row_ror:8 row_mask:0x1 bank_mask:0xc
  v_mfma_f32_16x16x32_bf16 v[44:47], v[12:15], a[24:27], 0
  v_mfma_f32_16x16x32_bf16 v[44:47], v[16:19], a[28:31], v[44:47]
  s_nop 0
  v_add_f32_dpp v20, v41, v40 row_ror:8 row_mask:0x2 bank_mask:0x3
  v_mfma_f32_16x16x32_bf16 v[40:43], v[12:15], a[32:35], 0
  v_mfma_f32_16x16x32_bf16 v[40:43], v[16:19], a[36:39], v[40:43]
  s_nop 3
  v_add_f32_dpp v20, v44, v45 row_ror:8 row_mask:0x2 bank_mask:0xc
  v_mfma_f32_16x16x32_bf16 v[44:47], v[12:15], a[40:43], 0
  v_mfma_f32_16x16x32_bf16 v[44:47], v[16:19], a[44:47], v[44:47]
  s_nop 0
  v_add_f32_dpp v20, v41, v40 row_ror:8 row_mask:0x4 bank_mask:0x3
  v_mfma_f32_16x16x32_bf16 v[40:43], v[12:15], a[48:51], 0
  v_mfma_f32_16x16x32_bf16 v[40:43], v[16:19], a[52:55], v[40:43]
  s_waitcnt vmcnt(6)
  s_add_u32 s32, s28, 262144
  buffer_load_dwordx4 v[60:63], v0, s[4:7], s32 offen offset:0
  s_nop 0
  v_add_f32_dpp v20, v44, v45 row_ror:8 row_mask:0x4 bank_mask:0xc
  v_mfma_f32_16x16x32_bf16 v[44:47], v[12:15], a[56:59], 0
  v_mfma_f32_16x16x32_bf16 v[44:47], v[16:19], a[60:63], v[44:47]
  s_nop 0
  v_add_f32_dpp v20, v41, v40 row_ror:8 row_mask:0x8 bank_mask:0x3
  v_mfma_f32_16x16x32_bf16 v[40:43], v[12:15], a[64:67], 0
  v_mfma_f32_16x16x32_bf16 v[40:43], v[16:19], a[68:71], v[40:43]
  s_nop 3
  v_add_f32_dpp v20, v44, v45 row_ror:8 row_mask:0x8 bank_mask:0xc
  v_mfma_f32_16x16x32_bf16 v[44:47], v[12:15], a[72:75], 0
  v_mfma_f32_16x16x32_bf16 v[44:47], v[16:19], a[76:79], v[44:47]
  s_nop 0
  v_add_f32_dpp v21, v41, v40 row_ror:8 row_mask:0x1 bank_mask:0x3
  v_mfma_f32_16x16x32_bf16 v[40:43], v[12:15], a[80:83], 0
  v_mfma_f32_16x16x32_bf16 v[40:43], v[16:19], a[84:87], v[40:43]
  s_waitcnt vmcnt(6)
  buffer_load_dwordx4 v[64:67], v0, s[4:7], s32 offen offset:128
  s_nop 1
  v_add_f32_dpp v21, v44, v45 row_ror:8 row_mask:0x1 bank_mask:0xc
  v_mfma_f32_16x16x32_bf16 v[44:47], v[12:15], a[88:91], 0
  v_mfma_f32_16x16x32_bf16 v[44:47], v[16:19], a[92:95], v[44:47]
  s_nop 0
  v_add_f32_dpp v21, v41, v40 row_ror:8 row_mask:0x2 bank_mask:0x3
  v_mfma_f32_16x16x32_bf16 v[40:43], v[12:15], a[96:99], 0
  v_mfma_f32_16x16x32_bf16 v[40:43], v[16:19], a[100:103], v[40:43]
  s_nop 3
  v_add_f32_dpp v21, v44, v45 row_ror:8 row_mask:0x2 bank_mask:0xc
  v_mfma_f32_16x16x32_bf16 v[44:47], v[12:15], a[104:107], 0
  v_mfma_f32_16x16x32_bf16 v[44:47], v[16:19], a[108:111], v[44:47]
  s_nop 0
  v_add_f32_dpp v21, v41, v40 row_ror:8 row_mask:0x4 bank_mask:0x3
  v_mfma_f32_16x16x32_bf16 v[40:43], v[12:15], a[112:115], 0
  v_mfma_f32_16x16x32_bf16 v[40:43], v[16:19], a[116:119], v[40:43]
  s_waitcnt vmcnt(6)
  buffer_load_dwordx4 v[68:71], v0, s[4:7], s32 offen offset:2048
  s_nop 1
  v_add_f32_dpp v21, v44, v45 row_ror:8 row_mask:0x4 bank_mask:0xc
  v_mfma_f32_16x16x32_bf16 v[44:47], v[12:15], a[120:123], 0
  v_mfma_f32_16x16x32_bf16 v[44:47], v[16:19], a[124:127], v[44:47]
  s_nop 0
  v_add_f32_dpp v21, v41, v40 row_ror:8 row_mask:0x8 bank_mask:0x3
  v_mfma_f32_16x16x32_bf16 v[40:43], v[12:15], a[128:131], 0
  v_mfma_f32_16x16x32_bf16 v[40:43], v[16:19], a[132:135], v[40:43]
  s_nop 3
  v_add_f32_dpp v21, v44, v45 row_ror:8 row_mask:0x8 bank_mask:0xc
  v_mfma_f32_16x16x32_bf16 v[44:47], v[12:15], a[136:139], 0
  v_mfma_f32_16x16x32_bf16 v[44:47], v[16:19], a[140:143], v[44:47]
  s_nop 0
  v_add_f32_dpp v22, v41, v40 row_ror:8 row_mask:0x1 bank_mask:0x3
  v_mfma_f32_16x16x32_bf16 v[40:43], v[12:15], a[144:147], 0
  v_mfma_f32_16x16x32_bf16 v[40:43], v[16:19], a[148:151], v[40:43]
  s_waitcnt vmcnt(6)
  buffer_load_dwordx4 v[72:75], v0, s[4:7], s32 offen offset:2176
  s_nop 1
  v_add_f32_dpp v22, v44, v45 row_ror:8 row_mask:0x1 bank_mask:0xc
  v_mfma_f32_16x16x32_bf16 v[44:47], v[12:15], a[152:155], 0
  v_mfma_f32_16x16x32_bf16 v[44:47], v[16:19], a[156:159], v[44:47]
  s_nop 0
  v_add_f32_dpp v22, v41, v40 row_ror:8 row_mask:0x2 bank_mask:0x3
  v_mfma_f32_16x16x32_bf16 v[40:43], v[12:15], a[160:163], 0
  v_mfma_f32_16x16x32_bf16 v[40:43], v[16:19], a[164:167], v[40:43]
  s_nop 3
  v_add_f32_dpp v22, v44, v45 row_ror:8 row_mask:0x2 bank_mask:0xc
  v_mfma_f32_16x16x32_bf16 v[44:47], v[12:15], a[168:171], 0
  v_mfma_f32_16x16x32_bf16 v[44:47], v[16:19], a[172:175], v[44:47]
  s_nop 0
  v_add_f32_dpp v22, v41, v40 row_ror:8 row_mask:0x4 bank_mask:0x3
  v_mfma_f32_16x16x32_bf16 v[40:43], v[12:15], a[176:179], 0
  v_mfma_f32_16x16x32_bf16 v[40:43], v[16:19], a[180:183], v[40:43]
  s_waitcnt vmcnt(6)
  s_add_u32 s32, s28, 266240
  buffer_load_dwordx4 v[76:79], v0, s[4:7], s32 offen offset:0
  s_nop 0
  v_add_f32_dpp v22, v44, v45 row_ror:8 row_mask:0x4 bank_mask:0xc
  v_mfma_f32_16x16x32_bf16 v[44:47], v[12:15], a[184:187], 0
  v_mfma_f32_16x16x32_bf16 v[44:47], v[16:19], a[188:191], v[44:47]
  s_nop 0
  v_add_f32_dpp v22, v41, v40 row_ror:8 row_mask:0x8 bank_mask:0x3
  v_mfma_f32_16x16x32_bf16 v[40:43], v[12:15], a[192:195], 0
  v_mfma_f32_16x16x32_bf16 v[40:43], v[16:19], a[196:199], v[40:43]
  s_nop 3
  v_add_f32_dpp v22, v44, v45 row_ror:8 row_mask:0x8 bank_mask:0xc
  v_mfma_f32_16x16x32_bf16 v[44:47], v[12:15], a[200:203], 0
  v_mfma_f32_16x16x32_bf16 v[44:47], v[16:19], a[204:207], v[44:47]
  s_nop 0
  v_add_f32_dpp v23, v41, v40 row_ror:8 row_mask:0x1 bank_mask:0x3
  v_mfma_f32_16x16x32_bf16 v[40:43], v[12:15], a[208:211], 0
  v_mfma_f32_16x16x32_bf16 v[40:43], v[16:19], a[212:215], v[40:43]
  s_waitcnt vmcnt(6)
  buffer_load_dwordx4 v[80:83], v0, s[4:7], s32 offen offset:128
  s_nop 1
  v_add_f32_dpp v23, v44, v45 row_ror:8 row_mask:0x1 bank_mask:0xc
  v_mfma_f32_16x16x32_bf16 v[44:47], v[12:15], a[216:219], 0
  v_mfma_f32_16x16x32_bf16 v[44:47], v[16:19], a[220:223], v[44:47]
  s_nop 0
  v_add_f32_dpp v23, v41, v40 row_ror:8 row_mask:0x2 bank_mask:0x3
  v_mfma_f32_16x16x32_bf16 v[40:43], v[12:15], a[224:227], 0
  v_mfma_f32_16x16x32_bf16 v[40:43], v[16:19], a[228:231], v[40:43]
  s_nop 3
  v_add_f32_dpp v23, v44, v45 row_ror:8 row_mask:0x2 bank_mask:0xc
  v_mfma_f32_16x16x32_bf16 v[44:47], v[12:15], a[232:235], 0
  v_mfma_f32_16x16x32_bf16 v[44:47], v[16:19], a[236:239], v[44:47]
  s_nop 0
  v_add_f32_dpp v23, v41, v40 row_ror:8 row_mask:0x4 bank_mask:0x3
  v_mfma_f32_16x16x32_bf16 v[40:43], v[12:15], a[240:243], 0
  v_mfma_f32_16x16x32_bf16 v[40:43], v[16:19], a[244:247], v[40:43]
  s_waitcnt vmcnt(6)
  buffer_load_dwordx4 v[84:87], v0, s[4:7], s32 offen offset:2048
  s_nop 1
  v_add_f32_dpp v23, v44, v45 row_ror:8 row_mask:0x4 bank_mask:0xc
  v_mfma_f32_16x16x32_bf16 v[44:47], v[12:15], a[248:251], 0
  v_mfma_f32_16x16x32_bf16 v[44:47], v[16:19], a[252:255], v[44:47]
  v_mov_b32 v24, 0xff800000
  v_add_f32_dpp v23, v41, v40 row_ror:8 row_mask:0x8 bank_mask:0x3
  v_mfma_f32_16x16x32_bf16 v[40:43], v[12:15], v[92:95], 0
  v_mfma_f32_16x16x32_bf16 v[40:43], v[16:19], v[96:99], v[40:43]
  s_nop 3
  v_add_f32_dpp v23, v44, v45 row_ror:8 row_mask:0x8 bank_mask:0xc
  v_mfma_f32_16x16x32_bf16 v[44:47], v[12:15], v[100:103], 0
  v_mfma_f32_16x16x32_bf16 v[44:47], v[16:19], v[104:107], v[44:47]
  s_nop 0
  v_add_f32_dpp v24, v41, v40 row_ror:8 row_mask:0x1 bank_mask:0x3
  v_mfma_f32_16x16x32_bf16 v[40:43], v[12:15], v[108:111], 0
  v_mfma_f32_16x16x32_bf16 v[40:43], v[16:19], v[112:115], v[40:43]
  s_waitcnt vmcnt(6)
  buffer_load_dwordx4 v[88:91], v0, s[4:7], s32 offen offset:2176
  s_nop 1
  v_add_f32_dpp v24, v45, v44 row_ror:8 row_mask:0x2 bank_mask:0x3
  v_mfma_f32_16x16x32_bf16 v[44:47], v[12:15], v[116:119], 0
  v_mfma_f32_16x16x32_bf16 v[44:47], v[16:19], v[120:123], v[44:47]
  s_nop 0
  v_add_f32_dpp v24, v41, v40 row_ror:8 row_mask:0x4 bank_mask:0x3
  s_nop 5
  v_add_f32_dpp v24, v45, v44 row_ror:8 row_mask:0x8 bank_mask:0x3
  v_mul_f32 v20, 0x3e0293ee, v20
  v_mul_f32 v21, 0x3e0293ee, v21
  v_mul_f32 v22, 0x3e0293ee, v22
  v_mul_f32 v23, 0x3e0293ee, v23
  v_mul_f32 v24, 0x3e0293ee, v24
  v_max3_f32 v40, v20, v21, v22
  v_max3_f32 v40, v40, v23, v24
  s_nop 1
  v_max_f32_dpp v40, v40, v40 row_ror:8 row_mask:0xf bank_mask:0xf
  s_nop 1
  v_max_f32_dpp v40, v40, v40 row_ror:4 row_mask:0xf bank_mask:0xf
  s_nop 1
  v_max_f32_dpp v40, v40, v40 row_ror:2 row_mask:0xf bank_mask:0xf
  s_nop 1
  v_max_f32_dpp v40, v40, v40 row_ror:1 row_mask:0xf bank_mask:0xf
  s_nop 1
  v_max_f32_dpp v40, v40, v40 row_bcast:15 row_mask:0xa bank_mask:0xf
  s_nop 1
  v_max_f32_dpp v40, v40, v40 row_bcast:31 row_mask:0xc bank_mask:0xf
  s_nop 0
  v_readlane_b32 s46, v40, 63
  v_mov_b32 v32, 0
  v_mov_b32 v33, 0
  v_mov_b32 v34, 0
  v_mov_b32 v35, 0
  s_mov_b32 s36, s46
  v_subrev_f32 v20, s36, v20
  v_subrev_f32 v21, s36, v21
  v_subrev_f32 v22, s36, v22
  v_subrev_f32 v23, s36, v23
  v_subrev_f32 v24, s36, v24
  v_exp_f32 v20, v20
  v_exp_f32 v21, v21
  v_exp_f32 v22, v22
  v_exp_f32 v23, v23
  v_exp_f32 v24, v24
  v_add_f32 v42, v20, v21
  v_add_f32 v43, v22, v23
  v_add_f32 v42, v42, v24
  v_add_f32 v10, v42, v43
  v_cvt_pk_bf16_f32 v20, v20, v20
  v_cvt_pk_bf16_f32 v21, v21, v21
  v_cvt_pk_bf16_f32 v22, v22, v22
  v_cvt_pk_bf16_f32 v23, v23, v23
  v_cvt_pk_bf16_f32 v24, v24, v24
  v_and_b32_dpp v48, v20, v6 row_newbcast:0 row_mask:0xf bank_mask:0xf
  v_and_b32_dpp v49, v20, v7 row_newbcast:0 row_mask:0xf bank_mask:0xf
  v_and_b32_dpp v50, v20, v8 row_newbcast:0 row_mask:0xf bank_mask:0xf
  v_and_b32_dpp v51, v20, v9 row_newbcast:0 row_mask:0xf bank_mask:0xf
  s_nop 1
  v_mfma_f32_16x16x32_bf16 v[32:35], v[48:51], v[124:127], v[32:35]
  v_and_b32_dpp v52, v20, v6 row_newbcast:1 row_mask:0xf bank_mask:0xf
  v_and_b32_dpp v53, v20, v7 row_newbcast:1 row_mask:0xf bank_mask:0xf
  v_and_b32_dpp v54, v20, v8 row_newbcast:1 row_mask:0xf bank_mask:0xf
  v_and_b32_dpp v55, v20, v9 row_newbcast:1 row_mask:0xf bank_mask:0xf
  s_nop 1
  v_mfma_f32_16x16x32_bf16 v[32:35], v[52:55], v[128:131], v[32:35]
  s_waitcnt vmcnt(6)
  v_mfma_f32_16x16x32_bf16 v[40:43], v[12:15], v[60:63], 0
  v_mfma_f32_16x16x32_bf16 v[40:43], v[16:19], v[64:67], v[40:43]
  s_add_u32 s32, s28, 270336
  buffer_load_dwordx4 v[60:63], v0, s[4:7], s32 offen offset:0
  v_and_b32_dpp v48, v20, v6 row_newbcast:2 row_mask:0xf bank_mask:0xf
  v_and_b32_dpp v49, v20, v7 row_newbcast:2 row_mask:0xf bank_mask:0xf
  v_and_b32_dpp v50, v20, v8 row_newbcast:2 row_mask:0xf bank_mask:0xf
  v_and_b32_dpp v51, v20, v9 row_newbcast:2 row_mask:0xf bank_mask:0xf
  s_nop 1
  v_mfma_f32_16x16x32_bf16 v[32:35], v[48:51], v[132:135], v[32:35]
  v_and_b32_dpp v52, v20, v6 row_newbcast:3 row_mask:0xf bank_mask:0xf
  v_and_b32_dpp v53, v20, v7 row_newbcast:3 row_mask:0xf bank_mask:0xf
  v_and_b32_dpp v54, v20, v8 row_newbcast:3 row_mask:0xf bank_mask:0xf
  v_and_b32_dpp v55, v20, v9 row_newbcast:3 row_mask:0xf bank_mask:0xf
  s_nop 1
  v_mfma_f32_16x16x32_bf16 v[32:35], v[52:55], v[136:139], v[32:35]
  s_waitcnt vmcnt(6)
  buffer_load_dwordx4 v[64:67], v0, s[4:7], s32 offen offset:128
  s_waitcnt vmcnt(6)
  v_mfma_f32_16x16x32_bf16 v[44:47], v[12:15], v[68:71], 0
  v_mfma_f32_16x16x32_bf16 v[44:47], v[16:19], v[72:75], v[44:47]
  buffer_load_dwordx4 v[68:71], v0, s[4:7], s32 offen offset:2048
  v_and_b32_dpp v48, v20, v6 row_newbcast:4 row_mask:0xf bank_mask:0xf
  v_and_b32_dpp v49, v20, v7 row_newbcast:4 row_mask:0xf bank_mask:0xf
  v_and_b32_dpp v50, v20, v8 row_newbcast:4 row_mask:0xf bank_mask:0xf
  v_and_b32_dpp v51, v20, v9 row_newbcast:4 row_mask:0xf bank_mask:0xf
  s_nop 1
  v_mfma_f32_16x16x32_bf16 v[32:35], v[48:51], v[140:143], v[32:35]
  v_and_b32_dpp v52, v20, v6 row_newbcast:5 row_mask:0xf bank_mask:0xf
  v_and_b32_dpp v53, v20, v7 row_newbcast:5 row_mask:0xf bank_mask:0xf
  v_and_b32_dpp v54, v20, v8 row_newbcast:5 row_mask:0xf bank_mask:0xf
  v_and_b32_dpp v55, v20, v9 row_newbcast:5 row_mask:0xf bank_mask:0xf
  s_nop 1
  v_mfma_f32_16x16x32_bf16 v[32:35], v[52:55], v[144:147], v[32:35]
  s_waitcnt vmcnt(6)
  buffer_load_dwordx4 v[72:75], v0, s[4:7], s32 offen offset:2176
  s_waitcnt vmcnt(6)
  v_add_f32_dpp v26, v41, v40 row_ror:8 row_mask:0x1 bank_mask:0x3
  v_mfma_f32_16x16x32_bf16 v[40:43], v[12:15], v[76:79], 0
  v_mfma_f32_16x16x32_bf16 v[40:43], v[16:19], v[80:83], v[40:43]
  s_add_u32 s32, s28, 274432
  buffer_load_dwordx4 v[76:79], v0, s[4:7], s32 offen offset:0
  v_and_b32_dpp v48, v20, v6 row_newbcast:6 row_mask:0xf bank_mask:0xf
  v_and_b32_dpp v49, v20, v7 row_newbcast:6 row_mask:0xf bank_mask:0xf
  v_and_b32_dpp v50, v20, v8 row_newbcast:6 row_mask:0xf bank_mask:0xf
  v_and_b32_dpp v51, v20, v9 row_newbcast:6 row_mask:0xf bank_mask:0xf
  s_nop 1
  v_mfma_f32_16x16x32_bf16 v[32:35], v[48:51], v[148:151], v[32:35]
  v_and_b32_dpp v52, v20, v6 row_newbcast:7 row_mask:0xf bank_mask:0xf
  v_and_b32_dpp v53, v20, v7 row_newbcast:7 row_mask:0xf bank_mask:0xf
  v_and_b32_dpp v54, v20, v8 row_newbcast:7 row_mask:0xf bank_mask:0xf
  v_and_b32_dpp v55, v20, v9 row_newbcast:7 row_mask:0xf bank_mask:0xf
  s_nop 1
  v_mfma_f32_16x16x32_bf16 v[32:35], v[52:55], v[152:155], v[32:35]
  s_waitcnt vmcnt(6)
  buffer_load_dwordx4 v[80:83], v0, s[4:7], s32 offen offset:128
  s_waitcnt vmcnt(6)
  v_add_f32_dpp v26, v44, v45 row_ror:8 row_mask:0x1 bank_mask:0xc
  v_mfma_f32_16x16x32_bf16 v[44:47], v[12:15], v[84:87], 0
  v_mfma_f32_16x16x32_bf16 v[44:47], v[16:19], v[88:91], v[44:47]
  buffer_load_dwordx4 v[84:87], v0, s[4:7], s32 offen offset:2048
  v_and_b32_dpp v48, v20, v6 row_newbcast:8 row_mask:0xf bank_mask:0xf
  v_and_b32_dpp v49, v20, v7 row_newbcast:8 row_mask:0xf bank_mask:0xf
  v_and_b32_dpp v50, v20, v8 row_newbcast:8 row_mask:0xf bank_mask:0xf
  v_and_b32_dpp v51, v20, v9 row_newbcast:8 row_mask:0xf bank_mask:0xf
  s_nop 1
  v_mfma_f32_16x16x32_bf16 v[32:35], v[48:51], v[156:159], v[32:35]
  v_and_b32_dpp v52, v20, v6 row_newbcast:9 row_mask:0xf bank_mask:0xf
  v_and_b32_dpp v53, v20, v7 row_newbcast:9 row_mask:0xf bank_mask:0xf
  v_and_b32_dpp v54, v20, v8 row_newbcast:9 row_mask:0xf bank_mask:0xf
  v_and_b32_dpp v55, v20, v9 row_newbcast:9 row_mask:0xf bank_mask:0xf
  s_nop 1
  v_mfma_f32_16x16x32_bf16 v[32:35], v[52:55], v[160:163], v[32:35]
  s_waitcnt vmcnt(6)
  buffer_load_dwordx4 v[88:91], v0, s[4:7], s32 offen offset:2176
  s_waitcnt vmcnt(6)
  v_add_f32_dpp v26, v41, v40 row_ror:8 row_mask:0x2 bank_mask:0x3
  v_mfma_f32_16x16x32_bf16 v[40:43], v[12:15], v[60:63], 0
  v_mfma_f32_16x16x32_bf16 v[40:43], v[16:19], v[64:67], v[40:43]
  s_add_u32 s32, s28, 327680
  buffer_load_dwordx4 v[60:63], v0, s[4:7], s32 offen offset:0
  v_and_b32_dpp v48, v20, v6 row_newbcast:10 row_mask:0xf bank_mask:0xf
  v_and_b32_dpp v49, v20, v7 row_newbcast:10 row_mask:0xf bank_mask:0xf
  v_and_b32_dpp v50, v20, v8 row_newbcast:10 row_mask:0xf bank_mask:0xf
  v_and_b32_dpp v51, v20, v9 row_newbcast:10 row_mask:0xf bank_mask:0xf
  s_nop 1
  v_mfma_f32_16x16x32_bf16 v[32:35], v[48:51], v[164:167], v[32:35]
  v_and_b32_dpp v52, v20, v6 row_newbcast:11 row_mask:0xf bank_mask:0xf
  v_and_b32_dpp v53, v20, v7 row_newbcast:11 row_mask:0xf bank_mask:0xf
  v_and_b32_dpp v54, v20, v8 row_newbcast:11 row_mask:0xf bank_mask:0xf
  v_and_b32_dpp v55, v20, v9 row_newbcast:11 row_mask:0xf bank_mask:0xf
  s_nop 1
  v_mfma_f32_16x16x32_bf16 v[32:35], v[52:55], v[168:171], v[32:35]
  s_waitcnt vmcnt(6)
  buffer_load_dwordx4 v[64:67], v0, s[4:7], s32 offen offset:128
  s_waitcnt vmcnt(6)
  v_add_f32_dpp v26, v44, v45 row_ror:8 row_mask:0x2 bank_mask:0xc
  v_mfma_f32_16x16x32_bf16 v[44:47], v[12:15], v[68:71], 0
  v_mfma_f32_16x16x32_bf16 v[44:47], v[16:19], v[72:75], v[44:47]
  buffer_load_dwordx4 v[68:71], v0, s[4:7], s32 offen offset:2048
  v_and_b32_dpp v48, v20, v6 row_newbcast:12 row_mask:0xf bank_mask:0xf
  v_and_b32_dpp v49, v20, v7 row_newbcast:12 row_mask:0xf bank_mask:0xf
  v_and_b32_dpp v50, v20, v8 row_newbcast:12 row_mask:0xf bank_mask:0xf
  v_and_b32_dpp v51, v20, v9 row_newbcast:12 row_mask:0xf bank_mask:0xf
  s_nop 1
  v_mfma_f32_16x16x32_bf16 v[32:35], v[48:51], v[172:175], v[32:35]
  v_and_b32_dpp v52, v20, v6 row_newbcast:13 row_mask:0xf bank_mask:0xf
  v_and_b32_dpp v53, v20, v7 row_newbcast:13 row_mask:0xf bank_mask:0xf
  v_and_b32_dpp v54, v20, v8 row_newbcast:13 row_mask:0xf bank_mask:0xf
  v_and_b32_dpp v55, v20, v9 row_newbcast:13 row_mask:0xf bank_mask:0xf
  s_nop 1
  v_mfma_f32_16x16x32_bf16 v[32:35], v[52:55], v[176:179], v[32:35]
  s_waitcnt vmcnt(6)
  buffer_load_dwordx4 v[72:75], v0, s[4:7], s32 offen offset:2176
  s_waitcnt vmcnt(6)
  v_add_f32_dpp v26, v41, v40 row_ror:8 row_mask:0x4 bank_mask:0x3
  v_mfma_f32_16x16x32_bf16 v[40:43], v[12:15], v[76:79], 0
  v_mfma_f32_16x16x32_bf16 v[40:43], v[16:19], v[80:83], v[40:43]
  s_add_u32 s32, s28, 331776
  buffer_load_dwordx4 v[76:79], v0, s[4:7], s32 offen offset:0
  v_and_b32_dpp v48, v20, v6 row_newbcast:14 row_mask:0xf bank_mask:0xf
  v_and_b32_dpp v49, v20, v7 row_newbcast:14 row_mask:0xf bank_mask:0xf
  v_and_b32_dpp v50, v20, v8 row_newbcast:14 row_mask:0xf bank_mask:0xf
  v_and_b32_dpp v51, v20, v9 row_newbcast:14 row_mask:0xf bank_mask:0xf
  s_nop 1
  v_mfma_f32_16x16x32_bf16 v[32:35], v[48:51], v[180:183], v[32:35]
  v_and_b32_dpp v52, v20, v6 row_newbcast:15 row_mask:0xf bank_mask:0xf
  v_and_b32_dpp v53, v20, v7 row_newbcast:15 row_mask:0xf bank_mask:0xf
  v_and_b32_dpp v54, v20, v8 row_newbcast:15 row_mask:0xf bank_mask:0xf
  v_and_b32_dpp v55, v20, v9 row_newbcast:15 row_mask:0xf bank_mask:0xf
  s_nop 1
  v_mfma_f32_16x16x32_bf16 v[32:35], v[52:55], v[184:187], v[32:35]
  s_waitcnt vmcnt(6)
  buffer_load_dwordx4 v[80:83], v0, s[4:7], s32 offen offset:128
  s_waitcnt vmcnt(6)
  v_add_f32_dpp v26, v44, v45 row_ror:8 row_mask:0x4 bank_mask:0xc
  v_mfma_f32_16x16x32_bf16 v[44:47], v[12:15], v[84:87], 0
  v_mfma_f32_16x16x32_bf16 v[44:47], v[16:19], v[88:91], v[44:47]
  buffer_load_dwordx4 v[84:87], v0, s[4:7], s32 offen offset:2048
  v_and_b32_dpp v48, v21, v6 row_newbcast:0 row_mask:0xf bank_mask:0xf
  v_and_b32_dpp v49, v21, v7 row_newbcast:0 row_mask:0xf bank_mask:0xf
  v_and_b32_dpp v50, v21, v8 row_newbcast:0 row_mask:0xf bank_mask:0xf
  v_and_b32_dpp v51, v21, v9 row_newbcast:0 row_mask:0xf bank_mask:0xf
  s_nop 1
  v_mfma_f32_16x16x32_bf16 v[32:35], v[48:51], v[188:191], v[32:35]
  v_and_b32_dpp v52, v21, v6 row_newbcast:1 row_mask:0xf bank_mask:0xf
  v_and_b32_dpp v53, v21, v7 row_newbcast:1 row_mask:0xf bank_mask:0xf
  v_and_b32_dpp v54, v21, v8 row_newbcast:1 row_mask:0xf bank_mask:0xf
  v_and_b32_dpp v55, v21, v9 row_newbcast:1 row_mask:0xf bank_mask:0xf
  s_nop 1
  v_mfma_f32_16x16x32_bf16 v[32:35], v[52:55], v[192:195], v[32:35]
  s_waitcnt vmcnt(6)
  buffer_load_dwordx4 v[88:91], v0, s[4:7], s32 offen offset:2176
  s_waitcnt vmcnt(6)
  v_add_f32_dpp v26, v41, v40 row_ror:8 row_mask:0x8 bank_mask:0x3
  v_mfma_f32_16x16x32_bf16 v[40:43], v[12:15], v[60:63], 0
  v_mfma_f32_16x16x32_bf16 v[40:43], v[16:19], v[64:67], v[40:43]
  s_add_u32 s32, s28, 335872
  buffer_load_dwordx4 v[60:63], v0, s[4:7], s32 offen offset:0
  v_and_b32_dpp v48, v21, v6 row_newbcast:2 row_mask:0xf bank_mask:0xf
  v_and_b32_dpp v49, v21, v7 row_newbcast:2 row_mask:0xf bank_mask:0xf
  v_and_b32_dpp v50, v21, v8 row_newbcast:2 row_mask:0xf bank_mask:0xf
  v_and_b32_dpp v51, v21, v9 row_newbcast:2 row_mask:0xf bank_mask:0xf
  s_nop 1
  v_mfma_f32_16x16x32_bf16 v[32:35], v[48:51], v[196:199], v[32:35]
  v_and_b32_dpp v52, v21, v6 row_newbcast:3 row_mask:0xf bank_mask:0xf
  v_and_b32_dpp v53, v21, v7 row_newbcast:3 row_mask:0xf bank_mask:0xf
  v_and_b32_dpp v54, v21, v8 row_newbcast:3 row_mask:0xf bank_mask:0xf
  v_and_b32_dpp v55, v21, v9 row_newbcast:3 row_mask:0xf bank_mask:0xf
  s_nop 1
  v_mfma_f32_16x16x32_bf16 v[32:35], v[52:55], v[200:203], v[32:35]
  s_waitcnt vmcnt(6)
  buffer_load_dwordx4 v[64:67], v0, s[4:7], s32 offen offset:128
  s_waitcnt vmcnt(6)
  v_add_f32_dpp v26, v44, v45 row_ror:8 row_mask:0x8 bank_mask:0xc
  v_mfma_f32_16x16x32_bf16 v[44:47], v[12:15], v[68:71], 0
  v_mfma_f32_16x16x32_bf16 v[44:47], v[16:19], v[72:75], v[44:47]
  buffer_load_dwordx4 v[68:71], v0, s[4:7], s32 offen offset:2048
  v_and_b32_dpp v48, v21, v6 row_newbcast:4 row_mask:0xf bank_mask:0xf
  v_and_b32_dpp v49, v21, v7 row_newbcast:4 row_mask:0xf bank_mask:0xf
  v_and_b32_dpp v50, v21, v8 row_newbcast:4 row_mask:0xf bank_mask:0xf
  v_and_b32_dpp v51, v21, v9 row_newbcast:4 row_mask:0xf bank_mask:0xf
  s_nop 1
  v_mfma_f32_16x16x32_bf16 v[32:35], v[48:51], v[204:207], v[32:35]
  v_and_b32_dpp v52, v21, v6 row_newbcast:5 row_mask:0xf bank_mask:0xf
  v_and_b32_dpp v53, v21, v7 row_newbcast:5 row_mask:0xf bank_mask:0xf
  v_and_b32_dpp v54, v21, v8 row_newbcast:5 row_mask:0xf bank_mask:0xf
  v_and_b32_dpp v55, v21, v9 row_newbcast:5 row_mask:0xf bank_mask:0xf
  s_nop 1
  v_mfma_f32_16x16x32_bf16 v[32:35], v[52:55], v[208:211], v[32:35]
  s_waitcnt vmcnt(6)
  buffer_load_dwordx4 v[72:75], v0, s[4:7], s32 offen offset:2176
  s_waitcnt vmcnt(6)
  v_add_f32_dpp v27, v41, v40 row_ror:8 row_mask:0x1 bank_mask:0x3
  v_mfma_f32_16x16x32_bf16 v[40:43], v[12:15], v[76:79], 0
  v_mfma_f32_16x16x32_bf16 v[40:43], v[16:19], v[80:83], v[40:43]
  s_add_u32 s32, s28, 339968
  buffer_load_dwordx4 v[76:79], v0, s[4:7], s32 offen offset:0
  v_and_b32_dpp v48, v21, v6 row_newbcast:6 row_mask:0xf bank_mask:0xf
  v_and_b32_dpp v49, v21, v7 row_newbcast:6 row_mask:0xf bank_mask:0xf
  v_and_b32_dpp v50, v21, v8 row_newbcast:6 row_mask:0xf bank_mask:0xf
  v_and_b32_dpp v51, v21, v9 row_newbcast:6 row_mask:0xf bank_mask:0xf
  s_nop 1
  v_mfma_f32_16x16x32_bf16 v[32:35], v[48:51], v[212:215], v[32:35]
  v_and_b32_dpp v52, v21, v6 row_newbcast:7 row_mask:0xf bank_mask:0xf
  v_and_b32_dpp v53, v21, v7 row_newbcast:7 row_mask:0xf bank_mask:0xf
  v_and_b32_dpp v54, v21, v8 row_newbcast:7 row_mask:0xf bank_mask:0xf
  v_and_b32_dpp v55, v21, v9 row_newbcast:7 row_mask:0xf bank_mask:0xf
  s_nop 1
  v_mfma_f32_16x16x32_bf16 v[32:35], v[52:55], v[216:219], v[32:35]
  s_waitcnt vmcnt(6)
  buffer_load_dwordx4 v[80:83], v0, s[4:7], s32 offen offset:128
  s_waitcnt vmcnt(6)
  v_add_f32_dpp v27, v44, v45 row_ror:8 row_mask:0x1 bank_mask:0xc
  v_mfma_f32_16x16x32_bf16 v[44:47], v[12:15], v[84:87], 0
  v_mfma_f32_16x16x32_bf16 v[44:47], v[16:19], v[88:91], v[44:47]
  buffer_load_dwordx4 v[84:87], v0, s[4:7], s32 offen offset:2048
  v_and_b32_dpp v48, v21, v6 row_newbcast:8 row_mask:0xf bank_mask:0xf
  v_and_b32_dpp v49, v21, v7 row_newbcast:8 row_mask:0xf bank_mask:0xf
  v_and_b32_dpp v50, v21, v8 row_newbcast:8 row_mask:0xf bank_mask:0xf
  v_and_b32_dpp v51, v21, v9 row_newbcast:8 row_mask:0xf bank_mask:0xf
  s_nop 1
  v_mfma_f32_16x16x32_bf16 v[32:35], v[48:51], v[220:223], v[32:35]
  v_and_b32_dpp v52, v21, v6 row_newbcast:9 row_mask:0xf bank_mask:0xf
  v_and_b32_dpp v53, v21, v7 row_newbcast:9 row_mask:0xf bank_mask:0xf
  v_and_b32_dpp v54, v21, v8 row_newbcast:9 row_mask:0xf bank_mask:0xf
  v_and_b32_dpp v55, v21, v9 row_newbcast:9 row_mask:0xf bank_mask:0xf
  s_nop 1
  v_mfma_f32_16x16x32_bf16 v[32:35], v[52:55], v[224:227], v[32:35]
  s_waitcnt vmcnt(6)
  buffer_load_dwordx4 v[88:91], v0, s[4:7], s32 offen offset:2176
  s_waitcnt vmcnt(6)
  v_add_f32_dpp v27, v41, v40 row_ror:8 row_mask:0x2 bank_mask:0x3
  v_mfma_f32_16x16x32_bf16 v[40:43], v[12:15], v[60:63], 0
  v_mfma_f32_16x16x32_bf16 v[40:43], v[16:19], v[64:67], v[40:43]
  s_add_u32 s32, s28, 393216
  buffer_load_dwordx4 v[60:63], v0, s[4:7], s32 offen offset:0
  v_and_b32_dpp v48, v21, v6 row_newbcast:10 row_mask:0xf bank_mask:0xf
  v_and_b32_dpp v49, v21, v7 row_newbcast:10 row_mask:0xf bank_mask:0xf
  v_and_b32_dpp v50, v21, v8 row_newbcast:10 row_mask:0xf bank_mask:0xf
  v_and_b32_dpp v51, v21, v9 row_newbcast:10 row_mask:0xf bank_mask:0xf
  s_nop 1
  v_mfma_f32_16x16x32_bf16 v[32:35], v[48:51], v[228:231], v[32:35]
  v_and_b32_dpp v52, v21, v6 row_newbcast:11 row_mask:0xf bank_mask:0xf
  v_and_b32_dpp v53, v21, v7 row_newbcast:11 row_mask:0xf bank_mask:0xf
  v_and_b32_dpp v54, v21, v8 row_newbcast:11 row_mask:0xf bank_mask:0xf
  v_and_b32_dpp v55, v21, v9 row_newbcast:11 row_mask:0xf bank_mask:0xf
  s_nop 1
  v_mfma_f32_16x16x32_bf16 v[32:35], v[52:55], v[232:235], v[32:35]
  s_waitcnt vmcnt(6)
  buffer_load_dwordx4 v[64:67], v0, s[4:7], s32 offen offset:128
  s_waitcnt vmcnt(6)
  v_add_f32_dpp v27, v44, v45 row_ror:8 row_mask:0x2 bank_mask:0xc
  v_mfma_f32_16x16x32_bf16 v[44:47], v[12:15], v[68:71], 0
  v_mfma_f32_16x16x32_bf16 v[44:47], v[16:19], v[72:75], v[44:47]
  buffer_load_dwordx4 v[68:71], v0, s[4:7], s32 offen offset:2048
  v_and_b32_dpp v48, v21, v6 row_newbcast:12 row_mask:0xf bank_mask:0xf
  v_and_b32_dpp v49, v21, v7 row_newbcast:12 row_mask:0xf bank_mask:0xf
  v_and_b32_dpp v50, v21, v8 row_newbcast:12 row_mask:0xf bank_mask:0xf
  v_and_b32_dpp v51, v21, v9 row_newbcast:12 row_mask:0xf bank_mask:0xf
  s_nop 1
  v_mfma_f32_16x16x32_bf16 v[32:35], v[48:51], v[236:239], v[32:35]
  v_and_b32_dpp v52, v21, v6 row_newbcast:13 row_mask:0xf bank_mask:0xf
  v_and_b32_dpp v53, v21, v7 row_newbcast:13 row_mask:0xf bank_mask:0xf
  v_and_b32_dpp v54, v21, v8 row_newbcast:13 row_mask:0xf bank_mask:0xf
  v_and_b32_dpp v55, v21, v9 row_newbcast:13 row_mask:0xf bank_mask:0xf
  s_nop 1
  v_mfma_f32_16x16x32_bf16 v[32:35], v[52:55], v[240:243], v[32:35]
  s_waitcnt vmcnt(6)
  buffer_load_dwordx4 v[72:75], v0, s[4:7], s32 offen offset:2176
  s_waitcnt vmcnt(6)
  v_add_f32_dpp v27, v41, v40 row_ror:8 row_mask:0x4 bank_mask:0x3
  v_mfma_f32_16x16x32_bf16 v[40:43], v[12:15], v[76:79], 0
  v_mfma_f32_16x16x32_bf16 v[40:43], v[16:19], v[80:83], v[40:43]
  s_add_u32 s32, s28, 397312
  buffer_load_dwordx4 v[76:79], v0, s[4:7], s32 offen offset:0
  v_and_b32_dpp v48, v21, v6 row_newbcast:14 row_mask:0xf bank_mask:0xf
  v_and_b32_dpp v49, v21, v7 row_newbcast:14 row_mask:0xf bank_mask:0xf
  v_and_b32_dpp v50, v21, v8 row_newbcast:14 row_mask:0xf bank_mask:0xf
  v_and_b32_dpp v51, v21, v9 row_newbcast:14 row_mask:0xf bank_mask:0xf
  s_nop 1
  v_mfma_f32_16x16x32_bf16 v[32:35], v[48:51], v[244:247], v[32:35]
  v_and_b32_dpp v52, v21, v6 row_newbcast:15 row_mask:0xf bank_mask:0xf
  v_and_b32_dpp v53, v21, v7 row_newbcast:15 row_mask:0xf bank_mask:0xf
  v_and_b32_dpp v54, v21, v8 row_newbcast:15 row_mask:0xf bank_mask:0xf
  v_and_b32_dpp v55, v21, v9 row_newbcast:15 row_mask:0xf bank_mask:0xf
  s_nop 1
  v_mfma_f32_16x16x32_bf16 v[32:35], v[52:55], v[248:251], v[32:35]
  s_waitcnt vmcnt(6)
  buffer_load_dwordx4 v[80:83], v0, s[4:7], s32 offen offset:128
  s_waitcnt vmcnt(6)
  v_add_f32_dpp v27, v44, v45 row_ror:8 row_mask:0x4 bank_mask:0xc
  v_mfma_f32_16x16x32_bf16 v[44:47], v[12:15], v[84:87], 0
  v_mfma_f32_16x16x32_bf16 v[44:47], v[16:19], v[88:91], v[44:47]
  buffer_load_dwordx4 v[84:87], v0, s[4:7], s32 offen offset:2048
  v_and_b32_dpp v48, v22, v6 row_newbcast:0 row_mask:0xf bank_mask:0xf
  v_and_b32_dpp v49, v22, v7 row_newbcast:0 row_mask:0xf bank_mask:0xf
  v_and_b32_dpp v50, v22, v8 row_newbcast:0 row_mask:0xf bank_mask:0xf
  v_and_b32_dpp v51, v22, v9 row_newbcast:0 row_mask:0xf bank_mask:0xf
  s_nop 1
  v_mfma_f32_16x16x32_bf16 v[32:35], v[48:51], v[252:255], v[32:35]
  ds_read_b128 v[56:59], v4 offset:0
  v_and_b32_dpp v52, v22, v6 row_newbcast:1 row_mask:0xf bank_mask:0xf
  v_and_b32_dpp v53, v22, v7 row_newbcast:1 row_mask:0xf bank_mask:0xf
  v_and_b32_dpp v54, v22, v8 row_newbcast:1 row_mask:0xf bank_mask:0xf
  v_and_b32_dpp v55, v22, v9 row_newbcast:1 row_mask:0xf bank_mask:0xf
  s_waitcnt lgkmcnt(0)
  s_nop 0
  v_mfma_f32_16x16x32_bf16 v[32:35], v[52:55], v[56:59], v[32:35]
  s_waitcnt vmcnt(6)
  buffer_load_dwordx4 v[88:91], v0, s[4:7], s32 offen offset:2176
  s_waitcnt vmcnt(6)
  v_add_f32_dpp v27, v41, v40 row_ror:8 row_mask:0x8 bank_mask:0x3
  v_mfma_f32_16x16x32_bf16 v[40:43], v[12:15], v[60:63], 0
  v_mfma_f32_16x16x32_bf16 v[40:43], v[16:19], v[64:67], v[40:43]
  s_add_u32 s32, s28, 401408
  buffer_load_dwordx4 v[60:63], v0, s[4:7], s32 offen offset:0 nt
  ds_read_b128 v[56:59], v4 offset:1024
  v_and_b32_dpp v48, v22, v6 row_newbcast:2 row_mask:0xf bank_mask:0xf
  v_and_b32_dpp v49, v22, v7 row_newbcast:2 row_mask:0xf bank_mask:0xf
  v_and_b32_dpp v50, v22, v8 row_newbcast:2 row_mask:0xf bank_mask:0xf
  v_and_b32_dpp v51, v22, v9 row_newbcast:2 row_mask:0xf bank_mask:0xf
  s_waitcnt lgkmcnt(0)
  s_nop 0
  v_mfma_f32_16x16x32_bf16 v[32:35], v[48:51], v[56:59], v[32:35]
  ds_read_b128 v[56:59], v4 offset:2048
  v_and_b32_dpp v52, v22, v6 row_newbcast:3 row_mask:0xf bank_mask:0xf
  v_and_b32_dpp v53, v22, v7 row_newbcast:3 row_mask:0xf bank_mask:0xf
  v_and_b32_dpp v54, v22, v8 row_newbcast:3 row_mask:0xf bank_mask:0xf
  v_and_b32_dpp v55, v22, v9 row_newbcast:3 row_mask:0xf bank_mask:0xf
  s_waitcnt lgkmcnt(0)
  s_nop 0
  v_mfma_f32_16x16x32_bf16 v[32:35], v[52:55], v[56:59], v[32:35]
  s_waitcnt vmcnt(6)
  buffer_load_dwordx4 v[64:67], v0, s[4:7], s32 offen offset:128 nt
  s_waitcnt vmcnt(6)
  v_add_f32_dpp v27, v44, v45 row_ror:8 row_mask:0x8 bank_mask:0xc
  v_mfma_f32_16x16x32_bf16 v[44:47], v[12:15], v[68:71], 0
  v_mfma_f32_16x16x32_bf16 v[44:47], v[16:19], v[72:75], v[44:47]
  buffer_load_dwordx4 v[68:71], v0, s[4:7], s32 offen offset:2048 nt
  ds_read_b128 v[56:59], v4 offset:3072
  v_and_b32_dpp v48, v22, v6 row_newbcast:4 row_mask:0xf bank_mask:0xf
  v_and_b32_dpp v49, v22, v7 row_newbcast:4 row_mask:0xf bank_mask:0xf
  v_and_b32_dpp v50, v22, v8 row_newbcast:4 row_mask:0xf bank_mask:0xf
  v_and_b32_dpp v51, v22, v9 row_newbcast:4 row_mask:0xf bank_mask:0xf
  s_waitcnt lgkmcnt(0)
  s_nop 0
  v_mfma_f32_16x16x32_bf16 v[32:35], v[48:51], v[56:59], v[32:35]
  ds_read_b128 v[56:59], v4 offset:4096
  v_and_b32_dpp v52, v22, v6 row_newbcast:5 row_mask:0xf bank_mask:0xf
  v_and_b32_dpp v53, v22, v7 row_newbcast:5 row_mask:0xf bank_mask:0xf
  v_and_b32_dpp v54, v22, v8 row_newbcast:5 row_mask:0xf bank_mask:0xf
  v_and_b32_dpp v55, v22, v9 row_newbcast:5 row_mask:0xf bank_mask:0xf
  s_waitcnt lgkmcnt(0)
  s_nop 0
  v_mfma_f32_16x16x32_bf16 v[32:35], v[52:55], v[56:59], v[32:35]
  s_waitcnt vmcnt(6)
  buffer_load_dwordx4 v[72:75], v0, s[4:7], s32 offen offset:2176 nt
  s_waitcnt vmcnt(6)
  v_add_f32_dpp v28, v41, v40 row_ror:8 row_mask:0x1 bank_mask:0x3
  v_mfma_f32_16x16x32_bf16 v[40:43], v[12:15], v[76:79], 0
  v_mfma_f32_16x16x32_bf16 v[40:43], v[16:19], v[80:83], v[40:43]
  s_add_u32 s32, s28, 405504
  buffer_load_dwordx4 v[76:79], v0, s[4:7], s32 offen offset:0 nt
  ds_read_b128 v[56:59], v4 offset:5120
  v_and_b32_dpp v48, v22, v6 row_newbcast:6 row_mask:0xf bank_mask:0xf
  v_and_b32_dpp v49, v22, v7 row_newbcast:6 row_mask:0xf bank_mask:0xf
  v_and_b32_dpp v50, v22, v8 row_newbcast:6 row_mask:0xf bank_mask:0xf
  v_and_b32_dpp v51, v22, v9 row_newbcast:6 row_mask:0xf bank_mask:0xf
  s_waitcnt lgkmcnt(0)
  s_nop 0
  v_mfma_f32_16x16x32_bf16 v[32:35], v[48:51], v[56:59], v[32:35]
  ds_read_b128 v[56:59], v4 offset:6144
  v_and_b32_dpp v52, v22, v6 row_newbcast:7 row_mask:0xf bank_mask:0xf
  v_and_b32_dpp v53, v22, v7 row_newbcast:7 row_mask:0xf bank_mask:0xf
  v_and_b32_dpp v54, v22, v8 row_newbcast:7 row_mask:0xf bank_mask:0xf
  v_and_b32_dpp v55, v22, v9 row_newbcast:7 row_mask:0xf bank_mask:0xf
  s_waitcnt lgkmcnt(0)
  s_nop 0
  v_mfma_f32_16x16x32_bf16 v[32:35], v[52:55], v[56:59], v[32:35]
  s_waitcnt vmcnt(6)
  buffer_load_dwordx4 v[80:83], v0, s[4:7], s32 offen offset:128 nt
  s_waitcnt vmcnt(6)
  v_add_f32_dpp v28, v44, v45 row_ror:8 row_mask:0x1 bank_mask:0xc
  v_mfma_f32_16x16x32_bf16 v[44:47], v[12:15], v[84:87], 0
  v_mfma_f32_16x16x32_bf16 v[44:47], v[16:19], v[88:91], v[44:47]
  buffer_load_dwordx4 v[84:87], v0, s[4:7], s32 offen offset:2048 nt
  ds_read_b128 v[56:59], v4 offset:7168
  v_and_b32_dpp v48, v22, v6 row_newbcast:8 row_mask:0xf bank_mask:0xf
  v_and_b32_dpp v49, v22, v7 row_newbcast:8 row_mask:0xf bank_mask:0xf
  v_and_b32_dpp v50, v22, v8 row_newbcast:8 row_mask:0xf bank_mask:0xf
  v_and_b32_dpp v51, v22, v9 row_newbcast:8 row_mask:0xf bank_mask:0xf
  s_waitcnt lgkmcnt(0)
  s_nop 0
  v_mfma_f32_16x16x32_bf16 v[32:35], v[48:51], v[56:59], v[32:35]
  ds_read_b128 v[56:59], v4 offset:8192
  v_and_b32_dpp v52, v22, v6 row_newbcast:9 row_mask:0xf bank_mask:0xf
  v_and_b32_dpp v53, v22, v7 row_newbcast:9 row_mask:0xf bank_mask:0xf
  v_and_b32_dpp v54, v22, v8 row_newbcast:9 row_mask:0xf bank_mask:0xf
  v_and_b32_dpp v55, v22, v9 row_newbcast:9 row_mask:0xf bank_mask:0xf
  s_waitcnt lgkmcnt(0)
  s_nop 0
  v_mfma_f32_16x16x32_bf16 v[32:35], v[52:55], v[56:59], v[32:35]
  s_waitcnt vmcnt(6)
  buffer_load_dwordx4 v[88:91], v0, s[4:7], s32 offen offset:2176 nt
  s_waitcnt vmcnt(6)
  v_add_f32_dpp v28, v41, v40 row_ror:8 row_mask:0x2 bank_mask:0x3
  v_mfma_f32_16x16x32_bf16 v[40:43], v[12:15], v[60:63], 0
  v_mfma_f32_16x16x32_bf16 v[40:43], v[16:19], v[64:67], v[40:43]
  s_add_u32 s32, s28, 458752
  buffer_load_dwordx4 v[60:63], v0, s[4:7], s32 offen offset:0 nt
  ds_read_b128 v[56:59], v4 offset:9216
  v_and_b32_dpp v48, v22, v6 row_newbcast:10 row_mask:0xf bank_mask:0xf
  v_and_b32_dpp v49, v22, v7 row_newbcast:10 row_mask:0xf bank_mask:0xf
  v_and_b32_dpp v50, v22, v8 row_newbcast:10 row_mask:0xf bank_mask:0xf
  v_and_b32_dpp v51, v22, v9 row_newbcast:10 row_mask:0xf bank_mask:0xf
  s_waitcnt lgkmcnt(0)
  s_nop 0
  v_mfma_f32_16x16x32_bf16 v[32:35], v[48:51], v[56:59], v[32:35]
  ds_read_b128 v[56:59], v4 offset:10240
  v_and_b32_dpp v52, v22, v6 row_newbcast:11 row_mask:0xf bank_mask:0xf
  v_and_b32_dpp v53, v22, v7 row_newbcast:11 row_mask:0xf bank_mask:0xf
  v_and_b32_dpp v54, v22, v8 row_newbcast:11 row_mask:0xf bank_mask:0xf
  v_and_b32_dpp v55, v22, v9 row_newbcast:11 row_mask:0xf bank_mask:0xf
  s_waitcnt lgkmcnt(0)
  s_nop 0
  v_mfma_f32_16x16x32_bf16 v[32:35], v[52:55], v[56:59], v[32:35]
  s_waitcnt vmcnt(6)
  buffer_load_dwordx4 v[64:67], v0, s[4:7], s32 offen offset:128 nt
  s_waitcnt vmcnt(6)
  v_add_f32_dpp v28, v44, v45 row_ror:8 row_mask:0x2 bank_mask:0xc
  v_mfma_f32_16x16x32_bf16 v[44:47], v[12:15], v[68:71], 0
  v_mfma_f32_16x16x32_bf16 v[44:47], v[16:19], v[72:75], v[44:47]
  buffer_load_dwordx4 v[68:71], v0, s[4:7], s32 offen offset:2048 nt
  ds_read_b128 v[56:59], v4 offset:11264
  v_and_b32_dpp v48, v22, v6 row_newbcast:12 row_mask:0xf bank_mask:0xf
  v_and_b32_dpp v49, v22, v7 row_newbcast:12 row_mask:0xf bank_mask:0xf
  v_and_b32_dpp v50, v22, v8 row_newbcast:12 row_mask:0xf bank_mask:0xf
  v_and_b32_dpp v51, v22, v9 row_newbcast:12 row_mask:0xf bank_mask:0xf
  s_waitcnt lgkmcnt(0)
  s_nop 0
  v_mfma_f32_16x16x32_bf16 v[32:35], v[48:51], v[56:59], v[32:35]
  ds_read_b128 v[56:59], v4 offset:12288
  v_and_b32_dpp v52, v22, v6 row_newbcast:13 row_mask:0xf bank_mask:0xf
  v_and_b32_dpp v53, v22, v7 row_newbcast:13 row_mask:0xf bank_mask:0xf
  v_and_b32_dpp v54, v22, v8 row_newbcast:13 row_mask:0xf bank_mask:0xf
  v_and_b32_dpp v55, v22, v9 row_newbcast:13 row_mask:0xf bank_mask:0xf
  s_waitcnt lgkmcnt(0)
  s_nop 0
  v_mfma_f32_16x16x32_bf16 v[32:35], v[52:55], v[56:59], v[32:35]
  s_waitcnt vmcnt(6)
  buffer_load_dwordx4 v[72:75], v0, s[4:7], s32 offen offset:2176 nt
  s_waitcnt vmcnt(6)
  v_add_f32_dpp v28, v41, v40 row_ror:8 row_mask:0x4 bank_mask:0x3
  v_mfma_f32_16x16x32_bf16 v[40:43], v[12:15], v[76:79], 0
  v_mfma_f32_16x16x32_bf16 v[40:43], v[16:19], v[80:83], v[40:43]
  s_add_u32 s32, s28, 462848
  buffer_load_dwordx4 v[76:79], v0, s[4:7], s32 offen offset:0 nt
  ds_read_b128 v[56:59], v4 offset:13312
  v_and_b32_dpp v48, v22, v6 row_newbcast:14 row_mask:0xf bank_mask:0xf
  v_and_b32_dpp v49, v22, v7 row_newbcast:14 row_mask:0xf bank_mask:0xf
  v_and_b32_dpp v50, v22, v8 row_newbcast:14 row_mask:0xf bank_mask:0xf
  v_and_b32_dpp v51, v22, v9 row_newbcast:14 row_mask:0xf bank_mask:0xf
  s_waitcnt lgkmcnt(0)
  s_nop 0
  v_mfma_f32_16x16x32_bf16 v[32:35], v[48:51], v[56:59], v[32:35]
  ds_read_b128 v[56:59], v4 offset:14336
  v_and_b32_dpp v52, v22, v6 row_newbcast:15 row_mask:0xf bank_mask:0xf
  v_and_b32_dpp v53, v22, v7 row_newbcast:15 row_mask:0xf bank_mask:0xf
  v_and_b32_dpp v54, v22, v8 row_newbcast:15 row_mask:0xf bank_mask:0xf
  v_and_b32_dpp v55, v22, v9 row_newbcast:15 row_mask:0xf bank_mask:0xf
  s_waitcnt lgkmcnt(0)
  s_nop 0
  v_mfma_f32_16x16x32_bf16 v[32:35], v[52:55], v[56:59], v[32:35]
  s_waitcnt vmcnt(6)
  buffer_load_dwordx4 v[80:83], v0, s[4:7], s32 offen offset:128 nt
  s_waitcnt vmcnt(6)
  v_add_f32_dpp v28, v44, v45 row_ror:8 row_mask:0x4 bank_mask:0xc
  v_mfma_f32_16x16x32_bf16 v[44:47], v[12:15], v[84:87], 0
  v_mfma_f32_16x16x32_bf16 v[44:47], v[16:19], v[88:91], v[44:47]
  buffer_load_dwordx4 v[84:87], v0, s[4:7], s32 offen offset:2048 nt
  ds_read_b128 v[56:59], v4 offset:15360
  v_and_b32_dpp v48, v23, v6 row_newbcast:0 row_mask:0xf bank_mask:0xf
  v_and_b32_dpp v49, v23, v7 row_newbcast:0 row_mask:0xf bank_mask:0xf
  v_and_b32_dpp v50, v23, v8 row_newbcast:0 row_mask:0xf bank_mask:0xf
  v_and_b32_dpp v51, v23, v9 row_newbcast:0 row_mask:0xf bank_mask:0xf
  s_waitcnt lgkmcnt(0)
  s_nop 0
  v_mfma_f32_16x16x32_bf16 v[32:35], v[48:51], v[56:59], v[32:35]
  ds_read_b128 v[56:59], v4 offset:16384
  v_and_b32_dpp v52, v23, v6 row_newbcast:1 row_mask:0xf bank_mask:0xf
  v_and_b32_dpp v53, v23, v7 row_newbcast:1 row_mask:0xf bank_mask:0xf
  v_and_b32_dpp v54, v23, v8 row_newbcast:1 row_mask:0xf bank_mask:0xf
  v_and_b32_dpp v55, v23, v9 row_newbcast:1 row_mask:0xf bank_mask:0xf
  s_waitcnt lgkmcnt(0)
  s_nop 0
  v_mfma_f32_16x16x32_bf16 v[32:35], v[52:55], v[56:59], v[32:35]
  s_waitcnt vmcnt(6)
  buffer_load_dwordx4 v[88:91], v0, s[4:7], s32 offen offset:2176 nt
  s_waitcnt vmcnt(6)
  v_add_f32_dpp v28, v41, v40 row_ror:8 row_mask:0x8 bank_mask:0x3
  v_mfma_f32_16x16x32_bf16 v[40:43], v[12:15], v[60:63], 0
  v_mfma_f32_16x16x32_bf16 v[40:43], v[16:19], v[64:67], v[40:43]
  s_add_u32 s32, s28, 466944
  buffer_load_dwordx4 v[60:63], v0, s[4:7], s32 offen offset:0 nt
  ds_read_b128 v[56:59], v4 offset:17408
  v_and_b32_dpp v48, v23, v6 row_newbcast:2 row_mask:0xf bank_mask:0xf
  v_and_b32_dpp v49, v23, v7 row_newbcast:2 row_mask:0xf bank_mask:0xf
  v_and_b32_dpp v50, v23, v8 row_newbcast:2 row_mask:0xf bank_mask:0xf
  v_and_b32_dpp v51, v23, v9 row_newbcast:2 row_mask:0xf bank_mask:0xf
  s_waitcnt lgkmcnt(0)
  s_nop 0
  v_mfma_f32_16x16x32_bf16 v[32:35], v[48:51], v[56:59], v[32:35]
  ds_read_b128 v[56:59], v4 offset:18432
  v_and_b32_dpp v52, v23, v6 row_newbcast:3 row_mask:0xf bank_mask:0xf
  v_and_b32_dpp v53, v23, v7 row_newbcast:3 row_mask:0xf bank_mask:0xf
  v_and_b32_dpp v54, v23, v8 row_newbcast:3 row_mask:0xf bank_mask:0xf
  v_and_b32_dpp v55, v23, v9 row_newbcast:3 row_mask:0xf bank_mask:0xf
  s_waitcnt lgkmcnt(0)
  s_nop 0
  v_mfma_f32_16x16x32_bf16 v[32:35], v[52:55], v[56:59], v[32:35]
  s_waitcnt vmcnt(6)
  buffer_load_dwordx4 v[64:67], v0, s[4:7], s32 offen offset:128 nt
  s_waitcnt vmcnt(6)
  v_add_f32_dpp v28, v44, v45 row_ror:8 row_mask:0x8 bank_mask:0xc
  v_mfma_f32_16x16x32_bf16 v[44:47], v[12:15], v[68:71], 0
  v_mfma_f32_16x16x32_bf16 v[44:47], v[16:19], v[72:75], v[44:47]
  buffer_load_dwordx4 v[68:71], v0, s[4:7], s32 offen offset:2048 nt
  ds_read_b128 v[56:59], v4 offset:19456
  v_and_b32_dpp v48, v23, v6 row_newbcast:4 row_mask:0xf bank_mask:0xf
  v_and_b32_dpp v49, v23, v7 row_newbcast:4 row_mask:0xf bank_mask:0xf
  v_and_b32_dpp v50, v23, v8 row_newbcast:4 row_mask:0xf bank_mask:0xf
  v_and_b32_dpp v51, v23, v9 row_newbcast:4 row_mask:0xf bank_mask:0xf
  s_waitcnt lgkmcnt(0)
  s_nop 0
  v_mfma_f32_16x16x32_bf16 v[32:35], v[48:51], v[56:59], v[32:35]
  ds_read_b128 v[56:59], v4 offset:20480
  v_and_b32_dpp v52, v23, v6 row_newbcast:5 row_mask:0xf bank_mask:0xf
  v_and_b32_dpp v53, v23, v7 row_newbcast:5 row_mask:0xf bank_mask:0xf
  v_and_b32_dpp v54, v23, v8 row_newbcast:5 row_mask:0xf bank_mask:0xf
  v_and_b32_dpp v55, v23, v9 row_newbcast:5 row_mask:0xf bank_mask:0xf
  s_waitcnt lgkmcnt(0)
  s_nop 0
  v_mfma_f32_16x16x32_bf16 v[32:35], v[52:55], v[56:59], v[32:35]
  s_waitcnt vmcnt(6)
  buffer_load_dwordx4 v[72:75], v0, s[4:7], s32 offen offset:2176 nt
  s_waitcnt vmcnt(6)
  v_add_f32_dpp v29, v41, v40 row_ror:8 row_mask:0x1 bank_mask:0x3
  v_mfma_f32_16x16x32_bf16 v[40:43], v[12:15], v[76:79], 0
  v_mfma_f32_16x16x32_bf16 v[40:43], v[16:19], v[80:83], v[40:43]
  s_add_u32 s32, s28, 471040
  buffer_load_dwordx4 v[76:79], v0, s[4:7], s32 offen offset:0 nt
  ds_read_b128 v[56:59], v4 offset:21504
  v_and_b32_dpp v48, v23, v6 row_newbcast:6 row_mask:0xf bank_mask:0xf
  v_and_b32_dpp v49, v23, v7 row_newbcast:6 row_mask:0xf bank_mask:0xf
  v_and_b32_dpp v50, v23, v8 row_newbcast:6 row_mask:0xf bank_mask:0xf
  v_and_b32_dpp v51, v23, v9 row_newbcast:6 row_mask:0xf bank_mask:0xf
  s_waitcnt lgkmcnt(0)
  s_nop 0
  v_mfma_f32_16x16x32_bf16 v[32:35], v[48:51], v[56:59], v[32:35]
  ds_read_b128 v[56:59], v4 offset:22528
  v_and_b32_dpp v52, v23, v6 row_newbcast:7 row_mask:0xf bank_mask:0xf
  v_and_b32_dpp v53, v23, v7 row_newbcast:7 row_mask:0xf bank_mask:0xf
  v_and_b32_dpp v54, v23, v8 row_newbcast:7 row_mask:0xf bank_mask:0xf
  v_and_b32_dpp v55, v23, v9 row_newbcast:7 row_mask:0xf bank_mask:0xf
  s_waitcnt lgkmcnt(0)
  s_nop 0
  v_mfma_f32_16x16x32_bf16 v[32:35], v[52:55], v[56:59], v[32:35]
  s_waitcnt vmcnt(6)
  buffer_load_dwordx4 v[80:83], v0, s[4:7], s32 offen offset:128 nt
  s_waitcnt vmcnt(6)
  v_add_f32_dpp v29, v44, v45 row_ror:8 row_mask:0x1 bank_mask:0xc
  v_mfma_f32_16x16x32_bf16 v[44:47], v[12:15], v[84:87], 0
  v_mfma_f32_16x16x32_bf16 v[44:47], v[16:19], v[88:91], v[44:47]
  buffer_load_dwordx4 v[84:87], v0, s[4:7], s32 offen offset:2048 nt
  ds_read_b128 v[56:59], v4 offset:23552
  v_and_b32_dpp v48, v23, v6 row_newbcast:8 row_mask:0xf bank_mask:0xf
  v_and_b32_dpp v49, v23, v7 row_newbcast:8 row_mask:0xf bank_mask:0xf
  v_and_b32_dpp v50, v23, v8 row_newbcast:8 row_mask:0xf bank_mask:0xf
  v_and_b32_dpp v51, v23, v9 row_newbcast:8 row_mask:0xf bank_mask:0xf
  s_waitcnt lgkmcnt(0)
  s_nop 0
  v_mfma_f32_16x16x32_bf16 v[32:35], v[48:51], v[56:59], v[32:35]
  ds_read_b128 v[56:59], v4 offset:24576
  v_and_b32_dpp v52, v23, v6 row_newbcast:9 row_mask:0xf bank_mask:0xf
  v_and_b32_dpp v53, v23, v7 row_newbcast:9 row_mask:0xf bank_mask:0xf
  v_and_b32_dpp v54, v23, v8 row_newbcast:9 row_mask:0xf bank_mask:0xf
  v_and_b32_dpp v55, v23, v9 row_newbcast:9 row_mask:0xf bank_mask:0xf
  s_waitcnt lgkmcnt(0)
  s_nop 0
  v_mfma_f32_16x16x32_bf16 v[32:35], v[52:55], v[56:59], v[32:35]
  s_waitcnt vmcnt(6)
  buffer_load_dwordx4 v[88:91], v0, s[4:7], s32 offen offset:2176 nt
  s_waitcnt vmcnt(6)
  v_add_f32_dpp v29, v41, v40 row_ror:8 row_mask:0x2 bank_mask:0x3
  v_mfma_f32_16x16x32_bf16 v[40:43], v[12:15], v[60:63], 0
  v_mfma_f32_16x16x32_bf16 v[40:43], v[16:19], v[64:67], v[40:43]
  s_add_u32 s32, s28, 532480
  buffer_load_dwordx4 v[60:63], v0, s[4:7], s32 offen offset:0 nt
  ds_read_b128 v[56:59], v4 offset:25600
  v_and_b32_dpp v48, v23, v6 row_newbcast:10 row_mask:0xf bank_mask:0xf
  v_and_b32_dpp v49, v23, v7 row_newbcast:10 row_mask:0xf bank_mask:0xf
  v_and_b32_dpp v50, v23, v8 row_newbcast:10 row_mask:0xf bank_mask:0xf
  v_and_b32_dpp v51, v23, v9 row_newbcast:10 row_mask:0xf bank_mask:0xf
  s_waitcnt lgkmcnt(0)
  s_nop 0
  v_mfma_f32_16x16x32_bf16 v[32:35], v[48:51], v[56:59], v[32:35]
  ds_read_b128 v[56:59], v4 offset:26624
  v_and_b32_dpp v52, v23, v6 row_newbcast:11 row_mask:0xf bank_mask:0xf
  v_and_b32_dpp v53, v23, v7 row_newbcast:11 row_mask:0xf bank_mask:0xf
  v_and_b32_dpp v54, v23, v8 row_newbcast:11 row_mask:0xf bank_mask:0xf
  v_and_b32_dpp v55, v23, v9 row_newbcast:11 row_mask:0xf bank_mask:0xf
  s_waitcnt lgkmcnt(0)
  s_nop 0
  v_mfma_f32_16x16x32_bf16 v[32:35], v[52:55], v[56:59], v[32:35]
  s_waitcnt vmcnt(6)
  buffer_load_dwordx4 v[64:67], v0, s[4:7], s32 offen offset:128 nt
  s_waitcnt vmcnt(6)
  v_add_f32_dpp v29, v44, v45 row_ror:8 row_mask:0x2 bank_mask:0xc
  v_mfma_f32_16x16x32_bf16 v[44:47], v[12:15], v[68:71], 0
  v_mfma_f32_16x16x32_bf16 v[44:47], v[16:19], v[72:75], v[44:47]
  buffer_load_dwordx4 v[68:71], v0, s[4:7], s32 offen offset:2048 nt
  ds_read_b128 v[56:59], v4 offset:27648
  v_and_b32_dpp v48, v23, v6 row_newbcast:12 row_mask:0xf bank_mask:0xf
  v_and_b32_dpp v49, v23, v7 row_newbcast:12 row_mask:0xf bank_mask:0xf
  v_and_b32_dpp v50, v23, v8 row_newbcast:12 row_mask:0xf bank_mask:0xf
  v_and_b32_dpp v51, v23, v9 row_newbcast:12 row_mask:0xf bank_mask:0xf
  s_waitcnt lgkmcnt(0)
  s_nop 0
  v_mfma_f32_16x16x32_bf16 v[32:35], v[48:51], v[56:59], v[32:35]
  ds_read_b128 v[56:59], v4 offset:28672
  v_and_b32_dpp v52, v23, v6 row_newbcast:13 row_mask:0xf bank_mask:0xf
  v_and_b32_dpp v53, v23, v7 row_newbcast:13 row_mask:0xf bank_mask:0xf
  v_and_b32_dpp v54, v23, v8 row_newbcast:13 row_mask:0xf bank_mask:0xf
  v_and_b32_dpp v55, v23, v9 row_newbcast:13 row_mask:0xf bank_mask:0xf
  s_waitcnt lgkmcnt(0)
  s_nop 0
  v_mfma_f32_16x16x32_bf16 v[32:35], v[52:55], v[56:59], v[32:35]
  s_waitcnt vmcnt(6)
  buffer_load_dwordx4 v[72:75], v0, s[4:7], s32 offen offset:2176 nt
  s_waitcnt vmcnt(6)
  v_add_f32_dpp v29, v41, v40 row_ror:8 row_mask:0x4 bank_mask:0x3
  v_mfma_f32_16x16x32_bf16 v[40:43], v[12:15], v[76:79], 0
  v_mfma_f32_16x16x32_bf16 v[40:43], v[16:19], v[80:83], v[40:43]
  s_add_u32 s32, s28, 536576
  buffer_load_dwordx4 v[76:79], v0, s[4:7], s32 offen offset:0 nt
  ds_read_b128 v[56:59], v4 offset:29696
  v_and_b32_dpp v48, v23, v6 row_newbcast:14 row_mask:0xf bank_mask:0xf
  v_and_b32_dpp v49, v23, v7 row_newbcast:14 row_mask:0xf bank_mask:0xf
  v_and_b32_dpp v50, v23, v8 row_newbcast:14 row_mask:0xf bank_mask:0xf
  v_and_b32_dpp v51, v23, v9 row_newbcast:14 row_mask:0xf bank_mask:0xf
  s_waitcnt lgkmcnt(0)
  s_nop 0
  v_mfma_f32_16x16x32_bf16 v[32:35], v[48:51], v[56:59], v[32:35]
  ds_read_b128 v[56:59], v4 offset:30720
  v_and_b32_dpp v52, v23, v6 row_newbcast:15 row_mask:0xf bank_mask:0xf
  v_and_b32_dpp v53, v23, v7 row_newbcast:15 row_mask:0xf bank_mask:0xf
  v_and_b32_dpp v54, v23, v8 row_newbcast:15 row_mask:0xf bank_mask:0xf
  v_and_b32_dpp v55, v23, v9 row_newbcast:15 row_mask:0xf bank_mask:0xf
  s_waitcnt lgkmcnt(0)
  s_nop 0
  v_mfma_f32_16x16x32_bf16 v[32:35], v[52:55], v[56:59], v[32:35]
  s_waitcnt vmcnt(6)
  buffer_load_dwordx4 v[80:83], v0, s[4:7], s32 offen offset:128 nt
  s_waitcnt vmcnt(6)
  v_add_f32_dpp v29, v44, v45 row_ror:8 row_mask:0x4 bank_mask:0xc
  v_mfma_f32_16x16x32_bf16 v[44:47], v[12:15], v[84:87], 0
  v_mfma_f32_16x16x32_bf16 v[44:47], v[16:19], v[88:91], v[44:47]
  buffer_load_dwordx4 v[84:87], v0, s[4:7], s32 offen offset:2048 nt
  ds_read_b128 v[56:59], v4 offset:31744
  v_and_b32_dpp v48, v24, v6 row_newbcast:0 row_mask:0xf bank_mask:0xf
  v_and_b32_dpp v49, v24, v7 row_newbcast:0 row_mask:0xf bank_mask:0xf
  v_and_b32_dpp v50, v24, v8 row_newbcast:0 row_mask:0xf bank_mask:0xf
  v_and_b32_dpp v51, v24, v9 row_newbcast:0 row_mask:0xf bank_mask:0xf
  s_waitcnt lgkmcnt(0)
  s_nop 0
  v_mfma_f32_16x16x32_bf16 v[32:35], v[48:51], v[56:59], v[32:35]
  ds_read_b128 v[56:59], v4 offset:32768
  v_and_b32_dpp v52, v24, v6 row_newbcast:1 row_mask:0xf bank_mask:0xf
  v_and_b32_dpp v53, v24, v7 row_newbcast:1 row_mask:0xf bank_mask:0xf
  v_and_b32_dpp v54, v24, v8 row_newbcast:1 row_mask:0xf bank_mask:0xf
  v_and_b32_dpp v55, v24, v9 row_newbcast:1 row_mask:0xf bank_mask:0xf
  s_waitcnt lgkmcnt(0)
  s_nop 0
  v_mfma_f32_16x16x32_bf16 v[32:35], v[52:55], v[56:59], v[32:35]
  s_waitcnt vmcnt(6)
  buffer_load_dwordx4 v[88:91], v0, s[4:7], s32 offen offset:2176 nt
  s_waitcnt vmcnt(6)
  v_mov_b32 v30, 0xff800000
  v_add_f32_dpp v29, v41, v40 row_ror:8 row_mask:0x8 bank_mask:0x3
  v_mfma_f32_16x16x32_bf16 v[40:43], v[12:15], v[60:63], 0
  v_mfma_f32_16x16x32_bf16 v[40:43], v[16:19], v[64:67], v[40:43]
  s_mov_b32 s32, s30
  s_mov_b64 exec, s[42:43]
  buffer_load_dwordx4 v[60:63], v0, s[4:7], s32 offen offset:0 nt
  s_mov_b64 exec, -1
  ds_read_b128 v[56:59], v4 offset:33792
  v_and_b32_dpp v48, v24, v6 row_newbcast:2 row_mask:0xf bank_mask:0xf
  v_and_b32_dpp v49, v24, v7 row_newbcast:2 row_mask:0xf bank_mask:0xf
  v_and_b32_dpp v50, v24, v8 row_newbcast:2 row_mask:0xf bank_mask:0xf
  v_and_b32_dpp v51, v24, v9 row_newbcast:2 row_mask:0xf bank_mask:0xf
  s_waitcnt lgkmcnt(0)
  s_nop 0
  v_mfma_f32_16x16x32_bf16 v[32:35], v[48:51], v[56:59], v[32:35]
  ds_read_b128 v[56:59], v4 offset:34816
  v_and_b32_dpp v52, v24, v6 row_newbcast:3 row_mask:0xf bank_mask:0xf
  v_and_b32_dpp v53, v24, v7 row_newbcast:3 row_mask:0xf bank_mask:0xf
  v_and_b32_dpp v54, v24, v8 row_newbcast:3 row_mask:0xf bank_mask:0xf
  v_and_b32_dpp v55, v24, v9 row_newbcast:3 row_mask:0xf bank_mask:0xf
  s_waitcnt lgkmcnt(0)
  s_nop 0
  v_mfma_f32_16x16x32_bf16 v[32:35], v[52:55], v[56:59], v[32:35]
  s_waitcnt vmcnt(6)
  s_mov_b64 exec, s[42:43]
  buffer_load_dwordx4 v[64:67], v0, s[4:7], s32 offen offset:128 nt
  s_mov_b64 exec, -1
  s_waitcnt vmcnt(6)
  v_add_f32_dpp v29, v44, v45 row_ror:8 row_mask:0x8 bank_mask:0xc
  v_mfma_f32_16x16x32_bf16 v[44:47], v[12:15], v[68:71], 0
  v_mfma_f32_16x16x32_bf16 v[44:47], v[16:19], v[72:75], v[44:47]
  s_mov_b64 exec, s[44:45]
  buffer_load_dwordx4 v[68:71], v0, s[4:7], s32 offen offset:2048 nt
  s_mov_b64 exec, -1
  ds_read_b128 v[56:59], v4 offset:35840
  v_and_b32_dpp v48, v24, v6 row_newbcast:4 row_mask:0xf bank_mask:0xf
  v_and_b32_dpp v49, v24, v7 row_newbcast:4 row_mask:0xf bank_mask:0xf
  v_and_b32_dpp v50, v24, v8 row_newbcast:4 row_mask:0xf bank_mask:0xf
  v_and_b32_dpp v51, v24, v9 row_newbcast:4 row_mask:0xf bank_mask:0xf
  s_waitcnt lgkmcnt(0)
  s_nop 0
  v_mfma_f32_16x16x32_bf16 v[32:35], v[48:51], v[56:59], v[32:35]
  ds_read_b128 v[56:59], v4 offset:36864
  v_and_b32_dpp v52, v24, v6 row_newbcast:5 row_mask:0xf bank_mask:0xf
  v_and_b32_dpp v53, v24, v7 row_newbcast:5 row_mask:0xf bank_mask:0xf
  v_and_b32_dpp v54, v24, v8 row_newbcast:5 row_mask:0xf bank_mask:0xf
  v_and_b32_dpp v55, v24, v9 row_newbcast:5 row_mask:0xf bank_mask:0xf
  s_waitcnt lgkmcnt(0)
  s_nop 0
  v_mfma_f32_16x16x32_bf16 v[32:35], v[52:55], v[56:59], v[32:35]
  s_waitcnt vmcnt(6)
  s_mov_b64 exec, s[44:45]
  buffer_load_dwordx4 v[72:75], v0, s[4:7], s32 offen offset:2176 nt
  s_mov_b64 exec, -1
  s_waitcnt vmcnt(6)
  s_lshl_b32 s46, s25, 8
  s_add_u32 s46, s46, 2408448
  s_add_u32 m0, s35, 256
  v_lshrrev_b32 v59, 2, v3
  buffer_load_dword v59, s[12:15], s46 offen sc1 lds
  v_add_f32_dpp v30, v41, v40 row_ror:8 row_mask:0x1 bank_mask:0x3
  v_mfma_f32_16x16x32_bf16 v[40:43], v[12:15], v[76:79], 0
  v_mfma_f32_16x16x32_bf16 v[40:43], v[16:19], v[80:83], v[40:43]
  ds_read_b128 v[56:59], v4 offset:37888
  v_and_b32_dpp v48, v24, v6 row_newbcast:6 row_mask:0xf bank_mask:0xf
  v_and_b32_dpp v49, v24, v7 row_newbcast:6 row_mask:0xf bank_mask:0xf
  v_and_b32_dpp v50, v24, v8 row_newbcast:6 row_mask:0xf bank_mask:0xf
  v_and_b32_dpp v51, v24, v9 row_newbcast:6 row_mask:0xf bank_mask:0xf
  s_waitcnt lgkmcnt(0)
  s_nop 0
  v_mfma_f32_16x16x32_bf16 v[32:35], v[48:51], v[56:59], v[32:35]
  ds_read_b128 v[56:59], v4 offset:38912
  v_and_b32_dpp v52, v24, v6 row_newbcast:7 row_mask:0xf bank_mask:0xf
  v_and_b32_dpp v53, v24, v7 row_newbcast:7 row_mask:0xf bank_mask:0xf
  v_and_b32_dpp v54, v24, v8 row_newbcast:7 row_mask:0xf bank_mask:0xf
  v_and_b32_dpp v55, v24, v9 row_newbcast:7 row_mask:0xf bank_mask:0xf
  s_waitcnt lgkmcnt(0)
  s_nop 0
  v_mfma_f32_16x16x32_bf16 v[32:35], v[52:55], v[56:59], v[32:35]
  s_waitcnt vmcnt(6)
  s_add_u32 s33, s28, 262144
  buffer_load_dwordx4 v[76:79], v1, s[8:11], s33 offen offset:0
  s_waitcnt vmcnt(6)
  buffer_load_dwordx4 v[80:83], v1, s[8:11], s33 offen offset:256
  v_add_f32_dpp v30, v45, v44 row_ror:8 row_mask:0x2 bank_mask:0x3
  v_mfma_f32_16x16x32_bf16 v[44:47], v[12:15], v[84:87], 0
  v_mfma_f32_16x16x32_bf16 v[44:47], v[16:19], v[88:91], v[44:47]
  s_waitcnt vmcnt(6)
  buffer_load_dwordx4 v[84:87], v1, s[8:11], s33 offen offset:512
  s_waitcnt vmcnt(6)
  buffer_load_dwordx4 v[88:91], v1, s[8:11], s33 offen offset:768
  v_mov_b32 v31, 0xff800000
  v_add_f32_dpp v30, v41, v40 row_ror:8 row_mask:0x4 bank_mask:0x3
  v_mfma_f32_16x16x32_bf16 v[40:43], v[12:15], v[60:63], 0
  v_mfma_f32_16x16x32_bf16 v[40:43], v[16:19], v[64:67], v[40:43]
  s_waitcnt vmcnt(6)
  buffer_load_dwordx4 v[60:63], v1, s[8:11], s33 offen offset:1024
  s_waitcnt vmcnt(6)
  buffer_load_dwordx4 v[64:67], v1, s[8:11], s33 offen offset:1280
  v_add_f32_dpp v30, v45, v44 row_ror:8 row_mask:0x8 bank_mask:0x3
  v_mfma_f32_16x16x32_bf16 v[44:47], v[12:15], v[68:71], 0
  v_mfma_f32_16x16x32_bf16 v[44:47], v[16:19], v[72:75], v[44:47]
  s_nop 0
  v_add_f32_dpp v31, v41, v40 row_ror:8 row_mask:0x1 bank_mask:0x3
  s_nop 5
  v_add_f32_dpp v31, v44, v45 row_ror:8 row_mask:0x1 bank_mask:0xc
  ds_bpermute_b32 v31, v5, v31
  s_waitcnt lgkmcnt(0)
  v_mul_f32 v26, 0x3e0293ee, v26
  v_mul_f32 v27, 0x3e0293ee, v27
  v_mul_f32 v28, 0x3e0293ee, v28
  v_mul_f32 v29, 0x3e0293ee, v29
  v_mul_f32 v30, 0x3e0293ee, v30
  v_mul_f32 v31, 0x3e0293ee, v31
  v_max3_f32 v40, v26, v27, v28
  v_max3_f32 v40, v40, v29, v30
  v_max_f32 v40, v40, v31
  v_max_f32 v40, s36, v40
  s_nop 1
  v_max_f32_dpp v40, v40, v40 row_ror:8 row_mask:0xf bank_mask:0xf
  s_nop 1
  v_max_f32_dpp v40, v40, v40 row_ror:4 row_mask:0xf bank_mask:0xf
  s_nop 1
  v_max_f32_dpp v40, v40, v40 row_ror:2 row_mask:0xf bank_mask:0xf
  s_nop 1
  v_max_f32_dpp v40, v40, v40 row_ror:1 row_mask:0xf bank_mask:0xf
  s_nop 1
  v_max_f32_dpp v40, v40, v40 row_bcast:15 row_mask:0xa bank_mask:0xf
  s_nop 1
  v_max_f32_dpp v40, v40, v40 row_bcast:31 row_mask:0xc bank_mask:0xf
  s_nop 0
  v_readlane_b32 s46, v40, 63
  s_nop 1
  v_mov_b32 v41, s46
  v_sub_f32 v41, s36, v41
  v_exp_f32 v41, v41
  s_nop 0
  v_mul_f32 v32, v32, v41
  v_mul_f32 v33, v33, v41
  v_mul_f32 v34, v34, v41
  v_mul_f32 v35, v35, v41
  v_mul_f32 v10, v10, v41
  s_mov_b32 s36, s46
  v_subrev_f32 v26, s36, v26
  v_subrev_f32 v27, s36, v27
  v_subrev_f32 v28, s36, v28
  v_subrev_f32 v29, s36, v29
  v_subrev_f32 v30, s36, v30
  v_subrev_f32 v31, s36, v31
  v_exp_f32 v26, v26
  v_exp_f32 v27, v27
  v_exp_f32 v28, v28
  v_exp_f32 v29, v29
  v_exp_f32 v30, v30
  v_exp_f32 v31, v31
  v_add_f32 v42, v26, v27
  v_add_f32 v43, v28, v29
  v_add_f32 v42, v42, v30
  v_add_f32 v43, v43, v31
  v_add_f32 v42, v42, v43
  v_add_f32 v10, v10, v42
  v_cvt_pk_bf16_f32 v26, v26, v26
  v_cvt_pk_bf16_f32 v27, v27, v27
  v_cvt_pk_bf16_f32 v28, v28, v28
  v_cvt_pk_bf16_f32 v29, v29, v29
  v_cvt_pk_bf16_f32 v30, v30, v30
  v_cvt_pk_bf16_f32 v31, v31, v31
  s_waitcnt vmcnt(6)
  buffer_load_dwordx4 v[68:71], v1, s[8:11], s33 offen offset:1536
  s_waitcnt vmcnt(6)
  buffer_load_dwordx4 v[72:75], v1, s[8:11], s33 offen offset:1792
  v_and_b32_dpp v48, v26, v6 row_newbcast:0 row_mask:0xf bank_mask:0xf
  v_and_b32_dpp v49, v26, v7 row_newbcast:0 row_mask:0xf bank_mask:0xf
  v_and_b32_dpp v50, v26, v8 row_newbcast:0 row_mask:0xf bank_mask:0xf
  v_and_b32_dpp v51, v26, v9 row_newbcast:0 row_mask:0xf bank_mask:0xf
  s_nop 1
  v_mfma_f32_16x16x32_bf16 v[32:35], v[48:51], v[76:79], v[32:35]
  s_waitcnt vmcnt(6)
  buffer_load_dwordx4 v[76:79], v1, s[8:11], s33 offen offset:2048
  v_and_b32_dpp v52, v26, v6 row_newbcast:1 row_mask:0xf bank_mask:0xf
  v_and_b32_dpp v53, v26, v7 row_newbcast:1 row_mask:0xf bank_mask:0xf
  v_and_b32_dpp v54, v26, v8 row_newbcast:1 row_mask:0xf bank_mask:0xf
  v_and_b32_dpp v55, v26, v9 row_newbcast:1 row_mask:0xf bank_mask:0xf
  s_nop 1
  v_mfma_f32_16x16x32_bf16 v[32:35], v[52:55], v[80:83], v[32:35]
  s_waitcnt vmcnt(6)
  buffer_load_dwordx4 v[80:83], v1, s[8:11], s33 offen offset:2304
  v_and_b32_dpp v48, v26, v6 row_newbcast:2 row_mask:0xf bank_mask:0xf
  v_and_b32_dpp v49, v26, v7 row_newbcast:2 row_mask:0xf bank_mask:0xf
  v_and_b32_dpp v50, v26, v8 row_newbcast:2 row_mask:0xf bank_mask:0xf
  v_and_b32_dpp v51, v26, v9 row_newbcast:2 row_mask:0xf bank_mask:0xf
  s_nop 1
  v_mfma_f32_16x16x32_bf16 v[32:35], v[48:51], v[84:87], v[32:35]
  s_waitcnt vmcnt(6)
  buffer_load_dwordx4 v[84:87], v1, s[8:11], s33 offen offset:2560
  v_and_b32_dpp v52, v26, v6 row_newbcast:3 row_mask:0xf bank_mask:0xf
  v_and_b32_dpp v53, v26, v7 row_newbcast:3 row_mask:0xf bank_mask:0xf
  v_and_b32_dpp v54, v26, v8 row_newbcast:3 row_mask:0xf bank_mask:0xf
  v_and_b32_dpp v55, v26, v9 row_newbcast:3 row_mask:0xf bank_mask:0xf
  s_nop 1
  v_mfma_f32_16x16x32_bf16 v[32:35], v[52:55], v[88:91], v[32:35]
  s_waitcnt vmcnt(6)
  buffer_load_dwordx4 v[88:91], v1, s[8:11], s33 offen offset:2816
  v_and_b32_dpp v48, v26, v6 row_newbcast:4 row_mask:0xf bank_mask:0xf
  v_and_b32_dpp v49, v26, v7 row_newbcast:4 row_mask:0xf bank_mask:0xf
  v_and_b32_dpp v50, v26, v8 row_newbcast:4 row_mask:0xf bank_mask:0xf
  v_and_b32_dpp v51, v26, v9 row_newbcast:4 row_mask:0xf bank_mask:0xf
  s_nop 1
  v_mfma_f32_16x16x32_bf16 v[32:35], v[48:51], v[60:63], v[32:35]
  s_waitcnt vmcnt(6)
  buffer_load_dwordx4 v[60:63], v1, s[8:11], s33 offen offset:3072
  v_and_b32_dpp v52, v26, v6 row_newbcast:5 row_mask:0xf bank_mask:0xf
  v_and_b32_dpp v53, v26, v7 row_newbcast:5 row_mask:0xf bank_mask:0xf
  v_and_b32_dpp v54, v26, v8 row_newbcast:5 row_mask:0xf bank_mask:0xf
  v_and_b32_dpp v55, v26, v9 row_newbcast:5 row_mask:0xf bank_mask:0xf
  s_nop 1
  v_mfma_f32_16x16x32_bf16 v[32:35], v[52:55], v[64:67], v[32:35]
  s_waitcnt vmcnt(6)
  buffer_load_dwordx4 v[64:67], v1, s[8:11], s33 offen offset:3328
  v_and_b32_dpp v48, v26, v6 row_newbcast:6 row_mask:0xf bank_mask:0xf
  v_and_b32_dpp v49, v26, v7 row_newbcast:6 row_mask:0xf bank_mask:0xf
  v_and_b32_dpp v50, v26, v8 row_newbcast:6 row_mask:0xf bank_mask:0xf
  v_and_b32_dpp v51, v26, v9 row_newbcast:6 row_mask:0xf bank_mask:0xf
  s_nop 1
  v_mfma_f32_16x16x32_bf16 v[32:35], v[48:51], v[68:71], v[32:35]
  s_waitcnt vmcnt(6)
  buffer_load_dwordx4 v[68:71], v1, s[8:11], s33 offen offset:3584
  v_and_b32_dpp v52, v26, v6 row_newbcast:7 row_mask:0xf bank_mask:0xf
  v_and_b32_dpp v53, v26, v7 row_newbcast:7 row_mask:0xf bank_mask:0xf
  v_and_b32_dpp v54, v26, v8 row_newbcast:7 row_mask:0xf bank_mask:0xf
  v_and_b32_dpp v55, v26, v9 row_newbcast:7 row_mask:0xf bank_mask:0xf
  s_nop 1
  v_mfma_f32_16x16x32_bf16 v[32:35], v[52:55], v[72:75], v[32:35]
  s_waitcnt vmcnt(6)
  buffer_load_dwordx4 v[72:75], v1, s[8:11], s33 offen offset:3840
  v_and_b32_dpp v48, v26, v6 row_newbcast:8 row_mask:0xf bank_mask:0xf
  v_and_b32_dpp v49, v26, v7 row_newbcast:8 row_mask:0xf bank_mask:0xf
  v_and_b32_dpp v50, v26, v8 row_newbcast:8 row_mask:0xf bank_mask:0xf
  v_and_b32_dpp v51, v26, v9 row_newbcast:8 row_mask:0xf bank_mask:0xf
  s_nop 1
  v_mfma_f32_16x16x32_bf16 v[32:35], v[48:51], v[76:79], v[32:35]
  s_waitcnt vmcnt(6)
  s_add_u32 s33, s28, 327680
  buffer_load_dwordx4 v[76:79], v1, s[8:11], s33 offen offset:0
  v_and_b32_dpp v52, v26, v6 row_newbcast:9 row_mask:0xf bank_mask:0xf
  v_and_b32_dpp v53, v26, v7 row_newbcast:9 row_mask:0xf bank_mask:0xf
  v_and_b32_dpp v54, v26, v8 row_newbcast:9 row_mask:0xf bank_mask:0xf
  v_and_b32_dpp v55, v26, v9 row_newbcast:9 row_mask:0xf bank_mask:0xf
  s_nop 1
  v_mfma_f32_16x16x32_bf16 v[32:35], v[52:55], v[80:83], v[32:35]
  s_waitcnt vmcnt(6)
  buffer_load_dwordx4 v[80:83], v1, s[8:11], s33 offen offset:256
  v_and_b32_dpp v48, v26, v6 row_newbcast:10 row_mask:0xf bank_mask:0xf
  v_and_b32_dpp v49, v26, v7 row_newbcast:10 row_mask:0xf bank_mask:0xf
  v_and_b32_dpp v50, v26, v8 row_newbcast:10 row_mask:0xf bank_mask:0xf
  v_and_b32_dpp v51, v26, v9 row_newbcast:10 row_mask:0xf bank_mask:0xf
  s_nop 1
  v_mfma_f32_16x16x32_bf16 v[32:35], v[48:51], v[84:87], v[32:35]
  s_waitcnt vmcnt(6)
  buffer_load_dwordx4 v[84:87], v1, s[8:11], s33 offen offset:512
  v_and_b32_dpp v52, v26, v6 row_newbcast:11 row_mask:0xf bank_mask:0xf
  v_and_b32_dpp v53, v26, v7 row_newbcast:11 row_mask:0xf bank_mask:0xf
  v_and_b32_dpp v54, v26, v8 row_newbcast:11 row_mask:0xf bank_mask:0xf
  v_and_b32_dpp v55, v26, v9 row_newbcast:11 row_mask:0xf bank_mask:0xf
  s_nop 1
  v_mfma_f32_16x16x32_bf16 v[32:35], v[52:55], v[88:91], v[32:35]
  s_waitcnt vmcnt(6)
  buffer_load_dwordx4 v[88:91], v1, s[8:11], s33 offen offset:768
  v_and_b32_dpp v48, v26, v6 row_newbcast:12 row_mask:0xf bank_mask:0xf
  v_and_b32_dpp v49, v26, v7 row_newbcast:12 row_mask:0xf bank_mask:0xf
  v_and_b32_dpp v50, v26, v8 row_newbcast:12 row_mask:0xf bank_mask:0xf
  v_and_b32_dpp v51, v26, v9 row_newbcast:12 row_mask:0xf bank_mask:0xf
  s_nop 1
  v_mfma_f32_16x16x32_bf16 v[32:35], v[48:51], v[60:63], v[32:35]
  s_waitcnt vmcnt(6)
  buffer_load_dwordx4 v[60:63], v1, s[8:11], s33 offen offset:1024
  v_and_b32_dpp v52, v26, v6 row_newbcast:13 row_mask:0xf bank_mask:0xf
  v_and_b32_dpp v53, v26, v7 row_newbcast:13 row_mask:0xf bank_mask:0xf
  v_and_b32_dpp v54, v26, v8 row_newbcast:13 row_mask:0xf bank_mask:0xf
  v_and_b32_dpp v55, v26, v9 row_newbcast:13 row_mask:0xf bank_mask:0xf
  s_nop 1
  v_mfma_f32_16x16x32_bf16 v[32:35], v[52:55], v[64:67], v[32:35]
  s_waitcnt vmcnt(6)
  buffer_load_dwordx4 v[64:67], v1, s[8:11], s33 offen offset:1280
  v_and_b32_dpp v48, v26, v6 row_newbcast:14 row_mask:0xf bank_mask:0xf
  v_and_b32_dpp v49, v26, v7 row_newbcast:14 row_mask:0xf bank_mask:0xf
  v_and_b32_dpp v50, v26, v8 row_newbcast:14 row_mask:0xf bank_mask:0xf
  v_and_b32_dpp v51, v26, v9 row_newbcast:14 row_mask:0xf bank_mask:0xf
  s_nop 1
  v_mfma_f32_16x16x32_bf16 v[32:35], v[48:51], v[68:71], v[32:35]
  s_waitcnt vmcnt(6)
  buffer_load_dwordx4 v[68:71], v1, s[8:11], s33 offen offset:1536
  v_and_b32_dpp v52, v26, v6 row_newbcast:15 row_mask:0xf bank_mask:0xf
  v_and_b32_dpp v53, v26, v7 row_newbcast:15 row_mask:0xf bank_mask:0xf
  v_and_b32_dpp v54, v26, v8 row_newbcast:15 row_mask:0xf bank_mask:0xf
  v_and_b32_dpp v55, v26, v9 row_newbcast:15 row_mask:0xf bank_mask:0xf
  s_nop 1
  v_mfma_f32_16x16x32_bf16 v[32:35], v[52:55], v[72:75], v[32:35]
  s_waitcnt vmcnt(6)
  buffer_load_dwordx4 v[72:75], v1, s[8:11], s33 offen offset:1792
  v_and_b32_dpp v48, v27, v6 row_newbcast:0 row_mask:0xf bank_mask:0xf
  v_and_b32_dpp v49, v27, v7 row_newbcast:0 row_mask:0xf bank_mask:0xf
  v_and_b32_dpp v50, v27, v8 row_newbcast:0 row_mask:0xf bank_mask:0xf
  v_and_b32_dpp v51, v27, v9 row_newbcast:0 row_mask:0xf bank_mask:0xf
  s_nop 1
  v_mfma_f32_16x16x32_bf16 v[32:35], v[48:51], v[76:79], v[32:35]
  s_waitcnt vmcnt(6)
  buffer_load_dwordx4 v[76:79], v1, s[8:11], s33 offen offset:2048
  v_and_b32_dpp v52, v27, v6 row_newbcast:1 row_mask:0xf bank_mask:0xf
  v_and_b32_dpp v53, v27, v7 row_newbcast:1 row_mask:0xf bank_mask:0xf
  v_and_b32_dpp v54, v27, v8 row_newbcast:1 row_mask:0xf bank_mask:0xf
  v_and_b32_dpp v55, v27, v9 row_newbcast:1 row_mask:0xf bank_mask:0xf
  s_nop 1
  v_mfma_f32_16x16x32_bf16 v[32:35], v[52:55], v[80:83], v[32:35]
  s_waitcnt vmcnt(6)
  buffer_load_dwordx4 v[80:83], v1, s[8:11], s33 offen offset:2304
  v_and_b32_dpp v48, v27, v6 row_newbcast:2 row_mask:0xf bank_mask:0xf
  v_and_b32_dpp v49, v27, v7 row_newbcast:2 row_mask:0xf bank_mask:0xf
  v_and_b32_dpp v50, v27, v8 row_newbcast:2 row_mask:0xf bank_mask:0xf
  v_and_b32_dpp v51, v27, v9 row_newbcast:2 row_mask:0xf bank_mask:0xf
  s_nop 1
  v_mfma_f32_16x16x32_bf16 v[32:35], v[48:51], v[84:87], v[32:35]
  s_waitcnt vmcnt(6)
  buffer_load_dwordx4 v[84:87], v1, s[8:11], s33 offen offset:2560
  v_and_b32_dpp v52, v27, v6 row_newbcast:3 row_mask:0xf bank_mask:0xf
  v_and_b32_dpp v53, v27, v7 row_newbcast:3 row_mask:0xf bank_mask:0xf
  v_and_b32_dpp v54, v27, v8 row_newbcast:3 row_mask:0xf bank_mask:0xf
  v_and_b32_dpp v55, v27, v9 row_newbcast:3 row_mask:0xf bank_mask:0xf
  s_nop 1
  v_mfma_f32_16x16x32_bf16 v[32:35], v[52:55], v[88:91], v[32:35]
  s_waitcnt vmcnt(6)
  buffer_load_dwordx4 v[88:91], v1, s[8:11], s33 offen offset:2816
  v_and_b32_dpp v48, v27, v6 row_newbcast:4 row_mask:0xf bank_mask:0xf
  v_and_b32_dpp v49, v27, v7 row_newbcast:4 row_mask:0xf bank_mask:0xf
  v_and_b32_dpp v50, v27, v8 row_newbcast:4 row_mask:0xf bank_mask:0xf
  v_and_b32_dpp v51, v27, v9 row_newbcast:4 row_mask:0xf bank_mask:0xf
  s_nop 1
  v_mfma_f32_16x16x32_bf16 v[32:35], v[48:51], v[60:63], v[32:35]
  s_waitcnt vmcnt(6)
  buffer_load_dwordx4 v[60:63], v1, s[8:11], s33 offen offset:3072
  v_and_b32_dpp v52, v27, v6 row_newbcast:5 row_mask:0xf bank_mask:0xf
  v_and_b32_dpp v53, v27, v7 row_newbcast:5 row_mask:0xf bank_mask:0xf
  v_and_b32_dpp v54, v27, v8 row_newbcast:5 row_mask:0xf bank_mask:0xf
  v_and_b32_dpp v55, v27, v9 row_newbcast:5 row_mask:0xf bank_mask:0xf
  s_nop 1
  v_mfma_f32_16x16x32_bf16 v[32:35], v[52:55], v[64:67], v[32:35]
  s_waitcnt vmcnt(6)
  buffer_load_dwordx4 v[64:67], v1, s[8:11], s33 offen offset:3328
  v_and_b32_dpp v48, v27, v6 row_newbcast:6 row_mask:0xf bank_mask:0xf
  v_and_b32_dpp v49, v27, v7 row_newbcast:6 row_mask:0xf bank_mask:0xf
  v_and_b32_dpp v50, v27, v8 row_newbcast:6 row_mask:0xf bank_mask:0xf
  v_and_b32_dpp v51, v27, v9 row_newbcast:6 row_mask:0xf bank_mask:0xf
  s_nop 1
  v_mfma_f32_16x16x32_bf16 v[32:35], v[48:51], v[68:71], v[32:35]
  s_waitcnt vmcnt(6)
  buffer_load_dwordx4 v[68:71], v1, s[8:11], s33 offen offset:3584
  v_and_b32_dpp v52, v27, v6 row_newbcast:7 row_mask:0xf bank_mask:0xf
  v_and_b32_dpp v53, v27, v7 row_newbcast:7 row_mask:0xf bank_mask:0xf
  v_and_b32_dpp v54, v27, v8 row_newbcast:7 row_mask:0xf bank_mask:0xf
  v_and_b32_dpp v55, v27, v9 row_newbcast:7 row_mask:0xf bank_mask:0xf
  s_nop 1
  v_mfma_f32_16x16x32_bf16 v[32:35], v[52:55], v[72:75], v[32:35]
  s_waitcnt vmcnt(6)
  buffer_load_dwordx4 v[72:75], v1, s[8:11], s33 offen offset:3840
  v_and_b32_dpp v48, v27, v6 row_newbcast:8 row_mask:0xf bank_mask:0xf
  v_and_b32_dpp v49, v27, v7 row_newbcast:8 row_mask:0xf bank_mask:0xf
  v_and_b32_dpp v50, v27, v8 row_newbcast:8 row_mask:0xf bank_mask:0xf
  v_and_b32_dpp v51, v27, v9 row_newbcast:8 row_mask:0xf bank_mask:0xf
  s_nop 1
  v_mfma_f32_16x16x32_bf16 v[32:35], v[48:51], v[76:79], v[32:35]
  s_waitcnt vmcnt(6)
  s_add_u32 s33, s28, 393216
  buffer_load_dwordx4 v[76:79], v1, s[8:11], s33 offen offset:0
  v_and_b32_dpp v52, v27, v6 row_newbcast:9 row_mask:0xf bank_mask:0xf
  v_and_b32_dpp v53, v27, v7 row_newbcast:9 row_mask:0xf bank_mask:0xf
  v_and_b32_dpp v54, v27, v8 row_newbcast:9 row_mask:0xf bank_mask:0xf
  v_and_b32_dpp v55, v27, v9 row_newbcast:9 row_mask:0xf bank_mask:0xf
  s_nop 1
  v_mfma_f32_16x16x32_bf16 v[32:35], v[52:55], v[80:83], v[32:35]
  s_waitcnt vmcnt(6)
  buffer_load_dwordx4 v[80:83], v1, s[8:11], s33 offen offset:256
  v_and_b32_dpp v48, v27, v6 row_newbcast:10 row_mask:0xf bank_mask:0xf
  v_and_b32_dpp v49, v27, v7 row_newbcast:10 row_mask:0xf bank_mask:0xf
  v_and_b32_dpp v50, v27, v8 row_newbcast:10 row_mask:0xf bank_mask:0xf
  v_and_b32_dpp v51, v27, v9 row_newbcast:10 row_mask:0xf bank_mask:0xf
  s_nop 1
  v_mfma_f32_16x16x32_bf16 v[32:35], v[48:51], v[84:87], v[32:35]
  s_waitcnt vmcnt(6)
  buffer_load_dwordx4 v[84:87], v1, s[8:11], s33 offen offset:512
  v_and_b32_dpp v52, v27, v6 row_newbcast:11 row_mask:0xf bank_mask:0xf
  v_and_b32_dpp v53, v27, v7 row_newbcast:11 row_mask:0xf bank_mask:0xf
  v_and_b32_dpp v54, v27, v8 row_newbcast:11 row_mask:0xf bank_mask:0xf
  v_and_b32_dpp v55, v27, v9 row_newbcast:11 row_mask:0xf bank_mask:0xf
  s_nop 1
  v_mfma_f32_16x16x32_bf16 v[32:35], v[52:55], v[88:91], v[32:35]
  s_waitcnt vmcnt(6)
  buffer_load_dwordx4 v[88:91], v1, s[8:11], s33 offen offset:768
  v_and_b32_dpp v48, v27, v6 row_newbcast:12 row_mask:0xf bank_mask:0xf
  v_and_b32_dpp v49, v27, v7 row_newbcast:12 row_mask:0xf bank_mask:0xf
  v_and_b32_dpp v50, v27, v8 row_newbcast:12 row_mask:0xf bank_mask:0xf
  v_and_b32_dpp v51, v27, v9 row_newbcast:12 row_mask:0xf bank_mask:0xf
  s_nop 1
  v_mfma_f32_16x16x32_bf16 v[32:35], v[48:51], v[60:63], v[32:35]
  s_waitcnt vmcnt(6)
  buffer_load_dwordx4 v[60:63], v1, s[8:11], s33 offen offset:1024
  v_and_b32_dpp v52, v27, v6 row_newbcast:13 row_mask:0xf bank_mask:0xf
  v_and_b32_dpp v53, v27, v7 row_newbcast:13 row_mask:0xf bank_mask:0xf
  v_and_b32_dpp v54, v27, v8 row_newbcast:13 row_mask:0xf bank_mask:0xf
  v_and_b32_dpp v55, v27, v9 row_newbcast:13 row_mask:0xf bank_mask:0xf
  s_nop 1
  v_mfma_f32_16x16x32_bf16 v[32:35], v[52:55], v[64:67], v[32:35]
  s_waitcnt vmcnt(6)
  buffer_load_dwordx4 v[64:67], v1, s[8:11], s33 offen offset:1280
  v_and_b32_dpp v48, v27, v6 row_newbcast:14 row_mask:0xf bank_mask:0xf
  v_and_b32_dpp v49, v27, v7 row_newbcast:14 row_mask:0xf bank_mask:0xf
  v_and_b32_dpp v50, v27, v8 row_newbcast:14 row_mask:0xf bank_mask:0xf
  v_and_b32_dpp v51, v27, v9 row_newbcast:14 row_mask:0xf bank_mask:0xf
  s_nop 1
  v_mfma_f32_16x16x32_bf16 v[32:35], v[48:51], v[68:71], v[32:35]
  s_waitcnt vmcnt(6)
  buffer_load_dwordx4 v[68:71], v1, s[8:11], s33 offen offset:1536
  v_and_b32_dpp v52, v27, v6 row_newbcast:15 row_mask:0xf bank_mask:0xf
  v_and_b32_dpp v53, v27, v7 row_newbcast:15 row_mask:0xf bank_mask:0xf
  v_and_b32_dpp v54, v27, v8 row_newbcast:15 row_mask:0xf bank_mask:0xf
  v_and_b32_dpp v55, v27, v9 row_newbcast:15 row_mask:0xf bank_mask:0xf
  s_nop 1
  v_mfma_f32_16x16x32_bf16 v[32:35], v[52:55], v[72:75], v[32:35]
  s_waitcnt vmcnt(6)
  buffer_load_dwordx4 v[72:75], v1, s[8:11], s33 offen offset:1792
  v_and_b32_dpp v48, v28, v6 row_newbcast:0 row_mask:0xf bank_mask:0xf
  v_and_b32_dpp v49, v28, v7 row_newbcast:0 row_mask:0xf bank_mask:0xf
  v_and_b32_dpp v50, v28, v8 row_newbcast:0 row_mask:0xf bank_mask:0xf
  v_and_b32_dpp v51, v28, v9 row_newbcast:0 row_mask:0xf bank_mask:0xf
  s_nop 1
  v_mfma_f32_16x16x32_bf16 v[32:35], v[48:51], v[76:79], v[32:35]
  s_waitcnt vmcnt(6)
  buffer_load_dwordx4 v[76:79], v1, s[8:11], s33 offen offset:2048 nt
  v_and_b32_dpp v52, v28, v6 row_newbcast:1 row_mask:0xf bank_mask:0xf
  v_and_b32_dpp v53, v28, v7 row_newbcast:1 row_mask:0xf bank_mask:0xf
  v_and_b32_dpp v54, v28, v8 row_newbcast:1 row_mask:0xf bank_mask:0xf
  v_and_b32_dpp v55, v28, v9 row_newbcast:1 row_mask:0xf bank_mask:0xf
  s_nop 1
  v_mfma_f32_16x16x32_bf16 v[32:35], v[52:55], v[80:83], v[32:35]
  s_waitcnt vmcnt(6)
  buffer_load_dwordx4 v[80:83], v1, s[8:11], s33 offen offset:2304 nt
  v_and_b32_dpp v48, v28, v6 row_newbcast:2 row_mask:0xf bank_mask:0xf
  v_and_b32_dpp v49, v28, v7 row_newbcast:2 row_mask:0xf bank_mask:0xf
  v_and_b32_dpp v50, v28, v8 row_newbcast:2 row_mask:0xf bank_mask:0xf
  v_and_b32_dpp v51, v28, v9 row_newbcast:2 row_mask:0xf bank_mask:0xf
  s_nop 1
  v_mfma_f32_16x16x32_bf16 v[32:35], v[48:51], v[84:87], v[32:35]
  s_waitcnt vmcnt(6)
  buffer_load_dwordx4 v[84:87], v1, s[8:11], s33 offen offset:2560 nt
  v_and_b32_dpp v52, v28, v6 row_newbcast:3 row_mask:0xf bank_mask:0xf
  v_and_b32_dpp v53, v28, v7 row_newbcast:3 row_mask:0xf bank_mask:0xf
  v_and_b32_dpp v54, v28, v8 row_newbcast:3 row_mask:0xf bank_mask:0xf
  v_and_b32_dpp v55, v28, v9 row_newbcast:3 row_mask:0xf bank_mask:0xf
  s_nop 1
  v_mfma_f32_16x16x32_bf16 v[32:35], v[52:55], v[88:91], v[32:35]
  s_waitcnt vmcnt(6)
  buffer_load_dwordx4 v[88:91], v1, s[8:11], s33 offen offset:2816 nt
  v_and_b32_dpp v48, v28, v6 row_newbcast:4 row_mask:0xf bank_mask:0xf
  v_and_b32_dpp v49, v28, v7 row_newbcast:4 row_mask:0xf bank_mask:0xf
  v_and_b32_dpp v50, v28, v8 row_newbcast:4 row_mask:0xf bank_mask:0xf
  v_and_b32_dpp v51, v28, v9 row_newbcast:4 row_mask:0xf bank_mask:0xf
  s_nop 1
  v_mfma_f32_16x16x32_bf16 v[32:35], v[48:51], v[60:63], v[32:35]
  s_waitcnt vmcnt(6)
  buffer_load_dwordx4 v[60:63], v1, s[8:11], s33 offen offset:3072 nt
  v_and_b32_dpp v52, v28, v6 row_newbcast:5 row_mask:0xf bank_mask:0xf
  v_and_b32_dpp v53, v28, v7 row_newbcast:5 row_mask:0xf bank_mask:0xf
  v_and_b32_dpp v54, v28, v8 row_newbcast:5 row_mask:0xf bank_mask:0xf
  v_and_b32_dpp v55, v28, v9 row_newbcast:5 row_mask:0xf bank_mask:0xf
  s_nop 1
  v_mfma_f32_16x16x32_bf16 v[32:35], v[52:55], v[64:67], v[32:35]
  s_waitcnt vmcnt(6)
  buffer_load_dwordx4 v[64:67], v1, s[8:11], s33 offen offset:3328 nt
  v_and_b32_dpp v48, v28, v6 row_newbcast:6 row_mask:0xf bank_mask:0xf
  v_and_b32_dpp v49, v28, v7 row_newbcast:6 row_mask:0xf bank_mask:0xf
  v_and_b32_dpp v50, v28, v8 row_newbcast:6 row_mask:0xf bank_mask:0xf
  v_and_b32_dpp v51, v28, v9 row_newbcast:6 row_mask:0xf bank_mask:0xf
  s_nop 1
  v_mfma_f32_16x16x32_bf16 v[32:35], v[48:51], v[68:71], v[32:35]
  s_waitcnt vmcnt(6)
  buffer_load_dwordx4 v[68:71], v1, s[8:11], s33 offen offset:3584 nt
  v_and_b32_dpp v52, v28, v6 row_newbcast:7 row_mask:0xf bank_mask:0xf
  v_and_b32_dpp v53, v28, v7 row_newbcast:7 row_mask:0xf bank_mask:0xf
  v_and_b32_dpp v54, v28, v8 row_newbcast:7 row_mask:0xf bank_mask:0xf
  v_and_b32_dpp v55, v28, v9 row_newbcast:7 row_mask:0xf bank_mask:0xf
  s_nop 1
  v_mfma_f32_16x16x32_bf16 v[32:35], v[52:55], v[72:75], v[32:35]
  s_waitcnt vmcnt(6)
  buffer_load_dwordx4 v[72:75], v1, s[8:11], s33 offen offset:3840 nt
  v_and_b32_dpp v48, v28, v6 row_newbcast:8 row_mask:0xf bank_mask:0xf
  v_and_b32_dpp v49, v28, v7 row_newbcast:8 row_mask:0xf bank_mask:0xf
  v_and_b32_dpp v50, v28, v8 row_newbcast:8 row_mask:0xf bank_mask:0xf
  v_and_b32_dpp v51, v28, v9 row_newbcast:8 row_mask:0xf bank_mask:0xf
  s_nop 1
  v_mfma_f32_16x16x32_bf16 v[32:35], v[48:51], v[76:79], v[32:35]
  s_waitcnt vmcnt(6)
  s_add_u32 s33, s28, 458752
  buffer_load_dwordx4 v[76:79], v1, s[8:11], s33 offen offset:0 nt
  v_and_b32_dpp v52, v28, v6 row_newbcast:9 row_mask:0xf bank_mask:0xf
  v_and_b32_dpp v53, v28, v7 row_newbcast:9 row_mask:0xf bank_mask:0xf
  v_and_b32_dpp v54, v28, v8 row_newbcast:9 row_mask:0xf bank_mask:0xf
  v_and_b32_dpp v55, v28, v9 row_newbcast:9 row_mask:0xf bank_mask:0xf
  s_nop 1
  v_mfma_f32_16x16x32_bf16 v[32:35], v[52:55], v[80:83], v[32:35]
  s_waitcnt vmcnt(6)
  buffer_load_dwordx4 v[80:83], v1, s[8:11], s33 offen offset:256 nt
  v_and_b32_dpp v48, v28, v6 row_newbcast:10 row_mask:0xf bank_mask:0xf
  v_and_b32_dpp v49, v28, v7 row_newbcast:10 row_mask:0xf bank_mask:0xf
  v_and_b32_dpp v50, v28, v8 row_newbcast:10 row_mask:0xf bank_mask:0xf
  v_and_b32_dpp v51, v28, v9 row_newbcast:10 row_mask:0xf bank_mask:0xf
  s_nop 1
  v_mfma_f32_16x16x32_bf16 v[32:35], v[48:51], v[84:87], v[32:35]
  s_waitcnt vmcnt(6)
  buffer_load_dwordx4 v[84:87], v1, s[8:11], s33 offen offset:512 nt
  v_and_b32_dpp v52, v28, v6 row_newbcast:11 row_mask:0xf bank_mask:0xf
  v_and_b32_dpp v53, v28, v7 row_newbcast:11 row_mask:0xf bank_mask:0xf
  v_and_b32_dpp v54, v28, v8 row_newbcast:11 row_mask:0xf bank_mask:0xf
  v_and_b32_dpp v55, v28, v9 row_newbcast:11 row_mask:0xf bank_mask:0xf
  s_nop 1
  v_mfma_f32_16x16x32_bf16 v[32:35], v[52:55], v[88:91], v[32:35]
  s_waitcnt vmcnt(6)
  buffer_load_dwordx4 v[88:91], v1, s[8:11], s33 offen offset:768 nt
  v_and_b32_dpp v48, v28, v6 row_newbcast:12 row_mask:0xf bank_mask:0xf
  v_and_b32_dpp v49, v28, v7 row_newbcast:12 row_mask:0xf bank_mask:0xf
  v_and_b32_dpp v50, v28, v8 row_newbcast:12 row_mask:0xf bank_mask:0xf
  v_and_b32_dpp v51, v28, v9 row_newbcast:12 row_mask:0xf bank_mask:0xf
  s_nop 1
  v_mfma_f32_16x16x32_bf16 v[32:35], v[48:51], v[60:63], v[32:35]
  s_waitcnt vmcnt(6)
  buffer_load_dwordx4 v[60:63], v1, s[8:11], s33 offen offset:1024 nt
  v_and_b32_dpp v52, v28, v6 row_newbcast:13 row_mask:0xf bank_mask:0xf
  v_and_b32_dpp v53, v28, v7 row_newbcast:13 row_mask:0xf bank_mask:0xf
  v_and_b32_dpp v54, v28, v8 row_newbcast:13 row_mask:0xf bank_mask:0xf
  v_and_b32_dpp v55, v28, v9 row_newbcast:13 row_mask:0xf bank_mask:0xf
  s_nop 1
  v_mfma_f32_16x16x32_bf16 v[32:35], v[52:55], v[64:67], v[32:35]
  s_waitcnt vmcnt(6)
  buffer_load_dwordx4 v[64:67], v1, s[8:11], s33 offen offset:1280 nt
  v_and_b32_dpp v48, v28, v6 row_newbcast:14 row_mask:0xf bank_mask:0xf
  v_and_b32_dpp v49, v28, v7 row_newbcast:14 row_mask:0xf bank_mask:0xf
  v_and_b32_dpp v50, v28, v8 row_newbcast:14 row_mask:0xf bank_mask:0xf
  v_and_b32_dpp v51, v28, v9 row_newbcast:14 row_mask:0xf bank_mask:0xf
  s_nop 1
  v_mfma_f32_16x16x32_bf16 v[32:35], v[48:51], v[68:71], v[32:35]
  s_waitcnt vmcnt(6)
  buffer_load_dwordx4 v[68:71], v1, s[8:11], s33 offen offset:1536 nt
  v_and_b32_dpp v52, v28, v6 row_newbcast:15 row_mask:0xf bank_mask:0xf
  v_and_b32_dpp v53, v28, v7 row_newbcast:15 row_mask:0xf bank_mask:0xf
  v_and_b32_dpp v54, v28, v8 row_newbcast:15 row_mask:0xf bank_mask:0xf
  v_and_b32_dpp v55, v28, v9 row_newbcast:15 row_mask:0xf bank_mask:0xf
  s_nop 1
  v_mfma_f32_16x16x32_bf16 v[32:35], v[52:55], v[72:75], v[32:35]
  s_waitcnt vmcnt(6)
  buffer_load_dwordx4 v[72:75], v1, s[8:11], s33 offen offset:1792 nt
  v_and_b32_dpp v48, v29, v6 row_newbcast:0 row_mask:0xf bank_mask:0xf
  v_and_b32_dpp v49, v29, v7 row_newbcast:0 row_mask:0xf bank_mask:0xf
  v_and_b32_dpp v50, v29, v8 row_newbcast:0 row_mask:0xf bank_mask:0xf
  v_and_b32_dpp v51, v29, v9 row_newbcast:0 row_mask:0xf bank_mask:0xf
  s_nop 1
  v_mfma_f32_16x16x32_bf16 v[32:35], v[48:51], v[76:79], v[32:35]
  s_waitcnt vmcnt(6)
  buffer_load_dwordx4 v[76:79], v1, s[8:11], s33 offen offset:2048 nt
  v_and_b32_dpp v52, v29, v6 row_newbcast:1 row_mask:0xf bank_mask:0xf
  v_and_b32_dpp v53, v29, v7 row_newbcast:1 row_mask:0xf bank_mask:0xf
  v_and_b32_dpp v54, v29, v8 row_newbcast:1 row_mask:0xf bank_mask:0xf
  v_and_b32_dpp v55, v29, v9 row_newbcast:1 row_mask:0xf bank_mask:0xf
  s_nop 1
  v_mfma_f32_16x16x32_bf16 v[32:35], v[52:55], v[80:83], v[32:35]
  s_waitcnt vmcnt(6)
  buffer_load_dwordx4 v[80:83], v1, s[8:11], s33 offen offset:2304 nt
  v_and_b32_dpp v48, v29, v6 row_newbcast:2 row_mask:0xf bank_mask:0xf
  v_and_b32_dpp v49, v29, v7 row_newbcast:2 row_mask:0xf bank_mask:0xf
  v_and_b32_dpp v50, v29, v8 row_newbcast:2 row_mask:0xf bank_mask:0xf
  v_and_b32_dpp v51, v29, v9 row_newbcast:2 row_mask:0xf bank_mask:0xf
  s_nop 1
  v_mfma_f32_16x16x32_bf16 v[32:35], v[48:51], v[84:87], v[32:35]
  s_waitcnt vmcnt(6)
  buffer_load_dwordx4 v[84:87], v1, s[8:11], s33 offen offset:2560 nt
  v_and_b32_dpp v52, v29, v6 row_newbcast:3 row_mask:0xf bank_mask:0xf
  v_and_b32_dpp v53, v29, v7 row_newbcast:3 row_mask:0xf bank_mask:0xf
  v_and_b32_dpp v54, v29, v8 row_newbcast:3 row_mask:0xf bank_mask:0xf
  v_and_b32_dpp v55, v29, v9 row_newbcast:3 row_mask:0xf bank_mask:0xf
  s_nop 1
  v_mfma_f32_16x16x32_bf16 v[32:35], v[52:55], v[88:91], v[32:35]
  s_waitcnt vmcnt(6)
  buffer_load_dwordx4 v[88:91], v1, s[8:11], s33 offen offset:2816 nt
  v_and_b32_dpp v48, v29, v6 row_newbcast:4 row_mask:0xf bank_mask:0xf
  v_and_b32_dpp v49, v29, v7 row_newbcast:4 row_mask:0xf bank_mask:0xf
  v_and_b32_dpp v50, v29, v8 row_newbcast:4 row_mask:0xf bank_mask:0xf
  v_and_b32_dpp v51, v29, v9 row_newbcast:4 row_mask:0xf bank_mask:0xf
  s_nop 1
  v_mfma_f32_16x16x32_bf16 v[32:35], v[48:51], v[60:63], v[32:35]
  s_waitcnt vmcnt(6)
  buffer_load_dwordx4 v[60:63], v1, s[8:11], s33 offen offset:3072 nt
  v_and_b32_dpp v52, v29, v6 row_newbcast:5 row_mask:0xf bank_mask:0xf
  v_and_b32_dpp v53, v29, v7 row_newbcast:5 row_mask:0xf bank_mask:0xf
  v_and_b32_dpp v54, v29, v8 row_newbcast:5 row_mask:0xf bank_mask:0xf
  v_and_b32_dpp v55, v29, v9 row_newbcast:5 row_mask:0xf bank_mask:0xf
  s_nop 1
  v_mfma_f32_16x16x32_bf16 v[32:35], v[52:55], v[64:67], v[32:35]
  s_waitcnt vmcnt(6)
  buffer_load_dwordx4 v[64:67], v1, s[8:11], s33 offen offset:3328 nt
  v_and_b32_dpp v48, v29, v6 row_newbcast:6 row_mask:0xf bank_mask:0xf
  v_and_b32_dpp v49, v29, v7 row_newbcast:6 row_mask:0xf bank_mask:0xf
  v_and_b32_dpp v50, v29, v8 row_newbcast:6 row_mask:0xf bank_mask:0xf
  v_and_b32_dpp v51, v29, v9 row_newbcast:6 row_mask:0xf bank_mask:0xf
  s_nop 1
  v_mfma_f32_16x16x32_bf16 v[32:35], v[48:51], v[68:71], v[32:35]
  s_waitcnt vmcnt(6)
  buffer_load_dwordx4 v[68:71], v1, s[8:11], s33 offen offset:3584 nt
  v_and_b32_dpp v52, v29, v6 row_newbcast:7 row_mask:0xf bank_mask:0xf
  v_and_b32_dpp v53, v29, v7 row_newbcast:7 row_mask:0xf bank_mask:0xf
  v_and_b32_dpp v54, v29, v8 row_newbcast:7 row_mask:0xf bank_mask:0xf
  v_and_b32_dpp v55, v29, v9 row_newbcast:7 row_mask:0xf bank_mask:0xf
  s_nop 1
  v_mfma_f32_16x16x32_bf16 v[32:35], v[52:55], v[72:75], v[32:35]
  s_waitcnt vmcnt(6)
  buffer_load_dwordx4 v[72:75], v1, s[8:11], s33 offen offset:3840 nt
  v_and_b32_dpp v48, v29, v6 row_newbcast:8 row_mask:0xf bank_mask:0xf
  v_and_b32_dpp v49, v29, v7 row_newbcast:8 row_mask:0xf bank_mask:0xf
  v_and_b32_dpp v50, v29, v8 row_newbcast:8 row_mask:0xf bank_mask:0xf
  v_and_b32_dpp v51, v29, v9 row_newbcast:8 row_mask:0xf bank_mask:0xf
  s_nop 1
  v_mfma_f32_16x16x32_bf16 v[32:35], v[48:51], v[76:79], v[32:35]
  s_waitcnt vmcnt(6)
  s_add_u32 s33, s28, 532480
  buffer_load_dwordx4 v[76:79], v2, s[8:11], s33 offen offset:0 nt
  v_and_b32_dpp v52, v29, v6 row_newbcast:9 row_mask:0xf bank_mask:0xf
  v_and_b32_dpp v53, v29, v7 row_newbcast:9 row_mask:0xf bank_mask:0xf
  v_and_b32_dpp v54, v29, v8 row_newbcast:9 row_mask:0xf bank_mask:0xf
  v_and_b32_dpp v55, v29, v9 row_newbcast:9 row_mask:0xf bank_mask:0xf
  s_nop 1
  v_mfma_f32_16x16x32_bf16 v[32:35], v[52:55], v[80:83], v[32:35]
  s_waitcnt vmcnt(6)
  buffer_load_dwordx4 v[80:83], v2, s[8:11], s33 offen offset:256 nt
  v_and_b32_dpp v48, v29, v6 row_newbcast:10 row_mask:0xf bank_mask:0xf
  v_and_b32_dpp v49, v29, v7 row_newbcast:10 row_mask:0xf bank_mask:0xf
  v_and_b32_dpp v50, v29, v8 row_newbcast:10 row_mask:0xf bank_mask:0xf
  v_and_b32_dpp v51, v29, v9 row_newbcast:10 row_mask:0xf bank_mask:0xf
  s_nop 1
  v_mfma_f32_16x16x32_bf16 v[32:35], v[48:51], v[84:87], v[32:35]
  s_waitcnt vmcnt(6)
  buffer_load_dwordx4 v[84:87], v2, s[8:11], s33 offen offset:512 nt
  v_and_b32_dpp v52, v29, v6 row_newbcast:11 row_mask:0xf bank_mask:0xf
  v_and_b32_dpp v53, v29, v7 row_newbcast:11 row_mask:0xf bank_mask:0xf
  v_and_b32_dpp v54, v29, v8 row_newbcast:11 row_mask:0xf bank_mask:0xf
  v_and_b32_dpp v55, v29, v9 row_newbcast:11 row_mask:0xf bank_mask:0xf
  s_nop 1
  v_mfma_f32_16x16x32_bf16 v[32:35], v[52:55], v[88:91], v[32:35]
  s_waitcnt vmcnt(6)
  buffer_load_dwordx4 v[88:91], v2, s[8:11], s33 offen offset:768 nt
  v_and_b32_dpp v48, v29, v6 row_newbcast:12 row_mask:0xf bank_mask:0xf
  v_and_b32_dpp v49, v29, v7 row_newbcast:12 row_mask:0xf bank_mask:0xf
  v_and_b32_dpp v50, v29, v8 row_newbcast:12 row_mask:0xf bank_mask:0xf
  v_and_b32_dpp v51, v29, v9 row_newbcast:12 row_mask:0xf bank_mask:0xf
  s_nop 1
  v_mfma_f32_16x16x32_bf16 v[32:35], v[48:51], v[60:63], v[32:35]
  s_waitcnt vmcnt(6)
  buffer_load_dwordx4 v[60:63], v2, s[8:11], s33 offen offset:1024 nt
  v_and_b32_dpp v52, v29, v6 row_newbcast:13 row_mask:0xf bank_mask:0xf
  v_and_b32_dpp v53, v29, v7 row_newbcast:13 row_mask:0xf bank_mask:0xf
  v_and_b32_dpp v54, v29, v8 row_newbcast:13 row_mask:0xf bank_mask:0xf
  v_and_b32_dpp v55, v29, v9 row_newbcast:13 row_mask:0xf bank_mask:0xf
  s_nop 1
  v_mfma_f32_16x16x32_bf16 v[32:35], v[52:55], v[64:67], v[32:35]
  s_waitcnt vmcnt(6)
  buffer_load_dwordx4 v[64:67], v2, s[8:11], s33 offen offset:1280 nt
  v_and_b32_dpp v48, v29, v6 row_newbcast:14 row_mask:0xf bank_mask:0xf
  v_and_b32_dpp v49, v29, v7 row_newbcast:14 row_mask:0xf bank_mask:0xf
  v_and_b32_dpp v50, v29, v8 row_newbcast:14 row_mask:0xf bank_mask:0xf
  v_and_b32_dpp v51, v29, v9 row_newbcast:14 row_mask:0xf bank_mask:0xf
  s_nop 1
  v_mfma_f32_16x16x32_bf16 v[32:35], v[48:51], v[68:71], v[32:35]
  s_waitcnt vmcnt(6)
  buffer_load_dwordx4 v[68:71], v2, s[8:11], s33 offen offset:1536 nt
  v_and_b32_dpp v52, v29, v6 row_newbcast:15 row_mask:0xf bank_mask:0xf
  v_and_b32_dpp v53, v29, v7 row_newbcast:15 row_mask:0xf bank_mask:0xf
  v_and_b32_dpp v54, v29, v8 row_newbcast:15 row_mask:0xf bank_mask:0xf
  v_and_b32_dpp v55, v29, v9 row_newbcast:15 row_mask:0xf bank_mask:0xf
  s_nop 1
  v_mfma_f32_16x16x32_bf16 v[32:35], v[52:55], v[72:75], v[32:35]
  s_waitcnt vmcnt(6)
  buffer_load_dwordx4 v[72:75], v2, s[8:11], s33 offen offset:1792 nt
  v_and_b32_dpp v48, v30, v6 row_newbcast:0 row_mask:0xf bank_mask:0xf
  v_and_b32_dpp v49, v30, v7 row_newbcast:0 row_mask:0xf bank_mask:0xf
  v_and_b32_dpp v50, v30, v8 row_newbcast:0 row_mask:0xf bank_mask:0xf
  v_and_b32_dpp v51, v30, v9 row_newbcast:0 row_mask:0xf bank_mask:0xf
  s_nop 1
  v_mfma_f32_16x16x32_bf16 v[32:35], v[48:51], v[76:79], v[32:35]
  s_waitcnt vmcnt(6)
  s_mov_b32 s33, s30
  s_mov_b64 exec, s[42:43]
  buffer_load_dwordx4 v[76:79], v3, s[8:11], s33 offen offset:0 nt
  s_mov_b64 exec, -1
  v_and_b32_dpp v52, v30, v6 row_newbcast:1 row_mask:0xf bank_mask:0xf
  v_and_b32_dpp v53, v30, v7 row_newbcast:1 row_mask:0xf bank_mask:0xf
  v_and_b32_dpp v54, v30, v8 row_newbcast:1 row_mask:0xf bank_mask:0xf
  v_and_b32_dpp v55, v30, v9 row_newbcast:1 row_mask:0xf bank_mask:0xf
  s_nop 1
  v_mfma_f32_16x16x32_bf16 v[32:35], v[52:55], v[80:83], v[32:35]
  s_waitcnt vmcnt(6)
  s_mov_b64 exec, s[42:43]
  buffer_load_dwordx4 v[80:83], v3, s[8:11], s33 offen offset:1024 nt
  s_mov_b64 exec, -1
  v_and_b32_dpp v48, v30, v6 row_newbcast:2 row_mask:0xf bank_mask:0xf
  v_and_b32_dpp v49, v30, v7 row_newbcast:2 row_mask:0xf bank_mask:0xf
  v_and_b32_dpp v50, v30, v8 row_newbcast:2 row_mask:0xf bank_mask:0xf
  v_and_b32_dpp v51, v30, v9 row_newbcast:2 row_mask:0xf bank_mask:0xf
  s_nop 1
  v_mfma_f32_16x16x32_bf16 v[32:35], v[48:51], v[84:87], v[32:35]
  s_waitcnt vmcnt(6)
  s_mov_b64 exec, s[44:45]
  buffer_load_dwordx4 v[84:87], v3, s[8:11], s33 offen offset:2048 nt
  s_mov_b64 exec, -1
  v_and_b32_dpp v52, v30, v6 row_newbcast:3 row_mask:0xf bank_mask:0xf
  v_and_b32_dpp v53, v30, v7 row_newbcast:3 row_mask:0xf bank_mask:0xf
  v_and_b32_dpp v54, v30, v8 row_newbcast:3 row_mask:0xf bank_mask:0xf
  v_and_b32_dpp v55, v30, v9 row_newbcast:3 row_mask:0xf bank_mask:0xf
  s_nop 1
  v_mfma_f32_16x16x32_bf16 v[32:35], v[52:55], v[88:91], v[32:35]
  s_waitcnt vmcnt(6)
  s_mov_b64 exec, s[44:45]
  buffer_load_dwordx4 v[88:91], v3, s[8:11], s33 offen offset:3072 nt
  s_mov_b64 exec, -1
  v_and_b32_dpp v48, v30, v6 row_newbcast:4 row_mask:0xf bank_mask:0xf
  v_and_b32_dpp v49, v30, v7 row_newbcast:4 row_mask:0xf bank_mask:0xf
  v_and_b32_dpp v50, v30, v8 row_newbcast:4 row_mask:0xf bank_mask:0xf
  v_and_b32_dpp v51, v30, v9 row_newbcast:4 row_mask:0xf bank_mask:0xf
  s_nop 1
  v_mfma_f32_16x16x32_bf16 v[32:35], v[48:51], v[60:63], v[32:35]
  s_waitcnt vmcnt(6)
  s_add_u32 s32, s29, 262144
  buffer_load_dwordx4 v[60:63], v0, s[4:7], s32 offen offset:0
  v_and_b32_dpp v52, v30, v6 row_newbcast:5 row_mask:0xf bank_mask:0xf
  v_and_b32_dpp v53, v30, v7 row_newbcast:5 row_mask:0xf bank_mask:0xf
  v_and_b32_dpp v54, v30, v8 row_newbcast:5 row_mask:0xf bank_mask:0xf
  v_and_b32_dpp v55, v30, v9 row_newbcast:5 row_mask:0xf bank_mask:0xf
  s_nop 1
  v_mfma_f32_16x16x32_bf16 v[32:35], v[52:55], v[64:67], v[32:35]
  s_waitcnt vmcnt(6)
  buffer_load_dwordx4 v[64:67], v0, s[4:7], s32 offen offset:128
  v_and_b32_dpp v48, v30, v6 row_newbcast:6 row_mask:0xf bank_mask:0xf
  v_and_b32_dpp v49, v30, v7 row_newbcast:6 row_mask:0xf bank_mask:0xf
  v_and_b32_dpp v50, v30, v8 row_newbcast:6 row_mask:0xf bank_mask:0xf
  v_and_b32_dpp v51, v30, v9 row_newbcast:6 row_mask:0xf bank_mask:0xf
  s_nop 1
  v_mfma_f32_16x16x32_bf16 v[32:35], v[48:51], v[68:71], v[32:35]
  s_waitcnt vmcnt(6)
  buffer_load_dwordx4 v[68:71], v0, s[4:7], s32 offen offset:2048
  v_and_b32_dpp v52, v30, v6 row_newbcast:7 row_mask:0xf bank_mask:0xf
  v_and_b32_dpp v53, v30, v7 row_newbcast:7 row_mask:0xf bank_mask:0xf
  v_and_b32_dpp v54, v30, v8 row_newbcast:7 row_mask:0xf bank_mask:0xf
  v_and_b32_dpp v55, v30, v9 row_newbcast:7 row_mask:0xf bank_mask:0xf
  s_nop 1
  v_mfma_f32_16x16x32_bf16 v[32:35], v[52:55], v[72:75], v[32:35]
  s_waitcnt vmcnt(6)
  buffer_load_dwordx4 v[72:75], v0, s[4:7], s32 offen offset:2176
  v_and_b32_dpp v48, v31, v6 row_newbcast:0 row_mask:0xf bank_mask:0xf
  v_and_b32_dpp v49, v31, v7 row_newbcast:0 row_mask:0xf bank_mask:0xf
  v_and_b32_dpp v50, v31, v8 row_newbcast:0 row_mask:0xf bank_mask:0xf
  v_and_b32_dpp v51, v31, v9 row_newbcast:0 row_mask:0xf bank_mask:0xf
  s_nop 1
  v_mfma_f32_16x16x32_bf16 v[32:35], v[48:51], v[76:79], v[32:35]
  s_waitcnt vmcnt(6)
  s_add_u32 s32, s29, 266240
  buffer_load_dwordx4 v[76:79], v0, s[4:7], s32 offen offset:0
  v_and_b32_dpp v52, v31, v6 row_newbcast:1 row_mask:0xf bank_mask:0xf
  v_and_b32_dpp v53, v31, v7 row_newbcast:1 row_mask:0xf bank_mask:0xf
  v_and_b32_dpp v54, v31, v8 row_newbcast:1 row_mask:0xf bank_mask:0xf
  v_and_b32_dpp v55, v31, v9 row_newbcast:1 row_mask:0xf bank_mask:0xf
  s_nop 1
  v_mfma_f32_16x16x32_bf16 v[32:35], v[52:55], v[80:83], v[32:35]
  s_waitcnt vmcnt(6)
  buffer_load_dwordx4 v[80:83], v0, s[4:7], s32 offen offset:128
  v_and_b32_dpp v48, v31, v6 row_newbcast:2 row_mask:0xf bank_mask:0xf
  v_and_b32_dpp v49, v31, v7 row_newbcast:2 row_mask:0xf bank_mask:0xf
  v_and_b32_dpp v50, v31, v8 row_newbcast:2 row_mask:0xf bank_mask:0xf
  v_and_b32_dpp v51, v31, v9 row_newbcast:2 row_mask:0xf bank_mask:0xf
  s_nop 1
  v_mfma_f32_16x16x32_bf16 v[32:35], v[48:51], v[84:87], v[32:35]
  s_waitcnt vmcnt(6)
  buffer_load_dwordx4 v[84:87], v0, s[4:7], s32 offen offset:2048
  v_and_b32_dpp v52, v31, v6 row_newbcast:3 row_mask:0xf bank_mask:0xf
  v_and_b32_dpp v53, v31, v7 row_newbcast:3 row_mask:0xf bank_mask:0xf
  v_and_b32_dpp v54, v31, v8 row_newbcast:3 row_mask:0xf bank_mask:0xf
  v_and_b32_dpp v55, v31, v9 row_newbcast:3 row_mask:0xf bank_mask:0xf
  s_nop 1
  v_mfma_f32_16x16x32_bf16 v[32:35], v[52:55], v[88:91], v[32:35]
  v_add_f32_dpp v10, v10, v10 row_ror:8 row_mask:0xf bank_mask:0xf
  s_nop 1
  v_add_f32_dpp v10, v10, v10 row_ror:4 row_mask:0xf bank_mask:0xf
  s_nop 1
  v_add_f32_dpp v10, v10, v10 row_ror:2 row_mask:0xf bank_mask:0xf
  s_nop 1
  v_add_f32_dpp v10, v10, v10 row_ror:1 row_mask:0xf bank_mask:0xf
  s_nop 1
  v_add_f32_dpp v10, v10, v10 row_bcast:15 row_mask:0xa bank_mask:0xf
  s_nop 1
  v_add_f32_dpp v10, v10, v10 row_bcast:31 row_mask:0xc bank_mask:0xf
  v_lshrrev_b32 v45, 4, v3
  v_and_b32 v40, 15, v45
  v_lshlrev_b32 v40, 5, v40
  v_lshrrev_b32 v41, 4, v45
  v_lshl_add_u32 v40, v41, 4, v40
  s_mul_i32 s46, s25, 28
  s_add_u32 s46, s46, s40
  s_lshl_b32 s46, s46, 9
  s_add_u32 s46, s46, 0
  s_mov_b32 exec_hi, 0
  buffer_store_dwordx4 v[32:35], v40, s[12:15], s46 offen sc1
  s_lshl_b32 s46, s25, 8
  s_lshl_b32 s47, s40, 3
  s_add_u32 s46, s46, s47
  s_add_u32 s46, s46, 1835008
  s_mov_b64 exec, -1
  v_mov_b32 v42, s36
  v_mov_b32 v43, v10
  v_mov_b32 v44, 0
  s_mov_b32 exec_lo, 0
  s_mov_b32 exec_hi, 0x80000000
  buffer_store_dwordx2 v[42:43], v44, s[12:15], s46 offen sc1
  s_mov_b64 exec, -1
  v_lshrrev_b32 v41, 4, v3
  v_and_b32 v40, 1, v41
  v_lshlrev_b32 v40, 6, v40
  v_lshrrev_b32 v41, 4, v41
  v_lshl_add_u32 v40, v41, 4, v40
  v_add_u32 v40, s35, v40
  ds_read_b128 v[12:15], v40 offset:256
  ds_read_b128 v[16:19], v40 offset:384
  s_waitcnt lgkmcnt(0)
  v_max3_u32 v42, v12, v13, v14
  v_max3_u32 v42, v42, v15, v16
  v_max3_u32 v42, v42, v17, v18
  v_max_u32 v42, v42, v19
  v_cmp_eq_u32 vcc, -1, v42
  s_nop 0
  s_cmp_lg_u64 vcc, 0
  s_nop 2
  s_cbranch_scc0 qok_6
qretry_7:
  s_sleep 2
  s_lshl_b32 s46, s25, 8
  s_add_u32 s46, s46, 2408448
  s_add_u32 m0, s35, 256
  v_lshrrev_b32 v59, 2, v3
  buffer_load_dword v59, s[12:15], s46 offen sc1 lds
  s_waitcnt vmcnt(0)
  v_lshrrev_b32 v41, 4, v3
  v_and_b32 v40, 1, v41
  v_lshlrev_b32 v40, 6, v40
  v_lshrrev_b32 v41, 4, v41
  v_lshl_add_u32 v40, v41, 4, v40
  v_add_u32 v40, s35, v40
  ds_read_b128 v[12:15], v40 offset:256
  ds_read_b128 v[16:19], v40 offset:384
  s_waitcnt lgkmcnt(0)
  v_max3_u32 v42, v12, v13, v14
  v_max3_u32 v42, v42, v15, v16
  v_max3_u32 v42, v42, v17, v18
  v_max_u32 v42, v42, v19
  v_cmp_eq_u32 vcc, -1, v42
  s_nop 0
  s_cmp_lg_u64 vcc, 0
  s_cbranch_scc0 qok_6
  s_sub_u32 s39, s39, 1
  s_cmp_gt_i32 s39, 0
  s_cbranch_scc1 qretry_7
qok_6:
  s_waitcnt vmcnt(8)
  buffer_load_dwordx4 v[88:91], v0, s[4:7], s32 offen offset:2176
  s_waitcnt vmcnt(8)
  v_mfma_f32_16x16x32_bf16 v[40:43], v[12:15], v[60:63], 0
  v_mfma_f32_16x16x32_bf16 v[40:43], v[16:19], v[64:67], v[40:43]
  s_add_u32 s32, s29, 270336
  buffer_load_dwordx4 v[60:63], v0, s[4:7], s32 offen offset:0
  s_waitcnt vmcnt(8)
  buffer_load_dwordx4 v[64:67], v0, s[4:7], s32 offen offset:128
  s_waitcnt vmcnt(8)
  v_mfma_f32_16x16x32_bf16 v[44:47], v[12:15], v[68:71], 0
  v_mfma_f32_16x16x32_bf16 v[44:47], v[16:19], v[72:75], v[44:47]
  buffer_load_dwordx4 v[68:71], v0, s[4:7], s32 offen offset:2048
  s_waitcnt vmcnt(8)
  buffer_load_dwordx4 v[72:75], v0, s[4:7], s32 offen offset:2176
  s_waitcnt vmcnt(8)
  v_add_f32_dpp v26, v41, v40 row_ror:8 row_mask:0x1 bank_mask:0x3
  v_mfma_f32_16x16x32_bf16 v[40:43], v[12:15], v[76:79], 0
  v_mfma_f32_16x16x32_bf16 v[40:43], v[16:19], v[80:83], v[40:43]
  s_add_u32 s32, s29, 274432
  buffer_load_dwordx4 v[76:79], v0, s[4:7], s32 offen offset:0
  s_waitcnt vmcnt(8)
  buffer_load_dwordx4 v[80:83], v0, s[4:7], s32 offen offset:128
  s_waitcnt vmcnt(6)
  v_add_f32_dpp v26, v44, v45 row_ror:8 row_mask:0x1 bank_mask:0xc
  v_mfma_f32_16x16x32_bf16 v[44:47], v[12:15], v[84:87], 0
  v_mfma_f32_16x16x32_bf16 v[44:47], v[16:19], v[88:91], v[44:47]
  buffer_load_dwordx4 v[84:87], v0, s[4:7], s32 offen offset:2048
  s_waitcnt vmcnt(6)
  buffer_load_dwordx4 v[88:91], v0, s[4:7], s32 offen offset:2176
  s_waitcnt vmcnt(6)
  v_add_f32_dpp v26, v41, v40 row_ror:8 row_mask:0x2 bank_mask:0x3
  v_mfma_f32_16x16x32_bf16 v[40:43], v[12:15], v[60:63], 0
  v_mfma_f32_16x16x32_bf16 v[40:43], v[16:19], v[64:67], v[40:43]
  s_add_u32 s32, s29, 327680
  buffer_load_dwordx4 v[60:63], v0, s[4:7], s32 offen offset:0
  s_waitcnt vmcnt(6)
  buffer_load_dwordx4 v[64:67], v0, s[4:7], s32 offen offset:128
  s_waitcnt vmcnt(6)
  v_add_f32_dpp v26, v44, v45 row_ror:8 row_mask:0x2 bank_mask:0xc
  v_mfma_f32_16x16x32_bf16 v[44:47], v[12:15], v[68:71], 0
  v_mfma_f32_16x16x32_bf16 v[44:47], v[16:19], v[72:75], v[44:47]
  buffer_load_dwordx4 v[68:71], v0, s[4:7], s32 offen offset:2048
  s_waitcnt vmcnt(6)
  buffer_load_dwordx4 v[72:75], v0, s[4:7], s32 offen offset:2176
  s_waitcnt vmcnt(6)
  v_add_f32_dpp v26, v41, v40 row_ror:8 row_mask:0x4 bank_mask:0x3
  v_mfma_f32_16x16x32_bf16 v[40:43], v[12:15], v[76:79], 0
  v_mfma_f32_16x16x32_bf16 v[40:43], v[16:19], v[80:83], v[40:43]
  s_add_u32 s32, s29, 331776
  buffer_load_dwordx4 v[76:79], v0, s[4:7], s32 offen offset:0
  s_waitcnt vmcnt(6)
  buffer_load_dwordx4 v[80:83], v0, s[4:7], s32 offen offset:128
  s_waitcnt vmcnt(6)
  v_add_f32_dpp v26, v44, v45 row_ror:8 row_mask:0x4 bank_mask:0xc
  v_mfma_f32_16x16x32_bf16 v[44:47], v[12:15], v[84:87], 0
  v_mfma_f32_16x16x32_bf16 v[44:47], v[16:19], v[88:91], v[44:47]
  buffer_load_dwordx4 v[84:87], v0, s[4:7], s32 offen offset:2048
  s_waitcnt vmcnt(6)
  buffer_load_dwordx4 v[88:91], v0, s[4:7], s32 offen offset:2176
  s_waitcnt vmcnt(6)
  v_add_f32_dpp v26, v41, v40 row_ror:8 row_mask:0x8 bank_mask:0x3
  v_mfma_f32_16x16x32_bf16 v[40:43], v[12:15], v[60:63], 0
  v_mfma_f32_16x16x32_bf16 v[40:43], v[16:19], v[64:67], v[40:43]
  s_add_u32 s32, s29, 335872
  buffer_load_dwordx4 v[60:63], v0, s[4:7], s32 offen offset:0
  s_waitcnt vmcnt(6)
  buffer_load_dwordx4 v[64:67], v0, s[4:7], s32 offen offset:128
  s_waitcnt vmcnt(6)
  v_add_f32_dpp v26, v44, v45 row_ror:8 row_mask:0x8 bank_mask:0xc
  v_mfma_f32_16x16x32_bf16 v[44:47], v[12:15], v[68:71], 0
  v_mfma_f32_16x16x32_bf16 v[44:47], v[16:19], v[72:75], v[44:47]
  buffer_load_dwordx4 v[68:71], v0, s[4:7], s32 offen offset:2048
  s_waitcnt vmcnt(6)
  buffer_load_dwordx4 v[72:75], v0, s[4:7], s32 offen offset:2176
  s_waitcnt vmcnt(6)
  v_add_f32_dpp v27, v41, v40 row_ror:8 row_mask:0x1 bank_mask:0x3
  v_mfma_f32_16x16x32_bf16 v[40:43], v[12:15], v[76:79], 0
  v_mfma_f32_16x16x32_bf16 v[40:43], v[16:19], v[80:83], v[40:43]
  s_add_u32 s32, s29, 339968
  buffer_load_dwordx4 v[76:79], v0, s[4:7], s32 offen offset:0
  s_waitcnt vmcnt(6)
  buffer_load_dwordx4 v[80:83], v0, s[4:7], s32 offen offset:128
  s_waitcnt vmcnt(6)
  v_add_f32_dpp v27, v44, v45 row_ror:8 row_mask:0x1 bank_mask:0xc
  v_mfma_f32_16x16x32_bf16 v[44:47], v[12:15], v[84:87], 0
  v_mfma_f32_16x16x32_bf16 v[44:47], v[16:19], v[88:91], v[44:47]
  buffer_load_dwordx4 v[84:87], v0, s[4:7], s32 offen offset:2048
  s_waitcnt vmcnt(6)
  buffer_load_dwordx4 v[88:91], v0, s[4:7], s32 offen offset:2176
  s_waitcnt vmcnt(6)
  v_add_f32_dpp v27, v41, v40 row_ror:8 row_mask:0x2 bank_mask:0x3
  v_mfma_f32_16x16x32_bf16 v[40:43], v[12:15], v[60:63], 0
  v_mfma_f32_16x16x32_bf16 v[40:43], v[16:19], v[64:67], v[40:43]
  s_add_u32 s32, s29, 393216
  buffer_load_dwordx4 v[60:63], v0, s[4:7], s32 offen offset:0
  s_waitcnt vmcnt(6)
  buffer_load_dwordx4 v[64:67], v0, s[4:7], s32 offen offset:128
  s_waitcnt vmcnt(6)
  v_add_f32_dpp v27, v44, v45 row_ror:8 row_mask:0x2 bank_mask:0xc
  v_mfma_f32_16x16x32_bf16 v[44:47], v[12:15], v[68:71], 0
  v_mfma_f32_16x16x32_bf16 v[44:47], v[16:19], v[72:75], v[44:47]
  buffer_load_dwordx4 v[68:71], v0, s[4:7], s32 offen offset:2048
  s_waitcnt vmcnt(6)
  buffer_load_dwordx4 v[72:75], v0, s[4:7], s32 offen offset:2176
  s_waitcnt vmcnt(6)
  v_add_f32_dpp v27, v41, v40 row_ror:8 row_mask:0x4 bank_mask:0x3
  v_mfma_f32_16x16x32_bf16 v[40:43], v[12:15], v[76:79], 0
  v_mfma_f32_16x16x32_bf16 v[40:43], v[16:19], v[80:83], v[40:43]
  s_add_u32 s32, s29, 397312
  buffer_load_dwordx4 v[76:79], v0, s[4:7], s32 offen offset:0
  s_waitcnt vmcnt(6)
  buffer_load_dwordx4 v[80:83], v0, s[4:7], s32 offen offset:128
  s_waitcnt vmcnt(6)
  v_add_f32_dpp v27, v44, v45 row_ror:8 row_mask:0x4 bank_mask:0xc
  v_mfma_f32_16x16x32_bf16 v[44:47], v[12:15], v[84:87], 0
  v_mfma_f32_16x16x32_bf16 v[44:47], v[16:19], v[88:91], v[44:47]
  buffer_load_dwordx4 v[84:87], v0, s[4:7], s32 offen offset:2048
  s_waitcnt vmcnt(6)
  buffer_load_dwordx4 v[88:91], v0, s[4:7], s32 offen offset:2176
  s_waitcnt vmcnt(6)
  v_add_f32_dpp v27, v41, v40 row_ror:8 row_mask:0x8 bank_mask:0x3
  v_mfma_f32_16x16x32_bf16 v[40:43], v[12:15], v[60:63], 0
  v_mfma_f32_16x16x32_bf16 v[40:43], v[16:19], v[64:67], v[40:43]
  s_add_u32 s32, s29, 401408
  buffer_load_dwordx4 v[60:63], v0, s[4:7], s32 offen offset:0 nt
  s_waitcnt vmcnt(6)
  buffer_load_dwordx4 v[64:67], v0, s[4:7], s32 offen offset:128 nt
  s_waitcnt vmcnt(6)
  v_add_f32_dpp v27, v44, v45 row_ror:8 row_mask:0x8 bank_mask:0xc
  v_mfma_f32_16x16x32_bf16 v[44:47], v[12:15], v[68:71], 0
  v_mfma_f32_16x16x32_bf16 v[44:47], v[16:19], v[72:75], v[44:47]
  buffer_load_dwordx4 v[68:71], v0, s[4:7], s32 offen offset:2048 nt
  s_waitcnt vmcnt(6)
  buffer_load_dwordx4 v[72:75], v0, s[4:7], s32 offen offset:2176 nt
  s_waitcnt vmcnt(6)
  v_add_f32_dpp v28, v41, v40 row_ror:8 row_mask:0x1 bank_mask:0x3
  v_mfma_f32_16x16x32_bf16 v[40:43], v[12:15], v[76:79], 0
  v_mfma_f32_16x16x32_bf16 v[40:43], v[16:19], v[80:83], v[40:43]
  s_add_u32 s32, s29, 405504
  buffer_load_dwordx4 v[76:79], v0, s[4:7], s32 offen offset:0 nt
  s_waitcnt vmcnt(6)
  buffer_load_dwordx4 v[80:83], v0, s[4:7], s32 offen offset:128 nt
  s_waitcnt vmcnt(6)
  v_add_f32_dpp v28, v44, v45 row_ror:8 row_mask:0x1 bank_mask:0xc
  v_mfma_f32_16x16x32_bf16 v[44:47], v[12:15], v[84:87], 0
  v_mfma_f32_16x16x32_bf16 v[44:47], v[16:19], v[88:91], v[44:47]
  buffer_load_dwordx4 v[84:87], v0, s[4:7], s32 offen offset:2048 nt
  s_waitcnt vmcnt(6)
  buffer_load_dwordx4 v[88:91], v0, s[4:7], s32 offen offset:2176 nt
  s_waitcnt vmcnt(6)
  v_add_f32_dpp v28, v41, v40 row_ror:8 row_mask:0x2 bank_mask:0x3
  v_mfma_f32_16x16x32_bf16 v[40:43], v[12:15], v[60:63], 0
  v_mfma_f32_16x16x32_bf16 v[40:43], v[16:19], v[64:67], v[40:43]
  s_add_u32 s32, s29, 458752
  buffer_load_dwordx4 v[60:63], v0, s[4:7], s32 offen offset:0 nt
  s_waitcnt vmcnt(6)
  buffer_load_dwordx4 v[64:67], v0, s[4:7], s32 offen offset:128 nt
  s_waitcnt vmcnt(6)
  v_add_f32_dpp v28, v44, v45 row_ror:8 row_mask:0x2 bank_mask:0xc
  v_mfma_f32_16x16x32_bf16 v[44:47], v[12:15], v[68:71], 0
  v_mfma_f32_16x16x32_bf16 v[44:47], v[16:19], v[72:75], v[44:47]
  buffer_load_dwordx4 v[68:71], v0, s[4:7], s32 offen offset:2048 nt
  s_waitcnt vmcnt(6)
  buffer_load_dwordx4 v[72:75], v0, s[4:7], s32 offen offset:2176 nt
  s_waitcnt vmcnt(6)
  v_add_f32_dpp v28, v41, v40 row_ror:8 row_mask:0x4 bank_mask:0x3
  v_mfma_f32_16x16x32_bf16 v[40:43], v[12:15], v[76:79], 0
  v_mfma_f32_16x16x32_bf16 v[40:43], v[16:19], v[80:83], v[40:43]
  s_add_u32 s32, s29, 462848
  buffer_load_dwordx4 v[76:79], v0, s[4:7], s32 offen offset:0 nt
  s_waitcnt vmcnt(6)
  buffer_load_dwordx4 v[80:83], v0, s[4:7], s32 offen offset:128 nt
  s_waitcnt vmcnt(6)
  v_add_f32_dpp v28, v44, v45 row_ror:8 row_mask:0x4 bank_mask:0xc
  v_mfma_f32_16x16x32_bf16 v[44:47], v[12:15], v[84:87], 0
  v_mfma_f32_16x16x32_bf16 v[44:47], v[16:19], v[88:91], v[44:47]
  buffer_load_dwordx4 v[84:87], v0, s[4:7], s32 offen offset:2048 nt
  s_waitcnt vmcnt(6)
  buffer_load_dwordx4 v[88:91], v0, s[4:7], s32 offen offset:2176 nt
  s_waitcnt vmcnt(6)
  v_add_f32_dpp v28, v41, v40 row_ror:8 row_mask:0x8 bank_mask:0x3
  v_mfma_f32_16x16x32_bf16 v[40:43], v[12:15], v[60:63], 0
  v_mfma_f32_16x16x32_bf16 v[40:43], v[16:19], v[64:67], v[40:43]
  s_add_u32 s32, s29, 466944
  buffer_load_dwordx4 v[60:63], v0, s[4:7], s32 offen offset:0 nt
  s_waitcnt vmcnt(6)
  buffer_load_dwordx4 v[64:67], v0, s[4:7], s32 offen offset:128 nt
  s_waitcnt vmcnt(6)
  v_add_f32_dpp v28, v44, v45 row_ror:8 row_mask:0x8 bank_mask:0xc
  v_mfma_f32_16x16x32_bf16 v[44:47], v[12:15], v[68:71], 0
  v_mfma_f32_16x16x32_bf16 v[44:47], v[16:19], v[72:75], v[44:47]
  buffer_load_dwordx4 v[68:71], v0, s[4:7], s32 offen offset:2048 nt
  s_waitcnt vmcnt(6)
  buffer_load_dwordx4 v[72:75], v0, s[4:7], s32 offen offset:2176 nt
  s_waitcnt vmcnt(6)
  v_add_f32_dpp v29, v41, v40 row_ror:8 row_mask:0x1 bank_mask:0x3
  v_mfma_f32_16x16x32_bf16 v[40:43], v[12:15], v[76:79], 0
  v_mfma_f32_16x16x32_bf16 v[40:43], v[16:19], v[80:83], v[40:43]
  s_add_u32 s32, s29, 471040
  buffer_load_dwordx4 v[76:79], v0, s[4:7], s32 offen offset:0 nt
  s_waitcnt vmcnt(6)
  buffer_load_dwordx4 v[80:83], v0, s[4:7], s32 offen offset:128 nt
  s_waitcnt vmcnt(6)
  v_add_f32_dpp v29, v44, v45 row_ror:8 row_mask:0x1 bank_mask:0xc
  v_mfma_f32_16x16x32_bf16 v[44:47], v[12:15], v[84:87], 0
  v_mfma_f32_16x16x32_bf16 v[44:47], v[16:19], v[88:91], v[44:47]
  buffer_load_dwordx4 v[84:87], v0, s[4:7], s32 offen offset:2048 nt
  s_waitcnt vmcnt(6)
  buffer_load_dwordx4 v[88:91], v0, s[4:7], s32 offen offset:2176 nt
  s_waitcnt vmcnt(6)
  v_add_f32_dpp v29, v41, v40 row_ror:8 row_mask:0x2 bank_mask:0x3
  v_mfma_f32_16x16x32_bf16 v[40:43], v[12:15], v[60:63], 0
  v_mfma_f32_16x16x32_bf16 v[40:43], v[16:19], v[64:67], v[40:43]
  s_add_u32 s32, s29, 532480
  buffer_load_dwordx4 v[60:63], v0, s[4:7], s32 offen offset:0 nt
  s_waitcnt vmcnt(6)
  buffer_load_dwordx4 v[64:67], v0, s[4:7], s32 offen offset:128 nt
  s_waitcnt vmcnt(6)
  v_add_f32_dpp v29, v44, v45 row_ror:8 row_mask:0x2 bank_mask:0xc
  v_mfma_f32_16x16x32_bf16 v[44:47], v[12:15], v[68:71], 0
  v_mfma_f32_16x16x32_bf16 v[44:47], v[16:19], v[72:75], v[44:47]
  buffer_load_dwordx4 v[68:71], v0, s[4:7], s32 offen offset:2048 nt
  s_waitcnt vmcnt(6)
  buffer_load_dwordx4 v[72:75], v0, s[4:7], s32 offen offset:2176 nt
  s_waitcnt vmcnt(6)
  v_add_f32_dpp v29, v41, v40 row_ror:8 row_mask:0x4 bank_mask:0x3
  v_mfma_f32_16x16x32_bf16 v[40:43], v[12:15], v[76:79], 0
  v_mfma_f32_16x16x32_bf16 v[40:43], v[16:19], v[80:83], v[40:43]
  s_add_u32 s32, s29, 536576
  buffer_load_dwordx4 v[76:79], v0, s[4:7], s32 offen offset:0 nt
  s_waitcnt vmcnt(6)
  buffer_load_dwordx4 v[80:83], v0, s[4:7], s32 offen offset:128 nt
  s_waitcnt vmcnt(6)
  v_add_f32_dpp v29, v44, v45 row_ror:8 row_mask:0x4 bank_mask:0xc
  v_mfma_f32_16x16x32_bf16 v[44:47], v[12:15], v[84:87], 0
  v_mfma_f32_16x16x32_bf16 v[44:47], v[16:19], v[88:91], v[44:47]
  buffer_load_dwordx4 v[84:87], v0, s[4:7], s32 offen offset:2048 nt
  s_waitcnt vmcnt(6)
  buffer_load_dwordx4 v[88:91], v0, s[4:7], s32 offen offset:2176 nt
  s_waitcnt vmcnt(6)
  v_mov_b32 v30, 0xff800000
  v_add_f32_dpp v29, v41, v40 row_ror:8 row_mask:0x8 bank_mask:0x3
  v_mfma_f32_16x16x32_bf16 v[40:43], v[12:15], v[60:63], 0
  v_mfma_f32_16x16x32_bf16 v[40:43], v[16:19], v[64:67], v[40:43]
  s_mov_b32 s32, s31
  s_mov_b64 exec, s[42:43]
  buffer_load_dwordx4 v[60:63], v0, s[4:7], s32 offen offset:0 nt
  s_mov_b64 exec, -1
  s_waitcnt vmcnt(6)
  s_mov_b64 exec, s[42:43]
  buffer_load_dwordx4 v[64:67], v0, s[4:7], s32 offen offset:128 nt
  s_mov_b64 exec, -1
  s_waitcnt vmcnt(6)
  v_add_f32_dpp v29, v44, v45 row_ror:8 row_mask:0x8 bank_mask:0xc
  v_mfma_f32_16x16x32_bf16 v[44:47], v[12:15], v[68:71], 0
  v_mfma_f32_16x16x32_bf16 v[44:47], v[16:19], v[72:75], v[44:47]
  s_mov_b64 exec, s[44:45]
  buffer_load_dwordx4 v[68:71], v0, s[4:7], s32 offen offset:2048 nt
  s_mov_b64 exec, -1
  s_waitcnt vmcnt(6)
  s_mov_b64 exec, s[44:45]
  buffer_load_dwordx4 v[72:75], v0, s[4:7], s32 offen offset:2176 nt
  s_mov_b64 exec, -1
  s_waitcnt vmcnt(6)
  v_add_f32_dpp v30, v41, v40 row_ror:8 row_mask:0x1 bank_mask:0x3
  v_mfma_f32_16x16x32_bf16 v[40:43], v[12:15], v[76:79], 0
  v_mfma_f32_16x16x32_bf16 v[40:43], v[16:19], v[80:83], v[40:43]
  s_add_u32 s33, s29, 262144
  buffer_load_dwordx4 v[76:79], v1, s[8:11], s33 offen offset:0
  s_waitcnt vmcnt(6)
  buffer_load_dwordx4 v[80:83], v1, s[8:11], s33 offen offset:256
  s_waitcnt vmcnt(6)
  v_add_f32_dpp v30, v45, v44 row_ror:8 row_mask:0x2 bank_mask:0x3
  v_mfma_f32_16x16x32_bf16 v[44:47], v[12:15], v[84:87], 0
  v_mfma_f32_16x16x32_bf16 v[44:47], v[16:19], v[88:91], v[44:47]
  buffer_load_dwordx4 v[84:87], v1, s[8:11], s33 offen offset:512
  s_waitcnt vmcnt(6)
  buffer_load_dwordx4 v[88:91], v1, s[8:11], s33 offen offset:768
  s_waitcnt vmcnt(6)
  v_mov_b32 v31, 0xff800000
  v_add_f32_dpp v30, v41, v40 row_ror:8 row_mask:0x4 bank_mask:0x3
  v_mfma_f32_16x16x32_bf16 v[40:43], v[12:15], v[60:63], 0
  v_mfma_f32_16x16x32_bf16 v[40:43], v[16:19], v[64:67], v[40:43]
  buffer_load_dwordx4 v[60:63], v1, s[8:11], s33 offen offset:1024
  s_waitcnt vmcnt(6)
  buffer_load_dwordx4 v[64:67], v1, s[8:11], s33 offen offset:1280
  s_waitcnt vmcnt(6)
  v_add_f32_dpp v30, v45, v44 row_ror:8 row_mask:0x8 bank_mask:0x3
  v_mfma_f32_16x16x32_bf16 v[44:47], v[12:15], v[68:71], 0
  v_mfma_f32_16x16x32_bf16 v[44:47], v[16:19], v[72:75], v[44:47]
  buffer_load_dwordx4 v[68:71], v1, s[8:11], s33 offen offset:1536
  v_add_f32_dpp v31, v41, v40 row_ror:8 row_mask:0x1 bank_mask:0x3
  s_nop 5
  v_add_f32_dpp v31, v44, v45 row_ror:8 row_mask:0x1 bank_mask:0xc
  ds_bpermute_b32 v31, v5, v31
  s_waitcnt lgkmcnt(0)
  v_mul_f32 v26, 0x3e0293ee, v26
  v_mul_f32 v27, 0x3e0293ee, v27
  v_mul_f32 v28, 0x3e0293ee, v28
  v_mul_f32 v29, 0x3e0293ee, v29
  v_mul_f32 v30, 0x3e0293ee, v30
  v_mul_f32 v31, 0x3e0293ee, v31
  v_max3_f32 v40, v26, v27, v28
  v_max3_f32 v40, v40, v29, v30
  v_max_f32 v40, v40, v31
  s_nop 1
  v_max_f32_dpp v40, v40, v40 row_ror:8 row_mask:0xf bank_mask:0xf
  s_nop 1
  v_max_f32_dpp v40, v40, v40 row_ror:4 row_mask:0xf bank_mask:0xf
  s_nop 1
  v_max_f32_dpp v40, v40, v40 row_ror:2 row_mask:0xf bank_mask:0xf
  s_nop 1
  v_max_f32_dpp v40, v40, v40 row_ror:1 row_mask:0xf bank_mask:0xf
  s_nop 1
  v_max_f32_dpp v40, v40, v40 row_bcast:15 row_mask:0xa bank_mask:0xf
  s_nop 1
  v_max_f32_dpp v40, v40, v40 row_bcast:31 row_mask:0xc bank_mask:0xf
  s_nop 0
  v_readlane_b32 s46, v40, 63
  v_mov_b32 v36, 0
  v_mov_b32 v37, 0
  v_mov_b32 v38, 0
  v_mov_b32 v39, 0
  s_mov_b32 s37, s46
  v_subrev_f32 v26, s37, v26
  v_subrev_f32 v27, s37, v27
  v_subrev_f32 v28, s37, v28
  v_subrev_f32 v29, s37, v29
  v_subrev_f32 v30, s37, v30
  v_subrev_f32 v31, s37, v31
  v_exp_f32 v26, v26
  v_exp_f32 v27, v27
  v_exp_f32 v28, v28
  v_exp_f32 v29, v29
  v_exp_f32 v30, v30
  v_exp_f32 v31, v31
  v_add_f32 v42, v26, v27
  v_add_f32 v43, v28, v29
  v_add_f32 v42, v42, v30
  v_add_f32 v43, v43, v31
  v_add_f32 v11, v42, v43
  v_cvt_pk_bf16_f32 v26, v26, v26
  v_cvt_pk_bf16_f32 v27, v27, v27
  v_cvt_pk_bf16_f32 v28, v28, v28
  v_cvt_pk_bf16_f32 v29, v29, v29
  v_cvt_pk_bf16_f32 v30, v30, v30
  v_cvt_pk_bf16_f32 v31, v31, v31
  s_waitcnt vmcnt(6)
  buffer_load_dwordx4 v[72:75], v1, s[8:11], s33 offen offset:1792
  v_and_b32_dpp v48, v26, v6 row_newbcast:0 row_mask:0xf bank_mask:0xf
  v_and_b32_dpp v49, v26, v7 row_newbcast:0 row_mask:0xf bank_mask:0xf
  v_and_b32_dpp v50, v26, v8 row_newbcast:0 row_mask:0xf bank_mask:0xf
  v_and_b32_dpp v51, v26, v9 row_newbcast:0 row_mask:0xf bank_mask:0xf
  s_nop 1
  v_mfma_f32_16x16x32_bf16 v[36:39], v[48:51], v[76:79], v[36:39]
  s_waitcnt vmcnt(6)
  buffer_load_dwordx4 v[76:79], v1, s[8:11], s33 offen offset:2048
  v_and_b32_dpp v52, v26, v6 row_newbcast:1 row_mask:0xf bank_mask:0xf
  v_and_b32_dpp v53, v26, v7 row_newbcast:1 row_mask:0xf bank_mask:0xf
  v_and_b32_dpp v54, v26, v8 row_newbcast:1 row_mask:0xf bank_mask:0xf
  v_and_b32_dpp v55, v26, v9 row_newbcast:1 row_mask:0xf bank_mask:0xf
  s_nop 1
  v_mfma_f32_16x16x32_bf16 v[36:39], v[52:55], v[80:83], v[36:39]
  s_waitcnt vmcnt(6)
  buffer_load_dwordx4 v[80:83], v1, s[8:11], s33 offen offset:2304
  v_and_b32_dpp v48, v26, v6 row_newbcast:2 row_mask:0xf bank_mask:0xf
  v_and_b32_dpp v49, v26, v7 row_newbcast:2 row_mask:0xf bank_mask:0xf
  v_and_b32_dpp v50, v26, v8 row_newbcast:2 row_mask:0xf bank_mask:0xf
  v_and_b32_dpp v51, v26, v9 row_newbcast:2 row_mask:0xf bank_mask:0xf
  s_nop 1
  v_mfma_f32_16x16x32_bf16 v[36:39], v[48:51], v[84:87], v[36:39]
  s_waitcnt vmcnt(6)
  buffer_load_dwordx4 v[84:87], v1, s[8:11], s33 offen offset:2560
  v_and_b32_dpp v52, v26, v6 row_newbcast:3 row_mask:0xf bank_mask:0xf
  v_and_b32_dpp v53, v26, v7 row_newbcast:3 row_mask:0xf bank_mask:0xf
  v_and_b32_dpp v54, v26, v8 row_newbcast:3 row_mask:0xf bank_mask:0xf
  v_and_b32_dpp v55, v26, v9 row_newbcast:3 row_mask:0xf bank_mask:0xf
  s_nop 1
  v_mfma_f32_16x16x32_bf16 v[36:39], v[52:55], v[88:91], v[36:39]
  s_waitcnt vmcnt(6)
  buffer_load_dwordx4 v[88:91], v1, s[8:11], s33 offen offset:2816
  v_and_b32_dpp v48, v26, v6 row_newbcast:4 row_mask:0xf bank_mask:0xf
  v_and_b32_dpp v49, v26, v7 row_newbcast:4 row_mask:0xf bank_mask:0xf
  v_and_b32_dpp v50, v26, v8 row_newbcast:4 row_mask:0xf bank_mask:0xf
  v_and_b32_dpp v51, v26, v9 row_newbcast:4 row_mask:0xf bank_mask:0xf
  s_nop 1
  v_mfma_f32_16x16x32_bf16 v[36:39], v[48:51], v[60:63], v[36:39]
  s_waitcnt vmcnt(6)
  buffer_load_dwordx4 v[60:63], v1, s[8:11], s33 offen offset:3072
  v_and_b32_dpp v52, v26, v6 row_newbcast:5 row_mask:0xf bank_mask:0xf
  v_and_b32_dpp v53, v26, v7 row_newbcast:5 row_mask:0xf bank_mask:0xf
  v_and_b32_dpp v54, v26, v8 row_newbcast:5 row_mask:0xf bank_mask:0xf
  v_and_b32_dpp v55, v26, v9 row_newbcast:5 row_mask:0xf bank_mask:0xf
  s_nop 1
  v_mfma_f32_16x16x32_bf16 v[36:39], v[52:55], v[64:67], v[36:39]
  s_waitcnt vmcnt(6)
  buffer_load_dwordx4 v[64:67], v1, s[8:11], s33 offen offset:3328
  v_and_b32_dpp v48, v26, v6 row_newbcast:6 row_mask:0xf bank_mask:0xf
  v_and_b32_dpp v49, v26, v7 row_newbcast:6 row_mask:0xf bank_mask:0xf
  v_and_b32_dpp v50, v26, v8 row_newbcast:6 row_mask:0xf bank_mask:0xf
  v_and_b32_dpp v51, v26, v9 row_newbcast:6 row_mask:0xf bank_mask:0xf
  s_nop 1
  v_mfma_f32_16x16x32_bf16 v[36:39], v[48:51], v[68:71], v[36:39]
  s_waitcnt vmcnt(6)
  buffer_load_dwordx4 v[68:71], v1, s[8:11], s33 offen offset:3584
  v_and_b32_dpp v52, v26, v6 row_newbcast:7 row_mask:0xf bank_mask:0xf
  v_and_b32_dpp v53, v26, v7 row_newbcast:7 row_mask:0xf bank_mask:0xf
  v_and_b32_dpp v54, v26, v8 row_newbcast:7 row_mask:0xf bank_mask:0xf
  v_and_b32_dpp v55, v26, v9 row_newbcast:7 row_mask:0xf bank_mask:0xf
  s_nop 1
  v_mfma_f32_16x16x32_bf16 v[36:39], v[52:55], v[72:75], v[36:39]
  s_waitcnt vmcnt(6)
  buffer_load_dwordx4 v[72:75], v1, s[8:11], s33 offen offset:3840
  v_and_b32_dpp v48, v26, v6 row_newbcast:8 row_mask:0xf bank_mask:0xf
  v_and_b32_dpp v49, v26, v7 row_newbcast:8 row_mask:0xf bank_mask:0xf
  v_and_b32_dpp v50, v26, v8 row_newbcast:8 row_mask:0xf bank_mask:0xf
  v_and_b32_dpp v51, v26, v9 row_newbcast:8 row_mask:0xf bank_mask:0xf
  s_nop 1
  v_mfma_f32_16x16x32_bf16 v[36:39], v[48:51], v[76:79], v[36:39]
  s_waitcnt vmcnt(6)
  s_add_u32 s33, s29, 327680
  buffer_load_dwordx4 v[76:79], v1, s[8:11], s33 offen offset:0
  v_and_b32_dpp v52, v26, v6 row_newbcast:9 row_mask:0xf bank_mask:0xf
  v_and_b32_dpp v53, v26, v7 row_newbcast:9 row_mask:0xf bank_mask:0xf
  v_and_b32_dpp v54, v26, v8 row_newbcast:9 row_mask:0xf bank_mask:0xf
  v_and_b32_dpp v55, v26, v9 row_newbcast:9 row_mask:0xf bank_mask:0xf
  s_nop 1
  v_mfma_f32_16x16x32_bf16 v[36:39], v[52:55], v[80:83], v[36:39]
  s_waitcnt vmcnt(6)
  buffer_load_dwordx4 v[80:83], v1, s[8:11], s33 offen offset:256
  v_and_b32_dpp v48, v26, v6 row_newbcast:10 row_mask:0xf bank_mask:0xf
  v_and_b32_dpp v49, v26, v7 row_newbcast:10 row_mask:0xf bank_mask:0xf
  v_and_b32_dpp v50, v26, v8 row_newbcast:10 row_mask:0xf bank_mask:0xf
  v_and_b32_dpp v51, v26, v9 row_newbcast:10 row_mask:0xf bank_mask:0xf
  s_nop 1
  v_mfma_f32_16x16x32_bf16 v[36:39], v[48:51], v[84:87], v[36:39]
  s_waitcnt vmcnt(6)
  buffer_load_dwordx4 v[84:87], v1, s[8:11], s33 offen offset:512
  v_and_b32_dpp v52, v26, v6 row_newbcast:11 row_mask:0xf bank_mask:0xf
  v_and_b32_dpp v53, v26, v7 row_newbcast:11 row_mask:0xf bank_mask:0xf
  v_and_b32_dpp v54, v26, v8 row_newbcast:11 row_mask:0xf bank_mask:0xf
  v_and_b32_dpp v55, v26, v9 row_newbcast:11 row_mask:0xf bank_mask:0xf
  s_nop 1
  v_mfma_f32_16x16x32_bf16 v[36:39], v[52:55], v[88:91], v[36:39]
  s_waitcnt vmcnt(6)
  buffer_load_dwordx4 v[88:91], v1, s[8:11], s33 offen offset:768
  v_and_b32_dpp v48, v26, v6 row_newbcast:12 row_mask:0xf bank_mask:0xf
  v_and_b32_dpp v49, v26, v7 row_newbcast:12 row_mask:0xf bank_mask:0xf
  v_and_b32_dpp v50, v26, v8 row_newbcast:12 row_mask:0xf bank_mask:0xf
  v_and_b32_dpp v51, v26, v9 row_newbcast:12 row_mask:0xf bank_mask:0xf
  s_nop 1
  v_mfma_f32_16x16x32_bf16 v[36:39], v[48:51], v[60:63], v[36:39]
  s_waitcnt vmcnt(6)
  buffer_load_dwordx4 v[60:63], v1, s[8:11], s33 offen offset:1024
  v_and_b32_dpp v52, v26, v6 row_newbcast:13 row_mask:0xf bank_mask:0xf
  v_and_b32_dpp v53, v26, v7 row_newbcast:13 row_mask:0xf bank_mask:0xf
  v_and_b32_dpp v54, v26, v8 row_newbcast:13 row_mask:0xf bank_mask:0xf
  v_and_b32_dpp v55, v26, v9 row_newbcast:13 row_mask:0xf bank_mask:0xf
  s_nop 1
  v_mfma_f32_16x16x32_bf16 v[36:39], v[52:55], v[64:67], v[36:39]
  s_waitcnt vmcnt(6)
  buffer_load_dwordx4 v[64:67], v1, s[8:11], s33 offen offset:1280
  v_and_b32_dpp v48, v26, v6 row_newbcast:14 row_mask:0xf bank_mask:0xf
  v_and_b32_dpp v49, v26, v7 row_newbcast:14 row_mask:0xf bank_mask:0xf
  v_and_b32_dpp v50, v26, v8 row_newbcast:14 row_mask:0xf bank_mask:0xf
  v_and_b32_dpp v51, v26, v9 row_newbcast:14 row_mask:0xf bank_mask:0xf
  s_nop 1
  v_mfma_f32_16x16x32_bf16 v[36:39], v[48:51], v[68:71], v[36:39]
  s_waitcnt vmcnt(6)
  buffer_load_dwordx4 v[68:71], v1, s[8:11], s33 offen offset:1536
  v_and_b32_dpp v52, v26, v6 row_newbcast:15 row_mask:0xf bank_mask:0xf
  v_and_b32_dpp v53, v26, v7 row_newbcast:15 row_mask:0xf bank_mask:0xf
  v_and_b32_dpp v54, v26, v8 row_newbcast:15 row_mask:0xf bank_mask:0xf
  v_and_b32_dpp v55, v26, v9 row_newbcast:15 row_mask:0xf bank_mask:0xf
  s_nop 1
  v_mfma_f32_16x16x32_bf16 v[36:39], v[52:55], v[72:75], v[36:39]
  s_waitcnt vmcnt(6)
  buffer_load_dwordx4 v[72:75], v1, s[8:11], s33 offen offset:1792
  v_and_b32_dpp v48, v27, v6 row_newbcast:0 row_mask:0xf bank_mask:0xf
  v_and_b32_dpp v49, v27, v7 row_newbcast:0 row_mask:0xf bank_mask:0xf
  v_and_b32_dpp v50, v27, v8 row_newbcast:0 row_mask:0xf bank_mask:0xf
  v_and_b32_dpp v51, v27, v9 row_newbcast:0 row_mask:0xf bank_mask:0xf
  s_nop 1
  v_mfma_f32_16x16x32_bf16 v[36:39], v[48:51], v[76:79], v[36:39]
  s_waitcnt vmcnt(6)
  buffer_load_dwordx4 v[76:79], v1, s[8:11], s33 offen offset:2048
  v_and_b32_dpp v52, v27, v6 row_newbcast:1 row_mask:0xf bank_mask:0xf
  v_and_b32_dpp v53, v27, v7 row_newbcast:1 row_mask:0xf bank_mask:0xf
  v_and_b32_dpp v54, v27, v8 row_newbcast:1 row_mask:0xf bank_mask:0xf
  v_and_b32_dpp v55, v27, v9 row_newbcast:1 row_mask:0xf bank_mask:0xf
  s_nop 1
  v_mfma_f32_16x16x32_bf16 v[36:39], v[52:55], v[80:83], v[36:39]
  s_waitcnt vmcnt(6)
  buffer_load_dwordx4 v[80:83], v1, s[8:11], s33 offen offset:2304
  v_and_b32_dpp v48, v27, v6 row_newbcast:2 row_mask:0xf bank_mask:0xf
  v_and_b32_dpp v49, v27, v7 row_newbcast:2 row_mask:0xf bank_mask:0xf
  v_and_b32_dpp v50, v27, v8 row_newbcast:2 row_mask:0xf bank_mask:0xf
  v_and_b32_dpp v51, v27, v9 row_newbcast:2 row_mask:0xf bank_mask:0xf
  s_nop 1
  v_mfma_f32_16x16x32_bf16 v[36:39], v[48:51], v[84:87], v[36:39]
  s_waitcnt vmcnt(6)
  buffer_load_dwordx4 v[84:87], v1, s[8:11], s33 offen offset:2560
  v_and_b32_dpp v52, v27, v6 row_newbcast:3 row_mask:0xf bank_mask:0xf
  v_and_b32_dpp v53, v27, v7 row_newbcast:3 row_mask:0xf bank_mask:0xf
  v_and_b32_dpp v54, v27, v8 row_newbcast:3 row_mask:0xf bank_mask:0xf
  v_and_b32_dpp v55, v27, v9 row_newbcast:3 row_mask:0xf bank_mask:0xf
  s_nop 1
  v_mfma_f32_16x16x32_bf16 v[36:39], v[52:55], v[88:91], v[36:39]
  s_waitcnt vmcnt(6)
  buffer_load_dwordx4 v[88:91], v1, s[8:11], s33 offen offset:2816
  v_and_b32_dpp v48, v27, v6 row_newbcast:4 row_mask:0xf bank_mask:0xf
  v_and_b32_dpp v49, v27, v7 row_newbcast:4 row_mask:0xf bank_mask:0xf
  v_and_b32_dpp v50, v27, v8 row_newbcast:4 row_mask:0xf bank_mask:0xf
  v_and_b32_dpp v51, v27, v9 row_newbcast:4 row_mask:0xf bank_mask:0xf
  s_nop 1
  v_mfma_f32_16x16x32_bf16 v[36:39], v[48:51], v[60:63], v[36:39]
  s_waitcnt vmcnt(6)
  buffer_load_dwordx4 v[60:63], v1, s[8:11], s33 offen offset:3072
  v_and_b32_dpp v52, v27, v6 row_newbcast:5 row_mask:0xf bank_mask:0xf
  v_and_b32_dpp v53, v27, v7 row_newbcast:5 row_mask:0xf bank_mask:0xf
  v_and_b32_dpp v54, v27, v8 row_newbcast:5 row_mask:0xf bank_mask:0xf
  v_and_b32_dpp v55, v27, v9 row_newbcast:5 row_mask:0xf bank_mask:0xf
  s_nop 1
  v_mfma_f32_16x16x32_bf16 v[36:39], v[52:55], v[64:67], v[36:39]
  s_waitcnt vmcnt(6)
  buffer_load_dwordx4 v[64:67], v1, s[8:11], s33 offen offset:3328
  v_and_b32_dpp v48, v27, v6 row_newbcast:6 row_mask:0xf bank_mask:0xf
  v_and_b32_dpp v49, v27, v7 row_newbcast:6 row_mask:0xf bank_mask:0xf
  v_and_b32_dpp v50, v27, v8 row_newbcast:6 row_mask:0xf bank_mask:0xf
  v_and_b32_dpp v51, v27, v9 row_newbcast:6 row_mask:0xf bank_mask:0xf
  s_nop 1
  v_mfma_f32_16x16x32_bf16 v[36:39], v[48:51], v[68:71], v[36:39]
  s_waitcnt vmcnt(6)
  buffer_load_dwordx4 v[68:71], v1, s[8:11], s33 offen offset:3584
  v_and_b32_dpp v52, v27, v6 row_newbcast:7 row_mask:0xf bank_mask:0xf
  v_and_b32_dpp v53, v27, v7 row_newbcast:7 row_mask:0xf bank_mask:0xf
  v_and_b32_dpp v54, v27, v8 row_newbcast:7 row_mask:0xf bank_mask:0xf
  v_and_b32_dpp v55, v27, v9 row_newbcast:7 row_mask:0xf bank_mask:0xf
  s_nop 1
  v_mfma_f32_16x16x32_bf16 v[36:39], v[52:55], v[72:75], v[36:39]
  s_waitcnt vmcnt(6)
  buffer_load_dwordx4 v[72:75], v1, s[8:11], s33 offen offset:3840
  v_and_b32_dpp v48, v27, v6 row_newbcast:8 row_mask:0xf bank_mask:0xf
  v_and_b32_dpp v49, v27, v7 row_newbcast:8 row_mask:0xf bank_mask:0xf
  v_and_b32_dpp v50, v27, v8 row_newbcast:8 row_mask:0xf bank_mask:0xf
  v_and_b32_dpp v51, v27, v9 row_newbcast:8 row_mask:0xf bank_mask:0xf
  s_nop 1
  v_mfma_f32_16x16x32_bf16 v[36:39], v[48:51], v[76:79], v[36:39]
  s_waitcnt vmcnt(6)
  s_add_u32 s33, s29, 393216
  buffer_load_dwordx4 v[76:79], v1, s[8:11], s33 offen offset:0
  v_and_b32_dpp v52, v27, v6 row_newbcast:9 row_mask:0xf bank_mask:0xf
  v_and_b32_dpp v53, v27, v7 row_newbcast:9 row_mask:0xf bank_mask:0xf
  v_and_b32_dpp v54, v27, v8 row_newbcast:9 row_mask:0xf bank_mask:0xf
  v_and_b32_dpp v55, v27, v9 row_newbcast:9 row_mask:0xf bank_mask:0xf
  s_nop 1
  v_mfma_f32_16x16x32_bf16 v[36:39], v[52:55], v[80:83], v[36:39]
  s_waitcnt vmcnt(6)
  buffer_load_dwordx4 v[80:83], v1, s[8:11], s33 offen offset:256
  v_and_b32_dpp v48, v27, v6 row_newbcast:10 row_mask:0xf bank_mask:0xf
  v_and_b32_dpp v49, v27, v7 row_newbcast:10 row_mask:0xf bank_mask:0xf
  v_and_b32_dpp v50, v27, v8 row_newbcast:10 row_mask:0xf bank_mask:0xf
  v_and_b32_dpp v51, v27, v9 row_newbcast:10 row_mask:0xf bank_mask:0xf
  s_nop 1
  v_mfma_f32_16x16x32_bf16 v[36:39], v[48:51], v[84:87], v[36:39]
  s_waitcnt vmcnt(6)
  buffer_load_dwordx4 v[84:87], v1, s[8:11], s33 offen offset:512
  v_and_b32_dpp v52, v27, v6 row_newbcast:11 row_mask:0xf bank_mask:0xf
  v_and_b32_dpp v53, v27, v7 row_newbcast:11 row_mask:0xf bank_mask:0xf
  v_and_b32_dpp v54, v27, v8 row_newbcast:11 row_mask:0xf bank_mask:0xf
  v_and_b32_dpp v55, v27, v9 row_newbcast:11 row_mask:0xf bank_mask:0xf
  s_nop 1
  v_mfma_f32_16x16x32_bf16 v[36:39], v[52:55], v[88:91], v[36:39]
  s_waitcnt vmcnt(6)
  buffer_load_dwordx4 v[88:91], v1, s[8:11], s33 offen offset:768
  v_and_b32_dpp v48, v27, v6 row_newbcast:12 row_mask:0xf bank_mask:0xf
  v_and_b32_dpp v49, v27, v7 row_newbcast:12 row_mask:0xf bank_mask:0xf
  v_and_b32_dpp v50, v27, v8 row_newbcast:12 row_mask:0xf bank_mask:0xf
  v_and_b32_dpp v51, v27, v9 row_newbcast:12 row_mask:0xf bank_mask:0xf
  s_nop 1
  v_mfma_f32_16x16x32_bf16 v[36:39], v[48:51], v[60:63], v[36:39]
  s_waitcnt vmcnt(6)
  buffer_load_dwordx4 v[60:63], v1, s[8:11], s33 offen offset:1024
  v_and_b32_dpp v52, v27, v6 row_newbcast:13 row_mask:0xf bank_mask:0xf
  v_and_b32_dpp v53, v27, v7 row_newbcast:13 row_mask:0xf bank_mask:0xf
  v_and_b32_dpp v54, v27, v8 row_newbcast:13 row_mask:0xf bank_mask:0xf
  v_and_b32_dpp v55, v27, v9 row_newbcast:13 row_mask:0xf bank_mask:0xf
  s_nop 1
  v_mfma_f32_16x16x32_bf16 v[36:39], v[52:55], v[64:67], v[36:39]
  s_waitcnt vmcnt(6)
  buffer_load_dwordx4 v[64:67], v1, s[8:11], s33 offen offset:1280
  v_and_b32_dpp v48, v27, v6 row_newbcast:14 row_mask:0xf bank_mask:0xf
  v_and_b32_dpp v49, v27, v7 row_newbcast:14 row_mask:0xf bank_mask:0xf
  v_and_b32_dpp v50, v27, v8 row_newbcast:14 row_mask:0xf bank_mask:0xf
  v_and_b32_dpp v51, v27, v9 row_newbcast:14 row_mask:0xf bank_mask:0xf
  s_nop 1
  v_mfma_f32_16x16x32_bf16 v[36:39], v[48:51], v[68:71], v[36:39]
  s_waitcnt vmcnt(6)
  buffer_load_dwordx4 v[68:71], v1, s[8:11], s33 offen offset:1536
  v_and_b32_dpp v52, v27, v6 row_newbcast:15 row_mask:0xf bank_mask:0xf
  v_and_b32_dpp v53, v27, v7 row_newbcast:15 row_mask:0xf bank_mask:0xf
  v_and_b32_dpp v54, v27, v8 row_newbcast:15 row_mask:0xf bank_mask:0xf
  v_and_b32_dpp v55, v27, v9 row_newbcast:15 row_mask:0xf bank_mask:0xf
  s_nop 1
  v_mfma_f32_16x16x32_bf16 v[36:39], v[52:55], v[72:75], v[36:39]
  s_waitcnt vmcnt(6)
  buffer_load_dwordx4 v[72:75], v1, s[8:11], s33 offen offset:1792
  v_and_b32_dpp v48, v28, v6 row_newbcast:0 row_mask:0xf bank_mask:0xf
  v_and_b32_dpp v49, v28, v7 row_newbcast:0 row_mask:0xf bank_mask:0xf
  v_and_b32_dpp v50, v28, v8 row_newbcast:0 row_mask:0xf bank_mask:0xf
  v_and_b32_dpp v51, v28, v9 row_newbcast:0 row_mask:0xf bank_mask:0xf
  s_nop 1
  v_mfma_f32_16x16x32_bf16 v[36:39], v[48:51], v[76:79], v[36:39]
  s_waitcnt vmcnt(6)
  buffer_load_dwordx4 v[76:79], v1, s[8:11], s33 offen offset:2048 nt
  v_and_b32_dpp v52, v28, v6 row_newbcast:1 row_mask:0xf bank_mask:0xf
  v_and_b32_dpp v53, v28, v7 row_newbcast:1 row_mask:0xf bank_mask:0xf
  v_and_b32_dpp v54, v28, v8 row_newbcast:1 row_mask:0xf bank_mask:0xf
  v_and_b32_dpp v55, v28, v9 row_newbcast:1 row_mask:0xf bank_mask:0xf
  s_nop 1
  v_mfma_f32_16x16x32_bf16 v[36:39], v[52:55], v[80:83], v[36:39]
  s_waitcnt vmcnt(6)
  buffer_load_dwordx4 v[80:83], v1, s[8:11], s33 offen offset:2304 nt
  v_and_b32_dpp v48, v28, v6 row_newbcast:2 row_mask:0xf bank_mask:0xf
  v_and_b32_dpp v49, v28, v7 row_newbcast:2 row_mask:0xf bank_mask:0xf
  v_and_b32_dpp v50, v28, v8 row_newbcast:2 row_mask:0xf bank_mask:0xf
  v_and_b32_dpp v51, v28, v9 row_newbcast:2 row_mask:0xf bank_mask:0xf
  s_nop 1
  v_mfma_f32_16x16x32_bf16 v[36:39], v[48:51], v[84:87], v[36:39]
  s_waitcnt vmcnt(6)
  buffer_load_dwordx4 v[84:87], v1, s[8:11], s33 offen offset:2560 nt
  v_and_b32_dpp v52, v28, v6 row_newbcast:3 row_mask:0xf bank_mask:0xf
  v_and_b32_dpp v53, v28, v7 row_newbcast:3 row_mask:0xf bank_mask:0xf
  v_and_b32_dpp v54, v28, v8 row_newbcast:3 row_mask:0xf bank_mask:0xf
  v_and_b32_dpp v55, v28, v9 row_newbcast:3 row_mask:0xf bank_mask:0xf
  s_nop 1
  v_mfma_f32_16x16x32_bf16 v[36:39], v[52:55], v[88:91], v[36:39]
  s_waitcnt vmcnt(6)
  buffer_load_dwordx4 v[88:91], v1, s[8:11], s33 offen offset:2816 nt
  v_and_b32_dpp v48, v28, v6 row_newbcast:4 row_mask:0xf bank_mask:0xf
  v_and_b32_dpp v49, v28, v7 row_newbcast:4 row_mask:0xf bank_mask:0xf
  v_and_b32_dpp v50, v28, v8 row_newbcast:4 row_mask:0xf bank_mask:0xf
  v_and_b32_dpp v51, v28, v9 row_newbcast:4 row_mask:0xf bank_mask:0xf
  s_nop 1
  v_mfma_f32_16x16x32_bf16 v[36:39], v[48:51], v[60:63], v[36:39]
  s_waitcnt vmcnt(6)
  buffer_load_dwordx4 v[60:63], v1, s[8:11], s33 offen offset:3072 nt
  v_and_b32_dpp v52, v28, v6 row_newbcast:5 row_mask:0xf bank_mask:0xf
  v_and_b32_dpp v53, v28, v7 row_newbcast:5 row_mask:0xf bank_mask:0xf
  v_and_b32_dpp v54, v28, v8 row_newbcast:5 row_mask:0xf bank_mask:0xf
  v_and_b32_dpp v55, v28, v9 row_newbcast:5 row_mask:0xf bank_mask:0xf
  s_nop 1
  v_mfma_f32_16x16x32_bf16 v[36:39], v[52:55], v[64:67], v[36:39]
  s_waitcnt vmcnt(6)
  buffer_load_dwordx4 v[64:67], v1, s[8:11], s33 offen offset:3328 nt
  v_and_b32_dpp v48, v28, v6 row_newbcast:6 row_mask:0xf bank_mask:0xf
  v_and_b32_dpp v49, v28, v7 row_newbcast:6 row_mask:0xf bank_mask:0xf
  v_and_b32_dpp v50, v28, v8 row_newbcast:6 row_mask:0xf bank_mask:0xf
  v_and_b32_dpp v51, v28, v9 row_newbcast:6 row_mask:0xf bank_mask:0xf
  s_nop 1
  v_mfma_f32_16x16x32_bf16 v[36:39], v[48:51], v[68:71], v[36:39]
  s_waitcnt vmcnt(6)
  buffer_load_dwordx4 v[68:71], v1, s[8:11], s33 offen offset:3584 nt
  v_and_b32_dpp v52, v28, v6 row_newbcast:7 row_mask:0xf bank_mask:0xf
  v_and_b32_dpp v53, v28, v7 row_newbcast:7 row_mask:0xf bank_mask:0xf
  v_and_b32_dpp v54, v28, v8 row_newbcast:7 row_mask:0xf bank_mask:0xf
  v_and_b32_dpp v55, v28, v9 row_newbcast:7 row_mask:0xf bank_mask:0xf
  s_nop 1
  v_mfma_f32_16x16x32_bf16 v[36:39], v[52:55], v[72:75], v[36:39]
  s_waitcnt vmcnt(6)
  buffer_load_dwordx4 v[72:75], v1, s[8:11], s33 offen offset:3840 nt
  v_and_b32_dpp v48, v28, v6 row_newbcast:8 row_mask:0xf bank_mask:0xf
  v_and_b32_dpp v49, v28, v7 row_newbcast:8 row_mask:0xf bank_mask:0xf
  v_and_b32_dpp v50, v28, v8 row_newbcast:8 row_mask:0xf bank_mask:0xf
  v_and_b32_dpp v51, v28, v9 row_newbcast:8 row_mask:0xf bank_mask:0xf
  s_nop 1
  v_mfma_f32_16x16x32_bf16 v[36:39], v[48:51], v[76:79], v[36:39]
  s_waitcnt vmcnt(6)
  s_add_u32 s33, s29, 458752
  buffer_load_dwordx4 v[76:79], v1, s[8:11], s33 offen offset:0 nt
  v_and_b32_dpp v52, v28, v6 row_newbcast:9 row_mask:0xf bank_mask:0xf
  v_and_b32_dpp v53, v28, v7 row_newbcast:9 row_mask:0xf bank_mask:0xf
  v_and_b32_dpp v54, v28, v8 row_newbcast:9 row_mask:0xf bank_mask:0xf
  v_and_b32_dpp v55, v28, v9 row_newbcast:9 row_mask:0xf bank_mask:0xf
  s_nop 1
  v_mfma_f32_16x16x32_bf16 v[36:39], v[52:55], v[80:83], v[36:39]
  s_waitcnt vmcnt(6)
  buffer_load_dwordx4 v[80:83], v1, s[8:11], s33 offen offset:256 nt
  v_and_b32_dpp v48, v28, v6 row_newbcast:10 row_mask:0xf bank_mask:0xf
  v_and_b32_dpp v49, v28, v7 row_newbcast:10 row_mask:0xf bank_mask:0xf
  v_and_b32_dpp v50, v28, v8 row_newbcast:10 row_mask:0xf bank_mask:0xf
  v_and_b32_dpp v51, v28, v9 row_newbcast:10 row_mask:0xf bank_mask:0xf
  s_nop 1
  v_mfma_f32_16x16x32_bf16 v[36:39], v[48:51], v[84:87], v[36:39]
  s_waitcnt vmcnt(6)
  buffer_load_dwordx4 v[84:87], v1, s[8:11], s33 offen offset:512 nt
  v_and_b32_dpp v52, v28, v6 row_newbcast:11 row_mask:0xf bank_mask:0xf
  v_and_b32_dpp v53, v28, v7 row_newbcast:11 row_mask:0xf bank_mask:0xf
  v_and_b32_dpp v54, v28, v8 row_newbcast:11 row_mask:0xf bank_mask:0xf
  v_and_b32_dpp v55, v28, v9 row_newbcast:11 row_mask:0xf bank_mask:0xf
  s_nop 1
  v_mfma_f32_16x16x32_bf16 v[36:39], v[52:55], v[88:91], v[36:39]
  s_waitcnt vmcnt(6)
  buffer_load_dwordx4 v[88:91], v1, s[8:11], s33 offen offset:768 nt
  v_and_b32_dpp v48, v28, v6 row_newbcast:12 row_mask:0xf bank_mask:0xf
  v_and_b32_dpp v49, v28, v7 row_newbcast:12 row_mask:0xf bank_mask:0xf
  v_and_b32_dpp v50, v28, v8 row_newbcast:12 row_mask:0xf bank_mask:0xf
  v_and_b32_dpp v51, v28, v9 row_newbcast:12 row_mask:0xf bank_mask:0xf
  s_nop 1
  v_mfma_f32_16x16x32_bf16 v[36:39], v[48:51], v[60:63], v[36:39]
  s_waitcnt vmcnt(6)
  buffer_load_dwordx4 v[60:63], v1, s[8:11], s33 offen offset:1024 nt
  v_and_b32_dpp v52, v28, v6 row_newbcast:13 row_mask:0xf bank_mask:0xf
  v_and_b32_dpp v53, v28, v7 row_newbcast:13 row_mask:0xf bank_mask:0xf
  v_and_b32_dpp v54, v28, v8 row_newbcast:13 row_mask:0xf bank_mask:0xf
  v_and_b32_dpp v55, v28, v9 row_newbcast:13 row_mask:0xf bank_mask:0xf
  s_nop 1
  v_mfma_f32_16x16x32_bf16 v[36:39], v[52:55], v[64:67], v[36:39]
  s_waitcnt vmcnt(6)
  buffer_load_dwordx4 v[64:67], v1, s[8:11], s33 offen offset:1280 nt
  v_and_b32_dpp v48, v28, v6 row_newbcast:14 row_mask:0xf bank_mask:0xf
  v_and_b32_dpp v49, v28, v7 row_newbcast:14 row_mask:0xf bank_mask:0xf
  v_and_b32_dpp v50, v28, v8 row_newbcast:14 row_mask:0xf bank_mask:0xf
  v_and_b32_dpp v51, v28, v9 row_newbcast:14 row_mask:0xf bank_mask:0xf
  s_nop 1
  v_mfma_f32_16x16x32_bf16 v[36:39], v[48:51], v[68:71], v[36:39]
  s_waitcnt vmcnt(6)
  buffer_load_dwordx4 v[68:71], v1, s[8:11], s33 offen offset:1536 nt
  v_and_b32_dpp v52, v28, v6 row_newbcast:15 row_mask:0xf bank_mask:0xf
  v_and_b32_dpp v53, v28, v7 row_newbcast:15 row_mask:0xf bank_mask:0xf
  v_and_b32_dpp v54, v28, v8 row_newbcast:15 row_mask:0xf bank_mask:0xf
  v_and_b32_dpp v55, v28, v9 row_newbcast:15 row_mask:0xf bank_mask:0xf
  s_nop 1
  v_mfma_f32_16x16x32_bf16 v[36:39], v[52:55], v[72:75], v[36:39]
  s_waitcnt vmcnt(6)
  buffer_load_dwordx4 v[72:75], v1, s[8:11], s33 offen offset:1792 nt
  v_and_b32_dpp v48, v29, v6 row_newbcast:0 row_mask:0xf bank_mask:0xf
  v_and_b32_dpp v49, v29, v7 row_newbcast:0 row_mask:0xf bank_mask:0xf
  v_and_b32_dpp v50, v29, v8 row_newbcast:0 row_mask:0xf bank_mask:0xf
  v_and_b32_dpp v51, v29, v9 row_newbcast:0 row_mask:0xf bank_mask:0xf
  s_nop 1
  v_mfma_f32_16x16x32_bf16 v[36:39], v[48:51], v[76:79], v[36:39]
  s_waitcnt vmcnt(6)
  buffer_load_dwordx4 v[76:79], v1, s[8:11], s33 offen offset:2048 nt
  v_and_b32_dpp v52, v29, v6 row_newbcast:1 row_mask:0xf bank_mask:0xf
  v_and_b32_dpp v53, v29, v7 row_newbcast:1 row_mask:0xf bank_mask:0xf
  v_and_b32_dpp v54, v29, v8 row_newbcast:1 row_mask:0xf bank_mask:0xf
  v_and_b32_dpp v55, v29, v9 row_newbcast:1 row_mask:0xf bank_mask:0xf
  s_nop 1
  v_mfma_f32_16x16x32_bf16 v[36:39], v[52:55], v[80:83], v[36:39]
  s_waitcnt vmcnt(6)
  buffer_load_dwordx4 v[80:83], v1, s[8:11], s33 offen offset:2304 nt
  v_and_b32_dpp v48, v29, v6 row_newbcast:2 row_mask:0xf bank_mask:0xf
  v_and_b32_dpp v49, v29, v7 row_newbcast:2 row_mask:0xf bank_mask:0xf
  v_and_b32_dpp v50, v29, v8 row_newbcast:2 row_mask:0xf bank_mask:0xf
  v_and_b32_dpp v51, v29, v9 row_newbcast:2 row_mask:0xf bank_mask:0xf
  s_nop 1
  v_mfma_f32_16x16x32_bf16 v[36:39], v[48:51], v[84:87], v[36:39]
  s_waitcnt vmcnt(6)
  buffer_load_dwordx4 v[84:87], v1, s[8:11], s33 offen offset:2560 nt
  v_and_b32_dpp v52, v29, v6 row_newbcast:3 row_mask:0xf bank_mask:0xf
  v_and_b32_dpp v53, v29, v7 row_newbcast:3 row_mask:0xf bank_mask:0xf
  v_and_b32_dpp v54, v29, v8 row_newbcast:3 row_mask:0xf bank_mask:0xf
  v_and_b32_dpp v55, v29, v9 row_newbcast:3 row_mask:0xf bank_mask:0xf
  s_nop 1
  v_mfma_f32_16x16x32_bf16 v[36:39], v[52:55], v[88:91], v[36:39]
  s_waitcnt vmcnt(6)
  buffer_load_dwordx4 v[88:91], v1, s[8:11], s33 offen offset:2816 nt
  v_and_b32_dpp v48, v29, v6 row_newbcast:4 row_mask:0xf bank_mask:0xf
  v_and_b32_dpp v49, v29, v7 row_newbcast:4 row_mask:0xf bank_mask:0xf
  v_and_b32_dpp v50, v29, v8 row_newbcast:4 row_mask:0xf bank_mask:0xf
  v_and_b32_dpp v51, v29, v9 row_newbcast:4 row_mask:0xf bank_mask:0xf
  s_nop 1
  v_mfma_f32_16x16x32_bf16 v[36:39], v[48:51], v[60:63], v[36:39]
  s_waitcnt vmcnt(6)
  buffer_load_dwordx4 v[60:63], v1, s[8:11], s33 offen offset:3072 nt
  v_and_b32_dpp v52, v29, v6 row_newbcast:5 row_mask:0xf bank_mask:0xf
  v_and_b32_dpp v53, v29, v7 row_newbcast:5 row_mask:0xf bank_mask:0xf
  v_and_b32_dpp v54, v29, v8 row_newbcast:5 row_mask:0xf bank_mask:0xf
  v_and_b32_dpp v55, v29, v9 row_newbcast:5 row_mask:0xf bank_mask:0xf
  s_nop 1
  v_mfma_f32_16x16x32_bf16 v[36:39], v[52:55], v[64:67], v[36:39]
  s_waitcnt vmcnt(6)
  buffer_load_dwordx4 v[64:67], v1, s[8:11], s33 offen offset:3328 nt
  v_and_b32_dpp v48, v29, v6 row_newbcast:6 row_mask:0xf bank_mask:0xf
  v_and_b32_dpp v49, v29, v7 row_newbcast:6 row_mask:0xf bank_mask:0xf
  v_and_b32_dpp v50, v29, v8 row_newbcast:6 row_mask:0xf bank_mask:0xf
  v_and_b32_dpp v51, v29, v9 row_newbcast:6 row_mask:0xf bank_mask:0xf
  s_nop 1
  v_mfma_f32_16x16x32_bf16 v[36:39], v[48:51], v[68:71], v[36:39]
  s_waitcnt vmcnt(6)
  buffer_load_dwordx4 v[68:71], v1, s[8:11], s33 offen offset:3584 nt
  v_and_b32_dpp v52, v29, v6 row_newbcast:7 row_mask:0xf bank_mask:0xf
  v_and_b32_dpp v53, v29, v7 row_newbcast:7 row_mask:0xf bank_mask:0xf
  v_and_b32_dpp v54, v29, v8 row_newbcast:7 row_mask:0xf bank_mask:0xf
  v_and_b32_dpp v55, v29, v9 row_newbcast:7 row_mask:0xf bank_mask:0xf
  s_nop 1
  v_mfma_f32_16x16x32_bf16 v[36:39], v[52:55], v[72:75], v[36:39]
  s_waitcnt vmcnt(6)
  buffer_load_dwordx4 v[72:75], v1, s[8:11], s33 offen offset:3840 nt
  v_and_b32_dpp v48, v29, v6 row_newbcast:8 row_mask:0xf bank_mask:0xf
  v_and_b32_dpp v49, v29, v7 row_newbcast:8 row_mask:0xf bank_mask:0xf
  v_and_b32_dpp v50, v29, v8 row_newbcast:8 row_mask:0xf bank_mask:0xf
  v_and_b32_dpp v51, v29, v9 row_newbcast:8 row_mask:0xf bank_mask:0xf
  s_nop 1
  v_mfma_f32_16x16x32_bf16 v[36:39], v[48:51], v[76:79], v[36:39]
  s_waitcnt vmcnt(6)
  s_lshl_b32 s46, s25, 8
  s_add_u32 s46, s46, 2416640
  s_add_u32 m0, s35, 0
  v_lshrrev_b32 v59, 2, v3
  buffer_load_dword v59, s[12:15], s46 offen sc1 lds
  v_and_b32_dpp v52, v29, v6 row_newbcast:9 row_mask:0xf bank_mask:0xf
  v_and_b32_dpp v53, v29, v7 row_newbcast:9 row_mask:0xf bank_mask:0xf
  v_and_b32_dpp v54, v29, v8 row_newbcast:9 row_mask:0xf bank_mask:0xf
  v_and_b32_dpp v55, v29, v9 row_newbcast:9 row_mask:0xf bank_mask:0xf
  s_nop 1
  v_mfma_f32_16x16x32_bf16 v[36:39], v[52:55], v[80:83], v[36:39]
  s_waitcnt vmcnt(6)
  s_add_u32 s33, s29, 532480
  buffer_load_dwordx4 v[76:79], v2, s[8:11], s33 offen offset:0 nt
  v_and_b32_dpp v48, v29, v6 row_newbcast:10 row_mask:0xf bank_mask:0xf
  v_and_b32_dpp v49, v29, v7 row_newbcast:10 row_mask:0xf bank_mask:0xf
  v_and_b32_dpp v50, v29, v8 row_newbcast:10 row_mask:0xf bank_mask:0xf
  v_and_b32_dpp v51, v29, v9 row_newbcast:10 row_mask:0xf bank_mask:0xf
  s_nop 1
  v_mfma_f32_16x16x32_bf16 v[36:39], v[48:51], v[84:87], v[36:39]
  s_waitcnt vmcnt(6)
  buffer_load_dwordx4 v[80:83], v2, s[8:11], s33 offen offset:256 nt
  v_and_b32_dpp v52, v29, v6 row_newbcast:11 row_mask:0xf bank_mask:0xf
  v_and_b32_dpp v53, v29, v7 row_newbcast:11 row_mask:0xf bank_mask:0xf
  v_and_b32_dpp v54, v29, v8 row_newbcast:11 row_mask:0xf bank_mask:0xf
  v_and_b32_dpp v55, v29, v9 row_newbcast:11 row_mask:0xf bank_mask:0xf
  s_nop 1
  v_mfma_f32_16x16x32_bf16 v[36:39], v[52:55], v[88:91], v[36:39]
  s_waitcnt vmcnt(6)
  buffer_load_dwordx4 v[84:87], v2, s[8:11], s33 offen offset:512 nt
  v_and_b32_dpp v48, v29, v6 row_newbcast:12 row_mask:0xf bank_mask:0xf
  v_and_b32_dpp v49, v29, v7 row_newbcast:12 row_mask:0xf bank_mask:0xf
  v_and_b32_dpp v50, v29, v8 row_newbcast:12 row_mask:0xf bank_mask:0xf
  v_and_b32_dpp v51, v29, v9 row_newbcast:12 row_mask:0xf bank_mask:0xf
  s_nop 1
  v_mfma_f32_16x16x32_bf16 v[36:39], v[48:51], v[60:63], v[36:39]
  s_waitcnt vmcnt(6)
  buffer_load_dwordx4 v[88:91], v2, s[8:11], s33 offen offset:768 nt
  v_and_b32_dpp v52, v29, v6 row_newbcast:13 row_mask:0xf bank_mask:0xf
  v_and_b32_dpp v53, v29, v7 row_newbcast:13 row_mask:0xf bank_mask:0xf
  v_and_b32_dpp v54, v29, v8 row_newbcast:13 row_mask:0xf bank_mask:0xf
  v_and_b32_dpp v55, v29, v9 row_newbcast:13 row_mask:0xf bank_mask:0xf
  s_nop 1
  v_mfma_f32_16x16x32_bf16 v[36:39], v[52:55], v[64:67], v[36:39]
  s_waitcnt vmcnt(6)
  buffer_load_dwordx4 v[60:63], v2, s[8:11], s33 offen offset:1024 nt
  v_and_b32_dpp v48, v29, v6 row_newbcast:14 row_mask:0xf bank_mask:0xf
  v_and_b32_dpp v49, v29, v7 row_newbcast:14 row_mask:0xf bank_mask:0xf
  v_and_b32_dpp v50, v29, v8 row_newbcast:14 row_mask:0xf bank_mask:0xf
  v_and_b32_dpp v51, v29, v9 row_newbcast:14 row_mask:0xf bank_mask:0xf
  s_nop 1
  v_mfma_f32_16x16x32_bf16 v[36:39], v[48:51], v[68:71], v[36:39]
  s_waitcnt vmcnt(6)
  buffer_load_dwordx4 v[64:67], v2, s[8:11], s33 offen offset:1280 nt
  v_and_b32_dpp v52, v29, v6 row_newbcast:15 row_mask:0xf bank_mask:0xf
  v_and_b32_dpp v53, v29, v7 row_newbcast:15 row_mask:0xf bank_mask:0xf
  v_and_b32_dpp v54, v29, v8 row_newbcast:15 row_mask:0xf bank_mask:0xf
  v_and_b32_dpp v55, v29, v9 row_newbcast:15 row_mask:0xf bank_mask:0xf
  s_nop 1
  v_mfma_f32_16x16x32_bf16 v[36:39], v[52:55], v[72:75], v[36:39]
  s_waitcnt vmcnt(6)
  buffer_load_dwordx4 v[68:71], v2, s[8:11], s33 offen offset:1536 nt
  s_waitcnt vmcnt(6)
  buffer_load_dwordx4 v[72:75], v2, s[8:11], s33 offen offset:1792 nt
  v_and_b32_dpp v48, v30, v6 row_newbcast:0 row_mask:0xf bank_mask:0xf
  v_and_b32_dpp v49, v30, v7 row_newbcast:0 row_mask:0xf bank_mask:0xf
  v_and_b32_dpp v50, v30, v8 row_newbcast:0 row_mask:0xf bank_mask:0xf
  v_and_b32_dpp v51, v30, v9 row_newbcast:0 row_mask:0xf bank_mask:0xf
  s_nop 1
  v_mfma_f32_16x16x32_bf16 v[36:39], v[48:51], v[76:79], v[36:39]
  s_waitcnt vmcnt(6)
  s_mov_b32 s33, s31
  s_mov_b64 exec, s[42:43]
  buffer_load_dwordx4 v[76:79], v3, s[8:11], s33 offen offset:0 nt
  s_mov_b64 exec, -1
  v_and_b32_dpp v52, v30, v6 row_newbcast:1 row_mask:0xf bank_mask:0xf
  v_and_b32_dpp v53, v30, v7 row_newbcast:1 row_mask:0xf bank_mask:0xf
  v_and_b32_dpp v54, v30, v8 row_newbcast:1 row_mask:0xf bank_mask:0xf
  v_and_b32_dpp v55, v30, v9 row_newbcast:1 row_mask:0xf bank_mask:0xf
  s_nop 1
  v_mfma_f32_16x16x32_bf16 v[36:39], v[52:55], v[80:83], v[36:39]
  s_waitcnt vmcnt(6)
  s_mov_b64 exec, s[42:43]
  buffer_load_dwordx4 v[80:83], v3, s[8:11], s33 offen offset:1024 nt
  s_mov_b64 exec, -1
  v_and_b32_dpp v48, v30, v6 row_newbcast:2 row_mask:0xf bank_mask:0xf
  v_and_b32_dpp v49, v30, v7 row_newbcast:2 row_mask:0xf bank_mask:0xf
  v_and_b32_dpp v50, v30, v8 row_newbcast:2 row_mask:0xf bank_mask:0xf
  v_and_b32_dpp v51, v30, v9 row_newbcast:2 row_mask:0xf bank_mask:0xf
  s_nop 1
  v_mfma_f32_16x16x32_bf16 v[36:39], v[48:51], v[84:87], v[36:39]
  s_waitcnt vmcnt(6)
  s_mov_b64 exec, s[44:45]
  buffer_load_dwordx4 v[84:87], v3, s[8:11], s33 offen offset:2048 nt
  s_mov_b64 exec, -1
  v_and_b32_dpp v52, v30, v6 row_newbcast:3 row_mask:0xf bank_mask:0xf
  v_and_b32_dpp v53, v30, v7 row_newbcast:3 row_mask:0xf bank_mask:0xf
  v_and_b32_dpp v54, v30, v8 row_newbcast:3 row_mask:0xf bank_mask:0xf
  v_and_b32_dpp v55, v30, v9 row_newbcast:3 row_mask:0xf bank_mask:0xf
  s_nop 1
  v_mfma_f32_16x16x32_bf16 v[36:39], v[52:55], v[88:91], v[36:39]
  s_waitcnt vmcnt(6)
  s_mov_b64 exec, s[44:45]
  buffer_load_dwordx4 v[88:91], v3, s[8:11], s33 offen offset:3072 nt
  s_mov_b64 exec, -1
  v_and_b32_dpp v48, v30, v6 row_newbcast:4 row_mask:0xf bank_mask:0xf
  v_and_b32_dpp v49, v30, v7 row_newbcast:4 row_mask:0xf bank_mask:0xf
  v_and_b32_dpp v50, v30, v8 row_newbcast:4 row_mask:0xf bank_mask:0xf
  v_and_b32_dpp v51, v30, v9 row_newbcast:4 row_mask:0xf bank_mask:0xf
  s_nop 1
  v_mfma_f32_16x16x32_bf16 v[36:39], v[48:51], v[60:63], v[36:39]
  s_waitcnt vmcnt(6)
  v_and_b32_dpp v52, v30, v6 row_newbcast:5 row_mask:0xf bank_mask:0xf
  v_and_b32_dpp v53, v30, v7 row_newbcast:5 row_mask:0xf bank_mask:0xf
  v_and_b32_dpp v54, v30, v8 row_newbcast:5 row_mask:0xf bank_mask:0xf
  v_and_b32_dpp v55, v30, v9 row_newbcast:5 row_mask:0xf bank_mask:0xf
  s_nop 1
  v_mfma_f32_16x16x32_bf16 v[36:39], v[52:55], v[64:67], v[36:39]
  s_waitcnt vmcnt(5)
  v_and_b32_dpp v48, v30, v6 row_newbcast:6 row_mask:0xf bank_mask:0xf
  v_and_b32_dpp v49, v30, v7 row_newbcast:6 row_mask:0xf bank_mask:0xf
  v_and_b32_dpp v50, v30, v8 row_newbcast:6 row_mask:0xf bank_mask:0xf
  v_and_b32_dpp v51, v30, v9 row_newbcast:6 row_mask:0xf bank_mask:0xf
  s_nop 1
  v_mfma_f32_16x16x32_bf16 v[36:39], v[48:51], v[68:71], v[36:39]
  s_waitcnt vmcnt(4)
  v_and_b32_dpp v52, v30, v6 row_newbcast:7 row_mask:0xf bank_mask:0xf
  v_and_b32_dpp v53, v30, v7 row_newbcast:7 row_mask:0xf bank_mask:0xf
  v_and_b32_dpp v54, v30, v8 row_newbcast:7 row_mask:0xf bank_mask:0xf
  v_and_b32_dpp v55, v30, v9 row_newbcast:7 row_mask:0xf bank_mask:0xf
  s_nop 1
  v_mfma_f32_16x16x32_bf16 v[36:39], v[52:55], v[72:75], v[36:39]
  s_waitcnt vmcnt(3)
  v_and_b32_dpp v48, v31, v6 row_newbcast:0 row_mask:0xf bank_mask:0xf
  v_and_b32_dpp v49, v31, v7 row_newbcast:0 row_mask:0xf bank_mask:0xf
  v_and_b32_dpp v50, v31, v8 row_newbcast:0 row_mask:0xf bank_mask:0xf
  v_and_b32_dpp v51, v31, v9 row_newbcast:0 row_mask:0xf bank_mask:0xf
  s_nop 1
  v_mfma_f32_16x16x32_bf16 v[36:39], v[48:51], v[76:79], v[36:39]
  s_waitcnt vmcnt(2)
  v_and_b32_dpp v52, v31, v6 row_newbcast:1 row_mask:0xf bank_mask:0xf
  v_and_b32_dpp v53, v31, v7 row_newbcast:1 row_mask:0xf bank_mask:0xf
  v_and_b32_dpp v54, v31, v8 row_newbcast:1 row_mask:0xf bank_mask:0xf
  v_and_b32_dpp v55, v31, v9 row_newbcast:1 row_mask:0xf bank_mask:0xf
  s_nop 1
  v_mfma_f32_16x16x32_bf16 v[36:39], v[52:55], v[80:83], v[36:39]
  s_waitcnt vmcnt(1)
  v_and_b32_dpp v48, v31, v6 row_newbcast:2 row_mask:0xf bank_mask:0xf
  v_and_b32_dpp v49, v31, v7 row_newbcast:2 row_mask:0xf bank_mask:0xf
  v_and_b32_dpp v50, v31, v8 row_newbcast:2 row_mask:0xf bank_mask:0xf
  v_and_b32_dpp v51, v31, v9 row_newbcast:2 row_mask:0xf bank_mask:0xf
  s_nop 1
  v_mfma_f32_16x16x32_bf16 v[36:39], v[48:51], v[84:87], v[36:39]
  s_waitcnt vmcnt(0)
  v_and_b32_dpp v52, v31, v6 row_newbcast:3 row_mask:0xf bank_mask:0xf
  v_and_b32_dpp v53, v31, v7 row_newbcast:3 row_mask:0xf bank_mask:0xf
  v_and_b32_dpp v54, v31, v8 row_newbcast:3 row_mask:0xf bank_mask:0xf
  v_and_b32_dpp v55, v31, v9 row_newbcast:3 row_mask:0xf bank_mask:0xf
  s_nop 1
  v_mfma_f32_16x16x32_bf16 v[36:39], v[52:55], v[88:91], v[36:39]
  v_lshrrev_b32 v41, 4, v3
  v_and_b32 v40, 1, v41
  v_lshlrev_b32 v40, 6, v40
  v_lshrrev_b32 v41, 4, v41
  v_lshl_add_u32 v40, v41, 4, v40
  v_add_u32 v40, s35, v40
  ds_read_b128 v[12:15], v40 offset:0
  ds_read_b128 v[16:19], v40 offset:128
  s_waitcnt lgkmcnt(0)
  v_max3_u32 v42, v12, v13, v14
  v_max3_u32 v42, v42, v15, v16
  v_max3_u32 v42, v42, v17, v18
  v_max_u32 v42, v42, v19
  v_cmp_eq_u32 vcc, -1, v42
  s_nop 0
  s_cmp_lg_u64 vcc, 0
  s_nop 2
  s_cbranch_scc0 qok_8
qretry_9:
  s_sleep 2
  s_lshl_b32 s46, s25, 8
  s_add_u32 s46, s46, 2416640
  s_add_u32 m0, s35, 0
  v_lshrrev_b32 v59, 2, v3
  buffer_load_dword v59, s[12:15], s46 offen sc1 lds
  s_waitcnt vmcnt(0)
  v_lshrrev_b32 v41, 4, v3
  v_and_b32 v40, 1, v41
  v_lshlrev_b32 v40, 6, v40
  v_lshrrev_b32 v41, 4, v41
  v_lshl_add_u32 v40, v41, 4, v40
  v_add_u32 v40, s35, v40
  ds_read_b128 v[12:15], v40 offset:0
  ds_read_b128 v[16:19], v40 offset:128
  s_waitcnt lgkmcnt(0)
  v_max3_u32 v42, v12, v13, v14
  v_max3_u32 v42, v42, v15, v16
  v_max3_u32 v42, v42, v17, v18
  v_max_u32 v42, v42, v19
  v_cmp_eq_u32 vcc, -1, v42
  s_nop 0
  s_cmp_lg_u64 vcc, 0
  s_cbranch_scc0 qok_8
  s_sub_u32 s39, s39, 1
  s_cmp_gt_i32 s39, 0
  s_cbranch_scc1 qretry_9
qok_8:
  v_mfma_f32_16x16x32_bf16 v[40:43], v[12:15], a[0:3], 0
  v_mfma_f32_16x16x32_bf16 v[40:43], v[16:19], a[4:7], v[40:43]
  s_mov_b32 s32, s29
  buffer_load_dwordx4 a[0:3], v0, s[4:7], s32 offen offset:0 nt
  v_mfma_f32_16x16x32_bf16 v[44:47], v[12:15], a[8:11], 0
  v_mfma_f32_16x16x32_bf16 v[44:47], v[16:19], a[12:15], v[44:47]
  s_nop 3
  v_add_f32_dpp v20, v41, v40 row_ror:8 row_mask:0x1 bank_mask:0x3
  v_mfma_f32_16x16x32_bf16 v[40:43], v[12:15], a[16:19], 0
  v_mfma_f32_16x16x32_bf16 v[40:43], v[16:19], a[20:23], v[40:43]
  s_nop 0
  v_add_f32_dpp v20, v44, v45 row_ror:8 row_mask:0x1 bank_mask:0xc
  v_mfma_f32_16x16x32_bf16 v[44:47], v[12:15], a[24:27], 0
  v_mfma_f32_16x16x32_bf16 v[44:47], v[16:19], a[28:31], v[44:47]
  s_nop 3
  v_add_f32_dpp v20, v41, v40 row_ror:8 row_mask:0x2 bank_mask:0x3
  v_mfma_f32_16x16x32_bf16 v[40:43], v[12:15], a[32:35], 0
  v_mfma_f32_16x16x32_bf16 v[40:43], v[16:19], a[36:39], v[40:43]
  buffer_load_dwordx4 a[4:7], v0, s[4:7], s32 offen offset:128 nt
  v_add_f32_dpp v20, v44, v45 row_ror:8 row_mask:0x2 bank_mask:0xc
  v_mfma_f32_16x16x32_bf16 v[44:47], v[12:15], a[40:43], 0
  v_mfma_f32_16x16x32_bf16 v[44:47], v[16:19], a[44:47], v[44:47]
  s_nop 3
  v_add_f32_dpp v20, v41, v40 row_ror:8 row_mask:0x4 bank_mask:0x3
  v_mfma_f32_16x16x32_bf16 v[40:43], v[12:15], a[48:51], 0
  v_mfma_f32_16x16x32_bf16 v[40:43], v[16:19], a[52:55], v[40:43]
  s_nop 0
  v_add_f32_dpp v20, v44, v45 row_ror:8 row_mask:0x4 bank_mask:0xc
  v_mfma_f32_16x16x32_bf16 v[44:47], v[12:15], a[56:59], 0
  v_mfma_f32_16x16x32_bf16 v[44:47], v[16:19], a[60:63], v[44:47]
  s_nop 3
  v_add_f32_dpp v20, v41, v40 row_ror:8 row_mask:0x8 bank_mask:0x3
  v_mfma_f32_16x16x32_bf16 v[40:43], v[12:15], a[64:67], 0
  v_mfma_f32_16x16x32_bf16 v[40:43], v[16:19], a[68:71], v[40:43]
  buffer_load_dwordx4 a[8:11], v0, s[4:7], s32 offen offset:2048 nt
  v_add_f32_dpp v20, v44, v45 row_ror:8 row_mask:0x8 bank_mask:0xc
  v_mfma_f32_16x16x32_bf16 v[44:47], v[12:15], a[72:75], 0
  v_mfma_f32_16x16x32_bf16 v[44:47], v[16:19], a[76:79], v[44:47]
  s_nop 3
  v_add_f32_dpp v21, v41, v40 row_ror:8 row_mask:0x1 bank_mask:0x3
  v_mfma_f32_16x16x32_bf16 v[40:43], v[12:15], a[80:83], 0
  v_mfma_f32_16x16x32_bf16 v[40:43], v[16:19], a[84:87], v[40:43]
  s_nop 0
  v_add_f32_dpp v21, v44, v45 row_ror:8 row_mask:0x1 bank_mask:0xc
  v_mfma_f32_16x16x32_bf16 v[44:47], v[12:15], a[88:91], 0
  v_mfma_f32_16x16x32_bf16 v[44:47], v[16:19], a[92:95], v[44:47]
  s_nop 3
  v_add_f32_dpp v21, v41, v40 row_ror:8 row_mask:0x2 bank_mask:0x3
  v_mfma_f32_16x16x32_bf16 v[40:43], v[12:15], a[96:99], 0
  v_mfma_f32_16x16x32_bf16 v[40:43], v[16:19], a[100:103], v[40:43]
  buffer_load_dwordx4 a[12:15], v0, s[4:7], s32 offen offset:2176 nt
  v_add_f32_dpp v21, v44, v45 row_ror:8 row_mask:0x2 bank_mask:0xc
  v_mfma_f32_16x16x32_bf16 v[44:47], v[12:15], a[104:107], 0
  v_mfma_f32_16x16x32_bf16 v[44:47], v[16:19], a[108:111], v[44:47]
  s_nop 3
  v_add_f32_dpp v21, v41, v40 row_ror:8 row_mask:0x4 bank_mask:0x3
  v_mfma_f32_16x16x32_bf16 v[40:43], v[12:15], a[112:115], 0
  v_mfma_f32_16x16x32_bf16 v[40:43], v[16:19], a[116:119], v[40:43]
  s_nop 0
  v_add_f32_dpp v21, v44, v45 row_ror:8 row_mask:0x4 bank_mask:0xc
  v_mfma_f32_16x16x32_bf16 v[44:47], v[12:15], a[120:123], 0
  v_mfma_f32_16x16x32_bf16 v[44:47], v[16:19], a[124:127], v[44:47]
  s_nop 3
  v_add_f32_dpp v21, v41, v40 row_ror:8 row_mask:0x8 bank_mask:0x3
  v_mfma_f32_16x16x32_bf16 v[40:43], v[12:15], a[128:131], 0
  v_mfma_f32_16x16x32_bf16 v[40:43], v[16:19], a[132:135], v[40:43]
  s_add_u32 s32, s29, 4096
  buffer_load_dwordx4 a[16:19], v0, s[4:7], s32 offen offset:0 nt
  v_add_f32_dpp v21, v44, v45 row_ror:8 row_mask:0x8 bank_mask:0xc
  v_mfma_f32_16x16x32_bf16 v[44:47], v[12:15], a[136:139], 0
  v_mfma_f32_16x16x32_bf16 v[44:47], v[16:19], a[140:143], v[44:47]
  s_nop 2
  v_add_f32_dpp v22, v41, v40 row_ror:8 row_mask:0x1 bank_mask:0x3
  v_mfma_f32_16x16x32_bf16 v[40:43], v[12:15], a[144:147], 0
  v_mfma_f32_16x16x32_bf16 v[40:43], v[16:19], a[148:151], v[40:43]
  s_nop 1
  v_add_f32_dpp v22, v44, v45 row_ror:8 row_mask:0x1 bank_mask:0xc
  v_mfma_f32_16x16x32_bf16 v[44:47], v[12:15], a[152:155], 0
  v_mfma_f32_16x16x32_bf16 v[44:47], v[16:19], a[156:159], v[44:47]
  s_nop 2
  v_add_f32_dpp v22, v41, v40 row_ror:8 row_mask:0x2 bank_mask:0x3
  v_mfma_f32_16x16x32_bf16 v[40:43], v[12:15], a[160:163], 0
  v_mfma_f32_16x16x32_bf16 v[40:43], v[16:19], a[164:167], v[40:43]
  buffer_load_dwordx4 a[20:23], v0, s[4:7], s32 offen offset:128 nt
  s_nop 0
  v_add_f32_dpp v22, v44, v45 row_ror:8 row_mask:0x2 bank_mask:0xc
  v_mfma_f32_16x16x32_bf16 v[44:47], v[12:15], a[168:171], 0
  v_mfma_f32_16x16x32_bf16 v[44:47], v[16:19], a[172:175], v[44:47]
  s_nop 2
  v_add_f32_dpp v22, v41, v40 row_ror:8 row_mask:0x4 bank_mask:0x3
  v_mfma_f32_16x16x32_bf16 v[40:43], v[12:15], a[176:179], 0
  v_mfma_f32_16x16x32_bf16 v[40:43], v[16:19], a[180:183], v[40:43]
  s_nop 1
  v_add_f32_dpp v22, v44, v45 row_ror:8 row_mask:0x4 bank_mask:0xc
  v_mfma_f32_16x16x32_bf16 v[44:47], v[12:15], a[184:187], 0
  v_mfma_f32_16x16x32_bf16 v[44:47], v[16:19], a[188:191], v[44:47]
  s_nop 2
  v_add_f32_dpp v22, v41, v40 row_ror:8 row_mask:0x8 bank_mask:0x3
  v_mfma_f32_16x16x32_bf16 v[40:43], v[12:15], a[192:195], 0
  v_mfma_f32_16x16x32_bf16 v[40:43], v[16:19], a[196:199], v[40:43]
  buffer_load_dwordx4 a[24:27], v0, s[4:7], s32 offen offset:2048 nt
  s_nop 0
  v_add_f32_dpp v22, v44, v45 row_ror:8 row_mask:0x8 bank_mask:0xc
  v_mfma_f32_16x16x32_bf16 v[44:47], v[12:15], a[200:203], 0
  v_mfma_f32_16x16x32_bf16 v[44:47], v[16:19], a[204:207], v[44:47]
  s_nop 2
  v_add_f32_dpp v23, v41, v40 row_ror:8 row_mask:0x1 bank_mask:0x3
  v_mfma_f32_16x16x32_bf16 v[40:43], v[12:15], a[208:211], 0
  v_mfma_f32_16x16x32_bf16 v[40:43], v[16:19], a[212:215], v[40:43]
  s_nop 1
  v_add_f32_dpp v23, v44, v45 row_ror:8 row_mask:0x1 bank_mask:0xc
  v_mfma_f32_16x16x32_bf16 v[44:47], v[12:15], a[216:219], 0
  v_mfma_f32_16x16x32_bf16 v[44:47], v[16:19], a[220:223], v[44:47]
  s_nop 2
  v_add_f32_dpp v23, v41, v40 row_ror:8 row_mask:0x2 bank_mask:0x3
  v_mfma_f32_16x16x32_bf16 v[40:43], v[12:15], a[224:227], 0
  v_mfma_f32_16x16x32_bf16 v[40:43], v[16:19], a[228:231], v[40:43]
  s_waitcnt vmcnt(6)
  buffer_load_dwordx4 a[28:31], v0, s[4:7], s32 offen offset:2176 nt
  v_add_f32_dpp v23, v44, v45 row_ror:8 row_mask:0x2 bank_mask:0xc
  v_mfma_f32_16x16x32_bf16 v[44:47], v[12:15], a[232:235], 0
  v_mfma_f32_16x16x32_bf16 v[44:47], v[16:19], a[236:239], v[44:47]
  s_nop 2
  v_add_f32_dpp v23, v41, v40 row_ror:8 row_mask:0x4 bank_mask:0x3
  v_mfma_f32_16x16x32_bf16 v[40:43], v[12:15], a[240:243], 0
  v_mfma_f32_16x16x32_bf16 v[40:43], v[16:19], a[244:247], v[40:43]
  s_nop 1
  v_add_f32_dpp v23, v44, v45 row_ror:8 row_mask:0x4 bank_mask:0xc
  v_mfma_f32_16x16x32_bf16 v[44:47], v[12:15], a[248:251], 0
  v_mfma_f32_16x16x32_bf16 v[44:47], v[16:19], a[252:255], v[44:47]
  v_mov_b32 v24, 0xff800000
  s_nop 1
  v_add_f32_dpp v23, v41, v40 row_ror:8 row_mask:0x8 bank_mask:0x3
  v_mfma_f32_16x16x32_bf16 v[40:43], v[12:15], v[92:95], 0
  v_mfma_f32_16x16x32_bf16 v[40:43], v[16:19], v[96:99], v[40:43]
  s_waitcnt vmcnt(6)
  s_add_u32 s32, s29, 8192
  buffer_load_dwordx4 a[32:35], v0, s[4:7], s32 offen offset:0 nt
  v_add_f32_dpp v23, v44, v45 row_ror:8 row_mask:0x8 bank_mask:0xc
  v_mfma_f32_16x16x32_bf16 v[44:47], v[12:15], v[100:103], 0
  v_mfma_f32_16x16x32_bf16 v[44:47], v[16:19], v[104:107], v[44:47]
  s_nop 1
  v_add_f32_dpp v24, v41, v40 row_ror:8 row_mask:0x1 bank_mask:0x3
  v_mfma_f32_16x16x32_bf16 v[40:43], v[12:15], v[108:111], 0
  v_mfma_f32_16x16x32_bf16 v[40:43], v[16:19], v[112:115], v[40:43]
  s_nop 2
  v_add_f32_dpp v24, v45, v44 row_ror:8 row_mask:0x2 bank_mask:0x3
  v_mfma_f32_16x16x32_bf16 v[44:47], v[12:15], v[116:119], 0
  v_mfma_f32_16x16x32_bf16 v[44:47], v[16:19], v[120:123], v[44:47]
  s_nop 1
  v_add_f32_dpp v24, v41, v40 row_ror:8 row_mask:0x4 bank_mask:0x3
  s_nop 4
  v_add_f32_dpp v24, v45, v44 row_ror:8 row_mask:0x8 bank_mask:0x3
  v_mul_f32 v20, 0x3e0293ee, v20
  v_mul_f32 v21, 0x3e0293ee, v21
  v_mul_f32 v22, 0x3e0293ee, v22
  v_mul_f32 v23, 0x3e0293ee, v23
  v_mul_f32 v24, 0x3e0293ee, v24
  v_max3_f32 v40, v20, v21, v22
  v_max3_f32 v40, v40, v23, v24
  s_nop 1
  v_max_f32_dpp v40, v40, v40 row_ror:8 row_mask:0xf bank_mask:0xf
  s_nop 1
  v_max_f32_dpp v40, v40, v40 row_ror:4 row_mask:0xf bank_mask:0xf
  s_nop 1
  v_max_f32_dpp v40, v40, v40 row_ror:2 row_mask:0xf bank_mask:0xf
  s_nop 1
  v_max_f32_dpp v40, v40, v40 row_ror:1 row_mask:0xf bank_mask:0xf
  s_nop 1
  v_max_f32_dpp v40, v40, v40 row_bcast:15 row_mask:0xa bank_mask:0xf
  s_nop 1
  v_max_f32_dpp v40, v40, v40 row_bcast:31 row_mask:0xc bank_mask:0xf
  s_nop 0
  v_readlane_b32 s46, v40, 63
  v_mov_b32 v32, 0
  v_mov_b32 v33, 0
  v_mov_b32 v34, 0
  v_mov_b32 v35, 0
  s_mov_b32 s36, s46
  v_subrev_f32 v20, s36, v20
  v_subrev_f32 v21, s36, v21
  v_subrev_f32 v22, s36, v22
  v_subrev_f32 v23, s36, v23
  v_subrev_f32 v24, s36, v24
  v_exp_f32 v20, v20
  v_exp_f32 v21, v21
  v_exp_f32 v22, v22
  v_exp_f32 v23, v23
  v_exp_f32 v24, v24
  v_add_f32 v42, v20, v21
  v_add_f32 v43, v22, v23
  v_add_f32 v42, v42, v24
  v_add_f32 v10, v42, v43
  v_cvt_pk_bf16_f32 v20, v20, v20
  v_cvt_pk_bf16_f32 v21, v21, v21
  v_cvt_pk_bf16_f32 v22, v22, v22
  v_cvt_pk_bf16_f32 v23, v23, v23
  v_cvt_pk_bf16_f32 v24, v24, v24
  s_waitcnt vmcnt(6)
  buffer_load_dwordx4 a[36:39], v0, s[4:7], s32 offen offset:128 nt
  v_and_b32_dpp v48, v20, v6 row_newbcast:0 row_mask:0xf bank_mask:0xf
  v_and_b32_dpp v49, v20, v7 row_newbcast:0 row_mask:0xf bank_mask:0xf
  v_and_b32_dpp v50, v20, v8 row_newbcast:0 row_mask:0xf bank_mask:0xf
  v_and_b32_dpp v51, v20, v9 row_newbcast:0 row_mask:0xf bank_mask:0xf
  s_nop 1
  v_mfma_f32_16x16x32_bf16 v[32:35], v[48:51], v[124:127], v[32:35]
  v_and_b32_dpp v52, v20, v6 row_newbcast:1 row_mask:0xf bank_mask:0xf
  v_and_b32_dpp v53, v20, v7 row_newbcast:1 row_mask:0xf bank_mask:0xf
  v_and_b32_dpp v54, v20, v8 row_newbcast:1 row_mask:0xf bank_mask:0xf
  v_and_b32_dpp v55, v20, v9 row_newbcast:1 row_mask:0xf bank_mask:0xf
  s_nop 1
  v_mfma_f32_16x16x32_bf16 v[32:35], v[52:55], v[128:131], v[32:35]
  v_and_b32_dpp v48, v20, v6 row_newbcast:2 row_mask:0xf bank_mask:0xf
  v_and_b32_dpp v49, v20, v7 row_newbcast:2 row_mask:0xf bank_mask:0xf
  v_and_b32_dpp v50, v20, v8 row_newbcast:2 row_mask:0xf bank_mask:0xf
  v_and_b32_dpp v51, v20, v9 row_newbcast:2 row_mask:0xf bank_mask:0xf
  s_nop 1
  v_mfma_f32_16x16x32_bf16 v[32:35], v[48:51], v[132:135], v[32:35]
  v_and_b32_dpp v52, v20, v6 row_newbcast:3 row_mask:0xf bank_mask:0xf
  v_and_b32_dpp v53, v20, v7 row_newbcast:3 row_mask:0xf bank_mask:0xf
  v_and_b32_dpp v54, v20, v8 row_newbcast:3 row_mask:0xf bank_mask:0xf
  v_and_b32_dpp v55, v20, v9 row_newbcast:3 row_mask:0xf bank_mask:0xf
  s_nop 1
  v_mfma_f32_16x16x32_bf16 v[32:35], v[52:55], v[136:139], v[32:35]
  s_waitcnt vmcnt(6)
  buffer_load_dwordx4 a[40:43], v0, s[4:7], s32 offen offset:2048 nt
  v_and_b32_dpp v48, v20, v6 row_newbcast:4 row_mask:0xf bank_mask:0xf
  v_and_b32_dpp v49, v20, v7 row_newbcast:4 row_mask:0xf bank_mask:0xf
  v_and_b32_dpp v50, v20, v8 row_newbcast:4 row_mask:0xf bank_mask:0xf
  v_and_b32_dpp v51, v20, v9 row_newbcast:4 row_mask:0xf bank_mask:0xf
  s_nop 1
  v_mfma_f32_16x16x32_bf16 v[32:35], v[48:51], v[140:143], v[32:35]
  v_and_b32_dpp v52, v20, v6 row_newbcast:5 row_mask:0xf bank_mask:0xf
  v_and_b32_dpp v53, v20, v7 row_newbcast:5 row_mask:0xf bank_mask:0xf
  v_and_b32_dpp v54, v20, v8 row_newbcast:5 row_mask:0xf bank_mask:0xf
  v_and_b32_dpp v55, v20, v9 row_newbcast:5 row_mask:0xf bank_mask:0xf
  s_nop 1
  v_mfma_f32_16x16x32_bf16 v[32:35], v[52:55], v[144:147], v[32:35]
  v_and_b32_dpp v48, v20, v6 row_newbcast:6 row_mask:0xf bank_mask:0xf
  v_and_b32_dpp v49, v20, v7 row_newbcast:6 row_mask:0xf bank_mask:0xf
  v_and_b32_dpp v50, v20, v8 row_newbcast:6 row_mask:0xf bank_mask:0xf
  v_and_b32_dpp v51, v20, v9 row_newbcast:6 row_mask:0xf bank_mask:0xf
  s_nop 1
  v_mfma_f32_16x16x32_bf16 v[32:35], v[48:51], v[148:151], v[32:35]
  v_and_b32_dpp v52, v20, v6 row_newbcast:7 row_mask:0xf bank_mask:0xf
  v_and_b32_dpp v53, v20, v7 row_newbcast:7 row_mask:0xf bank_mask:0xf
  v_and_b32_dpp v54, v20, v8 row_newbcast:7 row_mask:0xf bank_mask:0xf
  v_and_b32_dpp v55, v20, v9 row_newbcast:7 row_mask:0xf bank_mask:0xf
  s_nop 1
  v_mfma_f32_16x16x32_bf16 v[32:35], v[52:55], v[152:155], v[32:35]
  s_waitcnt vmcnt(6)
  buffer_load_dwordx4 a[44:47], v0, s[4:7], s32 offen offset:2176 nt
  v_and_b32_dpp v48, v20, v6 row_newbcast:8 row_mask:0xf bank_mask:0xf
  v_and_b32_dpp v49, v20, v7 row_newbcast:8 row_mask:0xf bank_mask:0xf
  v_and_b32_dpp v50, v20, v8 row_newbcast:8 row_mask:0xf bank_mask:0xf
  v_and_b32_dpp v51, v20, v9 row_newbcast:8 row_mask:0xf bank_mask:0xf
  s_nop 1
  v_mfma_f32_16x16x32_bf16 v[32:35], v[48:51], v[156:159], v[32:35]
  v_and_b32_dpp v52, v20, v6 row_newbcast:9 row_mask:0xf bank_mask:0xf
  v_and_b32_dpp v53, v20, v7 row_newbcast:9 row_mask:0xf bank_mask:0xf
  v_and_b32_dpp v54, v20, v8 row_newbcast:9 row_mask:0xf bank_mask:0xf
  v_and_b32_dpp v55, v20, v9 row_newbcast:9 row_mask:0xf bank_mask:0xf
  s_nop 1
  v_mfma_f32_16x16x32_bf16 v[32:35], v[52:55], v[160:163], v[32:35]
  v_and_b32_dpp v48, v20, v6 row_newbcast:10 row_mask:0xf bank_mask:0xf
  v_and_b32_dpp v49, v20, v7 row_newbcast:10 row_mask:0xf bank_mask:0xf
  v_and_b32_dpp v50, v20, v8 row_newbcast:10 row_mask:0xf bank_mask:0xf
  v_and_b32_dpp v51, v20, v9 row_newbcast:10 row_mask:0xf bank_mask:0xf
  s_nop 1
  v_mfma_f32_16x16x32_bf16 v[32:35], v[48:51], v[164:167], v[32:35]
  v_and_b32_dpp v52, v20, v6 row_newbcast:11 row_mask:0xf bank_mask:0xf
  v_and_b32_dpp v53, v20, v7 row_newbcast:11 row_mask:0xf bank_mask:0xf
  v_and_b32_dpp v54, v20, v8 row_newbcast:11 row_mask:0xf bank_mask:0xf
  v_and_b32_dpp v55, v20, v9 row_newbcast:11 row_mask:0xf bank_mask:0xf
  s_nop 1
  v_mfma_f32_16x16x32_bf16 v[32:35], v[52:55], v[168:171], v[32:35]
  s_waitcnt vmcnt(6)
  s_add_u32 s32, s29, 12288
  buffer_load_dwordx4 a[48:51], v0, s[4:7], s32 offen offset:0 nt
  v_and_b32_dpp v48, v20, v6 row_newbcast:12 row_mask:0xf bank_mask:0xf
  v_and_b32_dpp v49, v20, v7 row_newbcast:12 row_mask:0xf bank_mask:0xf
  v_and_b32_dpp v50, v20, v8 row_newbcast:12 row_mask:0xf bank_mask:0xf
  v_and_b32_dpp v51, v20, v9 row_newbcast:12 row_mask:0xf bank_mask:0xf
  s_nop 1
  v_mfma_f32_16x16x32_bf16 v[32:35], v[48:51], v[172:175], v[32:35]
  v_and_b32_dpp v52, v20, v6 row_newbcast:13 row_mask:0xf bank_mask:0xf
  v_and_b32_dpp v53, v20, v7 row_newbcast:13 row_mask:0xf bank_mask:0xf
  v_and_b32_dpp v54, v20, v8 row_newbcast:13 row_mask:0xf bank_mask:0xf
  v_and_b32_dpp v55, v20, v9 row_newbcast:13 row_mask:0xf bank_mask:0xf
  s_nop 1
  v_mfma_f32_16x16x32_bf16 v[32:35], v[52:55], v[176:179], v[32:35]
  v_and_b32_dpp v48, v20, v6 row_newbcast:14 row_mask:0xf bank_mask:0xf
  v_and_b32_dpp v49, v20, v7 row_newbcast:14 row_mask:0xf bank_mask:0xf
  v_and_b32_dpp v50, v20, v8 row_newbcast:14 row_mask:0xf bank_mask:0xf
  v_and_b32_dpp v51, v20, v9 row_newbcast:14 row_mask:0xf bank_mask:0xf
  s_nop 1
  v_mfma_f32_16x16x32_bf16 v[32:35], v[48:51], v[180:183], v[32:35]
  v_and_b32_dpp v52, v20, v6 row_newbcast:15 row_mask:0xf bank_mask:0xf
  v_and_b32_dpp v53, v20, v7 row_newbcast:15 row_mask:0xf bank_mask:0xf
  v_and_b32_dpp v54, v20, v8 row_newbcast:15 row_mask:0xf bank_mask:0xf
  v_and_b32_dpp v55, v20, v9 row_newbcast:15 row_mask:0xf bank_mask:0xf
  s_nop 1
  v_mfma_f32_16x16x32_bf16 v[32:35], v[52:55], v[184:187], v[32:35]
  s_waitcnt vmcnt(6)
  buffer_load_dwordx4 a[52:55], v0, s[4:7], s32 offen offset:128 nt
  v_and_b32_dpp v48, v21, v6 row_newbcast:0 row_mask:0xf bank_mask:0xf
  v_and_b32_dpp v49, v21, v7 row_newbcast:0 row_mask:0xf bank_mask:0xf
  v_and_b32_dpp v50, v21, v8 row_newbcast:0 row_mask:0xf bank_mask:0xf
  v_and_b32_dpp v51, v21, v9 row_newbcast:0 row_mask:0xf bank_mask:0xf
  s_nop 1
  v_mfma_f32_16x16x32_bf16 v[32:35], v[48:51], v[188:191], v[32:35]
  v_and_b32_dpp v52, v21, v6 row_newbcast:1 row_mask:0xf bank_mask:0xf
  v_and_b32_dpp v53, v21, v7 row_newbcast:1 row_mask:0xf bank_mask:0xf
  v_and_b32_dpp v54, v21, v8 row_newbcast:1 row_mask:0xf bank_mask:0xf
  v_and_b32_dpp v55, v21, v9 row_newbcast:1 row_mask:0xf bank_mask:0xf
  s_nop 1
  v_mfma_f32_16x16x32_bf16 v[32:35], v[52:55], v[192:195], v[32:35]
  v_and_b32_dpp v48, v21, v6 row_newbcast:2 row_mask:0xf bank_mask:0xf
  v_and_b32_dpp v49, v21, v7 row_newbcast:2 row_mask:0xf bank_mask:0xf
  v_and_b32_dpp v50, v21, v8 row_newbcast:2 row_mask:0xf bank_mask:0xf
  v_and_b32_dpp v51, v21, v9 row_newbcast:2 row_mask:0xf bank_mask:0xf
  s_nop 1
  v_mfma_f32_16x16x32_bf16 v[32:35], v[48:51], v[196:199], v[32:35]
  v_and_b32_dpp v52, v21, v6 row_newbcast:3 row_mask:0xf bank_mask:0xf
  v_and_b32_dpp v53, v21, v7 row_newbcast:3 row_mask:0xf bank_mask:0xf
  v_and_b32_dpp v54, v21, v8 row_newbcast:3 row_mask:0xf bank_mask:0xf
  v_and_b32_dpp v55, v21, v9 row_newbcast:3 row_mask:0xf bank_mask:0xf
  s_nop 1
  v_mfma_f32_16x16x32_bf16 v[32:35], v[52:55], v[200:203], v[32:35]
  s_waitcnt vmcnt(6)
  buffer_load_dwordx4 a[56:59], v0, s[4:7], s32 offen offset:2048 nt
  v_and_b32_dpp v48, v21, v6 row_newbcast:4 row_mask:0xf bank_mask:0xf
  v_and_b32_dpp v49, v21, v7 row_newbcast:4 row_mask:0xf bank_mask:0xf
  v_and_b32_dpp v50, v21, v8 row_newbcast:4 row_mask:0xf bank_mask:0xf
  v_and_b32_dpp v51, v21, v9 row_newbcast:4 row_mask:0xf bank_mask:0xf
  s_nop 1
  v_mfma_f32_16x16x32_bf16 v[32:35], v[48:51], v[204:207], v[32:35]
  v_and_b32_dpp v52, v21, v6 row_newbcast:5 row_mask:0xf bank_mask:0xf
  v_and_b32_dpp v53, v21, v7 row_newbcast:5 row_mask:0xf bank_mask:0xf
  v_and_b32_dpp v54, v21, v8 row_newbcast:5 row_mask:0xf bank_mask:0xf
  v_and_b32_dpp v55, v21, v9 row_newbcast:5 row_mask:0xf bank_mask:0xf
  s_nop 1
  v_mfma_f32_16x16x32_bf16 v[32:35], v[52:55], v[208:211], v[32:35]
  v_and_b32_dpp v48, v21, v6 row_newbcast:6 row_mask:0xf bank_mask:0xf
  v_and_b32_dpp v49, v21, v7 row_newbcast:6 row_mask:0xf bank_mask:0xf
  v_and_b32_dpp v50, v21, v8 row_newbcast:6 row_mask:0xf bank_mask:0xf
  v_and_b32_dpp v51, v21, v9 row_newbcast:6 row_mask:0xf bank_mask:0xf
  s_nop 1
  v_mfma_f32_16x16x32_bf16 v[32:35], v[48:51], v[212:215], v[32:35]
  v_and_b32_dpp v52, v21, v6 row_newbcast:7 row_mask:0xf bank_mask:0xf
  v_and_b32_dpp v53, v21, v7 row_newbcast:7 row_mask:0xf bank_mask:0xf
  v_and_b32_dpp v54, v21, v8 row_newbcast:7 row_mask:0xf bank_mask:0xf
  v_and_b32_dpp v55, v21, v9 row_newbcast:7 row_mask:0xf bank_mask:0xf
  s_nop 1
  v_mfma_f32_16x16x32_bf16 v[32:35], v[52:55], v[216:219], v[32:35]
  s_waitcnt vmcnt(6)
  buffer_load_dwordx4 a[60:63], v0, s[4:7], s32 offen offset:2176 nt
  v_and_b32_dpp v48, v21, v6 row_newbcast:8 row_mask:0xf bank_mask:0xf
  v_and_b32_dpp v49, v21, v7 row_newbcast:8 row_mask:0xf bank_mask:0xf
  v_and_b32_dpp v50, v21, v8 row_newbcast:8 row_mask:0xf bank_mask:0xf
  v_and_b32_dpp v51, v21, v9 row_newbcast:8 row_mask:0xf bank_mask:0xf
  s_nop 1
  v_mfma_f32_16x16x32_bf16 v[32:35], v[48:51], v[220:223], v[32:35]
  v_and_b32_dpp v52, v21, v6 row_newbcast:9 row_mask:0xf bank_mask:0xf
  v_and_b32_dpp v53, v21, v7 row_newbcast:9 row_mask:0xf bank_mask:0xf
  v_and_b32_dpp v54, v21, v8 row_newbcast:9 row_mask:0xf bank_mask:0xf
  v_and_b32_dpp v55, v21, v9 row_newbcast:9 row_mask:0xf bank_mask:0xf
  s_nop 1
  v_mfma_f32_16x16x32_bf16 v[32:35], v[52:55], v[224:227], v[32:35]
  v_and_b32_dpp v48, v21, v6 row_newbcast:10 row_mask:0xf bank_mask:0xf
  v_and_b32_dpp v49, v21, v7 row_newbcast:10 row_mask:0xf bank_mask:0xf
  v_and_b32_dpp v50, v21, v8 row_newbcast:10 row_mask:0xf bank_mask:0xf
  v_and_b32_dpp v51, v21, v9 row_newbcast:10 row_mask:0xf bank_mask:0xf
  s_nop 1
  v_mfma_f32_16x16x32_bf16 v[32:35], v[48:51], v[228:231], v[32:35]
  v_and_b32_dpp v52, v21, v6 row_newbcast:11 row_mask:0xf bank_mask:0xf
  v_and_b32_dpp v53, v21, v7 row_newbcast:11 row_mask:0xf bank_mask:0xf
  v_and_b32_dpp v54, v21, v8 row_newbcast:11 row_mask:0xf bank_mask:0xf
  v_and_b32_dpp v55, v21, v9 row_newbcast:11 row_mask:0xf bank_mask:0xf
  s_nop 1
  v_mfma_f32_16x16x32_bf16 v[32:35], v[52:55], v[232:235], v[32:35]
  s_waitcnt vmcnt(6)
  s_add_u32 s32, s29, 65536
  buffer_load_dwordx4 a[64:67], v0, s[4:7], s32 offen offset:0 nt
  v_and_b32_dpp v48, v21, v6 row_newbcast:12 row_mask:0xf bank_mask:0xf
  v_and_b32_dpp v49, v21, v7 row_newbcast:12 row_mask:0xf bank_mask:0xf
  v_and_b32_dpp v50, v21, v8 row_newbcast:12 row_mask:0xf bank_mask:0xf
  v_and_b32_dpp v51, v21, v9 row_newbcast:12 row_mask:0xf bank_mask:0xf
  s_nop 1
  v_mfma_f32_16x16x32_bf16 v[32:35], v[48:51], v[236:239], v[32:35]
  v_and_b32_dpp v52, v21, v6 row_newbcast:13 row_mask:0xf bank_mask:0xf
  v_and_b32_dpp v53, v21, v7 row_newbcast:13 row_mask:0xf bank_mask:0xf
  v_and_b32_dpp v54, v21, v8 row_newbcast:13 row_mask:0xf bank_mask:0xf
  v_and_b32_dpp v55, v21, v9 row_newbcast:13 row_mask:0xf bank_mask:0xf
  s_nop 1
  v_mfma_f32_16x16x32_bf16 v[32:35], v[52:55], v[240:243], v[32:35]
  v_and_b32_dpp v48, v21, v6 row_newbcast:14 row_mask:0xf bank_mask:0xf
  v_and_b32_dpp v49, v21, v7 row_newbcast:14 row_mask:0xf bank_mask:0xf
  v_and_b32_dpp v50, v21, v8 row_newbcast:14 row_mask:0xf bank_mask:0xf
  v_and_b32_dpp v51, v21, v9 row_newbcast:14 row_mask:0xf bank_mask:0xf
  s_nop 1
  v_mfma_f32_16x16x32_bf16 v[32:35], v[48:51], v[244:247], v[32:35]
  v_and_b32_dpp v52, v21, v6 row_newbcast:15 row_mask:0xf bank_mask:0xf
  v_and_b32_dpp v53, v21, v7 row_newbcast:15 row_mask:0xf bank_mask:0xf
  v_and_b32_dpp v54, v21, v8 row_newbcast:15 row_mask:0xf bank_mask:0xf
  v_and_b32_dpp v55, v21, v9 row_newbcast:15 row_mask:0xf bank_mask:0xf
  s_nop 1
  v_mfma_f32_16x16x32_bf16 v[32:35], v[52:55], v[248:251], v[32:35]
  s_waitcnt vmcnt(6)
  buffer_load_dwordx4 a[68:71], v0, s[4:7], s32 offen offset:128 nt
  v_and_b32_dpp v48, v22, v6 row_newbcast:0 row_mask:0xf bank_mask:0xf
  v_and_b32_dpp v49, v22, v7 row_newbcast:0 row_mask:0xf bank_mask:0xf
  v_and_b32_dpp v50, v22, v8 row_newbcast:0 row_mask:0xf bank_mask:0xf
  v_and_b32_dpp v51, v22, v9 row_newbcast:0 row_mask:0xf bank_mask:0xf
  s_nop 1
  v_mfma_f32_16x16x32_bf16 v[32:35], v[48:51], v[252:255], v[32:35]
  ds_read_b128 v[56:59], v4 offset:0
  v_and_b32_dpp v52, v22, v6 row_newbcast:1 row_mask:0xf bank_mask:0xf
  v_and_b32_dpp v53, v22, v7 row_newbcast:1 row_mask:0xf bank_mask:0xf
  v_and_b32_dpp v54, v22, v8 row_newbcast:1 row_mask:0xf bank_mask:0xf
  v_and_b32_dpp v55, v22, v9 row_newbcast:1 row_mask:0xf bank_mask:0xf
  s_waitcnt lgkmcnt(0)
  s_nop 0
  v_mfma_f32_16x16x32_bf16 v[32:35], v[52:55], v[56:59], v[32:35]
  ds_read_b128 v[56:59], v4 offset:1024
  v_and_b32_dpp v48, v22, v6 row_newbcast:2 row_mask:0xf bank_mask:0xf
  v_and_b32_dpp v49, v22, v7 row_newbcast:2 row_mask:0xf bank_mask:0xf
  v_and_b32_dpp v50, v22, v8 row_newbcast:2 row_mask:0xf bank_mask:0xf
  v_and_b32_dpp v51, v22, v9 row_newbcast:2 row_mask:0xf bank_mask:0xf
  s_waitcnt lgkmcnt(0)
  s_nop 0
  v_mfma_f32_16x16x32_bf16 v[32:35], v[48:51], v[56:59], v[32:35]
  ds_read_b128 v[56:59], v4 offset:2048
  v_and_b32_dpp v52, v22, v6 row_newbcast:3 row_mask:0xf bank_mask:0xf
  v_and_b32_dpp v53, v22, v7 row_newbcast:3 row_mask:0xf bank_mask:0xf
  v_and_b32_dpp v54, v22, v8 row_newbcast:3 row_mask:0xf bank_mask:0xf
  v_and_b32_dpp v55, v22, v9 row_newbcast:3 row_mask:0xf bank_mask:0xf
  s_waitcnt lgkmcnt(0)
  s_nop 0
  v_mfma_f32_16x16x32_bf16 v[32:35], v[52:55], v[56:59], v[32:35]
  s_waitcnt vmcnt(6)
  buffer_load_dwordx4 a[72:75], v0, s[4:7], s32 offen offset:2048 nt
  ds_read_b128 v[56:59], v4 offset:3072
  v_and_b32_dpp v48, v22, v6 row_newbcast:4 row_mask:0xf bank_mask:0xf
  v_and_b32_dpp v49, v22, v7 row_newbcast:4 row_mask:0xf bank_mask:0xf
  v_and_b32_dpp v50, v22, v8 row_newbcast:4 row_mask:0xf bank_mask:0xf
  v_and_b32_dpp v51, v22, v9 row_newbcast:4 row_mask:0xf bank_mask:0xf
  s_waitcnt lgkmcnt(0)
  s_nop 0
  v_mfma_f32_16x16x32_bf16 v[32:35], v[48:51], v[56:59], v[32:35]
  ds_read_b128 v[56:59], v4 offset:4096
  v_and_b32_dpp v52, v22, v6 row_newbcast:5 row_mask:0xf bank_mask:0xf
  v_and_b32_dpp v53, v22, v7 row_newbcast:5 row_mask:0xf bank_mask:0xf
  v_and_b32_dpp v54, v22, v8 row_newbcast:5 row_mask:0xf bank_mask:0xf
  v_and_b32_dpp v55, v22, v9 row_newbcast:5 row_mask:0xf bank_mask:0xf
  s_waitcnt lgkmcnt(0)
  s_nop 0
  v_mfma_f32_16x16x32_bf16 v[32:35], v[52:55], v[56:59], v[32:35]
  ds_read_b128 v[56:59], v4 offset:5120
  v_and_b32_dpp v48, v22, v6 row_newbcast:6 row_mask:0xf bank_mask:0xf
  v_and_b32_dpp v49, v22, v7 row_newbcast:6 row_mask:0xf bank_mask:0xf
  v_and_b32_dpp v50, v22, v8 row_newbcast:6 row_mask:0xf bank_mask:0xf
  v_and_b32_dpp v51, v22, v9 row_newbcast:6 row_mask:0xf bank_mask:0xf
  s_waitcnt lgkmcnt(0)
  s_nop 0
  v_mfma_f32_16x16x32_bf16 v[32:35], v[48:51], v[56:59], v[32:35]
  ds_read_b128 v[56:59], v4 offset:6144
  v_and_b32_dpp v52, v22, v6 row_newbcast:7 row_mask:0xf bank_mask:0xf
  v_and_b32_dpp v53, v22, v7 row_newbcast:7 row_mask:0xf bank_mask:0xf
  v_and_b32_dpp v54, v22, v8 row_newbcast:7 row_mask:0xf bank_mask:0xf
  v_and_b32_dpp v55, v22, v9 row_newbcast:7 row_mask:0xf bank_mask:0xf
  s_waitcnt lgkmcnt(0)
  s_nop 0
  v_mfma_f32_16x16x32_bf16 v[32:35], v[52:55], v[56:59], v[32:35]
  s_waitcnt vmcnt(6)
  buffer_load_dwordx4 a[76:79], v0, s[4:7], s32 offen offset:2176 nt
  ds_read_b128 v[56:59], v4 offset:7168
  v_and_b32_dpp v48, v22, v6 row_newbcast:8 row_mask:0xf bank_mask:0xf
  v_and_b32_dpp v49, v22, v7 row_newbcast:8 row_mask:0xf bank_mask:0xf
  v_and_b32_dpp v50, v22, v8 row_newbcast:8 row_mask:0xf bank_mask:0xf
  v_and_b32_dpp v51, v22, v9 row_newbcast:8 row_mask:0xf bank_mask:0xf
  s_waitcnt lgkmcnt(0)
  s_nop 0
  v_mfma_f32_16x16x32_bf16 v[32:35], v[48:51], v[56:59], v[32:35]
  ds_read_b128 v[56:59], v4 offset:8192
  v_and_b32_dpp v52, v22, v6 row_newbcast:9 row_mask:0xf bank_mask:0xf
  v_and_b32_dpp v53, v22, v7 row_newbcast:9 row_mask:0xf bank_mask:0xf
  v_and_b32_dpp v54, v22, v8 row_newbcast:9 row_mask:0xf bank_mask:0xf
  v_and_b32_dpp v55, v22, v9 row_newbcast:9 row_mask:0xf bank_mask:0xf
  s_waitcnt lgkmcnt(0)
  s_nop 0
  v_mfma_f32_16x16x32_bf16 v[32:35], v[52:55], v[56:59], v[32:35]
  ds_read_b128 v[56:59], v4 offset:9216
  v_and_b32_dpp v48, v22, v6 row_newbcast:10 row_mask:0xf bank_mask:0xf
  v_and_b32_dpp v49, v22, v7 row_newbcast:10 row_mask:0xf bank_mask:0xf
  v_and_b32_dpp v50, v22, v8 row_newbcast:10 row_mask:0xf bank_mask:0xf
  v_and_b32_dpp v51, v22, v9 row_newbcast:10 row_mask:0xf bank_mask:0xf
  s_waitcnt lgkmcnt(0)
  s_nop 0
  v_mfma_f32_16x16x32_bf16 v[32:35], v[48:51], v[56:59], v[32:35]
  ds_read_b128 v[56:59], v4 offset:10240
  v_and_b32_dpp v52, v22, v6 row_newbcast:11 row_mask:0xf bank_mask:0xf
  v_and_b32_dpp v53, v22, v7 row_newbcast:11 row_mask:0xf bank_mask:0xf
  v_and_b32_dpp v54, v22, v8 row_newbcast:11 row_mask:0xf bank_mask:0xf
  v_and_b32_dpp v55, v22, v9 row_newbcast:11 row_mask:0xf bank_mask:0xf
  s_waitcnt lgkmcnt(0)
  s_nop 0
  v_mfma_f32_16x16x32_bf16 v[32:35], v[52:55], v[56:59], v[32:35]
  s_waitcnt vmcnt(6)
  s_add_u32 s32, s29, 69632
  buffer_load_dwordx4 a[80:83], v0, s[4:7], s32 offen offset:0 nt
  ds_read_b128 v[56:59], v4 offset:11264
  v_and_b32_dpp v48, v22, v6 row_newbcast:12 row_mask:0xf bank_mask:0xf
  v_and_b32_dpp v49, v22, v7 row_newbcast:12 row_mask:0xf bank_mask:0xf
  v_and_b32_dpp v50, v22, v8 row_newbcast:12 row_mask:0xf bank_mask:0xf
  v_and_b32_dpp v51, v22, v9 row_newbcast:12 row_mask:0xf bank_mask:0xf
  s_waitcnt lgkmcnt(0)
  s_nop 0
  v_mfma_f32_16x16x32_bf16 v[32:35], v[48:51], v[56:59], v[32:35]
  ds_read_b128 v[56:59], v4 offset:12288
  v_and_b32_dpp v52, v22, v6 row_newbcast:13 row_mask:0xf bank_mask:0xf
  v_and_b32_dpp v53, v22, v7 row_newbcast:13 row_mask:0xf bank_mask:0xf
  v_and_b32_dpp v54, v22, v8 row_newbcast:13 row_mask:0xf bank_mask:0xf
  v_and_b32_dpp v55, v22, v9 row_newbcast:13 row_mask:0xf bank_mask:0xf
  s_waitcnt lgkmcnt(0)
  s_nop 0
  v_mfma_f32_16x16x32_bf16 v[32:35], v[52:55], v[56:59], v[32:35]
  ds_read_b128 v[56:59], v4 offset:13312
  v_and_b32_dpp v48, v22, v6 row_newbcast:14 row_mask:0xf bank_mask:0xf
  v_and_b32_dpp v49, v22, v7 row_newbcast:14 row_mask:0xf bank_mask:0xf
  v_and_b32_dpp v50, v22, v8 row_newbcast:14 row_mask:0xf bank_mask:0xf
  v_and_b32_dpp v51, v22, v9 row_newbcast:14 row_mask:0xf bank_mask:0xf
  s_waitcnt lgkmcnt(0)
  s_nop 0
  v_mfma_f32_16x16x32_bf16 v[32:35], v[48:51], v[56:59], v[32:35]
  ds_read_b128 v[56:59], v4 offset:14336
  v_and_b32_dpp v52, v22, v6 row_newbcast:15 row_mask:0xf bank_mask:0xf
  v_and_b32_dpp v53, v22, v7 row_newbcast:15 row_mask:0xf bank_mask:0xf
  v_and_b32_dpp v54, v22, v8 row_newbcast:15 row_mask:0xf bank_mask:0xf
  v_and_b32_dpp v55, v22, v9 row_newbcast:15 row_mask:0xf bank_mask:0xf
  s_waitcnt lgkmcnt(0)
  s_nop 0
  v_mfma_f32_16x16x32_bf16 v[32:35], v[52:55], v[56:59], v[32:35]
  s_waitcnt vmcnt(6)
  buffer_load_dwordx4 a[84:87], v0, s[4:7], s32 offen offset:128 nt
  ds_read_b128 v[56:59], v4 offset:15360
  v_and_b32_dpp v48, v23, v6 row_newbcast:0 row_mask:0xf bank_mask:0xf
  v_and_b32_dpp v49, v23, v7 row_newbcast:0 row_mask:0xf bank_mask:0xf
  v_and_b32_dpp v50, v23, v8 row_newbcast:0 row_mask:0xf bank_mask:0xf
  v_and_b32_dpp v51, v23, v9 row_newbcast:0 row_mask:0xf bank_mask:0xf
  s_waitcnt lgkmcnt(0)
  s_nop 0
  v_mfma_f32_16x16x32_bf16 v[32:35], v[48:51], v[56:59], v[32:35]
  ds_read_b128 v[56:59], v4 offset:16384
  v_and_b32_dpp v52, v23, v6 row_newbcast:1 row_mask:0xf bank_mask:0xf
  v_and_b32_dpp v53, v23, v7 row_newbcast:1 row_mask:0xf bank_mask:0xf
  v_and_b32_dpp v54, v23, v8 row_newbcast:1 row_mask:0xf bank_mask:0xf
  v_and_b32_dpp v55, v23, v9 row_newbcast:1 row_mask:0xf bank_mask:0xf
  s_waitcnt lgkmcnt(0)
  s_nop 0
  v_mfma_f32_16x16x32_bf16 v[32:35], v[52:55], v[56:59], v[32:35]
  ds_read_b128 v[56:59], v4 offset:17408
  v_and_b32_dpp v48, v23, v6 row_newbcast:2 row_mask:0xf bank_mask:0xf
  v_and_b32_dpp v49, v23, v7 row_newbcast:2 row_mask:0xf bank_mask:0xf
  v_and_b32_dpp v50, v23, v8 row_newbcast:2 row_mask:0xf bank_mask:0xf
  v_and_b32_dpp v51, v23, v9 row_newbcast:2 row_mask:0xf bank_mask:0xf
  s_waitcnt lgkmcnt(0)
  s_nop 0
  v_mfma_f32_16x16x32_bf16 v[32:35], v[48:51], v[56:59], v[32:35]
  ds_read_b128 v[56:59], v4 offset:18432
  v_and_b32_dpp v52, v23, v6 row_newbcast:3 row_mask:0xf bank_mask:0xf
  v_and_b32_dpp v53, v23, v7 row_newbcast:3 row_mask:0xf bank_mask:0xf
  v_and_b32_dpp v54, v23, v8 row_newbcast:3 row_mask:0xf bank_mask:0xf
  v_and_b32_dpp v55, v23, v9 row_newbcast:3 row_mask:0xf bank_mask:0xf
  s_waitcnt lgkmcnt(0)
  s_nop 0
  v_mfma_f32_16x16x32_bf16 v[32:35], v[52:55], v[56:59], v[32:35]
  s_waitcnt vmcnt(6)
  buffer_load_dwordx4 a[88:91], v0, s[4:7], s32 offen offset:2048 nt
  ds_read_b128 v[56:59], v4 offset:19456
  v_and_b32_dpp v48, v23, v6 row_newbcast:4 row_mask:0xf bank_mask:0xf
  v_and_b32_dpp v49, v23, v7 row_newbcast:4 row_mask:0xf bank_mask:0xf
  v_and_b32_dpp v50, v23, v8 row_newbcast:4 row_mask:0xf bank_mask:0xf
  v_and_b32_dpp v51, v23, v9 row_newbcast:4 row_mask:0xf bank_mask:0xf
  s_waitcnt lgkmcnt(0)
  s_nop 0
  v_mfma_f32_16x16x32_bf16 v[32:35], v[48:51], v[56:59], v[32:35]
  ds_read_b128 v[56:59], v4 offset:20480
  v_and_b32_dpp v52, v23, v6 row_newbcast:5 row_mask:0xf bank_mask:0xf
  v_and_b32_dpp v53, v23, v7 row_newbcast:5 row_mask:0xf bank_mask:0xf
  v_and_b32_dpp v54, v23, v8 row_newbcast:5 row_mask:0xf bank_mask:0xf
  v_and_b32_dpp v55, v23, v9 row_newbcast:5 row_mask:0xf bank_mask:0xf
  s_waitcnt lgkmcnt(0)
  s_nop 0
  v_mfma_f32_16x16x32_bf16 v[32:35], v[52:55], v[56:59], v[32:35]
  ds_read_b128 v[56:59], v4 offset:21504
  v_and_b32_dpp v48, v23, v6 row_newbcast:6 row_mask:0xf bank_mask:0xf
  v_and_b32_dpp v49, v23, v7 row_newbcast:6 row_mask:0xf bank_mask:0xf
  v_and_b32_dpp v50, v23, v8 row_newbcast:6 row_mask:0xf bank_mask:0xf
  v_and_b32_dpp v51, v23, v9 row_newbcast:6 row_mask:0xf bank_mask:0xf
  s_waitcnt lgkmcnt(0)
  s_nop 0
  v_mfma_f32_16x16x32_bf16 v[32:35], v[48:51], v[56:59], v[32:35]
  ds_read_b128 v[56:59], v4 offset:22528
  v_and_b32_dpp v52, v23, v6 row_newbcast:7 row_mask:0xf bank_mask:0xf
  v_and_b32_dpp v53, v23, v7 row_newbcast:7 row_mask:0xf bank_mask:0xf
  v_and_b32_dpp v54, v23, v8 row_newbcast:7 row_mask:0xf bank_mask:0xf
  v_and_b32_dpp v55, v23, v9 row_newbcast:7 row_mask:0xf bank_mask:0xf
  s_waitcnt lgkmcnt(0)
  s_nop 0
  v_mfma_f32_16x16x32_bf16 v[32:35], v[52:55], v[56:59], v[32:35]
  s_waitcnt vmcnt(6)
  buffer_load_dwordx4 a[92:95], v0, s[4:7], s32 offen offset:2176 nt
  ds_read_b128 v[56:59], v4 offset:23552
  v_and_b32_dpp v48, v23, v6 row_newbcast:8 row_mask:0xf bank_mask:0xf
  v_and_b32_dpp v49, v23, v7 row_newbcast:8 row_mask:0xf bank_mask:0xf
  v_and_b32_dpp v50, v23, v8 row_newbcast:8 row_mask:0xf bank_mask:0xf
  v_and_b32_dpp v51, v23, v9 row_newbcast:8 row_mask:0xf bank_mask:0xf
  s_waitcnt lgkmcnt(0)
  s_nop 0
  v_mfma_f32_16x16x32_bf16 v[32:35], v[48:51], v[56:59], v[32:35]
  ds_read_b128 v[56:59], v4 offset:24576
  v_and_b32_dpp v52, v23, v6 row_newbcast:9 row_mask:0xf bank_mask:0xf
  v_and_b32_dpp v53, v23, v7 row_newbcast:9 row_mask:0xf bank_mask:0xf
  v_and_b32_dpp v54, v23, v8 row_newbcast:9 row_mask:0xf bank_mask:0xf
  v_and_b32_dpp v55, v23, v9 row_newbcast:9 row_mask:0xf bank_mask:0xf
  s_waitcnt lgkmcnt(0)
  s_nop 0
  v_mfma_f32_16x16x32_bf16 v[32:35], v[52:55], v[56:59], v[32:35]
  ds_read_b128 v[56:59], v4 offset:25600
  v_and_b32_dpp v48, v23, v6 row_newbcast:10 row_mask:0xf bank_mask:0xf
  v_and_b32_dpp v49, v23, v7 row_newbcast:10 row_mask:0xf bank_mask:0xf
  v_and_b32_dpp v50, v23, v8 row_newbcast:10 row_mask:0xf bank_mask:0xf
  v_and_b32_dpp v51, v23, v9 row_newbcast:10 row_mask:0xf bank_mask:0xf
  s_waitcnt lgkmcnt(0)
  s_nop 0
  v_mfma_f32_16x16x32_bf16 v[32:35], v[48:51], v[56:59], v[32:35]
  ds_read_b128 v[56:59], v4 offset:26624
  v_and_b32_dpp v52, v23, v6 row_newbcast:11 row_mask:0xf bank_mask:0xf
  v_and_b32_dpp v53, v23, v7 row_newbcast:11 row_mask:0xf bank_mask:0xf
  v_and_b32_dpp v54, v23, v8 row_newbcast:11 row_mask:0xf bank_mask:0xf
  v_and_b32_dpp v55, v23, v9 row_newbcast:11 row_mask:0xf bank_mask:0xf
  s_waitcnt lgkmcnt(0)
  s_nop 0
  v_mfma_f32_16x16x32_bf16 v[32:35], v[52:55], v[56:59], v[32:35]
  s_waitcnt vmcnt(6)
  s_add_u32 s32, s29, 73728
  buffer_load_dwordx4 a[96:99], v0, s[4:7], s32 offen offset:0 nt
  ds_read_b128 v[56:59], v4 offset:27648
  v_and_b32_dpp v48, v23, v6 row_newbcast:12 row_mask:0xf bank_mask:0xf
  v_and_b32_dpp v49, v23, v7 row_newbcast:12 row_mask:0xf bank_mask:0xf
  v_and_b32_dpp v50, v23, v8 row_newbcast:12 row_mask:0xf bank_mask:0xf
  v_and_b32_dpp v51, v23, v9 row_newbcast:12 row_mask:0xf bank_mask:0xf
  s_waitcnt lgkmcnt(0)
  s_nop 0
  v_mfma_f32_16x16x32_bf16 v[32:35], v[48:51], v[56:59], v[32:35]
  ds_read_b128 v[56:59], v4 offset:28672
  v_and_b32_dpp v52, v23, v6 row_newbcast:13 row_mask:0xf bank_mask:0xf
  v_and_b32_dpp v53, v23, v7 row_newbcast:13 row_mask:0xf bank_mask:0xf
  v_and_b32_dpp v54, v23, v8 row_newbcast:13 row_mask:0xf bank_mask:0xf
  v_and_b32_dpp v55, v23, v9 row_newbcast:13 row_mask:0xf bank_mask:0xf
  s_waitcnt lgkmcnt(0)
  s_nop 0
  v_mfma_f32_16x16x32_bf16 v[32:35], v[52:55], v[56:59], v[32:35]
  ds_read_b128 v[56:59], v4 offset:29696
  v_and_b32_dpp v48, v23, v6 row_newbcast:14 row_mask:0xf bank_mask:0xf
  v_and_b32_dpp v49, v23, v7 row_newbcast:14 row_mask:0xf bank_mask:0xf
  v_and_b32_dpp v50, v23, v8 row_newbcast:14 row_mask:0xf bank_mask:0xf
  v_and_b32_dpp v51, v23, v9 row_newbcast:14 row_mask:0xf bank_mask:0xf
  s_waitcnt lgkmcnt(0)
  s_nop 0
  v_mfma_f32_16x16x32_bf16 v[32:35], v[48:51], v[56:59], v[32:35]
  ds_read_b128 v[56:59], v4 offset:30720
  v_and_b32_dpp v52, v23, v6 row_newbcast:15 row_mask:0xf bank_mask:0xf
  v_and_b32_dpp v53, v23, v7 row_newbcast:15 row_mask:0xf bank_mask:0xf
  v_and_b32_dpp v54, v23, v8 row_newbcast:15 row_mask:0xf bank_mask:0xf
  v_and_b32_dpp v55, v23, v9 row_newbcast:15 row_mask:0xf bank_mask:0xf
  s_waitcnt lgkmcnt(0)
  s_nop 0
  v_mfma_f32_16x16x32_bf16 v[32:35], v[52:55], v[56:59], v[32:35]
  s_waitcnt vmcnt(6)
  buffer_load_dwordx4 a[100:103], v0, s[4:7], s32 offen offset:128 nt
  ds_read_b128 v[56:59], v4 offset:31744
  v_and_b32_dpp v48, v24, v6 row_newbcast:0 row_mask:0xf bank_mask:0xf
  v_and_b32_dpp v49, v24, v7 row_newbcast:0 row_mask:0xf bank_mask:0xf
  v_and_b32_dpp v50, v24, v8 row_newbcast:0 row_mask:0xf bank_mask:0xf
  v_and_b32_dpp v51, v24, v9 row_newbcast:0 row_mask:0xf bank_mask:0xf
  s_waitcnt lgkmcnt(0)
  s_nop 0
  v_mfma_f32_16x16x32_bf16 v[32:35], v[48:51], v[56:59], v[32:35]
  ds_read_b128 v[56:59], v4 offset:32768
  v_and_b32_dpp v52, v24, v6 row_newbcast:1 row_mask:0xf bank_mask:0xf
  v_and_b32_dpp v53, v24, v7 row_newbcast:1 row_mask:0xf bank_mask:0xf
  v_and_b32_dpp v54, v24, v8 row_newbcast:1 row_mask:0xf bank_mask:0xf
  v_and_b32_dpp v55, v24, v9 row_newbcast:1 row_mask:0xf bank_mask:0xf
  s_waitcnt lgkmcnt(0)
  s_nop 0
  v_mfma_f32_16x16x32_bf16 v[32:35], v[52:55], v[56:59], v[32:35]
  ds_read_b128 v[56:59], v4 offset:33792
  v_and_b32_dpp v48, v24, v6 row_newbcast:2 row_mask:0xf bank_mask:0xf
  v_and_b32_dpp v49, v24, v7 row_newbcast:2 row_mask:0xf bank_mask:0xf
  v_and_b32_dpp v50, v24, v8 row_newbcast:2 row_mask:0xf bank_mask:0xf
  v_and_b32_dpp v51, v24, v9 row_newbcast:2 row_mask:0xf bank_mask:0xf
  s_waitcnt lgkmcnt(0)
  s_nop 0
  v_mfma_f32_16x16x32_bf16 v[32:35], v[48:51], v[56:59], v[32:35]
  ds_read_b128 v[56:59], v4 offset:34816
  v_and_b32_dpp v52, v24, v6 row_newbcast:3 row_mask:0xf bank_mask:0xf
  v_and_b32_dpp v53, v24, v7 row_newbcast:3 row_mask:0xf bank_mask:0xf
  v_and_b32_dpp v54, v24, v8 row_newbcast:3 row_mask:0xf bank_mask:0xf
  v_and_b32_dpp v55, v24, v9 row_newbcast:3 row_mask:0xf bank_mask:0xf
  s_waitcnt lgkmcnt(0)
  s_nop 0
  v_mfma_f32_16x16x32_bf16 v[32:35], v[52:55], v[56:59], v[32:35]
  s_waitcnt vmcnt(6)
  buffer_load_dwordx4 a[104:107], v0, s[4:7], s32 offen offset:2048 nt
  ds_read_b128 v[56:59], v4 offset:35840
  v_and_b32_dpp v48, v24, v6 row_newbcast:4 row_mask:0xf bank_mask:0xf
  v_and_b32_dpp v49, v24, v7 row_newbcast:4 row_mask:0xf bank_mask:0xf
  v_and_b32_dpp v50, v24, v8 row_newbcast:4 row_mask:0xf bank_mask:0xf
  v_and_b32_dpp v51, v24, v9 row_newbcast:4 row_mask:0xf bank_mask:0xf
  s_waitcnt lgkmcnt(0)
  s_nop 0
  v_mfma_f32_16x16x32_bf16 v[32:35], v[48:51], v[56:59], v[32:35]
  ds_read_b128 v[56:59], v4 offset:36864
  v_and_b32_dpp v52, v24, v6 row_newbcast:5 row_mask:0xf bank_mask:0xf
  v_and_b32_dpp v53, v24, v7 row_newbcast:5 row_mask:0xf bank_mask:0xf
  v_and_b32_dpp v54, v24, v8 row_newbcast:5 row_mask:0xf bank_mask:0xf
  v_and_b32_dpp v55, v24, v9 row_newbcast:5 row_mask:0xf bank_mask:0xf
  s_waitcnt lgkmcnt(0)
  s_nop 0
  v_mfma_f32_16x16x32_bf16 v[32:35], v[52:55], v[56:59], v[32:35]
  ds_read_b128 v[56:59], v4 offset:37888
  v_and_b32_dpp v48, v24, v6 row_newbcast:6 row_mask:0xf bank_mask:0xf
  v_and_b32_dpp v49, v24, v7 row_newbcast:6 row_mask:0xf bank_mask:0xf
  v_and_b32_dpp v50, v24, v8 row_newbcast:6 row_mask:0xf bank_mask:0xf
  v_and_b32_dpp v51, v24, v9 row_newbcast:6 row_mask:0xf bank_mask:0xf
  s_waitcnt lgkmcnt(0)
  s_nop 0
  v_mfma_f32_16x16x32_bf16 v[32:35], v[48:51], v[56:59], v[32:35]
  ds_read_b128 v[56:59], v4 offset:38912
  v_and_b32_dpp v52, v24, v6 row_newbcast:7 row_mask:0xf bank_mask:0xf
  v_and_b32_dpp v53, v24, v7 row_newbcast:7 row_mask:0xf bank_mask:0xf
  v_and_b32_dpp v54, v24, v8 row_newbcast:7 row_mask:0xf bank_mask:0xf
  v_and_b32_dpp v55, v24, v9 row_newbcast:7 row_mask:0xf bank_mask:0xf
  s_waitcnt lgkmcnt(0)
  s_nop 0
  v_mfma_f32_16x16x32_bf16 v[32:35], v[52:55], v[56:59], v[32:35]
  s_waitcnt vmcnt(6)
  buffer_load_dwordx4 a[108:111], v0, s[4:7], s32 offen offset:2176 nt
  v_lshrrev_b32 v41, 4, v3
  v_and_b32 v40, 1, v41
  v_lshlrev_b32 v40, 6, v40
  v_lshrrev_b32 v41, 4, v41
  v_lshl_add_u32 v40, v41, 4, v40
  v_add_u32 v40, s35, v40
  ds_read_b128 v[12:15], v40 offset:256
  ds_read_b128 v[16:19], v40 offset:384
  s_waitcnt lgkmcnt(0)
  v_mfma_f32_16x16x32_bf16 v[40:43], v[12:15], a[0:3], 0
  v_mfma_f32_16x16x32_bf16 v[40:43], v[16:19], a[4:7], v[40:43]
  v_mfma_f32_16x16x32_bf16 v[44:47], v[12:15], a[8:11], 0
  v_mfma_f32_16x16x32_bf16 v[44:47], v[16:19], a[12:15], v[44:47]
  s_nop 5
  v_add_f32_dpp v26, v41, v40 row_ror:8 row_mask:0x1 bank_mask:0x3
  v_mfma_f32_16x16x32_bf16 v[40:43], v[12:15], a[16:19], 0
  v_mfma_f32_16x16x32_bf16 v[40:43], v[16:19], a[20:23], v[40:43]
  s_waitcnt vmcnt(6)
  s_add_u32 s32, s29, 77824
  buffer_load_dwordx4 a[112:115], v0, s[4:7], s32 offen offset:0 nt
  v_add_f32_dpp v26, v44, v45 row_ror:8 row_mask:0x1 bank_mask:0xc
  v_mfma_f32_16x16x32_bf16 v[44:47], v[12:15], a[24:27], 0
  v_mfma_f32_16x16x32_bf16 v[44:47], v[16:19], a[28:31], v[44:47]
  s_nop 1
  v_add_f32_dpp v26, v41, v40 row_ror:8 row_mask:0x2 bank_mask:0x3
  v_mfma_f32_16x16x32_bf16 v[40:43], v[12:15], a[32:35], 0
  v_mfma_f32_16x16x32_bf16 v[40:43], v[16:19], a[36:39], v[40:43]
  s_nop 2
  v_add_f32_dpp v26, v44, v45 row_ror:8 row_mask:0x2 bank_mask:0xc
  v_mfma_f32_16x16x32_bf16 v[44:47], v[12:15], a[40:43], 0
  v_mfma_f32_16x16x32_bf16 v[44:47], v[16:19], a[44:47], v[44:47]
  s_nop 1
  v_add_f32_dpp v26, v41, v40 row_ror:8 row_mask:0x4 bank_mask:0x3
  v_mfma_f32_16x16x32_bf16 v[40:43], v[12:15], a[48:51], 0
  v_mfma_f32_16x16x32_bf16 v[40:43], v[16:19], a[52:55], v[40:43]
  s_waitcnt vmcnt(6)
  buffer_load_dwordx4 a[116:119], v0, s[4:7], s32 offen offset:128 nt
  s_nop 0
  v_add_f32_dpp v26, v44, v45 row_ror:8 row_mask:0x4 bank_mask:0xc
  v_mfma_f32_16x16x32_bf16 v[44:47], v[12:15], a[56:59], 0
  v_mfma_f32_16x16x32_bf16 v[44:47], v[16:19], a[60:63], v[44:47]
  s_nop 1
  v_add_f32_dpp v26, v41, v40 row_ror:8 row_mask:0x8 bank_mask:0x3
  v_mfma_f32_16x16x32_bf16 v[40:43], v[12:15], a[64:67], 0
  v_mfma_f32_16x16x32_bf16 v[40:43], v[16:19], a[68:71], v[40:43]
  s_nop 2
  v_add_f32_dpp v26, v44, v45 row_ror:8 row_mask:0x8 bank_mask:0xc
  v_mfma_f32_16x16x32_bf16 v[44:47], v[12:15], a[72:75], 0
  v_mfma_f32_16x16x32_bf16 v[44:47], v[16:19], a[76:79], v[44:47]
  s_nop 1
  v_add_f32_dpp v27, v41, v40 row_ror:8 row_mask:0x1 bank_mask:0x3
  v_mfma_f32_16x16x32_bf16 v[40:43], v[12:15], a[80:83], 0
  v_mfma_f32_16x16x32_bf16 v[40:43], v[16:19], a[84:87], v[40:43]
  s_waitcnt vmcnt(6)
  buffer_load_dwordx4 a[120:123], v0, s[4:7], s32 offen offset:2048 nt
  s_nop 0
  v_add_f32_dpp v27, v44, v45 row_ror:8 row_mask:0x1 bank_mask:0xc
  v_mfma_f32_16x16x32_bf16 v[44:47], v[12:15], a[88:91], 0
  v_mfma_f32_16x16x32_bf16 v[44:47], v[16:19], a[92:95], v[44:47]
  s_waitcnt vmcnt(6)
  buffer_load_dwordx4 a[124:127], v0, s[4:7], s32 offen offset:2176 nt
  s_waitcnt vmcnt(6)
  s_add_u32 s32, s29, 131072
  buffer_load_dwordx4 a[128:131], v0, s[4:7], s32 offen offset:0 nt
  v_add_f32_dpp v27, v41, v40 row_ror:8 row_mask:0x2 bank_mask:0x3
  v_mfma_f32_16x16x32_bf16 v[40:43], v[12:15], a[96:99], 0
  v_mfma_f32_16x16x32_bf16 v[40:43], v[16:19], a[100:103], v[40:43]
  s_waitcnt vmcnt(6)
  buffer_load_dwordx4 a[132:135], v0, s[4:7], s32 offen offset:128 nt
  s_waitcnt vmcnt(6)
  buffer_load_dwordx4 a[136:139], v0, s[4:7], s32 offen offset:2048 nt
  v_add_f32_dpp v27, v44, v45 row_ror:8 row_mask:0x2 bank_mask:0xc
  v_mfma_f32_16x16x32_bf16 v[44:47], v[12:15], a[104:107], 0
  v_mfma_f32_16x16x32_bf16 v[44:47], v[16:19], a[108:111], v[44:47]
  s_waitcnt vmcnt(6)
  buffer_load_dwordx4 a[140:143], v0, s[4:7], s32 offen offset:2176 nt
  s_waitcnt vmcnt(6)
  s_add_u32 s32, s29, 135168
  buffer_load_dwordx4 a[144:147], v0, s[4:7], s32 offen offset:0 nt
  v_add_f32_dpp v27, v41, v40 row_ror:8 row_mask:0x4 bank_mask:0x3
  v_mfma_f32_16x16x32_bf16 v[40:43], v[12:15], a[112:115], 0
  v_mfma_f32_16x16x32_bf16 v[40:43], v[16:19], a[116:119], v[40:43]
  s_waitcnt vmcnt(6)
  buffer_load_dwordx4 a[148:151], v0, s[4:7], s32 offen offset:128 nt
  s_waitcnt vmcnt(6)
  buffer_load_dwordx4 a[152:155], v0, s[4:7], s32 offen offset:2048 nt
  v_add_f32_dpp v27, v44, v45 row_ror:8 row_mask:0x4 bank_mask:0xc
  v_mfma_f32_16x16x32_bf16 v[44:47], v[12:15], a[120:123], 0
  v_mfma_f32_16x16x32_bf16 v[44:47], v[16:19], a[124:127], v[44:47]
  s_waitcnt vmcnt(6)
  buffer_load_dwordx4 a[156:159], v0, s[4:7], s32 offen offset:2176 nt
  s_waitcnt vmcnt(6)
  s_add_u32 s32, s29, 139264
  buffer_load_dwordx4 a[160:163], v0, s[4:7], s32 offen offset:0 nt
  v_add_f32_dpp v27, v41, v40 row_ror:8 row_mask:0x8 bank_mask:0x3
  v_mfma_f32_16x16x32_bf16 v[40:43], v[12:15], a[128:131], 0
  v_mfma_f32_16x16x32_bf16 v[40:43], v[16:19], a[132:135], v[40:43]
  s_waitcnt vmcnt(6)
  buffer_load_dwordx4 a[164:167], v0, s[4:7], s32 offen offset:128 nt
  s_waitcnt vmcnt(6)
  buffer_load_dwordx4 a[168:171], v0, s[4:7], s32 offen offset:2048 nt
  v_add_f32_dpp v27, v44, v45 row_ror:8 row_mask:0x8 bank_mask:0xc
  v_mfma_f32_16x16x32_bf16 v[44:47], v[12:15], a[136:139], 0
  v_mfma_f32_16x16x32_bf16 v[44:47], v[16:19], a[140:143], v[44:47]
  s_waitcnt vmcnt(6)
  buffer_load_dwordx4 a[172:175], v0, s[4:7], s32 offen offset:2176 nt
  s_waitcnt vmcnt(6)
  s_add_u32 s32, s29, 143360
  buffer_load_dwordx4 a[176:179], v0, s[4:7], s32 offen offset:0 nt
  v_add_f32_dpp v28, v41, v40 row_ror:8 row_mask:0x1 bank_mask:0x3
  v_mfma_f32_16x16x32_bf16 v[40:43], v[12:15], a[144:147], 0
  v_mfma_f32_16x16x32_bf16 v[40:43], v[16:19], a[148:151], v[40:43]
  s_waitcnt vmcnt(6)
  buffer_load_dwordx4 a[180:183], v0, s[4:7], s32 offen offset:128 nt
  s_waitcnt vmcnt(6)
  buffer_load_dwordx4 a[184:187], v0, s[4:7], s32 offen offset:2048 nt
  v_add_f32_dpp v28, v44, v45 row_ror:8 row_mask:0x1 bank_mask:0xc
  v_mfma_f32_16x16x32_bf16 v[44:47], v[12:15], a[152:155], 0
  v_mfma_f32_16x16x32_bf16 v[44:47], v[16:19], a[156:159], v[44:47]
  s_waitcnt vmcnt(6)
  buffer_load_dwordx4 a[188:191], v0, s[4:7], s32 offen offset:2176 nt
  s_waitcnt vmcnt(6)
  s_add_u32 s32, s29, 196608
  buffer_load_dwordx4 a[192:195], v0, s[4:7], s32 offen offset:0 nt
  v_add_f32_dpp v28, v41, v40 row_ror:8 row_mask:0x2 bank_mask:0x3
  v_mfma_f32_16x16x32_bf16 v[40:43], v[12:15], a[160:163], 0
  v_mfma_f32_16x16x32_bf16 v[40:43], v[16:19], a[164:167], v[40:43]
  s_waitcnt vmcnt(6)
  buffer_load_dwordx4 a[196:199], v0, s[4:7], s32 offen offset:128 nt
  s_waitcnt vmcnt(6)
  buffer_load_dwordx4 a[200:203], v0, s[4:7], s32 offen offset:2048 nt
  v_add_f32_dpp v28, v44, v45 row_ror:8 row_mask:0x2 bank_mask:0xc
  v_mfma_f32_16x16x32_bf16 v[44:47], v[12:15], a[168:171], 0
  v_mfma_f32_16x16x32_bf16 v[44:47], v[16:19], a[172:175], v[44:47]
  s_waitcnt vmcnt(6)
  buffer_load_dwordx4 a[204:207], v0, s[4:7], s32 offen offset:2176 nt
  s_waitcnt vmcnt(6)
  s_add_u32 s32, s29, 200704
  buffer_load_dwordx4 a[208:211], v0, s[4:7], s32 offen offset:0 nt
  v_add_f32_dpp v28, v41, v40 row_ror:8 row_mask:0x4 bank_mask:0x3
  v_mfma_f32_16x16x32_bf16 v[40:43], v[12:15], a[176:179], 0
  v_mfma_f32_16x16x32_bf16 v[40:43], v[16:19], a[180:183], v[40:43]
  s_waitcnt vmcnt(6)
  buffer_load_dwordx4 a[212:215], v0, s[4:7], s32 offen offset:128 nt
  s_waitcnt vmcnt(6)
  buffer_load_dwordx4 a[216:219], v0, s[4:7], s32 offen offset:2048 nt
  v_add_f32_dpp v28, v44, v45 row_ror:8 row_mask:0x4 bank_mask:0xc
  v_mfma_f32_16x16x32_bf16 v[44:47], v[12:15], a[184:187], 0
  v_mfma_f32_16x16x32_bf16 v[44:47], v[16:19], a[188:191], v[44:47]
  s_waitcnt vmcnt(6)
  buffer_load_dwordx4 a[220:223], v0, s[4:7], s32 offen offset:2176 nt
  s_waitcnt vmcnt(6)
  s_add_u32 s32, s29, 204800
  buffer_load_dwordx4 a[224:227], v0, s[4:7], s32 offen offset:0 nt
  v_add_f32_dpp v28, v41, v40 row_ror:8 row_mask:0x8 bank_mask:0x3
  v_mfma_f32_16x16x32_bf16 v[40:43], v[12:15], a[192:195], 0
  v_mfma_f32_16x16x32_bf16 v[40:43], v[16:19], a[196:199], v[40:43]
  s_waitcnt vmcnt(6)
  buffer_load_dwordx4 a[228:231], v0, s[4:7], s32 offen offset:128 nt
  s_waitcnt vmcnt(6)
  buffer_load_dwordx4 a[232:235], v0, s[4:7], s32 offen offset:2048 nt
  v_add_f32_dpp v28, v44, v45 row_ror:8 row_mask:0x8 bank_mask:0xc
  v_mfma_f32_16x16x32_bf16 v[44:47], v[12:15], a[200:203], 0
  v_mfma_f32_16x16x32_bf16 v[44:47], v[16:19], a[204:207], v[44:47]
  s_waitcnt vmcnt(6)
  buffer_load_dwordx4 a[236:239], v0, s[4:7], s32 offen offset:2176 nt
  s_waitcnt vmcnt(6)
  s_add_u32 s32, s29, 208896
  buffer_load_dwordx4 a[240:243], v0, s[4:7], s32 offen offset:0 nt
  v_add_f32_dpp v29, v41, v40 row_ror:8 row_mask:0x1 bank_mask:0x3
  v_mfma_f32_16x16x32_bf16 v[40:43], v[12:15], a[208:211], 0
  v_mfma_f32_16x16x32_bf16 v[40:43], v[16:19], a[212:215], v[40:43]
  s_waitcnt vmcnt(6)
  buffer_load_dwordx4 a[244:247], v0, s[4:7], s32 offen offset:128 nt
  s_waitcnt vmcnt(6)
  buffer_load_dwordx4 a[248:251], v0, s[4:7], s32 offen offset:2048 nt
  v_add_f32_dpp v29, v44, v45 row_ror:8 row_mask:0x1 bank_mask:0xc
  v_mfma_f32_16x16x32_bf16 v[44:47], v[12:15], a[216:219], 0
  v_mfma_f32_16x16x32_bf16 v[44:47], v[16:19], a[220:223], v[44:47]
  s_waitcnt vmcnt(6)
  buffer_load_dwordx4 a[252:255], v0, s[4:7], s32 offen offset:2176 nt
  s_waitcnt vmcnt(6)
  s_add_u32 s32, s29, 524288
  buffer_load_dwordx4 v[92:95], v0, s[4:7], s32 offen offset:0 nt
  v_add_f32_dpp v29, v41, v40 row_ror:8 row_mask:0x2 bank_mask:0x3
  v_mfma_f32_16x16x32_bf16 v[40:43], v[12:15], a[224:227], 0
  v_mfma_f32_16x16x32_bf16 v[40:43], v[16:19], a[228:231], v[40:43]
  s_waitcnt vmcnt(6)
  buffer_load_dwordx4 v[96:99], v0, s[4:7], s32 offen offset:128 nt
  s_waitcnt vmcnt(6)
  buffer_load_dwordx4 v[100:103], v0, s[4:7], s32 offen offset:2048 nt
  v_add_f32_dpp v29, v44, v45 row_ror:8 row_mask:0x2 bank_mask:0xc
  v_mfma_f32_16x16x32_bf16 v[44:47], v[12:15], a[232:235], 0
  v_mfma_f32_16x16x32_bf16 v[44:47], v[16:19], a[236:239], v[44:47]
  s_waitcnt vmcnt(6)
  buffer_load_dwordx4 v[104:107], v0, s[4:7], s32 offen offset:2176 nt
  s_waitcnt vmcnt(6)
  s_add_u32 s32, s29, 528384
  buffer_load_dwordx4 v[108:111], v0, s[4:7], s32 offen offset:0 nt
  v_add_f32_dpp v29, v41, v40 row_ror:8 row_mask:0x4 bank_mask:0x3
  v_mfma_f32_16x16x32_bf16 v[40:43], v[12:15], a[240:243], 0
  v_mfma_f32_16x16x32_bf16 v[40:43], v[16:19], a[244:247], v[40:43]
  s_waitcnt vmcnt(6)
  buffer_load_dwordx4 v[112:115], v0, s[4:7], s32 offen offset:128 nt
  s_waitcnt vmcnt(6)
  buffer_load_dwordx4 v[116:119], v0, s[4:7], s32 offen offset:2048 nt
  v_add_f32_dpp v29, v44, v45 row_ror:8 row_mask:0x4 bank_mask:0xc
  v_mfma_f32_16x16x32_bf16 v[44:47], v[12:15], a[248:251], 0
  v_mfma_f32_16x16x32_bf16 v[44:47], v[16:19], a[252:255], v[44:47]
  s_waitcnt vmcnt(6)
  buffer_load_dwordx4 v[120:123], v0, s[4:7], s32 offen offset:2176 nt
  s_waitcnt vmcnt(6)
  s_mov_b32 s33, s29
  buffer_load_dwordx4 v[124:127], v1, s[8:11], s33 offen offset:0 nt
  v_mov_b32 v30, 0xff800000
  v_add_f32_dpp v29, v41, v40 row_ror:8 row_mask:0x8 bank_mask:0x3
  v_mfma_f32_16x16x32_bf16 v[40:43], v[12:15], v[92:95], 0
  v_mfma_f32_16x16x32_bf16 v[40:43], v[16:19], v[96:99], v[40:43]
  s_waitcnt vmcnt(6)
  buffer_load_dwordx4 v[128:131], v1, s[8:11], s33 offen offset:256 nt
  s_waitcnt vmcnt(6)
  buffer_load_dwordx4 v[132:135], v1, s[8:11], s33 offen offset:512 nt
  v_add_f32_dpp v29, v44, v45 row_ror:8 row_mask:0x8 bank_mask:0xc
  v_mfma_f32_16x16x32_bf16 v[44:47], v[12:15], v[100:103], 0
  v_mfma_f32_16x16x32_bf16 v[44:47], v[16:19], v[104:107], v[44:47]
  s_waitcnt vmcnt(6)
  buffer_load_dwordx4 v[136:139], v1, s[8:11], s33 offen offset:768 nt
  s_waitcnt vmcnt(6)
  buffer_load_dwordx4 v[140:143], v1, s[8:11], s33 offen offset:1024 nt
  v_add_f32_dpp v30, v41, v40 row_ror:8 row_mask:0x1 bank_mask:0x3
  v_mfma_f32_16x16x32_bf16 v[40:43], v[12:15], v[108:111], 0
  v_mfma_f32_16x16x32_bf16 v[40:43], v[16:19], v[112:115], v[40:43]
  s_waitcnt vmcnt(6)
  buffer_load_dwordx4 v[144:147], v1, s[8:11], s33 offen offset:1280 nt
  s_waitcnt vmcnt(6)
  buffer_load_dwordx4 v[148:151], v1, s[8:11], s33 offen offset:1536 nt
  v_add_f32_dpp v30, v45, v44 row_ror:8 row_mask:0x2 bank_mask:0x3
  v_mfma_f32_16x16x32_bf16 v[44:47], v[12:15], v[116:119], 0
  v_mfma_f32_16x16x32_bf16 v[44:47], v[16:19], v[120:123], v[44:47]
  s_nop 0
  v_add_f32_dpp v30, v41, v40 row_ror:8 row_mask:0x4 bank_mask:0x3
  s_nop 5
  v_add_f32_dpp v30, v45, v44 row_ror:8 row_mask:0x8 bank_mask:0x3
  v_mul_f32 v26, 0x3e0293ee, v26
  v_mul_f32 v27, 0x3e0293ee, v27
  v_mul_f32 v28, 0x3e0293ee, v28
  v_mul_f32 v29, 0x3e0293ee, v29
  v_mul_f32 v30, 0x3e0293ee, v30
  v_max3_f32 v40, v26, v27, v28
  v_max3_f32 v40, v40, v29, v30
  v_max_f32 v40, s37, v40
  s_nop 1
  v_max_f32_dpp v40, v40, v40 row_ror:8 row_mask:0xf bank_mask:0xf
  s_nop 1
  v_max_f32_dpp v40, v40, v40 row_ror:4 row_mask:0xf bank_mask:0xf
  s_nop 1
  v_max_f32_dpp v40, v40, v40 row_ror:2 row_mask:0xf bank_mask:0xf
  s_nop 1
  v_max_f32_dpp v40, v40, v40 row_ror:1 row_mask:0xf bank_mask:0xf
  s_nop 1
  v_max_f32_dpp v40, v40, v40 row_bcast:15 row_mask:0xa bank_mask:0xf
  s_nop 1
  v_max_f32_dpp v40, v40, v40 row_bcast:31 row_mask:0xc bank_mask:0xf
  s_nop 0
  v_readlane_b32 s46, v40, 63
  s_nop 1
  v_mov_b32 v41, s46
  v_sub_f32 v41, s37, v41
  v_exp_f32 v41, v41
  s_nop 0
  v_mul_f32 v36, v36, v41
  v_mul_f32 v37, v37, v41
  v_mul_f32 v38, v38, v41
  v_mul_f32 v39, v39, v41
  v_mul_f32 v11, v11, v41
  s_mov_b32 s37, s46
  v_subrev_f32 v26, s37, v26
  v_subrev_f32 v27, s37, v27
  v_subrev_f32 v28, s37, v28
  v_subrev_f32 v29, s37, v29
  v_subrev_f32 v30, s37, v30
  v_exp_f32 v26, v26
  v_exp_f32 v27, v27
  v_exp_f32 v28, v28
  v_exp_f32 v29, v29
  v_exp_f32 v30, v30
  v_add_f32 v42, v26, v27
  v_add_f32 v43, v28, v29
  v_add_f32 v42, v42, v30
  v_add_f32 v42, v42, v43
  v_add_f32 v11, v11, v42
  v_cvt_pk_bf16_f32 v26, v26, v26
  v_cvt_pk_bf16_f32 v27, v27, v27
  v_cvt_pk_bf16_f32 v28, v28, v28
  v_cvt_pk_bf16_f32 v29, v29, v29
  v_cvt_pk_bf16_f32 v30, v30, v30
  s_waitcnt vmcnt(6)
  buffer_load_dwordx4 v[152:155], v1, s[8:11], s33 offen offset:1792 nt
  v_and_b32_dpp v48, v26, v6 row_newbcast:0 row_mask:0xf bank_mask:0xf
  v_and_b32_dpp v49, v26, v7 row_newbcast:0 row_mask:0xf bank_mask:0xf
  v_and_b32_dpp v50, v26, v8 row_newbcast:0 row_mask:0xf bank_mask:0xf
  v_and_b32_dpp v51, v26, v9 row_newbcast:0 row_mask:0xf bank_mask:0xf
  s_nop 1
  v_mfma_f32_16x16x32_bf16 v[36:39], v[48:51], v[124:127], v[36:39]
  s_waitcnt vmcnt(6)
  buffer_load_dwordx4 v[156:159], v1, s[8:11], s33 offen offset:2048 nt
  v_and_b32_dpp v52, v26, v6 row_newbcast:1 row_mask:0xf bank_mask:0xf
  v_and_b32_dpp v53, v26, v7 row_newbcast:1 row_mask:0xf bank_mask:0xf
  v_and_b32_dpp v54, v26, v8 row_newbcast:1 row_mask:0xf bank_mask:0xf
  v_and_b32_dpp v55, v26, v9 row_newbcast:1 row_mask:0xf bank_mask:0xf
  s_nop 1
  v_mfma_f32_16x16x32_bf16 v[36:39], v[52:55], v[128:131], v[36:39]
  s_waitcnt vmcnt(6)
  buffer_load_dwordx4 v[160:163], v1, s[8:11], s33 offen offset:2304 nt
  v_and_b32_dpp v48, v26, v6 row_newbcast:2 row_mask:0xf bank_mask:0xf
  v_and_b32_dpp v49, v26, v7 row_newbcast:2 row_mask:0xf bank_mask:0xf
  v_and_b32_dpp v50, v26, v8 row_newbcast:2 row_mask:0xf bank_mask:0xf
  v_and_b32_dpp v51, v26, v9 row_newbcast:2 row_mask:0xf bank_mask:0xf
  s_nop 1
  v_mfma_f32_16x16x32_bf16 v[36:39], v[48:51], v[132:135], v[36:39]
  s_waitcnt vmcnt(6)
  buffer_load_dwordx4 v[164:167], v1, s[8:11], s33 offen offset:2560 nt
  v_and_b32_dpp v52, v26, v6 row_newbcast:3 row_mask:0xf bank_mask:0xf
  v_and_b32_dpp v53, v26, v7 row_newbcast:3 row_mask:0xf bank_mask:0xf
  v_and_b32_dpp v54, v26, v8 row_newbcast:3 row_mask:0xf bank_mask:0xf
  v_and_b32_dpp v55, v26, v9 row_newbcast:3 row_mask:0xf bank_mask:0xf
  s_nop 1
  v_mfma_f32_16x16x32_bf16 v[36:39], v[52:55], v[136:139], v[36:39]
  s_waitcnt vmcnt(6)
  buffer_load_dwordx4 v[168:171], v1, s[8:11], s33 offen offset:2816 nt
  v_and_b32_dpp v48, v26, v6 row_newbcast:4 row_mask:0xf bank_mask:0xf
  v_and_b32_dpp v49, v26, v7 row_newbcast:4 row_mask:0xf bank_mask:0xf
  v_and_b32_dpp v50, v26, v8 row_newbcast:4 row_mask:0xf bank_mask:0xf
  v_and_b32_dpp v51, v26, v9 row_newbcast:4 row_mask:0xf bank_mask:0xf
  s_nop 1
  v_mfma_f32_16x16x32_bf16 v[36:39], v[48:51], v[140:143], v[36:39]
  s_waitcnt vmcnt(6)
  buffer_load_dwordx4 v[172:175], v1, s[8:11], s33 offen offset:3072 nt
  v_and_b32_dpp v52, v26, v6 row_newbcast:5 row_mask:0xf bank_mask:0xf
  v_and_b32_dpp v53, v26, v7 row_newbcast:5 row_mask:0xf bank_mask:0xf
  v_and_b32_dpp v54, v26, v8 row_newbcast:5 row_mask:0xf bank_mask:0xf
  v_and_b32_dpp v55, v26, v9 row_newbcast:5 row_mask:0xf bank_mask:0xf
  s_nop 1
  v_mfma_f32_16x16x32_bf16 v[36:39], v[52:55], v[144:147], v[36:39]
  s_waitcnt vmcnt(6)
  buffer_load_dwordx4 v[176:179], v1, s[8:11], s33 offen offset:3328 nt
  v_and_b32_dpp v48, v26, v6 row_newbcast:6 row_mask:0xf bank_mask:0xf
  v_and_b32_dpp v49, v26, v7 row_newbcast:6 row_mask:0xf bank_mask:0xf
  v_and_b32_dpp v50, v26, v8 row_newbcast:6 row_mask:0xf bank_mask:0xf
  v_and_b32_dpp v51, v26, v9 row_newbcast:6 row_mask:0xf bank_mask:0xf
  s_nop 1
  v_mfma_f32_16x16x32_bf16 v[36:39], v[48:51], v[148:151], v[36:39]
  s_waitcnt vmcnt(6)
  buffer_load_dwordx4 v[180:183], v1, s[8:11], s33 offen offset:3584 nt
  v_and_b32_dpp v52, v26, v6 row_newbcast:7 row_mask:0xf bank_mask:0xf
  v_and_b32_dpp v53, v26, v7 row_newbcast:7 row_mask:0xf bank_mask:0xf
  v_and_b32_dpp v54, v26, v8 row_newbcast:7 row_mask:0xf bank_mask:0xf
  v_and_b32_dpp v55, v26, v9 row_newbcast:7 row_mask:0xf bank_mask:0xf
  s_nop 1
  v_mfma_f32_16x16x32_bf16 v[36:39], v[52:55], v[152:155], v[36:39]
  s_waitcnt vmcnt(6)
  buffer_load_dwordx4 v[184:187], v1, s[8:11], s33 offen offset:3840 nt
  v_and_b32_dpp v48, v26, v6 row_newbcast:8 row_mask:0xf bank_mask:0xf
  v_and_b32_dpp v49, v26, v7 row_newbcast:8 row_mask:0xf bank_mask:0xf
  v_and_b32_dpp v50, v26, v8 row_newbcast:8 row_mask:0xf bank_mask:0xf
  v_and_b32_dpp v51, v26, v9 row_newbcast:8 row_mask:0xf bank_mask:0xf
  s_nop 1
  v_mfma_f32_16x16x32_bf16 v[36:39], v[48:51], v[156:159], v[36:39]
  s_waitcnt vmcnt(6)
  s_add_u32 s33, s29, 65536
  buffer_load_dwordx4 v[188:191], v1, s[8:11], s33 offen offset:0 nt
  v_and_b32_dpp v52, v26, v6 row_newbcast:9 row_mask:0xf bank_mask:0xf
  v_and_b32_dpp v53, v26, v7 row_newbcast:9 row_mask:0xf bank_mask:0xf
  v_and_b32_dpp v54, v26, v8 row_newbcast:9 row_mask:0xf bank_mask:0xf
  v_and_b32_dpp v55, v26, v9 row_newbcast:9 row_mask:0xf bank_mask:0xf
  s_nop 1
  v_mfma_f32_16x16x32_bf16 v[36:39], v[52:55], v[160:163], v[36:39]
  s_waitcnt vmcnt(6)
  buffer_load_dwordx4 v[192:195], v1, s[8:11], s33 offen offset:256 nt
  v_and_b32_dpp v48, v26, v6 row_newbcast:10 row_mask:0xf bank_mask:0xf
  v_and_b32_dpp v49, v26, v7 row_newbcast:10 row_mask:0xf bank_mask:0xf
  v_and_b32_dpp v50, v26, v8 row_newbcast:10 row_mask:0xf bank_mask:0xf
  v_and_b32_dpp v51, v26, v9 row_newbcast:10 row_mask:0xf bank_mask:0xf
  s_nop 1
  v_mfma_f32_16x16x32_bf16 v[36:39], v[48:51], v[164:167], v[36:39]
  s_waitcnt vmcnt(6)
  buffer_load_dwordx4 v[196:199], v1, s[8:11], s33 offen offset:512 nt
  v_and_b32_dpp v52, v26, v6 row_newbcast:11 row_mask:0xf bank_mask:0xf
  v_and_b32_dpp v53, v26, v7 row_newbcast:11 row_mask:0xf bank_mask:0xf
  v_and_b32_dpp v54, v26, v8 row_newbcast:11 row_mask:0xf bank_mask:0xf
  v_and_b32_dpp v55, v26, v9 row_newbcast:11 row_mask:0xf bank_mask:0xf
  s_nop 1
  v_mfma_f32_16x16x32_bf16 v[36:39], v[52:55], v[168:171], v[36:39]
  s_waitcnt vmcnt(6)
  buffer_load_dwordx4 v[200:203], v1, s[8:11], s33 offen offset:768 nt
  v_and_b32_dpp v48, v26, v6 row_newbcast:12 row_mask:0xf bank_mask:0xf
  v_and_b32_dpp v49, v26, v7 row_newbcast:12 row_mask:0xf bank_mask:0xf
  v_and_b32_dpp v50, v26, v8 row_newbcast:12 row_mask:0xf bank_mask:0xf
  v_and_b32_dpp v51, v26, v9 row_newbcast:12 row_mask:0xf bank_mask:0xf
  s_nop 1
  v_mfma_f32_16x16x32_bf16 v[36:39], v[48:51], v[172:175], v[36:39]
  s_waitcnt vmcnt(6)
  buffer_load_dwordx4 v[204:207], v1, s[8:11], s33 offen offset:1024 nt
  v_and_b32_dpp v52, v26, v6 row_newbcast:13 row_mask:0xf bank_mask:0xf
  v_and_b32_dpp v53, v26, v7 row_newbcast:13 row_mask:0xf bank_mask:0xf
  v_and_b32_dpp v54, v26, v8 row_newbcast:13 row_mask:0xf bank_mask:0xf
  v_and_b32_dpp v55, v26, v9 row_newbcast:13 row_mask:0xf bank_mask:0xf
  s_nop 1
  v_mfma_f32_16x16x32_bf16 v[36:39], v[52:55], v[176:179], v[36:39]
  s_waitcnt vmcnt(6)
  buffer_load_dwordx4 v[208:211], v1, s[8:11], s33 offen offset:1280 nt
  v_and_b32_dpp v48, v26, v6 row_newbcast:14 row_mask:0xf bank_mask:0xf
  v_and_b32_dpp v49, v26, v7 row_newbcast:14 row_mask:0xf bank_mask:0xf
  v_and_b32_dpp v50, v26, v8 row_newbcast:14 row_mask:0xf bank_mask:0xf
  v_and_b32_dpp v51, v26, v9 row_newbcast:14 row_mask:0xf bank_mask:0xf
  s_nop 1
  v_mfma_f32_16x16x32_bf16 v[36:39], v[48:51], v[180:183], v[36:39]
  s_waitcnt vmcnt(6)
  buffer_load_dwordx4 v[212:215], v1, s[8:11], s33 offen offset:1536 nt
  v_and_b32_dpp v52, v26, v6 row_newbcast:15 row_mask:0xf bank_mask:0xf
  v_and_b32_dpp v53, v26, v7 row_newbcast:15 row_mask:0xf bank_mask:0xf
  v_and_b32_dpp v54, v26, v8 row_newbcast:15 row_mask:0xf bank_mask:0xf
  v_and_b32_dpp v55, v26, v9 row_newbcast:15 row_mask:0xf bank_mask:0xf
  s_nop 1
  v_mfma_f32_16x16x32_bf16 v[36:39], v[52:55], v[184:187], v[36:39]
  s_waitcnt vmcnt(6)
  buffer_load_dwordx4 v[216:219], v1, s[8:11], s33 offen offset:1792 nt
  v_and_b32_dpp v48, v27, v6 row_newbcast:0 row_mask:0xf bank_mask:0xf
  v_and_b32_dpp v49, v27, v7 row_newbcast:0 row_mask:0xf bank_mask:0xf
  v_and_b32_dpp v50, v27, v8 row_newbcast:0 row_mask:0xf bank_mask:0xf
  v_and_b32_dpp v51, v27, v9 row_newbcast:0 row_mask:0xf bank_mask:0xf
  s_nop 1
  v_mfma_f32_16x16x32_bf16 v[36:39], v[48:51], v[188:191], v[36:39]
  s_waitcnt vmcnt(6)
  buffer_load_dwordx4 v[220:223], v1, s[8:11], s33 offen offset:2048 nt
  v_and_b32_dpp v52, v27, v6 row_newbcast:1 row_mask:0xf bank_mask:0xf
  v_and_b32_dpp v53, v27, v7 row_newbcast:1 row_mask:0xf bank_mask:0xf
  v_and_b32_dpp v54, v27, v8 row_newbcast:1 row_mask:0xf bank_mask:0xf
  v_and_b32_dpp v55, v27, v9 row_newbcast:1 row_mask:0xf bank_mask:0xf
  s_nop 1
  v_mfma_f32_16x16x32_bf16 v[36:39], v[52:55], v[192:195], v[36:39]
  s_waitcnt vmcnt(6)
  buffer_load_dwordx4 v[224:227], v1, s[8:11], s33 offen offset:2304 nt
  v_and_b32_dpp v48, v27, v6 row_newbcast:2 row_mask:0xf bank_mask:0xf
  v_and_b32_dpp v49, v27, v7 row_newbcast:2 row_mask:0xf bank_mask:0xf
  v_and_b32_dpp v50, v27, v8 row_newbcast:2 row_mask:0xf bank_mask:0xf
  v_and_b32_dpp v51, v27, v9 row_newbcast:2 row_mask:0xf bank_mask:0xf
  s_nop 1
  v_mfma_f32_16x16x32_bf16 v[36:39], v[48:51], v[196:199], v[36:39]
  s_waitcnt vmcnt(6)
  buffer_load_dwordx4 v[228:231], v1, s[8:11], s33 offen offset:2560 nt
  v_and_b32_dpp v52, v27, v6 row_newbcast:3 row_mask:0xf bank_mask:0xf
  v_and_b32_dpp v53, v27, v7 row_newbcast:3 row_mask:0xf bank_mask:0xf
  v_and_b32_dpp v54, v27, v8 row_newbcast:3 row_mask:0xf bank_mask:0xf
  v_and_b32_dpp v55, v27, v9 row_newbcast:3 row_mask:0xf bank_mask:0xf
  s_nop 1
  v_mfma_f32_16x16x32_bf16 v[36:39], v[52:55], v[200:203], v[36:39]
  s_waitcnt vmcnt(6)
  buffer_load_dwordx4 v[232:235], v1, s[8:11], s33 offen offset:2816 nt
  v_and_b32_dpp v48, v27, v6 row_newbcast:4 row_mask:0xf bank_mask:0xf
  v_and_b32_dpp v49, v27, v7 row_newbcast:4 row_mask:0xf bank_mask:0xf
  v_and_b32_dpp v50, v27, v8 row_newbcast:4 row_mask:0xf bank_mask:0xf
  v_and_b32_dpp v51, v27, v9 row_newbcast:4 row_mask:0xf bank_mask:0xf
  s_nop 1
  v_mfma_f32_16x16x32_bf16 v[36:39], v[48:51], v[204:207], v[36:39]
  s_waitcnt vmcnt(6)
  buffer_load_dwordx4 v[236:239], v1, s[8:11], s33 offen offset:3072 nt
  v_and_b32_dpp v52, v27, v6 row_newbcast:5 row_mask:0xf bank_mask:0xf
  v_and_b32_dpp v53, v27, v7 row_newbcast:5 row_mask:0xf bank_mask:0xf
  v_and_b32_dpp v54, v27, v8 row_newbcast:5 row_mask:0xf bank_mask:0xf
  v_and_b32_dpp v55, v27, v9 row_newbcast:5 row_mask:0xf bank_mask:0xf
  s_nop 1
  v_mfma_f32_16x16x32_bf16 v[36:39], v[52:55], v[208:211], v[36:39]
  s_waitcnt vmcnt(6)
  buffer_load_dwordx4 v[240:243], v1, s[8:11], s33 offen offset:3328 nt
  v_and_b32_dpp v48, v27, v6 row_newbcast:6 row_mask:0xf bank_mask:0xf
  v_and_b32_dpp v49, v27, v7 row_newbcast:6 row_mask:0xf bank_mask:0xf
  v_and_b32_dpp v50, v27, v8 row_newbcast:6 row_mask:0xf bank_mask:0xf
  v_and_b32_dpp v51, v27, v9 row_newbcast:6 row_mask:0xf bank_mask:0xf
  s_nop 1
  v_mfma_f32_16x16x32_bf16 v[36:39], v[48:51], v[212:215], v[36:39]
  s_waitcnt vmcnt(6)
  buffer_load_dwordx4 v[244:247], v1, s[8:11], s33 offen offset:3584 nt
  v_and_b32_dpp v52, v27, v6 row_newbcast:7 row_mask:0xf bank_mask:0xf
  v_and_b32_dpp v53, v27, v7 row_newbcast:7 row_mask:0xf bank_mask:0xf
  v_and_b32_dpp v54, v27, v8 row_newbcast:7 row_mask:0xf bank_mask:0xf
  v_and_b32_dpp v55, v27, v9 row_newbcast:7 row_mask:0xf bank_mask:0xf
  s_nop 1
  v_mfma_f32_16x16x32_bf16 v[36:39], v[52:55], v[216:219], v[36:39]
  s_waitcnt vmcnt(6)
  buffer_load_dwordx4 v[248:251], v1, s[8:11], s33 offen offset:3840 nt
  v_and_b32_dpp v48, v27, v6 row_newbcast:8 row_mask:0xf bank_mask:0xf
  v_and_b32_dpp v49, v27, v7 row_newbcast:8 row_mask:0xf bank_mask:0xf
  v_and_b32_dpp v50, v27, v8 row_newbcast:8 row_mask:0xf bank_mask:0xf
  v_and_b32_dpp v51, v27, v9 row_newbcast:8 row_mask:0xf bank_mask:0xf
  s_nop 1
  v_mfma_f32_16x16x32_bf16 v[36:39], v[48:51], v[220:223], v[36:39]
  s_waitcnt vmcnt(6)
  s_add_u32 s33, s29, 131072
  buffer_load_dwordx4 v[252:255], v1, s[8:11], s33 offen offset:0 nt
  v_and_b32_dpp v52, v27, v6 row_newbcast:9 row_mask:0xf bank_mask:0xf
  v_and_b32_dpp v53, v27, v7 row_newbcast:9 row_mask:0xf bank_mask:0xf
  v_and_b32_dpp v54, v27, v8 row_newbcast:9 row_mask:0xf bank_mask:0xf
  v_and_b32_dpp v55, v27, v9 row_newbcast:9 row_mask:0xf bank_mask:0xf
  s_nop 1
  v_mfma_f32_16x16x32_bf16 v[36:39], v[52:55], v[224:227], v[36:39]
  s_waitcnt vmcnt(6)
  s_add_u32 m0, s34, 3840
  s_nop 0
  buffer_load_dwordx4 v1, s[8:11], s33 offen offset:256 nt lds
  v_and_b32_dpp v48, v27, v6 row_newbcast:10 row_mask:0xf bank_mask:0xf
  v_and_b32_dpp v49, v27, v7 row_newbcast:10 row_mask:0xf bank_mask:0xf
  v_and_b32_dpp v50, v27, v8 row_newbcast:10 row_mask:0xf bank_mask:0xf
  v_and_b32_dpp v51, v27, v9 row_newbcast:10 row_mask:0xf bank_mask:0xf
  s_nop 1
  v_mfma_f32_16x16x32_bf16 v[36:39], v[48:51], v[228:231], v[36:39]
  s_waitcnt vmcnt(6)
  s_add_u32 m0, s34, 4608
  s_nop 0
  buffer_load_dwordx4 v1, s[8:11], s33 offen offset:512 nt lds
  v_and_b32_dpp v52, v27, v6 row_newbcast:11 row_mask:0xf bank_mask:0xf
  v_and_b32_dpp v53, v27, v7 row_newbcast:11 row_mask:0xf bank_mask:0xf
  v_and_b32_dpp v54, v27, v8 row_newbcast:11 row_mask:0xf bank_mask:0xf
  v_and_b32_dpp v55, v27, v9 row_newbcast:11 row_mask:0xf bank_mask:0xf
  s_nop 1
  v_mfma_f32_16x16x32_bf16 v[36:39], v[52:55], v[232:235], v[36:39]
  s_waitcnt vmcnt(6)
  s_add_u32 m0, s34, 5376
  s_nop 0
  buffer_load_dwordx4 v1, s[8:11], s33 offen offset:768 nt lds
  v_and_b32_dpp v48, v27, v6 row_newbcast:12 row_mask:0xf bank_mask:0xf
  v_and_b32_dpp v49, v27, v7 row_newbcast:12 row_mask:0xf bank_mask:0xf
  v_and_b32_dpp v50, v27, v8 row_newbcast:12 row_mask:0xf bank_mask:0xf
  v_and_b32_dpp v51, v27, v9 row_newbcast:12 row_mask:0xf bank_mask:0xf
  s_nop 1
  v_mfma_f32_16x16x32_bf16 v[36:39], v[48:51], v[236:239], v[36:39]
  s_waitcnt vmcnt(6)
  s_add_u32 m0, s34, 6144
  s_nop 0
  buffer_load_dwordx4 v1, s[8:11], s33 offen offset:1024 nt lds
  v_and_b32_dpp v52, v27, v6 row_newbcast:13 row_mask:0xf bank_mask:0xf
  v_and_b32_dpp v53, v27, v7 row_newbcast:13 row_mask:0xf bank_mask:0xf
  v_and_b32_dpp v54, v27, v8 row_newbcast:13 row_mask:0xf bank_mask:0xf
  v_and_b32_dpp v55, v27, v9 row_newbcast:13 row_mask:0xf bank_mask:0xf
  s_nop 1
  v_mfma_f32_16x16x32_bf16 v[36:39], v[52:55], v[240:243], v[36:39]
  s_waitcnt vmcnt(6)
  s_add_u32 m0, s34, 6912
  s_nop 0
  buffer_load_dwordx4 v1, s[8:11], s33 offen offset:1280 nt lds
  v_and_b32_dpp v48, v27, v6 row_newbcast:14 row_mask:0xf bank_mask:0xf
  v_and_b32_dpp v49, v27, v7 row_newbcast:14 row_mask:0xf bank_mask:0xf
  v_and_b32_dpp v50, v27, v8 row_newbcast:14 row_mask:0xf bank_mask:0xf
  v_and_b32_dpp v51, v27, v9 row_newbcast:14 row_mask:0xf bank_mask:0xf
  s_nop 1
  v_mfma_f32_16x16x32_bf16 v[36:39], v[48:51], v[244:247], v[36:39]
  s_waitcnt vmcnt(6)
  s_add_u32 m0, s34, 7680
  s_nop 0
  buffer_load_dwordx4 v1, s[8:11], s33 offen offset:1536 nt lds
  v_and_b32_dpp v52, v27, v6 row_newbcast:15 row_mask:0xf bank_mask:0xf
  v_and_b32_dpp v53, v27, v7 row_newbcast:15 row_mask:0xf bank_mask:0xf
  v_and_b32_dpp v54, v27, v8 row_newbcast:15 row_mask:0xf bank_mask:0xf
  v_and_b32_dpp v55, v27, v9 row_newbcast:15 row_mask:0xf bank_mask:0xf
  s_nop 1
  v_mfma_f32_16x16x32_bf16 v[36:39], v[52:55], v[248:251], v[36:39]
  s_waitcnt vmcnt(6)
  s_add_u32 m0, s34, 8448
  s_nop 0
  buffer_load_dwordx4 v1, s[8:11], s33 offen offset:1792 nt lds
  v_and_b32_dpp v48, v28, v6 row_newbcast:0 row_mask:0xf bank_mask:0xf
  v_and_b32_dpp v49, v28, v7 row_newbcast:0 row_mask:0xf bank_mask:0xf
  v_and_b32_dpp v50, v28, v8 row_newbcast:0 row_mask:0xf bank_mask:0xf
  v_and_b32_dpp v51, v28, v9 row_newbcast:0 row_mask:0xf bank_mask:0xf
  s_nop 1
  v_mfma_f32_16x16x32_bf16 v[36:39], v[48:51], v[252:255], v[36:39]
  s_waitcnt vmcnt(6)
  s_add_u32 m0, s34, 9216
  s_nop 0
  buffer_load_dwordx4 v1, s[8:11], s33 offen offset:2048 nt lds
  ds_read_b128 v[56:59], v4 offset:0
  v_and_b32_dpp v52, v28, v6 row_newbcast:1 row_mask:0xf bank_mask:0xf
  v_and_b32_dpp v53, v28, v7 row_newbcast:1 row_mask:0xf bank_mask:0xf
  v_and_b32_dpp v54, v28, v8 row_newbcast:1 row_mask:0xf bank_mask:0xf
  v_and_b32_dpp v55, v28, v9 row_newbcast:1 row_mask:0xf bank_mask:0xf
  s_waitcnt lgkmcnt(0)
  s_nop 0
  v_mfma_f32_16x16x32_bf16 v[36:39], v[52:55], v[56:59], v[36:39]
  s_waitcnt vmcnt(6)
  s_add_u32 m0, s34, 9984
  s_nop 0
  buffer_load_dwordx4 v1, s[8:11], s33 offen offset:2304 nt lds
  ds_read_b128 v[56:59], v4 offset:1024
  v_and_b32_dpp v48, v28, v6 row_newbcast:2 row_mask:0xf bank_mask:0xf
  v_and_b32_dpp v49, v28, v7 row_newbcast:2 row_mask:0xf bank_mask:0xf
  v_and_b32_dpp v50, v28, v8 row_newbcast:2 row_mask:0xf bank_mask:0xf
  v_and_b32_dpp v51, v28, v9 row_newbcast:2 row_mask:0xf bank_mask:0xf
  s_waitcnt lgkmcnt(0)
  s_nop 0
  v_mfma_f32_16x16x32_bf16 v[36:39], v[48:51], v[56:59], v[36:39]
  s_waitcnt vmcnt(6)
  s_add_u32 m0, s34, 10752
  s_nop 0
  buffer_load_dwordx4 v1, s[8:11], s33 offen offset:2560 nt lds
  ds_read_b128 v[56:59], v4 offset:2048
  v_and_b32_dpp v52, v28, v6 row_newbcast:3 row_mask:0xf bank_mask:0xf
  v_and_b32_dpp v53, v28, v7 row_newbcast:3 row_mask:0xf bank_mask:0xf
  v_and_b32_dpp v54, v28, v8 row_newbcast:3 row_mask:0xf bank_mask:0xf
  v_and_b32_dpp v55, v28, v9 row_newbcast:3 row_mask:0xf bank_mask:0xf
  s_waitcnt lgkmcnt(0)
  s_nop 0
  v_mfma_f32_16x16x32_bf16 v[36:39], v[52:55], v[56:59], v[36:39]
  s_waitcnt vmcnt(6)
  s_add_u32 m0, s34, 11520
  s_nop 0
  buffer_load_dwordx4 v1, s[8:11], s33 offen offset:2816 nt lds
  ds_read_b128 v[56:59], v4 offset:3072
  v_and_b32_dpp v48, v28, v6 row_newbcast:4 row_mask:0xf bank_mask:0xf
  v_and_b32_dpp v49, v28, v7 row_newbcast:4 row_mask:0xf bank_mask:0xf
  v_and_b32_dpp v50, v28, v8 row_newbcast:4 row_mask:0xf bank_mask:0xf
  v_and_b32_dpp v51, v28, v9 row_newbcast:4 row_mask:0xf bank_mask:0xf
  s_waitcnt lgkmcnt(0)
  s_nop 0
  v_mfma_f32_16x16x32_bf16 v[36:39], v[48:51], v[56:59], v[36:39]
  s_waitcnt vmcnt(6)
  s_add_u32 m0, s34, 12288
  s_nop 0
  buffer_load_dwordx4 v1, s[8:11], s33 offen offset:3072 nt lds
  ds_read_b128 v[56:59], v4 offset:4096
  v_and_b32_dpp v52, v28, v6 row_newbcast:5 row_mask:0xf bank_mask:0xf
  v_and_b32_dpp v53, v28, v7 row_newbcast:5 row_mask:0xf bank_mask:0xf
  v_and_b32_dpp v54, v28, v8 row_newbcast:5 row_mask:0xf bank_mask:0xf
  v_and_b32_dpp v55, v28, v9 row_newbcast:5 row_mask:0xf bank_mask:0xf
  s_waitcnt lgkmcnt(0)
  s_nop 0
  v_mfma_f32_16x16x32_bf16 v[36:39], v[52:55], v[56:59], v[36:39]
  s_waitcnt vmcnt(6)
  s_add_u32 m0, s34, 13056
  s_nop 0
  buffer_load_dwordx4 v1, s[8:11], s33 offen offset:3328 nt lds
  ds_read_b128 v[56:59], v4 offset:5120
  v_and_b32_dpp v48, v28, v6 row_newbcast:6 row_mask:0xf bank_mask:0xf
  v_and_b32_dpp v49, v28, v7 row_newbcast:6 row_mask:0xf bank_mask:0xf
  v_and_b32_dpp v50, v28, v8 row_newbcast:6 row_mask:0xf bank_mask:0xf
  v_and_b32_dpp v51, v28, v9 row_newbcast:6 row_mask:0xf bank_mask:0xf
  s_waitcnt lgkmcnt(0)
  s_nop 0
  v_mfma_f32_16x16x32_bf16 v[36:39], v[48:51], v[56:59], v[36:39]
  s_waitcnt vmcnt(6)
  s_add_u32 m0, s34, 13824
  s_nop 0
  buffer_load_dwordx4 v1, s[8:11], s33 offen offset:3584 nt lds
  ds_read_b128 v[56:59], v4 offset:6144
  v_and_b32_dpp v52, v28, v6 row_newbcast:7 row_mask:0xf bank_mask:0xf
  v_and_b32_dpp v53, v28, v7 row_newbcast:7 row_mask:0xf bank_mask:0xf
  v_and_b32_dpp v54, v28, v8 row_newbcast:7 row_mask:0xf bank_mask:0xf
  v_and_b32_dpp v55, v28, v9 row_newbcast:7 row_mask:0xf bank_mask:0xf
  s_waitcnt lgkmcnt(0)
  s_nop 0
  v_mfma_f32_16x16x32_bf16 v[36:39], v[52:55], v[56:59], v[36:39]
  s_waitcnt vmcnt(6)
  s_add_u32 m0, s34, 14592
  s_nop 0
  buffer_load_dwordx4 v1, s[8:11], s33 offen offset:3840 nt lds
  ds_read_b128 v[56:59], v4 offset:7168
  v_and_b32_dpp v48, v28, v6 row_newbcast:8 row_mask:0xf bank_mask:0xf
  v_and_b32_dpp v49, v28, v7 row_newbcast:8 row_mask:0xf bank_mask:0xf
  v_and_b32_dpp v50, v28, v8 row_newbcast:8 row_mask:0xf bank_mask:0xf
  v_and_b32_dpp v51, v28, v9 row_newbcast:8 row_mask:0xf bank_mask:0xf
  s_waitcnt lgkmcnt(0)
  s_nop 0
  v_mfma_f32_16x16x32_bf16 v[36:39], v[48:51], v[56:59], v[36:39]
  s_waitcnt vmcnt(6)
  s_add_u32 s33, s29, 196608
  s_add_u32 m0, s34, 19456
  s_nop 0
  buffer_load_dwordx4 v1, s[8:11], s33 offen offset:0 nt lds
  ds_read_b128 v[56:59], v4 offset:8192
  v_and_b32_dpp v52, v28, v6 row_newbcast:9 row_mask:0xf bank_mask:0xf
  v_and_b32_dpp v53, v28, v7 row_newbcast:9 row_mask:0xf bank_mask:0xf
  v_and_b32_dpp v54, v28, v8 row_newbcast:9 row_mask:0xf bank_mask:0xf
  v_and_b32_dpp v55, v28, v9 row_newbcast:9 row_mask:0xf bank_mask:0xf
  s_waitcnt lgkmcnt(0)
  s_nop 0
  v_mfma_f32_16x16x32_bf16 v[36:39], v[52:55], v[56:59], v[36:39]
  s_waitcnt vmcnt(6)
  s_add_u32 m0, s34, 20224
  s_nop 0
  buffer_load_dwordx4 v1, s[8:11], s33 offen offset:256 nt lds
  ds_read_b128 v[56:59], v4 offset:9216
  v_and_b32_dpp v48, v28, v6 row_newbcast:10 row_mask:0xf bank_mask:0xf
  v_and_b32_dpp v49, v28, v7 row_newbcast:10 row_mask:0xf bank_mask:0xf
  v_and_b32_dpp v50, v28, v8 row_newbcast:10 row_mask:0xf bank_mask:0xf
  v_and_b32_dpp v51, v28, v9 row_newbcast:10 row_mask:0xf bank_mask:0xf
  s_waitcnt lgkmcnt(0)
  s_nop 0
  v_mfma_f32_16x16x32_bf16 v[36:39], v[48:51], v[56:59], v[36:39]
  s_waitcnt vmcnt(6)
  s_add_u32 m0, s34, 20992
  s_nop 0
  buffer_load_dwordx4 v1, s[8:11], s33 offen offset:512 nt lds
  ds_read_b128 v[56:59], v4 offset:10240
  v_and_b32_dpp v52, v28, v6 row_newbcast:11 row_mask:0xf bank_mask:0xf
  v_and_b32_dpp v53, v28, v7 row_newbcast:11 row_mask:0xf bank_mask:0xf
  v_and_b32_dpp v54, v28, v8 row_newbcast:11 row_mask:0xf bank_mask:0xf
  v_and_b32_dpp v55, v28, v9 row_newbcast:11 row_mask:0xf bank_mask:0xf
  s_waitcnt lgkmcnt(0)
  s_nop 0
  v_mfma_f32_16x16x32_bf16 v[36:39], v[52:55], v[56:59], v[36:39]
  s_waitcnt vmcnt(6)
  s_add_u32 m0, s34, 21760
  s_nop 0
  buffer_load_dwordx4 v1, s[8:11], s33 offen offset:768 nt lds
  ds_read_b128 v[56:59], v4 offset:11264
  v_and_b32_dpp v48, v28, v6 row_newbcast:12 row_mask:0xf bank_mask:0xf
  v_and_b32_dpp v49, v28, v7 row_newbcast:12 row_mask:0xf bank_mask:0xf
  v_and_b32_dpp v50, v28, v8 row_newbcast:12 row_mask:0xf bank_mask:0xf
  v_and_b32_dpp v51, v28, v9 row_newbcast:12 row_mask:0xf bank_mask:0xf
  s_waitcnt lgkmcnt(0)
  s_nop 0
  v_mfma_f32_16x16x32_bf16 v[36:39], v[48:51], v[56:59], v[36:39]
  s_waitcnt vmcnt(6)
  s_add_u32 m0, s34, 22528
  s_nop 0
  buffer_load_dwordx4 v1, s[8:11], s33 offen offset:1024 nt lds
  ds_read_b128 v[56:59], v4 offset:12288
  v_and_b32_dpp v52, v28, v6 row_newbcast:13 row_mask:0xf bank_mask:0xf
  v_and_b32_dpp v53, v28, v7 row_newbcast:13 row_mask:0xf bank_mask:0xf
  v_and_b32_dpp v54, v28, v8 row_newbcast:13 row_mask:0xf bank_mask:0xf
  v_and_b32_dpp v55, v28, v9 row_newbcast:13 row_mask:0xf bank_mask:0xf
  s_waitcnt lgkmcnt(0)
  s_nop 0
  v_mfma_f32_16x16x32_bf16 v[36:39], v[52:55], v[56:59], v[36:39]
  s_waitcnt vmcnt(6)
  s_add_u32 m0, s34, 23296
  s_nop 0
  buffer_load_dwordx4 v1, s[8:11], s33 offen offset:1280 nt lds
  ds_read_b128 v[56:59], v4 offset:13312
  v_and_b32_dpp v48, v28, v6 row_newbcast:14 row_mask:0xf bank_mask:0xf
  v_and_b32_dpp v49, v28, v7 row_newbcast:14 row_mask:0xf bank_mask:0xf
  v_and_b32_dpp v50, v28, v8 row_newbcast:14 row_mask:0xf bank_mask:0xf
  v_and_b32_dpp v51, v28, v9 row_newbcast:14 row_mask:0xf bank_mask:0xf
  s_waitcnt lgkmcnt(0)
  s_nop 0
  v_mfma_f32_16x16x32_bf16 v[36:39], v[48:51], v[56:59], v[36:39]
  s_waitcnt vmcnt(6)
  s_add_u32 m0, s34, 24064
  s_nop 0
  buffer_load_dwordx4 v1, s[8:11], s33 offen offset:1536 nt lds
  ds_read_b128 v[56:59], v4 offset:14336
  v_and_b32_dpp v52, v28, v6 row_newbcast:15 row_mask:0xf bank_mask:0xf
  v_and_b32_dpp v53, v28, v7 row_newbcast:15 row_mask:0xf bank_mask:0xf
  v_and_b32_dpp v54, v28, v8 row_newbcast:15 row_mask:0xf bank_mask:0xf
  v_and_b32_dpp v55, v28, v9 row_newbcast:15 row_mask:0xf bank_mask:0xf
  s_waitcnt lgkmcnt(0)
  s_nop 0
  v_mfma_f32_16x16x32_bf16 v[36:39], v[52:55], v[56:59], v[36:39]
  s_waitcnt vmcnt(6)
  s_add_u32 m0, s34, 24832
  s_nop 0
  buffer_load_dwordx4 v1, s[8:11], s33 offen offset:1792 nt lds
  ds_read_b128 v[56:59], v4 offset:15360
  v_and_b32_dpp v48, v29, v6 row_newbcast:0 row_mask:0xf bank_mask:0xf
  v_and_b32_dpp v49, v29, v7 row_newbcast:0 row_mask:0xf bank_mask:0xf
  v_and_b32_dpp v50, v29, v8 row_newbcast:0 row_mask:0xf bank_mask:0xf
  v_and_b32_dpp v51, v29, v9 row_newbcast:0 row_mask:0xf bank_mask:0xf
  s_waitcnt lgkmcnt(0)
  s_nop 0
  v_mfma_f32_16x16x32_bf16 v[36:39], v[48:51], v[56:59], v[36:39]
  s_waitcnt vmcnt(6)
  s_add_u32 m0, s34, 25600
  s_nop 0
  buffer_load_dwordx4 v1, s[8:11], s33 offen offset:2048 nt lds
  ds_read_b128 v[56:59], v4 offset:16384
  v_and_b32_dpp v52, v29, v6 row_newbcast:1 row_mask:0xf bank_mask:0xf
  v_and_b32_dpp v53, v29, v7 row_newbcast:1 row_mask:0xf bank_mask:0xf
  v_and_b32_dpp v54, v29, v8 row_newbcast:1 row_mask:0xf bank_mask:0xf
  v_and_b32_dpp v55, v29, v9 row_newbcast:1 row_mask:0xf bank_mask:0xf
  s_waitcnt lgkmcnt(0)
  s_nop 0
  v_mfma_f32_16x16x32_bf16 v[36:39], v[52:55], v[56:59], v[36:39]
  s_waitcnt vmcnt(6)
  s_add_u32 m0, s34, 26368
  s_nop 0
  buffer_load_dwordx4 v1, s[8:11], s33 offen offset:2304 nt lds
  ds_read_b128 v[56:59], v4 offset:17408
  v_and_b32_dpp v48, v29, v6 row_newbcast:2 row_mask:0xf bank_mask:0xf
  v_and_b32_dpp v49, v29, v7 row_newbcast:2 row_mask:0xf bank_mask:0xf
  v_and_b32_dpp v50, v29, v8 row_newbcast:2 row_mask:0xf bank_mask:0xf
  v_and_b32_dpp v51, v29, v9 row_newbcast:2 row_mask:0xf bank_mask:0xf
  s_waitcnt lgkmcnt(0)
  s_nop 0
  v_mfma_f32_16x16x32_bf16 v[36:39], v[48:51], v[56:59], v[36:39]
  s_waitcnt vmcnt(6)
  s_add_u32 m0, s34, 27136
  s_nop 0
  buffer_load_dwordx4 v1, s[8:11], s33 offen offset:2560 nt lds
  ds_read_b128 v[56:59], v4 offset:18432
  v_and_b32_dpp v52, v29, v6 row_newbcast:3 row_mask:0xf bank_mask:0xf
  v_and_b32_dpp v53, v29, v7 row_newbcast:3 row_mask:0xf bank_mask:0xf
  v_and_b32_dpp v54, v29, v8 row_newbcast:3 row_mask:0xf bank_mask:0xf
  v_and_b32_dpp v55, v29, v9 row_newbcast:3 row_mask:0xf bank_mask:0xf
  s_waitcnt lgkmcnt(0)
  s_nop 0
  v_mfma_f32_16x16x32_bf16 v[36:39], v[52:55], v[56:59], v[36:39]
  s_waitcnt vmcnt(6)
  s_add_u32 m0, s34, 27904
  s_nop 0
  buffer_load_dwordx4 v1, s[8:11], s33 offen offset:2816 nt lds
  ds_read_b128 v[56:59], v4 offset:19456
  v_and_b32_dpp v48, v29, v6 row_newbcast:4 row_mask:0xf bank_mask:0xf
  v_and_b32_dpp v49, v29, v7 row_newbcast:4 row_mask:0xf bank_mask:0xf
  v_and_b32_dpp v50, v29, v8 row_newbcast:4 row_mask:0xf bank_mask:0xf
  v_and_b32_dpp v51, v29, v9 row_newbcast:4 row_mask:0xf bank_mask:0xf
  s_waitcnt lgkmcnt(0)
  s_nop 0
  v_mfma_f32_16x16x32_bf16 v[36:39], v[48:51], v[56:59], v[36:39]
  s_waitcnt vmcnt(6)
  s_add_u32 m0, s34, 28672
  s_nop 0
  buffer_load_dwordx4 v1, s[8:11], s33 offen offset:3072 nt lds
  ds_read_b128 v[56:59], v4 offset:20480
  v_and_b32_dpp v52, v29, v6 row_newbcast:5 row_mask:0xf bank_mask:0xf
  v_and_b32_dpp v53, v29, v7 row_newbcast:5 row_mask:0xf bank_mask:0xf
  v_and_b32_dpp v54, v29, v8 row_newbcast:5 row_mask:0xf bank_mask:0xf
  v_and_b32_dpp v55, v29, v9 row_newbcast:5 row_mask:0xf bank_mask:0xf
  s_waitcnt lgkmcnt(0)
  s_nop 0
  v_mfma_f32_16x16x32_bf16 v[36:39], v[52:55], v[56:59], v[36:39]
  s_waitcnt vmcnt(6)
  s_add_u32 m0, s34, 29440
  s_nop 0
  buffer_load_dwordx4 v1, s[8:11], s33 offen offset:3328 nt lds
  ds_read_b128 v[56:59], v4 offset:21504
  v_and_b32_dpp v48, v29, v6 row_newbcast:6 row_mask:0xf bank_mask:0xf
  v_and_b32_dpp v49, v29, v7 row_newbcast:6 row_mask:0xf bank_mask:0xf
  v_and_b32_dpp v50, v29, v8 row_newbcast:6 row_mask:0xf bank_mask:0xf
  v_and_b32_dpp v51, v29, v9 row_newbcast:6 row_mask:0xf bank_mask:0xf
  s_waitcnt lgkmcnt(0)
  s_nop 0
  v_mfma_f32_16x16x32_bf16 v[36:39], v[48:51], v[56:59], v[36:39]
  s_waitcnt vmcnt(6)
  s_add_u32 m0, s34, 30208
  s_nop 0
  buffer_load_dwordx4 v1, s[8:11], s33 offen offset:3584 nt lds
  ds_read_b128 v[56:59], v4 offset:22528
  v_and_b32_dpp v52, v29, v6 row_newbcast:7 row_mask:0xf bank_mask:0xf
  v_and_b32_dpp v53, v29, v7 row_newbcast:7 row_mask:0xf bank_mask:0xf
  v_and_b32_dpp v54, v29, v8 row_newbcast:7 row_mask:0xf bank_mask:0xf
  v_and_b32_dpp v55, v29, v9 row_newbcast:7 row_mask:0xf bank_mask:0xf
  s_waitcnt lgkmcnt(0)
  s_nop 0
  v_mfma_f32_16x16x32_bf16 v[36:39], v[52:55], v[56:59], v[36:39]
  s_waitcnt vmcnt(6)
  s_add_u32 m0, s34, 30976
  s_nop 0
  buffer_load_dwordx4 v1, s[8:11], s33 offen offset:3840 nt lds
  ds_read_b128 v[56:59], v4 offset:23552
  v_and_b32_dpp v48, v29, v6 row_newbcast:8 row_mask:0xf bank_mask:0xf
  v_and_b32_dpp v49, v29, v7 row_newbcast:8 row_mask:0xf bank_mask:0xf
  v_and_b32_dpp v50, v29, v8 row_newbcast:8 row_mask:0xf bank_mask:0xf
  v_and_b32_dpp v51, v29, v9 row_newbcast:8 row_mask:0xf bank_mask:0xf
  s_waitcnt lgkmcnt(0)
  s_nop 0
  v_mfma_f32_16x16x32_bf16 v[36:39], v[48:51], v[56:59], v[36:39]
  s_waitcnt vmcnt(6)
  s_add_u32 s33, s29, 524288
  s_add_u32 m0, s34, 35840
  s_nop 0
  buffer_load_dwordx4 v2, s[8:11], s33 offen offset:0 nt lds
  ds_read_b128 v[56:59], v4 offset:24576
  v_and_b32_dpp v52, v29, v6 row_newbcast:9 row_mask:0xf bank_mask:0xf
  v_and_b32_dpp v53, v29, v7 row_newbcast:9 row_mask:0xf bank_mask:0xf
  v_and_b32_dpp v54, v29, v8 row_newbcast:9 row_mask:0xf bank_mask:0xf
  v_and_b32_dpp v55, v29, v9 row_newbcast:9 row_mask:0xf bank_mask:0xf
  s_waitcnt lgkmcnt(0)
  s_nop 0
  v_mfma_f32_16x16x32_bf16 v[36:39], v[52:55], v[56:59], v[36:39]
  s_waitcnt vmcnt(6)
  s_add_u32 m0, s34, 36608
  s_nop 0
  buffer_load_dwordx4 v2, s[8:11], s33 offen offset:256 nt lds
  ds_read_b128 v[56:59], v4 offset:25600
  v_and_b32_dpp v48, v29, v6 row_newbcast:10 row_mask:0xf bank_mask:0xf
  v_and_b32_dpp v49, v29, v7 row_newbcast:10 row_mask:0xf bank_mask:0xf
  v_and_b32_dpp v50, v29, v8 row_newbcast:10 row_mask:0xf bank_mask:0xf
  v_and_b32_dpp v51, v29, v9 row_newbcast:10 row_mask:0xf bank_mask:0xf
  s_waitcnt lgkmcnt(0)
  s_nop 0
  v_mfma_f32_16x16x32_bf16 v[36:39], v[48:51], v[56:59], v[36:39]
  s_waitcnt vmcnt(6)
  s_add_u32 m0, s34, 37376
  s_nop 0
  buffer_load_dwordx4 v2, s[8:11], s33 offen offset:512 nt lds
  ds_read_b128 v[56:59], v4 offset:26624
  v_and_b32_dpp v52, v29, v6 row_newbcast:11 row_mask:0xf bank_mask:0xf
  v_and_b32_dpp v53, v29, v7 row_newbcast:11 row_mask:0xf bank_mask:0xf
  v_and_b32_dpp v54, v29, v8 row_newbcast:11 row_mask:0xf bank_mask:0xf
  v_and_b32_dpp v55, v29, v9 row_newbcast:11 row_mask:0xf bank_mask:0xf
  s_waitcnt lgkmcnt(0)
  s_nop 0
  v_mfma_f32_16x16x32_bf16 v[36:39], v[52:55], v[56:59], v[36:39]
  s_waitcnt vmcnt(6)
  s_add_u32 m0, s34, 38144
  s_nop 0
  buffer_load_dwordx4 v2, s[8:11], s33 offen offset:768 nt lds
  ds_read_b128 v[56:59], v4 offset:27648
  v_and_b32_dpp v48, v29, v6 row_newbcast:12 row_mask:0xf bank_mask:0xf
  v_and_b32_dpp v49, v29, v7 row_newbcast:12 row_mask:0xf bank_mask:0xf
  v_and_b32_dpp v50, v29, v8 row_newbcast:12 row_mask:0xf bank_mask:0xf
  v_and_b32_dpp v51, v29, v9 row_newbcast:12 row_mask:0xf bank_mask:0xf
  s_waitcnt lgkmcnt(0)
  s_nop 0
  v_mfma_f32_16x16x32_bf16 v[36:39], v[48:51], v[56:59], v[36:39]
  s_waitcnt vmcnt(6)
  s_add_u32 m0, s34, 38912
  s_nop 0
  buffer_load_dwordx4 v2, s[8:11], s33 offen offset:1024 nt lds
  ds_read_b128 v[56:59], v4 offset:28672
  v_and_b32_dpp v52, v29, v6 row_newbcast:13 row_mask:0xf bank_mask:0xf
  v_and_b32_dpp v53, v29, v7 row_newbcast:13 row_mask:0xf bank_mask:0xf
  v_and_b32_dpp v54, v29, v8 row_newbcast:13 row_mask:0xf bank_mask:0xf
  v_and_b32_dpp v55, v29, v9 row_newbcast:13 row_mask:0xf bank_mask:0xf
  s_waitcnt lgkmcnt(0)
  s_nop 0
  v_mfma_f32_16x16x32_bf16 v[36:39], v[52:55], v[56:59], v[36:39]
  s_waitcnt vmcnt(6)
  s_add_u32 m0, s34, 39680
  s_nop 0
  buffer_load_dwordx4 v2, s[8:11], s33 offen offset:1280 nt lds
  ds_read_b128 v[56:59], v4 offset:29696
  v_and_b32_dpp v48, v29, v6 row_newbcast:14 row_mask:0xf bank_mask:0xf
  v_and_b32_dpp v49, v29, v7 row_newbcast:14 row_mask:0xf bank_mask:0xf
  v_and_b32_dpp v50, v29, v8 row_newbcast:14 row_mask:0xf bank_mask:0xf
  v_and_b32_dpp v51, v29, v9 row_newbcast:14 row_mask:0xf bank_mask:0xf
  s_waitcnt lgkmcnt(0)
  s_nop 0
  v_mfma_f32_16x16x32_bf16 v[36:39], v[48:51], v[56:59], v[36:39]
  s_waitcnt vmcnt(6)
  s_add_u32 m0, s34, 40448
  s_nop 0
  buffer_load_dwordx4 v2, s[8:11], s33 offen offset:1536 nt lds
  ds_read_b128 v[56:59], v4 offset:30720
  v_and_b32_dpp v52, v29, v6 row_newbcast:15 row_mask:0xf bank_mask:0xf
  v_and_b32_dpp v53, v29, v7 row_newbcast:15 row_mask:0xf bank_mask:0xf
  v_and_b32_dpp v54, v29, v8 row_newbcast:15 row_mask:0xf bank_mask:0xf
  v_and_b32_dpp v55, v29, v9 row_newbcast:15 row_mask:0xf bank_mask:0xf
  s_waitcnt lgkmcnt(0)
  s_nop 0
  v_mfma_f32_16x16x32_bf16 v[36:39], v[52:55], v[56:59], v[36:39]
  s_waitcnt vmcnt(6)
  s_add_u32 m0, s34, 41216
  s_nop 0
  buffer_load_dwordx4 v2, s[8:11], s33 offen offset:1792 nt lds
  ds_read_b128 v[56:59], v4 offset:31744
  v_and_b32_dpp v48, v30, v6 row_newbcast:0 row_mask:0xf bank_mask:0xf
  v_and_b32_dpp v49, v30, v7 row_newbcast:0 row_mask:0xf bank_mask:0xf
  v_and_b32_dpp v50, v30, v8 row_newbcast:0 row_mask:0xf bank_mask:0xf
  v_and_b32_dpp v51, v30, v9 row_newbcast:0 row_mask:0xf bank_mask:0xf
  s_waitcnt lgkmcnt(0)
  s_nop 0
  v_mfma_f32_16x16x32_bf16 v[36:39], v[48:51], v[56:59], v[36:39]
  s_waitcnt vmcnt(6)
  s_add_u32 s32, s28, 262144
  buffer_load_dwordx4 v[60:63], v0, s[4:7], s32 offen offset:0 nt
  ds_read_b128 v[56:59], v4 offset:32768
  v_and_b32_dpp v52, v30, v6 row_newbcast:1 row_mask:0xf bank_mask:0xf
  v_and_b32_dpp v53, v30, v7 row_newbcast:1 row_mask:0xf bank_mask:0xf
  v_and_b32_dpp v54, v30, v8 row_newbcast:1 row_mask:0xf bank_mask:0xf
  v_and_b32_dpp v55, v30, v9 row_newbcast:1 row_mask:0xf bank_mask:0xf
  s_waitcnt lgkmcnt(0)
  s_nop 0
  v_mfma_f32_16x16x32_bf16 v[36:39], v[52:55], v[56:59], v[36:39]
  s_waitcnt vmcnt(6)
  buffer_load_dwordx4 v[64:67], v0, s[4:7], s32 offen offset:128 nt
  ds_read_b128 v[56:59], v4 offset:33792
  v_and_b32_dpp v48, v30, v6 row_newbcast:2 row_mask:0xf bank_mask:0xf
  v_and_b32_dpp v49, v30, v7 row_newbcast:2 row_mask:0xf bank_mask:0xf
  v_and_b32_dpp v50, v30, v8 row_newbcast:2 row_mask:0xf bank_mask:0xf
  v_and_b32_dpp v51, v30, v9 row_newbcast:2 row_mask:0xf bank_mask:0xf
  s_waitcnt lgkmcnt(0)
  s_nop 0
  v_mfma_f32_16x16x32_bf16 v[36:39], v[48:51], v[56:59], v[36:39]
  s_waitcnt vmcnt(6)
  buffer_load_dwordx4 v[68:71], v0, s[4:7], s32 offen offset:2048 nt
  ds_read_b128 v[56:59], v4 offset:34816
  v_and_b32_dpp v52, v30, v6 row_newbcast:3 row_mask:0xf bank_mask:0xf
  v_and_b32_dpp v53, v30, v7 row_newbcast:3 row_mask:0xf bank_mask:0xf
  v_and_b32_dpp v54, v30, v8 row_newbcast:3 row_mask:0xf bank_mask:0xf
  v_and_b32_dpp v55, v30, v9 row_newbcast:3 row_mask:0xf bank_mask:0xf
  s_waitcnt lgkmcnt(0)
  s_nop 0
  v_mfma_f32_16x16x32_bf16 v[36:39], v[52:55], v[56:59], v[36:39]
  s_waitcnt vmcnt(6)
  buffer_load_dwordx4 v[72:75], v0, s[4:7], s32 offen offset:2176 nt
  ds_read_b128 v[56:59], v4 offset:35840
  v_and_b32_dpp v48, v30, v6 row_newbcast:4 row_mask:0xf bank_mask:0xf
  v_and_b32_dpp v49, v30, v7 row_newbcast:4 row_mask:0xf bank_mask:0xf
  v_and_b32_dpp v50, v30, v8 row_newbcast:4 row_mask:0xf bank_mask:0xf
  v_and_b32_dpp v51, v30, v9 row_newbcast:4 row_mask:0xf bank_mask:0xf
  s_waitcnt lgkmcnt(0)
  s_nop 0
  v_mfma_f32_16x16x32_bf16 v[36:39], v[48:51], v[56:59], v[36:39]
  s_waitcnt vmcnt(6)
  s_add_u32 s32, s28, 266240
  buffer_load_dwordx4 v[76:79], v0, s[4:7], s32 offen offset:0 nt
  ds_read_b128 v[56:59], v4 offset:36864
  v_and_b32_dpp v52, v30, v6 row_newbcast:5 row_mask:0xf bank_mask:0xf
  v_and_b32_dpp v53, v30, v7 row_newbcast:5 row_mask:0xf bank_mask:0xf
  v_and_b32_dpp v54, v30, v8 row_newbcast:5 row_mask:0xf bank_mask:0xf
  v_and_b32_dpp v55, v30, v9 row_newbcast:5 row_mask:0xf bank_mask:0xf
  s_waitcnt lgkmcnt(0)
  s_nop 0
  v_mfma_f32_16x16x32_bf16 v[36:39], v[52:55], v[56:59], v[36:39]
  s_waitcnt vmcnt(6)
  buffer_load_dwordx4 v[80:83], v0, s[4:7], s32 offen offset:128 nt
  ds_read_b128 v[56:59], v4 offset:37888
  v_and_b32_dpp v48, v30, v6 row_newbcast:6 row_mask:0xf bank_mask:0xf
  v_and_b32_dpp v49, v30, v7 row_newbcast:6 row_mask:0xf bank_mask:0xf
  v_and_b32_dpp v50, v30, v8 row_newbcast:6 row_mask:0xf bank_mask:0xf
  v_and_b32_dpp v51, v30, v9 row_newbcast:6 row_mask:0xf bank_mask:0xf
  s_waitcnt lgkmcnt(0)
  s_nop 0
  v_mfma_f32_16x16x32_bf16 v[36:39], v[48:51], v[56:59], v[36:39]
  s_waitcnt vmcnt(6)
  buffer_load_dwordx4 v[84:87], v0, s[4:7], s32 offen offset:2048 nt
  ds_read_b128 v[56:59], v4 offset:38912
  v_and_b32_dpp v52, v30, v6 row_newbcast:7 row_mask:0xf bank_mask:0xf
  v_and_b32_dpp v53, v30, v7 row_newbcast:7 row_mask:0xf bank_mask:0xf
  v_and_b32_dpp v54, v30, v8 row_newbcast:7 row_mask:0xf bank_mask:0xf
  v_and_b32_dpp v55, v30, v9 row_newbcast:7 row_mask:0xf bank_mask:0xf
  s_waitcnt lgkmcnt(0)
  s_nop 0
  v_mfma_f32_16x16x32_bf16 v[36:39], v[52:55], v[56:59], v[36:39]
  v_add_f32_dpp v11, v11, v11 row_ror:8 row_mask:0xf bank_mask:0xf
  s_nop 1
  v_add_f32_dpp v11, v11, v11 row_ror:4 row_mask:0xf bank_mask:0xf
  s_nop 1
  v_add_f32_dpp v11, v11, v11 row_ror:2 row_mask:0xf bank_mask:0xf
  s_nop 1
  v_add_f32_dpp v11, v11, v11 row_ror:1 row_mask:0xf bank_mask:0xf
  s_nop 1
  v_add_f32_dpp v11, v11, v11 row_bcast:15 row_mask:0xa bank_mask:0xf
  s_nop 1
  v_add_f32_dpp v11, v11, v11 row_bcast:31 row_mask:0xc bank_mask:0xf
  v_lshrrev_b32 v45, 4, v3
  v_and_b32 v40, 15, v45
  v_lshlrev_b32 v40, 5, v40
  v_lshrrev_b32 v41, 4, v45
  v_lshl_add_u32 v40, v41, 4, v40
  s_mul_i32 s46, s25, 28
  s_add_u32 s46, s46, s40
  s_lshl_b32 s46, s46, 9
  s_add_u32 s46, s46, 458752
  s_mov_b32 exec_hi, 0
  buffer_store_dwordx4 v[36:39], v40, s[12:15], s46 offen sc1
  s_lshl_b32 s46, s25, 8
  s_lshl_b32 s47, s40, 3
  s_add_u32 s46, s46, s47
  s_add_u32 s46, s46, 1843200
  s_mov_b64 exec, -1
  v_mov_b32 v42, s37
  v_mov_b32 v43, v11
  v_mov_b32 v44, 0
  s_mov_b32 exec_lo, 0
  s_mov_b32 exec_hi, 0x80000000
  buffer_store_dwordx2 v[42:43], v44, s[12:15], s46 offen sc1
  s_mov_b64 exec, -1
  v_lshrrev_b32 v41, 4, v3
  v_and_b32 v40, 1, v41
  v_lshlrev_b32 v40, 6, v40
  v_lshrrev_b32 v41, 4, v41
  v_lshl_add_u32 v40, v41, 4, v40
  v_add_u32 v40, s35, v40
  ds_read_b128 v[12:15], v40 offset:0
  ds_read_b128 v[16:19], v40 offset:128
  s_waitcnt lgkmcnt(0)
  s_waitcnt vmcnt(8)
  buffer_load_dwordx4 v[88:91], v0, s[4:7], s32 offen offset:2176 nt
  s_waitcnt vmcnt(8)
  v_mfma_f32_16x16x32_bf16 v[40:43], v[12:15], v[60:63], 0
  v_mfma_f32_16x16x32_bf16 v[40:43], v[16:19], v[64:67], v[40:43]
  s_add_u32 s32, s28, 270336
  buffer_load_dwordx4 v[60:63], v0, s[4:7], s32 offen offset:0 nt
  s_waitcnt vmcnt(8)
  buffer_load_dwordx4 v[64:67], v0, s[4:7], s32 offen offset:128 nt
  s_waitcnt vmcnt(8)
  v_mfma_f32_16x16x32_bf16 v[44:47], v[12:15], v[68:71], 0
  v_mfma_f32_16x16x32_bf16 v[44:47], v[16:19], v[72:75], v[44:47]
  buffer_load_dwordx4 v[68:71], v0, s[4:7], s32 offen offset:2048 nt
  s_waitcnt vmcnt(8)
  buffer_load_dwordx4 v[72:75], v0, s[4:7], s32 offen offset:2176 nt
  s_waitcnt vmcnt(8)
  v_add_f32_dpp v20, v41, v40 row_ror:8 row_mask:0x1 bank_mask:0x3
  v_mfma_f32_16x16x32_bf16 v[40:43], v[12:15], v[76:79], 0
  v_mfma_f32_16x16x32_bf16 v[40:43], v[16:19], v[80:83], v[40:43]
  s_add_u32 s32, s28, 274432
  buffer_load_dwordx4 v[76:79], v0, s[4:7], s32 offen offset:0 nt
  s_waitcnt vmcnt(8)
  buffer_load_dwordx4 v[80:83], v0, s[4:7], s32 offen offset:128 nt
  s_waitcnt vmcnt(6)
  v_add_f32_dpp v20, v44, v45 row_ror:8 row_mask:0x1 bank_mask:0xc
  v_mfma_f32_16x16x32_bf16 v[44:47], v[12:15], v[84:87], 0
  v_mfma_f32_16x16x32_bf16 v[44:47], v[16:19], v[88:91], v[44:47]
  buffer_load_dwordx4 v[84:87], v0, s[4:7], s32 offen offset:2048 nt
  s_waitcnt vmcnt(6)
  buffer_load_dwordx4 v[88:91], v0, s[4:7], s32 offen offset:2176 nt
  s_waitcnt vmcnt(6)
  v_add_f32_dpp v20, v41, v40 row_ror:8 row_mask:0x2 bank_mask:0x3
  v_mfma_f32_16x16x32_bf16 v[40:43], v[12:15], v[60:63], 0
  v_mfma_f32_16x16x32_bf16 v[40:43], v[16:19], v[64:67], v[40:43]
  s_add_u32 s32, s28, 327680
  buffer_load_dwordx4 v[60:63], v0, s[4:7], s32 offen offset:0 nt
  s_waitcnt vmcnt(6)
  buffer_load_dwordx4 v[64:67], v0, s[4:7], s32 offen offset:128 nt
  s_waitcnt vmcnt(6)
  v_add_f32_dpp v20, v44, v45 row_ror:8 row_mask:0x2 bank_mask:0xc
  v_mfma_f32_16x16x32_bf16 v[44:47], v[12:15], v[68:71], 0
  v_mfma_f32_16x16x32_bf16 v[44:47], v[16:19], v[72:75], v[44:47]
  buffer_load_dwordx4 v[68:71], v0, s[4:7], s32 offen offset:2048 nt
  s_waitcnt vmcnt(6)
  buffer_load_dwordx4 v[72:75], v0, s[4:7], s32 offen offset:2176 nt
  s_waitcnt vmcnt(6)
  v_add_f32_dpp v20, v41, v40 row_ror:8 row_mask:0x4 bank_mask:0x3
  v_mfma_f32_16x16x32_bf16 v[40:43], v[12:15], v[76:79], 0
  v_mfma_f32_16x16x32_bf16 v[40:43], v[16:19], v[80:83], v[40:43]
  s_add_u32 s32, s28, 331776
  buffer_load_dwordx4 v[76:79], v0, s[4:7], s32 offen offset:0 nt
  s_waitcnt vmcnt(6)
  buffer_load_dwordx4 v[80:83], v0, s[4:7], s32 offen offset:128 nt
  s_waitcnt vmcnt(6)
  v_add_f32_dpp v20, v44, v45 row_ror:8 row_mask:0x4 bank_mask:0xc
  v_mfma_f32_16x16x32_bf16 v[44:47], v[12:15], v[84:87], 0
  v_mfma_f32_16x16x32_bf16 v[44:47], v[16:19], v[88:91], v[44:47]
  buffer_load_dwordx4 v[84:87], v0, s[4:7], s32 offen offset:2048 nt
  s_waitcnt vmcnt(6)
  buffer_load_dwordx4 v[88:91], v0, s[4:7], s32 offen offset:2176 nt
  s_waitcnt vmcnt(6)
  v_add_f32_dpp v20, v41, v40 row_ror:8 row_mask:0x8 bank_mask:0x3
  v_mfma_f32_16x16x32_bf16 v[40:43], v[12:15], v[60:63], 0
  v_mfma_f32_16x16x32_bf16 v[40:43], v[16:19], v[64:67], v[40:43]
  s_add_u32 s32, s28, 335872
  buffer_load_dwordx4 v[60:63], v0, s[4:7], s32 offen offset:0 nt
  s_waitcnt vmcnt(6)
  buffer_load_dwordx4 v[64:67], v0, s[4:7], s32 offen offset:128 nt
  s_waitcnt vmcnt(6)
  v_add_f32_dpp v20, v44, v45 row_ror:8 row_mask:0x8 bank_mask:0xc
  v_mfma_f32_16x16x32_bf16 v[44:47], v[12:15], v[68:71], 0
  v_mfma_f32_16x16x32_bf16 v[44:47], v[16:19], v[72:75], v[44:47]
  buffer_load_dwordx4 v[68:71], v0, s[4:7], s32 offen offset:2048 nt
  s_waitcnt vmcnt(6)
  buffer_load_dwordx4 v[72:75], v0, s[4:7], s32 offen offset:2176 nt
  s_waitcnt vmcnt(6)
  v_add_f32_dpp v21, v41, v40 row_ror:8 row_mask:0x1 bank_mask:0x3
  v_mfma_f32_16x16x32_bf16 v[40:43], v[12:15], v[76:79], 0
  v_mfma_f32_16x16x32_bf16 v[40:43], v[16:19], v[80:83], v[40:43]
  s_add_u32 s32, s28, 339968
  buffer_load_dwordx4 v[76:79], v0, s[4:7], s32 offen offset:0 nt
  s_waitcnt vmcnt(6)
  buffer_load_dwordx4 v[80:83], v0, s[4:7], s32 offen offset:128 nt
  s_waitcnt vmcnt(6)
  v_add_f32_dpp v21, v44, v45 row_ror:8 row_mask:0x1 bank_mask:0xc
  v_mfma_f32_16x16x32_bf16 v[44:47], v[12:15], v[84:87], 0
  v_mfma_f32_16x16x32_bf16 v[44:47], v[16:19], v[88:91], v[44:47]
  buffer_load_dwordx4 v[84:87], v0, s[4:7], s32 offen offset:2048 nt
  s_waitcnt vmcnt(6)
  buffer_load_dwordx4 v[88:91], v0, s[4:7], s32 offen offset:2176 nt
  s_waitcnt vmcnt(6)
  v_add_f32_dpp v21, v41, v40 row_ror:8 row_mask:0x2 bank_mask:0x3
  v_mfma_f32_16x16x32_bf16 v[40:43], v[12:15], v[60:63], 0
  v_mfma_f32_16x16x32_bf16 v[40:43], v[16:19], v[64:67], v[40:43]
  s_add_u32 s32, s28, 393216
  buffer_load_dwordx4 v[60:63], v0, s[4:7], s32 offen offset:0 nt
  s_waitcnt vmcnt(6)
  buffer_load_dwordx4 v[64:67], v0, s[4:7], s32 offen offset:128 nt
  s_waitcnt vmcnt(6)
  v_add_f32_dpp v21, v44, v45 row_ror:8 row_mask:0x2 bank_mask:0xc
  v_mfma_f32_16x16x32_bf16 v[44:47], v[12:15], v[68:71], 0
  v_mfma_f32_16x16x32_bf16 v[44:47], v[16:19], v[72:75], v[44:47]
  buffer_load_dwordx4 v[68:71], v0, s[4:7], s32 offen offset:2048 nt
  s_waitcnt vmcnt(6)
  buffer_load_dwordx4 v[72:75], v0, s[4:7], s32 offen offset:2176 nt
  s_waitcnt vmcnt(6)
  v_add_f32_dpp v21, v41, v40 row_ror:8 row_mask:0x4 bank_mask:0x3
  v_mfma_f32_16x16x32_bf16 v[40:43], v[12:15], v[76:79], 0
  v_mfma_f32_16x16x32_bf16 v[40:43], v[16:19], v[80:83], v[40:43]
  s_add_u32 s32, s28, 397312
  buffer_load_dwordx4 v[76:79], v0, s[4:7], s32 offen offset:0 nt
  s_waitcnt vmcnt(6)
  buffer_load_dwordx4 v[80:83], v0, s[4:7], s32 offen offset:128 nt
  s_waitcnt vmcnt(6)
  v_add_f32_dpp v21, v44, v45 row_ror:8 row_mask:0x4 bank_mask:0xc
  v_mfma_f32_16x16x32_bf16 v[44:47], v[12:15], v[84:87], 0
  v_mfma_f32_16x16x32_bf16 v[44:47], v[16:19], v[88:91], v[44:47]
  buffer_load_dwordx4 v[84:87], v0, s[4:7], s32 offen offset:2048 nt
  s_waitcnt vmcnt(6)
  buffer_load_dwordx4 v[88:91], v0, s[4:7], s32 offen offset:2176 nt
  s_waitcnt vmcnt(6)
  v_add_f32_dpp v21, v41, v40 row_ror:8 row_mask:0x8 bank_mask:0x3
  v_mfma_f32_16x16x32_bf16 v[40:43], v[12:15], v[60:63], 0
  v_mfma_f32_16x16x32_bf16 v[40:43], v[16:19], v[64:67], v[40:43]
  s_add_u32 s32, s28, 401408
  buffer_load_dwordx4 v[60:63], v0, s[4:7], s32 offen offset:0 nt
  s_waitcnt vmcnt(6)
  buffer_load_dwordx4 v[64:67], v0, s[4:7], s32 offen offset:128 nt
  s_waitcnt vmcnt(6)
  v_add_f32_dpp v21, v44, v45 row_ror:8 row_mask:0x8 bank_mask:0xc
  v_mfma_f32_16x16x32_bf16 v[44:47], v[12:15], v[68:71], 0
  v_mfma_f32_16x16x32_bf16 v[44:47], v[16:19], v[72:75], v[44:47]
  buffer_load_dwordx4 v[68:71], v0, s[4:7], s32 offen offset:2048 nt
  s_waitcnt vmcnt(6)
  buffer_load_dwordx4 v[72:75], v0, s[4:7], s32 offen offset:2176 nt
  s_waitcnt vmcnt(6)
  v_add_f32_dpp v22, v41, v40 row_ror:8 row_mask:0x1 bank_mask:0x3
  v_mfma_f32_16x16x32_bf16 v[40:43], v[12:15], v[76:79], 0
  v_mfma_f32_16x16x32_bf16 v[40:43], v[16:19], v[80:83], v[40:43]
  s_add_u32 s32, s28, 405504
  buffer_load_dwordx4 v[76:79], v0, s[4:7], s32 offen offset:0 nt
  s_waitcnt vmcnt(6)
  buffer_load_dwordx4 v[80:83], v0, s[4:7], s32 offen offset:128 nt
  s_waitcnt vmcnt(6)
  v_add_f32_dpp v22, v44, v45 row_ror:8 row_mask:0x1 bank_mask:0xc
  v_mfma_f32_16x16x32_bf16 v[44:47], v[12:15], v[84:87], 0
  v_mfma_f32_16x16x32_bf16 v[44:47], v[16:19], v[88:91], v[44:47]
  buffer_load_dwordx4 v[84:87], v0, s[4:7], s32 offen offset:2048 nt
  s_waitcnt vmcnt(6)
  buffer_load_dwordx4 v[88:91], v0, s[4:7], s32 offen offset:2176 nt
  s_waitcnt vmcnt(6)
  v_add_f32_dpp v22, v41, v40 row_ror:8 row_mask:0x2 bank_mask:0x3
  v_mfma_f32_16x16x32_bf16 v[40:43], v[12:15], v[60:63], 0
  v_mfma_f32_16x16x32_bf16 v[40:43], v[16:19], v[64:67], v[40:43]
  s_add_u32 s32, s28, 458752
  buffer_load_dwordx4 v[60:63], v0, s[4:7], s32 offen offset:0 nt
  s_waitcnt vmcnt(6)
  buffer_load_dwordx4 v[64:67], v0, s[4:7], s32 offen offset:128 nt
  s_waitcnt vmcnt(6)
  v_add_f32_dpp v22, v44, v45 row_ror:8 row_mask:0x2 bank_mask:0xc
  v_mfma_f32_16x16x32_bf16 v[44:47], v[12:15], v[68:71], 0
  v_mfma_f32_16x16x32_bf16 v[44:47], v[16:19], v[72:75], v[44:47]
  buffer_load_dwordx4 v[68:71], v0, s[4:7], s32 offen offset:2048 nt
  s_waitcnt vmcnt(6)
  buffer_load_dwordx4 v[72:75], v0, s[4:7], s32 offen offset:2176 nt
  s_waitcnt vmcnt(6)
  v_add_f32_dpp v22, v41, v40 row_ror:8 row_mask:0x4 bank_mask:0x3
  v_mfma_f32_16x16x32_bf16 v[40:43], v[12:15], v[76:79], 0
  v_mfma_f32_16x16x32_bf16 v[40:43], v[16:19], v[80:83], v[40:43]
  s_add_u32 s32, s28, 462848
  buffer_load_dwordx4 v[76:79], v0, s[4:7], s32 offen offset:0 nt
  s_waitcnt vmcnt(6)
  buffer_load_dwordx4 v[80:83], v0, s[4:7], s32 offen offset:128 nt
  s_waitcnt vmcnt(6)
  v_add_f32_dpp v22, v44, v45 row_ror:8 row_mask:0x4 bank_mask:0xc
  v_mfma_f32_16x16x32_bf16 v[44:47], v[12:15], v[84:87], 0
  v_mfma_f32_16x16x32_bf16 v[44:47], v[16:19], v[88:91], v[44:47]
  buffer_load_dwordx4 v[84:87], v0, s[4:7], s32 offen offset:2048 nt
  s_waitcnt vmcnt(6)
  buffer_load_dwordx4 v[88:91], v0, s[4:7], s32 offen offset:2176 nt
  s_waitcnt vmcnt(6)
  v_add_f32_dpp v22, v41, v40 row_ror:8 row_mask:0x8 bank_mask:0x3
  v_mfma_f32_16x16x32_bf16 v[40:43], v[12:15], v[60:63], 0
  v_mfma_f32_16x16x32_bf16 v[40:43], v[16:19], v[64:67], v[40:43]
  s_add_u32 s32, s28, 466944
  buffer_load_dwordx4 v[60:63], v0, s[4:7], s32 offen offset:0 nt
  s_waitcnt vmcnt(6)
  buffer_load_dwordx4 v[64:67], v0, s[4:7], s32 offen offset:128 nt
  s_waitcnt vmcnt(6)
  v_add_f32_dpp v22, v44, v45 row_ror:8 row_mask:0x8 bank_mask:0xc
  v_mfma_f32_16x16x32_bf16 v[44:47], v[12:15], v[68:71], 0
  v_mfma_f32_16x16x32_bf16 v[44:47], v[16:19], v[72:75], v[44:47]
  buffer_load_dwordx4 v[68:71], v0, s[4:7], s32 offen offset:2048 nt
  s_waitcnt vmcnt(6)
  buffer_load_dwordx4 v[72:75], v0, s[4:7], s32 offen offset:2176 nt
  s_waitcnt vmcnt(6)
  v_add_f32_dpp v23, v41, v40 row_ror:8 row_mask:0x1 bank_mask:0x3
  v_mfma_f32_16x16x32_bf16 v[40:43], v[12:15], v[76:79], 0
  v_mfma_f32_16x16x32_bf16 v[40:43], v[16:19], v[80:83], v[40:43]
  s_add_u32 s32, s28, 471040
  buffer_load_dwordx4 v[76:79], v0, s[4:7], s32 offen offset:0 nt
  s_waitcnt vmcnt(6)
  buffer_load_dwordx4 v[80:83], v0, s[4:7], s32 offen offset:128 nt
  s_waitcnt vmcnt(6)
  v_add_f32_dpp v23, v44, v45 row_ror:8 row_mask:0x1 bank_mask:0xc
  v_mfma_f32_16x16x32_bf16 v[44:47], v[12:15], v[84:87], 0
  v_mfma_f32_16x16x32_bf16 v[44:47], v[16:19], v[88:91], v[44:47]
  buffer_load_dwordx4 v[84:87], v0, s[4:7], s32 offen offset:2048 nt
  s_waitcnt vmcnt(6)
  buffer_load_dwordx4 v[88:91], v0, s[4:7], s32 offen offset:2176 nt
  s_waitcnt vmcnt(6)
  v_add_f32_dpp v23, v41, v40 row_ror:8 row_mask:0x2 bank_mask:0x3
  v_mfma_f32_16x16x32_bf16 v[40:43], v[12:15], v[60:63], 0
  v_mfma_f32_16x16x32_bf16 v[40:43], v[16:19], v[64:67], v[40:43]
  s_add_u32 s32, s28, 532480
  buffer_load_dwordx4 v[60:63], v0, s[4:7], s32 offen offset:0 nt
  s_waitcnt vmcnt(6)
  buffer_load_dwordx4 v[64:67], v0, s[4:7], s32 offen offset:128 nt
  s_waitcnt vmcnt(6)
  v_add_f32_dpp v23, v44, v45 row_ror:8 row_mask:0x2 bank_mask:0xc
  v_mfma_f32_16x16x32_bf16 v[44:47], v[12:15], v[68:71], 0
  v_mfma_f32_16x16x32_bf16 v[44:47], v[16:19], v[72:75], v[44:47]
  buffer_load_dwordx4 v[68:71], v0, s[4:7], s32 offen offset:2048 nt
  s_waitcnt vmcnt(6)
  buffer_load_dwordx4 v[72:75], v0, s[4:7], s32 offen offset:2176 nt
  s_waitcnt vmcnt(6)
  v_add_f32_dpp v23, v41, v40 row_ror:8 row_mask:0x4 bank_mask:0x3
  v_mfma_f32_16x16x32_bf16 v[40:43], v[12:15], v[76:79], 0
  v_mfma_f32_16x16x32_bf16 v[40:43], v[16:19], v[80:83], v[40:43]
  s_add_u32 s32, s28, 536576
  buffer_load_dwordx4 v[76:79], v0, s[4:7], s32 offen offset:0 nt
  s_waitcnt vmcnt(6)
  buffer_load_dwordx4 v[80:83], v0, s[4:7], s32 offen offset:128 nt
  s_waitcnt vmcnt(6)
  v_add_f32_dpp v23, v44, v45 row_ror:8 row_mask:0x4 bank_mask:0xc
  v_mfma_f32_16x16x32_bf16 v[44:47], v[12:15], v[84:87], 0
  v_mfma_f32_16x16x32_bf16 v[44:47], v[16:19], v[88:91], v[44:47]
  buffer_load_dwordx4 v[84:87], v0, s[4:7], s32 offen offset:2048 nt
  s_waitcnt vmcnt(6)
  buffer_load_dwordx4 v[88:91], v0, s[4:7], s32 offen offset:2176 nt
  s_waitcnt vmcnt(6)
  v_mov_b32 v24, 0xff800000
  v_add_f32_dpp v23, v41, v40 row_ror:8 row_mask:0x8 bank_mask:0x3
  v_mfma_f32_16x16x32_bf16 v[40:43], v[12:15], v[60:63], 0
  v_mfma_f32_16x16x32_bf16 v[40:43], v[16:19], v[64:67], v[40:43]
  s_mov_b32 s32, s30
  s_mov_b64 exec, s[42:43]
  buffer_load_dwordx4 v[60:63], v0, s[4:7], s32 offen offset:0 nt
  s_mov_b64 exec, -1
  s_waitcnt vmcnt(6)
  s_mov_b64 exec, s[42:43]
  buffer_load_dwordx4 v[64:67], v0, s[4:7], s32 offen offset:128 nt
  s_mov_b64 exec, -1
  s_waitcnt vmcnt(6)
  v_add_f32_dpp v23, v44, v45 row_ror:8 row_mask:0x8 bank_mask:0xc
  v_mfma_f32_16x16x32_bf16 v[44:47], v[12:15], v[68:71], 0
  v_mfma_f32_16x16x32_bf16 v[44:47], v[16:19], v[72:75], v[44:47]
  s_mov_b64 exec, s[44:45]
  buffer_load_dwordx4 v[68:71], v0, s[4:7], s32 offen offset:2048 nt
  s_mov_b64 exec, -1
  s_waitcnt vmcnt(6)
  s_mov_b64 exec, s[44:45]
  buffer_load_dwordx4 v[72:75], v0, s[4:7], s32 offen offset:2176 nt
  s_mov_b64 exec, -1
  s_waitcnt vmcnt(6)
  v_add_f32_dpp v24, v41, v40 row_ror:8 row_mask:0x1 bank_mask:0x3
  v_mfma_f32_16x16x32_bf16 v[40:43], v[12:15], v[76:79], 0
  v_mfma_f32_16x16x32_bf16 v[40:43], v[16:19], v[80:83], v[40:43]
  s_add_u32 s33, s28, 262144
  buffer_load_dwordx4 v[76:79], v1, s[8:11], s33 offen offset:0 nt
  s_waitcnt vmcnt(6)
  buffer_load_dwordx4 v[80:83], v1, s[8:11], s33 offen offset:256 nt
  s_waitcnt vmcnt(6)
  v_add_f32_dpp v24, v45, v44 row_ror:8 row_mask:0x2 bank_mask:0x3
  v_mfma_f32_16x16x32_bf16 v[44:47], v[12:15], v[84:87], 0
  v_mfma_f32_16x16x32_bf16 v[44:47], v[16:19], v[88:91], v[44:47]
  buffer_load_dwordx4 v[84:87], v1, s[8:11], s33 offen offset:512 nt
  s_waitcnt vmcnt(6)
  buffer_load_dwordx4 v[88:91], v1, s[8:11], s33 offen offset:768 nt
  s_waitcnt vmcnt(6)
  v_mov_b32 v25, 0xff800000
  v_add_f32_dpp v24, v41, v40 row_ror:8 row_mask:0x4 bank_mask:0x3
  v_mfma_f32_16x16x32_bf16 v[40:43], v[12:15], v[60:63], 0
  v_mfma_f32_16x16x32_bf16 v[40:43], v[16:19], v[64:67], v[40:43]
  buffer_load_dwordx4 v[60:63], v1, s[8:11], s33 offen offset:1024 nt
  s_waitcnt vmcnt(6)
  buffer_load_dwordx4 v[64:67], v1, s[8:11], s33 offen offset:1280 nt
  s_waitcnt vmcnt(6)
  v_add_f32_dpp v24, v45, v44 row_ror:8 row_mask:0x8 bank_mask:0x3
  v_mfma_f32_16x16x32_bf16 v[44:47], v[12:15], v[68:71], 0
  v_mfma_f32_16x16x32_bf16 v[44:47], v[16:19], v[72:75], v[44:47]
  buffer_load_dwordx4 v[68:71], v1, s[8:11], s33 offen offset:1536 nt
  v_add_f32_dpp v25, v41, v40 row_ror:8 row_mask:0x1 bank_mask:0x3
  s_nop 5
  v_add_f32_dpp v25, v44, v45 row_ror:8 row_mask:0x1 bank_mask:0xc
  ds_bpermute_b32 v25, v5, v25
  s_waitcnt lgkmcnt(0)
  v_mul_f32 v20, 0x3e0293ee, v20
  v_mul_f32 v21, 0x3e0293ee, v21
  v_mul_f32 v22, 0x3e0293ee, v22
  v_mul_f32 v23, 0x3e0293ee, v23
  v_mul_f32 v24, 0x3e0293ee, v24
  v_mul_f32 v25, 0x3e0293ee, v25
  v_max3_f32 v40, v20, v21, v22
  v_max3_f32 v40, v40, v23, v24
  v_max_f32 v40, v40, v25
  v_max_f32 v40, s36, v40
  s_nop 1
  v_max_f32_dpp v40, v40, v40 row_ror:8 row_mask:0xf bank_mask:0xf
  s_nop 1
  v_max_f32_dpp v40, v40, v40 row_ror:4 row_mask:0xf bank_mask:0xf
  s_nop 1
  v_max_f32_dpp v40, v40, v40 row_ror:2 row_mask:0xf bank_mask:0xf
  s_nop 1
  v_max_f32_dpp v40, v40, v40 row_ror:1 row_mask:0xf bank_mask:0xf
  s_nop 1
  v_max_f32_dpp v40, v40, v40 row_bcast:15 row_mask:0xa bank_mask:0xf
  s_nop 1
  v_max_f32_dpp v40, v40, v40 row_bcast:31 row_mask:0xc bank_mask:0xf
  s_nop 0
  v_readlane_b32 s46, v40, 63
  s_nop 1
  v_mov_b32 v41, s46
  v_sub_f32 v41, s36, v41
  v_exp_f32 v41, v41
  s_nop 0
  v_mul_f32 v32, v32, v41
  v_mul_f32 v33, v33, v41
  v_mul_f32 v34, v34, v41
  v_mul_f32 v35, v35, v41
  v_mul_f32 v10, v10, v41
  s_mov_b32 s36, s46
  v_subrev_f32 v20, s36, v20
  v_subrev_f32 v21, s36, v21
  v_subrev_f32 v22, s36, v22
  v_subrev_f32 v23, s36, v23
  v_subrev_f32 v24, s36, v24
  v_subrev_f32 v25, s36, v25
  v_exp_f32 v20, v20
  v_exp_f32 v21, v21
  v_exp_f32 v22, v22
  v_exp_f32 v23, v23
  v_exp_f32 v24, v24
  v_exp_f32 v25, v25
  v_add_f32 v42, v20, v21
  v_add_f32 v43, v22, v23
  v_add_f32 v42, v42, v24
  v_add_f32 v43, v43, v25
  v_add_f32 v42, v42, v43
  v_add_f32 v10, v10, v42
  v_cvt_pk_bf16_f32 v20, v20, v20
  v_cvt_pk_bf16_f32 v21, v21, v21
  v_cvt_pk_bf16_f32 v22, v22, v22
  v_cvt_pk_bf16_f32 v23, v23, v23
  v_cvt_pk_bf16_f32 v24, v24, v24
  v_cvt_pk_bf16_f32 v25, v25, v25
  s_waitcnt vmcnt(6)
  buffer_load_dwordx4 v[72:75], v1, s[8:11], s33 offen offset:1792 nt
  v_and_b32_dpp v48, v20, v6 row_newbcast:0 row_mask:0xf bank_mask:0xf
  v_and_b32_dpp v49, v20, v7 row_newbcast:0 row_mask:0xf bank_mask:0xf
  v_and_b32_dpp v50, v20, v8 row_newbcast:0 row_mask:0xf bank_mask:0xf
  v_and_b32_dpp v51, v20, v9 row_newbcast:0 row_mask:0xf bank_mask:0xf
  s_nop 1
  v_mfma_f32_16x16x32_bf16 v[32:35], v[48:51], v[76:79], v[32:35]
  s_waitcnt vmcnt(6)
  buffer_load_dwordx4 v[76:79], v1, s[8:11], s33 offen offset:2048 nt
  v_and_b32_dpp v52, v20, v6 row_newbcast:1 row_mask:0xf bank_mask:0xf
  v_and_b32_dpp v53, v20, v7 row_newbcast:1 row_mask:0xf bank_mask:0xf
  v_and_b32_dpp v54, v20, v8 row_newbcast:1 row_mask:0xf bank_mask:0xf
  v_and_b32_dpp v55, v20, v9 row_newbcast:1 row_mask:0xf bank_mask:0xf
  s_nop 1
  v_mfma_f32_16x16x32_bf16 v[32:35], v[52:55], v[80:83], v[32:35]
  s_waitcnt vmcnt(6)
  buffer_load_dwordx4 v[80:83], v1, s[8:11], s33 offen offset:2304 nt
  v_and_b32_dpp v48, v20, v6 row_newbcast:2 row_mask:0xf bank_mask:0xf
  v_and_b32_dpp v49, v20, v7 row_newbcast:2 row_mask:0xf bank_mask:0xf
  v_and_b32_dpp v50, v20, v8 row_newbcast:2 row_mask:0xf bank_mask:0xf
  v_and_b32_dpp v51, v20, v9 row_newbcast:2 row_mask:0xf bank_mask:0xf
  s_nop 1
  v_mfma_f32_16x16x32_bf16 v[32:35], v[48:51], v[84:87], v[32:35]
  s_waitcnt vmcnt(6)
  buffer_load_dwordx4 v[84:87], v1, s[8:11], s33 offen offset:2560 nt
  v_and_b32_dpp v52, v20, v6 row_newbcast:3 row_mask:0xf bank_mask:0xf
  v_and_b32_dpp v53, v20, v7 row_newbcast:3 row_mask:0xf bank_mask:0xf
  v_and_b32_dpp v54, v20, v8 row_newbcast:3 row_mask:0xf bank_mask:0xf
  v_and_b32_dpp v55, v20, v9 row_newbcast:3 row_mask:0xf bank_mask:0xf
  s_nop 1
  v_mfma_f32_16x16x32_bf16 v[32:35], v[52:55], v[88:91], v[32:35]
  s_waitcnt vmcnt(6)
  buffer_load_dwordx4 v[88:91], v1, s[8:11], s33 offen offset:2816 nt
  v_and_b32_dpp v48, v20, v6 row_newbcast:4 row_mask:0xf bank_mask:0xf
  v_and_b32_dpp v49, v20, v7 row_newbcast:4 row_mask:0xf bank_mask:0xf
  v_and_b32_dpp v50, v20, v8 row_newbcast:4 row_mask:0xf bank_mask:0xf
  v_and_b32_dpp v51, v20, v9 row_newbcast:4 row_mask:0xf bank_mask:0xf
  s_nop 1
  v_mfma_f32_16x16x32_bf16 v[32:35], v[48:51], v[60:63], v[32:35]
  s_waitcnt vmcnt(6)
  buffer_load_dwordx4 v[60:63], v1, s[8:11], s33 offen offset:3072 nt
  v_and_b32_dpp v52, v20, v6 row_newbcast:5 row_mask:0xf bank_mask:0xf
  v_and_b32_dpp v53, v20, v7 row_newbcast:5 row_mask:0xf bank_mask:0xf
  v_and_b32_dpp v54, v20, v8 row_newbcast:5 row_mask:0xf bank_mask:0xf
  v_and_b32_dpp v55, v20, v9 row_newbcast:5 row_mask:0xf bank_mask:0xf
  s_nop 1
  v_mfma_f32_16x16x32_bf16 v[32:35], v[52:55], v[64:67], v[32:35]
  s_waitcnt vmcnt(6)
  buffer_load_dwordx4 v[64:67], v1, s[8:11], s33 offen offset:3328 nt
  v_and_b32_dpp v48, v20, v6 row_newbcast:6 row_mask:0xf bank_mask:0xf
  v_and_b32_dpp v49, v20, v7 row_newbcast:6 row_mask:0xf bank_mask:0xf
  v_and_b32_dpp v50, v20, v8 row_newbcast:6 row_mask:0xf bank_mask:0xf
  v_and_b32_dpp v51, v20, v9 row_newbcast:6 row_mask:0xf bank_mask:0xf
  s_nop 1
  v_mfma_f32_16x16x32_bf16 v[32:35], v[48:51], v[68:71], v[32:35]
  s_waitcnt vmcnt(6)
  buffer_load_dwordx4 v[68:71], v1, s[8:11], s33 offen offset:3584 nt
  v_and_b32_dpp v52, v20, v6 row_newbcast:7 row_mask:0xf bank_mask:0xf
  v_and_b32_dpp v53, v20, v7 row_newbcast:7 row_mask:0xf bank_mask:0xf
  v_and_b32_dpp v54, v20, v8 row_newbcast:7 row_mask:0xf bank_mask:0xf
  v_and_b32_dpp v55, v20, v9 row_newbcast:7 row_mask:0xf bank_mask:0xf
  s_nop 1
  v_mfma_f32_16x16x32_bf16 v[32:35], v[52:55], v[72:75], v[32:35]
  s_waitcnt vmcnt(6)
  buffer_load_dwordx4 v[72:75], v1, s[8:11], s33 offen offset:3840 nt
  v_and_b32_dpp v48, v20, v6 row_newbcast:8 row_mask:0xf bank_mask:0xf
  v_and_b32_dpp v49, v20, v7 row_newbcast:8 row_mask:0xf bank_mask:0xf
  v_and_b32_dpp v50, v20, v8 row_newbcast:8 row_mask:0xf bank_mask:0xf
  v_and_b32_dpp v51, v20, v9 row_newbcast:8 row_mask:0xf bank_mask:0xf
  s_nop 1
  v_mfma_f32_16x16x32_bf16 v[32:35], v[48:51], v[76:79], v[32:35]
  s_waitcnt vmcnt(6)
  s_add_u32 s33, s28, 327680
  buffer_load_dwordx4 v[76:79], v1, s[8:11], s33 offen offset:0 nt
  v_and_b32_dpp v52, v20, v6 row_newbcast:9 row_mask:0xf bank_mask:0xf
  v_and_b32_dpp v53, v20, v7 row_newbcast:9 row_mask:0xf bank_mask:0xf
  v_and_b32_dpp v54, v20, v8 row_newbcast:9 row_mask:0xf bank_mask:0xf
  v_and_b32_dpp v55, v20, v9 row_newbcast:9 row_mask:0xf bank_mask:0xf
  s_nop 1
  v_mfma_f32_16x16x32_bf16 v[32:35], v[52:55], v[80:83], v[32:35]
  s_waitcnt vmcnt(6)
  buffer_load_dwordx4 v[80:83], v1, s[8:11], s33 offen offset:256 nt
  v_and_b32_dpp v48, v20, v6 row_newbcast:10 row_mask:0xf bank_mask:0xf
  v_and_b32_dpp v49, v20, v7 row_newbcast:10 row_mask:0xf bank_mask:0xf
  v_and_b32_dpp v50, v20, v8 row_newbcast:10 row_mask:0xf bank_mask:0xf
  v_and_b32_dpp v51, v20, v9 row_newbcast:10 row_mask:0xf bank_mask:0xf
  s_nop 1
  v_mfma_f32_16x16x32_bf16 v[32:35], v[48:51], v[84:87], v[32:35]
  s_waitcnt vmcnt(6)
  buffer_load_dwordx4 v[84:87], v1, s[8:11], s33 offen offset:512 nt
  v_and_b32_dpp v52, v20, v6 row_newbcast:11 row_mask:0xf bank_mask:0xf
  v_and_b32_dpp v53, v20, v7 row_newbcast:11 row_mask:0xf bank_mask:0xf
  v_and_b32_dpp v54, v20, v8 row_newbcast:11 row_mask:0xf bank_mask:0xf
  v_and_b32_dpp v55, v20, v9 row_newbcast:11 row_mask:0xf bank_mask:0xf
  s_nop 1
  v_mfma_f32_16x16x32_bf16 v[32:35], v[52:55], v[88:91], v[32:35]
  s_waitcnt vmcnt(6)
  buffer_load_dwordx4 v[88:91], v1, s[8:11], s33 offen offset:768 nt
  v_and_b32_dpp v48, v20, v6 row_newbcast:12 row_mask:0xf bank_mask:0xf
  v_and_b32_dpp v49, v20, v7 row_newbcast:12 row_mask:0xf bank_mask:0xf
  v_and_b32_dpp v50, v20, v8 row_newbcast:12 row_mask:0xf bank_mask:0xf
  v_and_b32_dpp v51, v20, v9 row_newbcast:12 row_mask:0xf bank_mask:0xf
  s_nop 1
  v_mfma_f32_16x16x32_bf16 v[32:35], v[48:51], v[60:63], v[32:35]
  s_waitcnt vmcnt(6)
  buffer_load_dwordx4 v[60:63], v1, s[8:11], s33 offen offset:1024 nt
  v_and_b32_dpp v52, v20, v6 row_newbcast:13 row_mask:0xf bank_mask:0xf
  v_and_b32_dpp v53, v20, v7 row_newbcast:13 row_mask:0xf bank_mask:0xf
  v_and_b32_dpp v54, v20, v8 row_newbcast:13 row_mask:0xf bank_mask:0xf
  v_and_b32_dpp v55, v20, v9 row_newbcast:13 row_mask:0xf bank_mask:0xf
  s_nop 1
  v_mfma_f32_16x16x32_bf16 v[32:35], v[52:55], v[64:67], v[32:35]
  s_waitcnt vmcnt(6)
  buffer_load_dwordx4 v[64:67], v1, s[8:11], s33 offen offset:1280 nt
  v_and_b32_dpp v48, v20, v6 row_newbcast:14 row_mask:0xf bank_mask:0xf
  v_and_b32_dpp v49, v20, v7 row_newbcast:14 row_mask:0xf bank_mask:0xf
  v_and_b32_dpp v50, v20, v8 row_newbcast:14 row_mask:0xf bank_mask:0xf
  v_and_b32_dpp v51, v20, v9 row_newbcast:14 row_mask:0xf bank_mask:0xf
  s_nop 1
  v_mfma_f32_16x16x32_bf16 v[32:35], v[48:51], v[68:71], v[32:35]
  s_waitcnt vmcnt(6)
  buffer_load_dwordx4 v[68:71], v1, s[8:11], s33 offen offset:1536 nt
  v_and_b32_dpp v52, v20, v6 row_newbcast:15 row_mask:0xf bank_mask:0xf
  v_and_b32_dpp v53, v20, v7 row_newbcast:15 row_mask:0xf bank_mask:0xf
  v_and_b32_dpp v54, v20, v8 row_newbcast:15 row_mask:0xf bank_mask:0xf
  v_and_b32_dpp v55, v20, v9 row_newbcast:15 row_mask:0xf bank_mask:0xf
  s_nop 1
  v_mfma_f32_16x16x32_bf16 v[32:35], v[52:55], v[72:75], v[32:35]
  s_waitcnt vmcnt(6)
  buffer_load_dwordx4 v[72:75], v1, s[8:11], s33 offen offset:1792 nt
  v_and_b32_dpp v48, v21, v6 row_newbcast:0 row_mask:0xf bank_mask:0xf
  v_and_b32_dpp v49, v21, v7 row_newbcast:0 row_mask:0xf bank_mask:0xf
  v_and_b32_dpp v50, v21, v8 row_newbcast:0 row_mask:0xf bank_mask:0xf
  v_and_b32_dpp v51, v21, v9 row_newbcast:0 row_mask:0xf bank_mask:0xf
  s_nop 1
  v_mfma_f32_16x16x32_bf16 v[32:35], v[48:51], v[76:79], v[32:35]
  s_waitcnt vmcnt(6)
  buffer_load_dwordx4 v[76:79], v1, s[8:11], s33 offen offset:2048 nt
  v_and_b32_dpp v52, v21, v6 row_newbcast:1 row_mask:0xf bank_mask:0xf
  v_and_b32_dpp v53, v21, v7 row_newbcast:1 row_mask:0xf bank_mask:0xf
  v_and_b32_dpp v54, v21, v8 row_newbcast:1 row_mask:0xf bank_mask:0xf
  v_and_b32_dpp v55, v21, v9 row_newbcast:1 row_mask:0xf bank_mask:0xf
  s_nop 1
  v_mfma_f32_16x16x32_bf16 v[32:35], v[52:55], v[80:83], v[32:35]
  s_waitcnt vmcnt(6)
  buffer_load_dwordx4 v[80:83], v1, s[8:11], s33 offen offset:2304 nt
  v_and_b32_dpp v48, v21, v6 row_newbcast:2 row_mask:0xf bank_mask:0xf
  v_and_b32_dpp v49, v21, v7 row_newbcast:2 row_mask:0xf bank_mask:0xf
  v_and_b32_dpp v50, v21, v8 row_newbcast:2 row_mask:0xf bank_mask:0xf
  v_and_b32_dpp v51, v21, v9 row_newbcast:2 row_mask:0xf bank_mask:0xf
  s_nop 1
  v_mfma_f32_16x16x32_bf16 v[32:35], v[48:51], v[84:87], v[32:35]
  s_waitcnt vmcnt(6)
  buffer_load_dwordx4 v[84:87], v1, s[8:11], s33 offen offset:2560 nt
  v_and_b32_dpp v52, v21, v6 row_newbcast:3 row_mask:0xf bank_mask:0xf
  v_and_b32_dpp v53, v21, v7 row_newbcast:3 row_mask:0xf bank_mask:0xf
  v_and_b32_dpp v54, v21, v8 row_newbcast:3 row_mask:0xf bank_mask:0xf
  v_and_b32_dpp v55, v21, v9 row_newbcast:3 row_mask:0xf bank_mask:0xf
  s_nop 1
  v_mfma_f32_16x16x32_bf16 v[32:35], v[52:55], v[88:91], v[32:35]
  s_waitcnt vmcnt(6)
  buffer_load_dwordx4 v[88:91], v1, s[8:11], s33 offen offset:2816 nt
  v_and_b32_dpp v48, v21, v6 row_newbcast:4 row_mask:0xf bank_mask:0xf
  v_and_b32_dpp v49, v21, v7 row_newbcast:4 row_mask:0xf bank_mask:0xf
  v_and_b32_dpp v50, v21, v8 row_newbcast:4 row_mask:0xf bank_mask:0xf
  v_and_b32_dpp v51, v21, v9 row_newbcast:4 row_mask:0xf bank_mask:0xf
  s_nop 1
  v_mfma_f32_16x16x32_bf16 v[32:35], v[48:51], v[60:63], v[32:35]
  s_waitcnt vmcnt(6)
  buffer_load_dwordx4 v[60:63], v1, s[8:11], s33 offen offset:3072 nt
  v_and_b32_dpp v52, v21, v6 row_newbcast:5 row_mask:0xf bank_mask:0xf
  v_and_b32_dpp v53, v21, v7 row_newbcast:5 row_mask:0xf bank_mask:0xf
  v_and_b32_dpp v54, v21, v8 row_newbcast:5 row_mask:0xf bank_mask:0xf
  v_and_b32_dpp v55, v21, v9 row_newbcast:5 row_mask:0xf bank_mask:0xf
  s_nop 1
  v_mfma_f32_16x16x32_bf16 v[32:35], v[52:55], v[64:67], v[32:35]
  s_waitcnt vmcnt(6)
  buffer_load_dwordx4 v[64:67], v1, s[8:11], s33 offen offset:3328 nt
  v_and_b32_dpp v48, v21, v6 row_newbcast:6 row_mask:0xf bank_mask:0xf
  v_and_b32_dpp v49, v21, v7 row_newbcast:6 row_mask:0xf bank_mask:0xf
  v_and_b32_dpp v50, v21, v8 row_newbcast:6 row_mask:0xf bank_mask:0xf
  v_and_b32_dpp v51, v21, v9 row_newbcast:6 row_mask:0xf bank_mask:0xf
  s_nop 1
  v_mfma_f32_16x16x32_bf16 v[32:35], v[48:51], v[68:71], v[32:35]
  s_waitcnt vmcnt(6)
  buffer_load_dwordx4 v[68:71], v1, s[8:11], s33 offen offset:3584 nt
  v_and_b32_dpp v52, v21, v6 row_newbcast:7 row_mask:0xf bank_mask:0xf
  v_and_b32_dpp v53, v21, v7 row_newbcast:7 row_mask:0xf bank_mask:0xf
  v_and_b32_dpp v54, v21, v8 row_newbcast:7 row_mask:0xf bank_mask:0xf
  v_and_b32_dpp v55, v21, v9 row_newbcast:7 row_mask:0xf bank_mask:0xf
  s_nop 1
  v_mfma_f32_16x16x32_bf16 v[32:35], v[52:55], v[72:75], v[32:35]
  s_waitcnt vmcnt(6)
  buffer_load_dwordx4 v[72:75], v1, s[8:11], s33 offen offset:3840 nt
  v_and_b32_dpp v48, v21, v6 row_newbcast:8 row_mask:0xf bank_mask:0xf
  v_and_b32_dpp v49, v21, v7 row_newbcast:8 row_mask:0xf bank_mask:0xf
  v_and_b32_dpp v50, v21, v8 row_newbcast:8 row_mask:0xf bank_mask:0xf
  v_and_b32_dpp v51, v21, v9 row_newbcast:8 row_mask:0xf bank_mask:0xf
  s_nop 1
  v_mfma_f32_16x16x32_bf16 v[32:35], v[48:51], v[76:79], v[32:35]
  s_waitcnt vmcnt(6)
  s_add_u32 s33, s28, 393216
  buffer_load_dwordx4 v[76:79], v1, s[8:11], s33 offen offset:0 nt
  v_and_b32_dpp v52, v21, v6 row_newbcast:9 row_mask:0xf bank_mask:0xf
  v_and_b32_dpp v53, v21, v7 row_newbcast:9 row_mask:0xf bank_mask:0xf
  v_and_b32_dpp v54, v21, v8 row_newbcast:9 row_mask:0xf bank_mask:0xf
  v_and_b32_dpp v55, v21, v9 row_newbcast:9 row_mask:0xf bank_mask:0xf
  s_nop 1
  v_mfma_f32_16x16x32_bf16 v[32:35], v[52:55], v[80:83], v[32:35]
  s_waitcnt vmcnt(6)
  buffer_load_dwordx4 v[80:83], v1, s[8:11], s33 offen offset:256 nt
  v_and_b32_dpp v48, v21, v6 row_newbcast:10 row_mask:0xf bank_mask:0xf
  v_and_b32_dpp v49, v21, v7 row_newbcast:10 row_mask:0xf bank_mask:0xf
  v_and_b32_dpp v50, v21, v8 row_newbcast:10 row_mask:0xf bank_mask:0xf
  v_and_b32_dpp v51, v21, v9 row_newbcast:10 row_mask:0xf bank_mask:0xf
  s_nop 1
  v_mfma_f32_16x16x32_bf16 v[32:35], v[48:51], v[84:87], v[32:35]
  s_waitcnt vmcnt(6)
  buffer_load_dwordx4 v[84:87], v1, s[8:11], s33 offen offset:512 nt
  v_and_b32_dpp v52, v21, v6 row_newbcast:11 row_mask:0xf bank_mask:0xf
  v_and_b32_dpp v53, v21, v7 row_newbcast:11 row_mask:0xf bank_mask:0xf
  v_and_b32_dpp v54, v21, v8 row_newbcast:11 row_mask:0xf bank_mask:0xf
  v_and_b32_dpp v55, v21, v9 row_newbcast:11 row_mask:0xf bank_mask:0xf
  s_nop 1
  v_mfma_f32_16x16x32_bf16 v[32:35], v[52:55], v[88:91], v[32:35]
  s_waitcnt vmcnt(6)
  buffer_load_dwordx4 v[88:91], v1, s[8:11], s33 offen offset:768 nt
  v_and_b32_dpp v48, v21, v6 row_newbcast:12 row_mask:0xf bank_mask:0xf
  v_and_b32_dpp v49, v21, v7 row_newbcast:12 row_mask:0xf bank_mask:0xf
  v_and_b32_dpp v50, v21, v8 row_newbcast:12 row_mask:0xf bank_mask:0xf
  v_and_b32_dpp v51, v21, v9 row_newbcast:12 row_mask:0xf bank_mask:0xf
  s_nop 1
  v_mfma_f32_16x16x32_bf16 v[32:35], v[48:51], v[60:63], v[32:35]
  s_waitcnt vmcnt(6)
  buffer_load_dwordx4 v[60:63], v1, s[8:11], s33 offen offset:1024 nt
  v_and_b32_dpp v52, v21, v6 row_newbcast:13 row_mask:0xf bank_mask:0xf
  v_and_b32_dpp v53, v21, v7 row_newbcast:13 row_mask:0xf bank_mask:0xf
  v_and_b32_dpp v54, v21, v8 row_newbcast:13 row_mask:0xf bank_mask:0xf
  v_and_b32_dpp v55, v21, v9 row_newbcast:13 row_mask:0xf bank_mask:0xf
  s_nop 1
  v_mfma_f32_16x16x32_bf16 v[32:35], v[52:55], v[64:67], v[32:35]
  s_waitcnt vmcnt(6)
  buffer_load_dwordx4 v[64:67], v1, s[8:11], s33 offen offset:1280 nt
  v_and_b32_dpp v48, v21, v6 row_newbcast:14 row_mask:0xf bank_mask:0xf
  v_and_b32_dpp v49, v21, v7 row_newbcast:14 row_mask:0xf bank_mask:0xf
  v_and_b32_dpp v50, v21, v8 row_newbcast:14 row_mask:0xf bank_mask:0xf
  v_and_b32_dpp v51, v21, v9 row_newbcast:14 row_mask:0xf bank_mask:0xf
  s_nop 1
  v_mfma_f32_16x16x32_bf16 v[32:35], v[48:51], v[68:71], v[32:35]
  s_waitcnt vmcnt(6)
  buffer_load_dwordx4 v[68:71], v1, s[8:11], s33 offen offset:1536 nt
  v_and_b32_dpp v52, v21, v6 row_newbcast:15 row_mask:0xf bank_mask:0xf
  v_and_b32_dpp v53, v21, v7 row_newbcast:15 row_mask:0xf bank_mask:0xf
  v_and_b32_dpp v54, v21, v8 row_newbcast:15 row_mask:0xf bank_mask:0xf
  v_and_b32_dpp v55, v21, v9 row_newbcast:15 row_mask:0xf bank_mask:0xf
  s_nop 1
  v_mfma_f32_16x16x32_bf16 v[32:35], v[52:55], v[72:75], v[32:35]
  s_waitcnt vmcnt(6)
  buffer_load_dwordx4 v[72:75], v1, s[8:11], s33 offen offset:1792 nt
  v_and_b32_dpp v48, v22, v6 row_newbcast:0 row_mask:0xf bank_mask:0xf
  v_and_b32_dpp v49, v22, v7 row_newbcast:0 row_mask:0xf bank_mask:0xf
  v_and_b32_dpp v50, v22, v8 row_newbcast:0 row_mask:0xf bank_mask:0xf
  v_and_b32_dpp v51, v22, v9 row_newbcast:0 row_mask:0xf bank_mask:0xf
  s_nop 1
  v_mfma_f32_16x16x32_bf16 v[32:35], v[48:51], v[76:79], v[32:35]
  s_waitcnt vmcnt(6)
  buffer_load_dwordx4 v[76:79], v1, s[8:11], s33 offen offset:2048 nt
  v_and_b32_dpp v52, v22, v6 row_newbcast:1 row_mask:0xf bank_mask:0xf
  v_and_b32_dpp v53, v22, v7 row_newbcast:1 row_mask:0xf bank_mask:0xf
  v_and_b32_dpp v54, v22, v8 row_newbcast:1 row_mask:0xf bank_mask:0xf
  v_and_b32_dpp v55, v22, v9 row_newbcast:1 row_mask:0xf bank_mask:0xf
  s_nop 1
  v_mfma_f32_16x16x32_bf16 v[32:35], v[52:55], v[80:83], v[32:35]
  s_waitcnt vmcnt(6)
  buffer_load_dwordx4 v[80:83], v1, s[8:11], s33 offen offset:2304 nt
  v_and_b32_dpp v48, v22, v6 row_newbcast:2 row_mask:0xf bank_mask:0xf
  v_and_b32_dpp v49, v22, v7 row_newbcast:2 row_mask:0xf bank_mask:0xf
  v_and_b32_dpp v50, v22, v8 row_newbcast:2 row_mask:0xf bank_mask:0xf
  v_and_b32_dpp v51, v22, v9 row_newbcast:2 row_mask:0xf bank_mask:0xf
  s_nop 1
  v_mfma_f32_16x16x32_bf16 v[32:35], v[48:51], v[84:87], v[32:35]
  s_waitcnt vmcnt(6)
  buffer_load_dwordx4 v[84:87], v1, s[8:11], s33 offen offset:2560 nt
  v_and_b32_dpp v52, v22, v6 row_newbcast:3 row_mask:0xf bank_mask:0xf
  v_and_b32_dpp v53, v22, v7 row_newbcast:3 row_mask:0xf bank_mask:0xf
  v_and_b32_dpp v54, v22, v8 row_newbcast:3 row_mask:0xf bank_mask:0xf
  v_and_b32_dpp v55, v22, v9 row_newbcast:3 row_mask:0xf bank_mask:0xf
  s_nop 1
  v_mfma_f32_16x16x32_bf16 v[32:35], v[52:55], v[88:91], v[32:35]
  s_waitcnt vmcnt(6)
  buffer_load_dwordx4 v[88:91], v1, s[8:11], s33 offen offset:2816 nt
  v_and_b32_dpp v48, v22, v6 row_newbcast:4 row_mask:0xf bank_mask:0xf
  v_and_b32_dpp v49, v22, v7 row_newbcast:4 row_mask:0xf bank_mask:0xf
  v_and_b32_dpp v50, v22, v8 row_newbcast:4 row_mask:0xf bank_mask:0xf
  v_and_b32_dpp v51, v22, v9 row_newbcast:4 row_mask:0xf bank_mask:0xf
  s_nop 1
  v_mfma_f32_16x16x32_bf16 v[32:35], v[48:51], v[60:63], v[32:35]
  s_waitcnt vmcnt(6)
  buffer_load_dwordx4 v[60:63], v1, s[8:11], s33 offen offset:3072 nt
  v_and_b32_dpp v52, v22, v6 row_newbcast:5 row_mask:0xf bank_mask:0xf
  v_and_b32_dpp v53, v22, v7 row_newbcast:5 row_mask:0xf bank_mask:0xf
  v_and_b32_dpp v54, v22, v8 row_newbcast:5 row_mask:0xf bank_mask:0xf
  v_and_b32_dpp v55, v22, v9 row_newbcast:5 row_mask:0xf bank_mask:0xf
  s_nop 1
  v_mfma_f32_16x16x32_bf16 v[32:35], v[52:55], v[64:67], v[32:35]
  s_waitcnt vmcnt(6)
  buffer_load_dwordx4 v[64:67], v1, s[8:11], s33 offen offset:3328 nt
  v_and_b32_dpp v48, v22, v6 row_newbcast:6 row_mask:0xf bank_mask:0xf
  v_and_b32_dpp v49, v22, v7 row_newbcast:6 row_mask:0xf bank_mask:0xf
  v_and_b32_dpp v50, v22, v8 row_newbcast:6 row_mask:0xf bank_mask:0xf
  v_and_b32_dpp v51, v22, v9 row_newbcast:6 row_mask:0xf bank_mask:0xf
  s_nop 1
  v_mfma_f32_16x16x32_bf16 v[32:35], v[48:51], v[68:71], v[32:35]
  s_waitcnt vmcnt(6)
  buffer_load_dwordx4 v[68:71], v1, s[8:11], s33 offen offset:3584 nt
  v_and_b32_dpp v52, v22, v6 row_newbcast:7 row_mask:0xf bank_mask:0xf
  v_and_b32_dpp v53, v22, v7 row_newbcast:7 row_mask:0xf bank_mask:0xf
  v_and_b32_dpp v54, v22, v8 row_newbcast:7 row_mask:0xf bank_mask:0xf
  v_and_b32_dpp v55, v22, v9 row_newbcast:7 row_mask:0xf bank_mask:0xf
  s_nop 1
  v_mfma_f32_16x16x32_bf16 v[32:35], v[52:55], v[72:75], v[32:35]
  s_waitcnt vmcnt(6)
  buffer_load_dwordx4 v[72:75], v1, s[8:11], s33 offen offset:3840 nt
  v_and_b32_dpp v48, v22, v6 row_newbcast:8 row_mask:0xf bank_mask:0xf
  v_and_b32_dpp v49, v22, v7 row_newbcast:8 row_mask:0xf bank_mask:0xf
  v_and_b32_dpp v50, v22, v8 row_newbcast:8 row_mask:0xf bank_mask:0xf
  v_and_b32_dpp v51, v22, v9 row_newbcast:8 row_mask:0xf bank_mask:0xf
  s_nop 1
  v_mfma_f32_16x16x32_bf16 v[32:35], v[48:51], v[76:79], v[32:35]
  s_waitcnt vmcnt(6)
  s_add_u32 s33, s28, 458752
  buffer_load_dwordx4 v[76:79], v1, s[8:11], s33 offen offset:0 nt
  v_and_b32_dpp v52, v22, v6 row_newbcast:9 row_mask:0xf bank_mask:0xf
  v_and_b32_dpp v53, v22, v7 row_newbcast:9 row_mask:0xf bank_mask:0xf
  v_and_b32_dpp v54, v22, v8 row_newbcast:9 row_mask:0xf bank_mask:0xf
  v_and_b32_dpp v55, v22, v9 row_newbcast:9 row_mask:0xf bank_mask:0xf
  s_nop 1
  v_mfma_f32_16x16x32_bf16 v[32:35], v[52:55], v[80:83], v[32:35]
  s_waitcnt vmcnt(6)
  buffer_load_dwordx4 v[80:83], v1, s[8:11], s33 offen offset:256 nt
  v_and_b32_dpp v48, v22, v6 row_newbcast:10 row_mask:0xf bank_mask:0xf
  v_and_b32_dpp v49, v22, v7 row_newbcast:10 row_mask:0xf bank_mask:0xf
  v_and_b32_dpp v50, v22, v8 row_newbcast:10 row_mask:0xf bank_mask:0xf
  v_and_b32_dpp v51, v22, v9 row_newbcast:10 row_mask:0xf bank_mask:0xf
  s_nop 1
  v_mfma_f32_16x16x32_bf16 v[32:35], v[48:51], v[84:87], v[32:35]
  s_waitcnt vmcnt(6)
  buffer_load_dwordx4 v[84:87], v1, s[8:11], s33 offen offset:512 nt
  v_and_b32_dpp v52, v22, v6 row_newbcast:11 row_mask:0xf bank_mask:0xf
  v_and_b32_dpp v53, v22, v7 row_newbcast:11 row_mask:0xf bank_mask:0xf
  v_and_b32_dpp v54, v22, v8 row_newbcast:11 row_mask:0xf bank_mask:0xf
  v_and_b32_dpp v55, v22, v9 row_newbcast:11 row_mask:0xf bank_mask:0xf
  s_nop 1
  v_mfma_f32_16x16x32_bf16 v[32:35], v[52:55], v[88:91], v[32:35]
  s_waitcnt vmcnt(6)
  buffer_load_dwordx4 v[88:91], v1, s[8:11], s33 offen offset:768 nt
  v_and_b32_dpp v48, v22, v6 row_newbcast:12 row_mask:0xf bank_mask:0xf
  v_and_b32_dpp v49, v22, v7 row_newbcast:12 row_mask:0xf bank_mask:0xf
  v_and_b32_dpp v50, v22, v8 row_newbcast:12 row_mask:0xf bank_mask:0xf
  v_and_b32_dpp v51, v22, v9 row_newbcast:12 row_mask:0xf bank_mask:0xf
  s_nop 1
  v_mfma_f32_16x16x32_bf16 v[32:35], v[48:51], v[60:63], v[32:35]
  s_waitcnt vmcnt(6)
  buffer_load_dwordx4 v[60:63], v1, s[8:11], s33 offen offset:1024 nt
  v_and_b32_dpp v52, v22, v6 row_newbcast:13 row_mask:0xf bank_mask:0xf
  v_and_b32_dpp v53, v22, v7 row_newbcast:13 row_mask:0xf bank_mask:0xf
  v_and_b32_dpp v54, v22, v8 row_newbcast:13 row_mask:0xf bank_mask:0xf
  v_and_b32_dpp v55, v22, v9 row_newbcast:13 row_mask:0xf bank_mask:0xf
  s_nop 1
  v_mfma_f32_16x16x32_bf16 v[32:35], v[52:55], v[64:67], v[32:35]
  s_waitcnt vmcnt(6)
  buffer_load_dwordx4 v[64:67], v1, s[8:11], s33 offen offset:1280 nt
  v_and_b32_dpp v48, v22, v6 row_newbcast:14 row_mask:0xf bank_mask:0xf
  v_and_b32_dpp v49, v22, v7 row_newbcast:14 row_mask:0xf bank_mask:0xf
  v_and_b32_dpp v50, v22, v8 row_newbcast:14 row_mask:0xf bank_mask:0xf
  v_and_b32_dpp v51, v22, v9 row_newbcast:14 row_mask:0xf bank_mask:0xf
  s_nop 1
  v_mfma_f32_16x16x32_bf16 v[32:35], v[48:51], v[68:71], v[32:35]
  s_waitcnt vmcnt(6)
  buffer_load_dwordx4 v[68:71], v1, s[8:11], s33 offen offset:1536 nt
  v_and_b32_dpp v52, v22, v6 row_newbcast:15 row_mask:0xf bank_mask:0xf
  v_and_b32_dpp v53, v22, v7 row_newbcast:15 row_mask:0xf bank_mask:0xf
  v_and_b32_dpp v54, v22, v8 row_newbcast:15 row_mask:0xf bank_mask:0xf
  v_and_b32_dpp v55, v22, v9 row_newbcast:15 row_mask:0xf bank_mask:0xf
  s_nop 1
  v_mfma_f32_16x16x32_bf16 v[32:35], v[52:55], v[72:75], v[32:35]
  s_waitcnt vmcnt(6)
  buffer_load_dwordx4 v[72:75], v1, s[8:11], s33 offen offset:1792 nt
  v_and_b32_dpp v48, v23, v6 row_newbcast:0 row_mask:0xf bank_mask:0xf
  v_and_b32_dpp v49, v23, v7 row_newbcast:0 row_mask:0xf bank_mask:0xf
  v_and_b32_dpp v50, v23, v8 row_newbcast:0 row_mask:0xf bank_mask:0xf
  v_and_b32_dpp v51, v23, v9 row_newbcast:0 row_mask:0xf bank_mask:0xf
  s_nop 1
  v_mfma_f32_16x16x32_bf16 v[32:35], v[48:51], v[76:79], v[32:35]
  s_waitcnt vmcnt(6)
  buffer_load_dwordx4 v[76:79], v1, s[8:11], s33 offen offset:2048 nt
  v_and_b32_dpp v52, v23, v6 row_newbcast:1 row_mask:0xf bank_mask:0xf
  v_and_b32_dpp v53, v23, v7 row_newbcast:1 row_mask:0xf bank_mask:0xf
  v_and_b32_dpp v54, v23, v8 row_newbcast:1 row_mask:0xf bank_mask:0xf
  v_and_b32_dpp v55, v23, v9 row_newbcast:1 row_mask:0xf bank_mask:0xf
  s_nop 1
  v_mfma_f32_16x16x32_bf16 v[32:35], v[52:55], v[80:83], v[32:35]
  s_waitcnt vmcnt(6)
  buffer_load_dwordx4 v[80:83], v1, s[8:11], s33 offen offset:2304 nt
  v_and_b32_dpp v48, v23, v6 row_newbcast:2 row_mask:0xf bank_mask:0xf
  v_and_b32_dpp v49, v23, v7 row_newbcast:2 row_mask:0xf bank_mask:0xf
  v_and_b32_dpp v50, v23, v8 row_newbcast:2 row_mask:0xf bank_mask:0xf
  v_and_b32_dpp v51, v23, v9 row_newbcast:2 row_mask:0xf bank_mask:0xf
  s_nop 1
  v_mfma_f32_16x16x32_bf16 v[32:35], v[48:51], v[84:87], v[32:35]
  s_waitcnt vmcnt(6)
  buffer_load_dwordx4 v[84:87], v1, s[8:11], s33 offen offset:2560 nt
  v_and_b32_dpp v52, v23, v6 row_newbcast:3 row_mask:0xf bank_mask:0xf
  v_and_b32_dpp v53, v23, v7 row_newbcast:3 row_mask:0xf bank_mask:0xf
  v_and_b32_dpp v54, v23, v8 row_newbcast:3 row_mask:0xf bank_mask:0xf
  v_and_b32_dpp v55, v23, v9 row_newbcast:3 row_mask:0xf bank_mask:0xf
  s_nop 1
  v_mfma_f32_16x16x32_bf16 v[32:35], v[52:55], v[88:91], v[32:35]
  s_waitcnt vmcnt(6)
  buffer_load_dwordx4 v[88:91], v1, s[8:11], s33 offen offset:2816 nt
  v_and_b32_dpp v48, v23, v6 row_newbcast:4 row_mask:0xf bank_mask:0xf
  v_and_b32_dpp v49, v23, v7 row_newbcast:4 row_mask:0xf bank_mask:0xf
  v_and_b32_dpp v50, v23, v8 row_newbcast:4 row_mask:0xf bank_mask:0xf
  v_and_b32_dpp v51, v23, v9 row_newbcast:4 row_mask:0xf bank_mask:0xf
  s_nop 1
  v_mfma_f32_16x16x32_bf16 v[32:35], v[48:51], v[60:63], v[32:35]
  s_waitcnt vmcnt(6)
  buffer_load_dwordx4 v[60:63], v1, s[8:11], s33 offen offset:3072 nt
  v_and_b32_dpp v52, v23, v6 row_newbcast:5 row_mask:0xf bank_mask:0xf
  v_and_b32_dpp v53, v23, v7 row_newbcast:5 row_mask:0xf bank_mask:0xf
  v_and_b32_dpp v54, v23, v8 row_newbcast:5 row_mask:0xf bank_mask:0xf
  v_and_b32_dpp v55, v23, v9 row_newbcast:5 row_mask:0xf bank_mask:0xf
  s_nop 1
  v_mfma_f32_16x16x32_bf16 v[32:35], v[52:55], v[64:67], v[32:35]
  s_waitcnt vmcnt(6)
  buffer_load_dwordx4 v[64:67], v1, s[8:11], s33 offen offset:3328 nt
  v_and_b32_dpp v48, v23, v6 row_newbcast:6 row_mask:0xf bank_mask:0xf
  v_and_b32_dpp v49, v23, v7 row_newbcast:6 row_mask:0xf bank_mask:0xf
  v_and_b32_dpp v50, v23, v8 row_newbcast:6 row_mask:0xf bank_mask:0xf
  v_and_b32_dpp v51, v23, v9 row_newbcast:6 row_mask:0xf bank_mask:0xf
  s_nop 1
  v_mfma_f32_16x16x32_bf16 v[32:35], v[48:51], v[68:71], v[32:35]
  s_waitcnt vmcnt(6)
  buffer_load_dwordx4 v[68:71], v1, s[8:11], s33 offen offset:3584 nt
  v_and_b32_dpp v52, v23, v6 row_newbcast:7 row_mask:0xf bank_mask:0xf
  v_and_b32_dpp v53, v23, v7 row_newbcast:7 row_mask:0xf bank_mask:0xf
  v_and_b32_dpp v54, v23, v8 row_newbcast:7 row_mask:0xf bank_mask:0xf
  v_and_b32_dpp v55, v23, v9 row_newbcast:7 row_mask:0xf bank_mask:0xf
  s_nop 1
  v_mfma_f32_16x16x32_bf16 v[32:35], v[52:55], v[72:75], v[32:35]
  s_waitcnt vmcnt(6)
  buffer_load_dwordx4 v[72:75], v1, s[8:11], s33 offen offset:3840 nt
  v_and_b32_dpp v48, v23, v6 row_newbcast:8 row_mask:0xf bank_mask:0xf
  v_and_b32_dpp v49, v23, v7 row_newbcast:8 row_mask:0xf bank_mask:0xf
  v_and_b32_dpp v50, v23, v8 row_newbcast:8 row_mask:0xf bank_mask:0xf
  v_and_b32_dpp v51, v23, v9 row_newbcast:8 row_mask:0xf bank_mask:0xf
  s_nop 1
  v_mfma_f32_16x16x32_bf16 v[32:35], v[48:51], v[76:79], v[32:35]
  s_waitcnt vmcnt(6)
  s_lshl_b32 s46, s25, 8
  s_add_u32 s46, s46, 2424832
  s_add_u32 m0, s35, 256
  v_lshrrev_b32 v59, 2, v3
  buffer_load_dword v59, s[12:15], s46 offen sc1 lds
  v_and_b32_dpp v52, v23, v6 row_newbcast:9 row_mask:0xf bank_mask:0xf
  v_and_b32_dpp v53, v23, v7 row_newbcast:9 row_mask:0xf bank_mask:0xf
  v_and_b32_dpp v54, v23, v8 row_newbcast:9 row_mask:0xf bank_mask:0xf
  v_and_b32_dpp v55, v23, v9 row_newbcast:9 row_mask:0xf bank_mask:0xf
  s_nop 1
  v_mfma_f32_16x16x32_bf16 v[32:35], v[52:55], v[80:83], v[32:35]
  s_waitcnt vmcnt(6)
  s_add_u32 s33, s28, 532480
  buffer_load_dwordx4 v[76:79], v2, s[8:11], s33 offen offset:0 nt
  v_and_b32_dpp v48, v23, v6 row_newbcast:10 row_mask:0xf bank_mask:0xf
  v_and_b32_dpp v49, v23, v7 row_newbcast:10 row_mask:0xf bank_mask:0xf
  v_and_b32_dpp v50, v23, v8 row_newbcast:10 row_mask:0xf bank_mask:0xf
  v_and_b32_dpp v51, v23, v9 row_newbcast:10 row_mask:0xf bank_mask:0xf
  s_nop 1
  v_mfma_f32_16x16x32_bf16 v[32:35], v[48:51], v[84:87], v[32:35]
  s_waitcnt vmcnt(6)
  buffer_load_dwordx4 v[80:83], v2, s[8:11], s33 offen offset:256 nt
  v_and_b32_dpp v52, v23, v6 row_newbcast:11 row_mask:0xf bank_mask:0xf
  v_and_b32_dpp v53, v23, v7 row_newbcast:11 row_mask:0xf bank_mask:0xf
  v_and_b32_dpp v54, v23, v8 row_newbcast:11 row_mask:0xf bank_mask:0xf
  v_and_b32_dpp v55, v23, v9 row_newbcast:11 row_mask:0xf bank_mask:0xf
  s_nop 1
  v_mfma_f32_16x16x32_bf16 v[32:35], v[52:55], v[88:91], v[32:35]
  s_waitcnt vmcnt(6)
  buffer_load_dwordx4 v[84:87], v2, s[8:11], s33 offen offset:512 nt
  v_and_b32_dpp v48, v23, v6 row_newbcast:12 row_mask:0xf bank_mask:0xf
  v_and_b32_dpp v49, v23, v7 row_newbcast:12 row_mask:0xf bank_mask:0xf
  v_and_b32_dpp v50, v23, v8 row_newbcast:12 row_mask:0xf bank_mask:0xf
  v_and_b32_dpp v51, v23, v9 row_newbcast:12 row_mask:0xf bank_mask:0xf
  s_nop 1
  v_mfma_f32_16x16x32_bf16 v[32:35], v[48:51], v[60:63], v[32:35]
  s_waitcnt vmcnt(6)
  buffer_load_dwordx4 v[88:91], v2, s[8:11], s33 offen offset:768 nt
  v_and_b32_dpp v52, v23, v6 row_newbcast:13 row_mask:0xf bank_mask:0xf
  v_and_b32_dpp v53, v23, v7 row_newbcast:13 row_mask:0xf bank_mask:0xf
  v_and_b32_dpp v54, v23, v8 row_newbcast:13 row_mask:0xf bank_mask:0xf
  v_and_b32_dpp v55, v23, v9 row_newbcast:13 row_mask:0xf bank_mask:0xf
  s_nop 1
  v_mfma_f32_16x16x32_bf16 v[32:35], v[52:55], v[64:67], v[32:35]
  s_waitcnt vmcnt(6)
  buffer_load_dwordx4 v[60:63], v2, s[8:11], s33 offen offset:1024 nt
  v_and_b32_dpp v48, v23, v6 row_newbcast:14 row_mask:0xf bank_mask:0xf
  v_and_b32_dpp v49, v23, v7 row_newbcast:14 row_mask:0xf bank_mask:0xf
  v_and_b32_dpp v50, v23, v8 row_newbcast:14 row_mask:0xf bank_mask:0xf
  v_and_b32_dpp v51, v23, v9 row_newbcast:14 row_mask:0xf bank_mask:0xf
  s_nop 1
  v_mfma_f32_16x16x32_bf16 v[32:35], v[48:51], v[68:71], v[32:35]
  s_waitcnt vmcnt(6)
  buffer_load_dwordx4 v[64:67], v2, s[8:11], s33 offen offset:1280 nt
  v_and_b32_dpp v52, v23, v6 row_newbcast:15 row_mask:0xf bank_mask:0xf
  v_and_b32_dpp v53, v23, v7 row_newbcast:15 row_mask:0xf bank_mask:0xf
  v_and_b32_dpp v54, v23, v8 row_newbcast:15 row_mask:0xf bank_mask:0xf
  v_and_b32_dpp v55, v23, v9 row_newbcast:15 row_mask:0xf bank_mask:0xf
  s_nop 1
  v_mfma_f32_16x16x32_bf16 v[32:35], v[52:55], v[72:75], v[32:35]
  s_waitcnt vmcnt(6)
  buffer_load_dwordx4 v[68:71], v2, s[8:11], s33 offen offset:1536 nt
  s_waitcnt vmcnt(6)
  buffer_load_dwordx4 v[72:75], v2, s[8:11], s33 offen offset:1792 nt
  v_and_b32_dpp v48, v24, v6 row_newbcast:0 row_mask:0xf bank_mask:0xf
  v_and_b32_dpp v49, v24, v7 row_newbcast:0 row_mask:0xf bank_mask:0xf
  v_and_b32_dpp v50, v24, v8 row_newbcast:0 row_mask:0xf bank_mask:0xf
  v_and_b32_dpp v51, v24, v9 row_newbcast:0 row_mask:0xf bank_mask:0xf
  s_nop 1
  v_mfma_f32_16x16x32_bf16 v[32:35], v[48:51], v[76:79], v[32:35]
  s_waitcnt vmcnt(6)
  s_mov_b32 s33, s30
  s_mov_b64 exec, s[42:43]
  buffer_load_dwordx4 v[76:79], v3, s[8:11], s33 offen offset:0 nt
  s_mov_b64 exec, -1
  v_and_b32_dpp v52, v24, v6 row_newbcast:1 row_mask:0xf bank_mask:0xf
  v_and_b32_dpp v53, v24, v7 row_newbcast:1 row_mask:0xf bank_mask:0xf
  v_and_b32_dpp v54, v24, v8 row_newbcast:1 row_mask:0xf bank_mask:0xf
  v_and_b32_dpp v55, v24, v9 row_newbcast:1 row_mask:0xf bank_mask:0xf
  s_nop 1
  v_mfma_f32_16x16x32_bf16 v[32:35], v[52:55], v[80:83], v[32:35]
  s_waitcnt vmcnt(6)
  s_mov_b64 exec, s[42:43]
  buffer_load_dwordx4 v[80:83], v3, s[8:11], s33 offen offset:1024 nt
  s_mov_b64 exec, -1
  v_and_b32_dpp v48, v24, v6 row_newbcast:2 row_mask:0xf bank_mask:0xf
  v_and_b32_dpp v49, v24, v7 row_newbcast:2 row_mask:0xf bank_mask:0xf
  v_and_b32_dpp v50, v24, v8 row_newbcast:2 row_mask:0xf bank_mask:0xf
  v_and_b32_dpp v51, v24, v9 row_newbcast:2 row_mask:0xf bank_mask:0xf
  s_nop 1
  v_mfma_f32_16x16x32_bf16 v[32:35], v[48:51], v[84:87], v[32:35]
  s_waitcnt vmcnt(6)
  s_mov_b64 exec, s[44:45]
  buffer_load_dwordx4 v[84:87], v3, s[8:11], s33 offen offset:2048 nt
  s_mov_b64 exec, -1
  v_and_b32_dpp v52, v24, v6 row_newbcast:3 row_mask:0xf bank_mask:0xf
  v_and_b32_dpp v53, v24, v7 row_newbcast:3 row_mask:0xf bank_mask:0xf
  v_and_b32_dpp v54, v24, v8 row_newbcast:3 row_mask:0xf bank_mask:0xf
  v_and_b32_dpp v55, v24, v9 row_newbcast:3 row_mask:0xf bank_mask:0xf
  s_nop 1
  v_mfma_f32_16x16x32_bf16 v[32:35], v[52:55], v[88:91], v[32:35]
  s_waitcnt vmcnt(6)
  s_mov_b64 exec, s[44:45]
  buffer_load_dwordx4 v[88:91], v3, s[8:11], s33 offen offset:3072 nt
  s_mov_b64 exec, -1
  v_and_b32_dpp v48, v24, v6 row_newbcast:4 row_mask:0xf bank_mask:0xf
  v_and_b32_dpp v49, v24, v7 row_newbcast:4 row_mask:0xf bank_mask:0xf
  v_and_b32_dpp v50, v24, v8 row_newbcast:4 row_mask:0xf bank_mask:0xf
  v_and_b32_dpp v51, v24, v9 row_newbcast:4 row_mask:0xf bank_mask:0xf
  s_nop 1
  v_mfma_f32_16x16x32_bf16 v[32:35], v[48:51], v[60:63], v[32:35]
  s_waitcnt vmcnt(6)
  s_add_u32 s32, s29, 262144
  buffer_load_dwordx4 v[60:63], v0, s[4:7], s32 offen offset:0 nt
  v_and_b32_dpp v52, v24, v6 row_newbcast:5 row_mask:0xf bank_mask:0xf
  v_and_b32_dpp v53, v24, v7 row_newbcast:5 row_mask:0xf bank_mask:0xf
  v_and_b32_dpp v54, v24, v8 row_newbcast:5 row_mask:0xf bank_mask:0xf
  v_and_b32_dpp v55, v24, v9 row_newbcast:5 row_mask:0xf bank_mask:0xf
  s_nop 1
  v_mfma_f32_16x16x32_bf16 v[32:35], v[52:55], v[64:67], v[32:35]
  s_waitcnt vmcnt(6)
  buffer_load_dwordx4 v[64:67], v0, s[4:7], s32 offen offset:128 nt
  v_and_b32_dpp v48, v24, v6 row_newbcast:6 row_mask:0xf bank_mask:0xf
  v_and_b32_dpp v49, v24, v7 row_newbcast:6 row_mask:0xf bank_mask:0xf
  v_and_b32_dpp v50, v24, v8 row_newbcast:6 row_mask:0xf bank_mask:0xf
  v_and_b32_dpp v51, v24, v9 row_newbcast:6 row_mask:0xf bank_mask:0xf
  s_nop 1
  v_mfma_f32_16x16x32_bf16 v[32:35], v[48:51], v[68:71], v[32:35]
  s_waitcnt vmcnt(6)
  buffer_load_dwordx4 v[68:71], v0, s[4:7], s32 offen offset:2048 nt
  v_and_b32_dpp v52, v24, v6 row_newbcast:7 row_mask:0xf bank_mask:0xf
  v_and_b32_dpp v53, v24, v7 row_newbcast:7 row_mask:0xf bank_mask:0xf
  v_and_b32_dpp v54, v24, v8 row_newbcast:7 row_mask:0xf bank_mask:0xf
  v_and_b32_dpp v55, v24, v9 row_newbcast:7 row_mask:0xf bank_mask:0xf
  s_nop 1
  v_mfma_f32_16x16x32_bf16 v[32:35], v[52:55], v[72:75], v[32:35]
  s_waitcnt vmcnt(6)
  buffer_load_dwordx4 v[72:75], v0, s[4:7], s32 offen offset:2176 nt
  v_and_b32_dpp v48, v25, v6 row_newbcast:0 row_mask:0xf bank_mask:0xf
  v_and_b32_dpp v49, v25, v7 row_newbcast:0 row_mask:0xf bank_mask:0xf
  v_and_b32_dpp v50, v25, v8 row_newbcast:0 row_mask:0xf bank_mask:0xf
  v_and_b32_dpp v51, v25, v9 row_newbcast:0 row_mask:0xf bank_mask:0xf
  s_nop 1
  v_mfma_f32_16x16x32_bf16 v[32:35], v[48:51], v[76:79], v[32:35]
  s_waitcnt vmcnt(6)
  s_add_u32 s32, s29, 266240
  buffer_load_dwordx4 v[76:79], v0, s[4:7], s32 offen offset:0 nt
  v_and_b32_dpp v52, v25, v6 row_newbcast:1 row_mask:0xf bank_mask:0xf
  v_and_b32_dpp v53, v25, v7 row_newbcast:1 row_mask:0xf bank_mask:0xf
  v_and_b32_dpp v54, v25, v8 row_newbcast:1 row_mask:0xf bank_mask:0xf
  v_and_b32_dpp v55, v25, v9 row_newbcast:1 row_mask:0xf bank_mask:0xf
  s_nop 1
  v_mfma_f32_16x16x32_bf16 v[32:35], v[52:55], v[80:83], v[32:35]
  s_waitcnt vmcnt(6)
  buffer_load_dwordx4 v[80:83], v0, s[4:7], s32 offen offset:128 nt
  v_and_b32_dpp v48, v25, v6 row_newbcast:2 row_mask:0xf bank_mask:0xf
  v_and_b32_dpp v49, v25, v7 row_newbcast:2 row_mask:0xf bank_mask:0xf
  v_and_b32_dpp v50, v25, v8 row_newbcast:2 row_mask:0xf bank_mask:0xf
  v_and_b32_dpp v51, v25, v9 row_newbcast:2 row_mask:0xf bank_mask:0xf
  s_nop 1
  v_mfma_f32_16x16x32_bf16 v[32:35], v[48:51], v[84:87], v[32:35]
  s_waitcnt vmcnt(6)
  buffer_load_dwordx4 v[84:87], v0, s[4:7], s32 offen offset:2048 nt
  v_and_b32_dpp v52, v25, v6 row_newbcast:3 row_mask:0xf bank_mask:0xf
  v_and_b32_dpp v53, v25, v7 row_newbcast:3 row_mask:0xf bank_mask:0xf
  v_and_b32_dpp v54, v25, v8 row_newbcast:3 row_mask:0xf bank_mask:0xf
  v_and_b32_dpp v55, v25, v9 row_newbcast:3 row_mask:0xf bank_mask:0xf
  s_nop 1
  v_mfma_f32_16x16x32_bf16 v[32:35], v[52:55], v[88:91], v[32:35]
  v_add_f32_dpp v10, v10, v10 row_ror:8 row_mask:0xf bank_mask:0xf
  s_nop 1
  v_add_f32_dpp v10, v10, v10 row_ror:4 row_mask:0xf bank_mask:0xf
  s_nop 1
  v_add_f32_dpp v10, v10, v10 row_ror:2 row_mask:0xf bank_mask:0xf
  s_nop 1
  v_add_f32_dpp v10, v10, v10 row_ror:1 row_mask:0xf bank_mask:0xf
  s_nop 1
  v_add_f32_dpp v10, v10, v10 row_bcast:15 row_mask:0xa bank_mask:0xf
  s_nop 1
  v_add_f32_dpp v10, v10, v10 row_bcast:31 row_mask:0xc bank_mask:0xf
  v_lshrrev_b32 v45, 4, v3
  v_and_b32 v40, 15, v45
  v_lshlrev_b32 v40, 5, v40
  v_lshrrev_b32 v41, 4, v45
  v_lshl_add_u32 v40, v41, 4, v40
  s_mul_i32 s46, s25, 28
  s_add_u32 s46, s46, s40
  s_lshl_b32 s46, s46, 9
  s_add_u32 s46, s46, 917504
  s_mov_b32 exec_hi, 0
  buffer_store_dwordx4 v[32:35], v40, s[12:15], s46 offen sc1
  s_lshl_b32 s46, s25, 8
  s_lshl_b32 s47, s40, 3
  s_add_u32 s46, s46, s47
  s_add_u32 s46, s46, 1851392
  s_mov_b64 exec, -1
  v_mov_b32 v42, s36
  v_mov_b32 v43, v10
  v_mov_b32 v44, 0
  s_mov_b32 exec_lo, 0
  s_mov_b32 exec_hi, 0x80000000
  buffer_store_dwordx2 v[42:43], v44, s[12:15], s46 offen sc1
  s_mov_b64 exec, -1
  v_lshrrev_b32 v41, 4, v3
  v_and_b32 v40, 1, v41
  v_lshlrev_b32 v40, 6, v40
  v_lshrrev_b32 v41, 4, v41
  v_lshl_add_u32 v40, v41, 4, v40
  v_add_u32 v40, s35, v40
  ds_read_b128 v[12:15], v40 offset:256
  ds_read_b128 v[16:19], v40 offset:384
  s_waitcnt lgkmcnt(0)
  v_max3_u32 v42, v12, v13, v14
  v_max3_u32 v42, v42, v15, v16
  v_max3_u32 v42, v42, v17, v18
  v_max_u32 v42, v42, v19
  v_cmp_eq_u32 vcc, -1, v42
  s_nop 0
  s_cmp_lg_u64 vcc, 0
  s_nop 2
  s_cbranch_scc0 qok_10
qretry_11:
  s_sleep 2
  s_lshl_b32 s46, s25, 8
  s_add_u32 s46, s46, 2424832
  s_add_u32 m0, s35, 256
  v_lshrrev_b32 v59, 2, v3
  buffer_load_dword v59, s[12:15], s46 offen sc1 lds
  s_waitcnt vmcnt(0)
  v_lshrrev_b32 v41, 4, v3
  v_and_b32 v40, 1, v41
  v_lshlrev_b32 v40, 6, v40
  v_lshrrev_b32 v41, 4, v41
  v_lshl_add_u32 v40, v41, 4, v40
  v_add_u32 v40, s35, v40
  ds_read_b128 v[12:15], v40 offset:256
  ds_read_b128 v[16:19], v40 offset:384
  s_waitcnt lgkmcnt(0)
  v_max3_u32 v42, v12, v13, v14
  v_max3_u32 v42, v42, v15, v16
  v_max3_u32 v42, v42, v17, v18
  v_max_u32 v42, v42, v19
  v_cmp_eq_u32 vcc, -1, v42
  s_nop 0
  s_cmp_lg_u64 vcc, 0
  s_cbranch_scc0 qok_10
  s_sub_u32 s39, s39, 1
  s_cmp_gt_i32 s39, 0
  s_cbranch_scc1 qretry_11
qok_10:
  v_mfma_f32_16x16x32_bf16 v[40:43], v[12:15], a[0:3], 0
  v_mfma_f32_16x16x32_bf16 v[40:43], v[16:19], a[4:7], v[40:43]
  s_waitcnt vmcnt(8)
  buffer_load_dwordx4 v[88:91], v0, s[4:7], s32 offen offset:2176 nt
  v_mfma_f32_16x16x32_bf16 v[44:47], v[12:15], a[8:11], 0
  v_mfma_f32_16x16x32_bf16 v[44:47], v[16:19], a[12:15], v[44:47]
  s_nop 3
  v_add_f32_dpp v26, v41, v40 row_ror:8 row_mask:0x1 bank_mask:0x3
  v_mfma_f32_16x16x32_bf16 v[40:43], v[12:15], a[16:19], 0
  v_mfma_f32_16x16x32_bf16 v[40:43], v[16:19], a[20:23], v[40:43]
  s_waitcnt vmcnt(8)
  v_add_f32_dpp v26, v44, v45 row_ror:8 row_mask:0x1 bank_mask:0xc
  v_mfma_f32_16x16x32_bf16 v[44:47], v[12:15], v[60:63], 0
  v_mfma_f32_16x16x32_bf16 v[44:47], v[16:19], v[64:67], v[44:47]
  s_add_u32 s32, s29, 270336
  buffer_load_dwordx4 v[60:63], v0, s[4:7], s32 offen offset:0 nt
  s_nop 1
  v_add_f32_dpp v26, v41, v40 row_ror:8 row_mask:0x2 bank_mask:0x3
  v_mfma_f32_16x16x32_bf16 v[40:43], v[12:15], a[24:27], 0
  v_mfma_f32_16x16x32_bf16 v[40:43], v[16:19], a[28:31], v[40:43]
  s_nop 0
  v_add_f32_dpp v20, v45, v44 row_ror:8 row_mask:0x1 bank_mask:0x3
  v_mfma_f32_16x16x32_bf16 v[44:47], v[12:15], a[32:35], 0
  v_mfma_f32_16x16x32_bf16 v[44:47], v[16:19], a[36:39], v[44:47]
  s_nop 3
  v_add_f32_dpp v26, v40, v41 row_ror:8 row_mask:0x2 bank_mask:0xc
  v_mfma_f32_16x16x32_bf16 v[40:43], v[12:15], a[40:43], 0
  v_mfma_f32_16x16x32_bf16 v[40:43], v[16:19], a[44:47], v[40:43]
  s_waitcnt vmcnt(8)
  buffer_load_dwordx4 v[64:67], v0, s[4:7], s32 offen offset:128 nt
  s_waitcnt vmcnt(8)
  v_add_f32_dpp v26, v45, v44 row_ror:8 row_mask:0x4 bank_mask:0x3
  v_mfma_f32_16x16x32_bf16 v[44:47], v[12:15], v[68:71], 0
  v_mfma_f32_16x16x32_bf16 v[44:47], v[16:19], v[72:75], v[44:47]
  buffer_load_dwordx4 v[68:71], v0, s[4:7], s32 offen offset:2048 nt
  s_nop 0
  v_add_f32_dpp v26, v40, v41 row_ror:8 row_mask:0x4 bank_mask:0xc
  v_mfma_f32_16x16x32_bf16 v[40:43], v[12:15], a[48:51], 0
  v_mfma_f32_16x16x32_bf16 v[40:43], v[16:19], a[52:55], v[40:43]
  s_nop 2
  v_add_f32_dpp v20, v44, v45 row_ror:8 row_mask:0x1 bank_mask:0xc
  v_mfma_f32_16x16x32_bf16 v[44:47], v[12:15], a[56:59], 0
  v_mfma_f32_16x16x32_bf16 v[44:47], v[16:19], a[60:63], v[44:47]
  s_nop 1
  v_add_f32_dpp v26, v41, v40 row_ror:8 row_mask:0x8 bank_mask:0x3
  v_mfma_f32_16x16x32_bf16 v[40:43], v[12:15], a[64:67], 0
  v_mfma_f32_16x16x32_bf16 v[40:43], v[16:19], a[68:71], v[40:43]
  s_waitcnt vmcnt(8)
  buffer_load_dwordx4 v[72:75], v0, s[4:7], s32 offen offset:2176 nt
  s_waitcnt vmcnt(8)
  v_add_f32_dpp v26, v44, v45 row_ror:8 row_mask:0x8 bank_mask:0xc
  v_mfma_f32_16x16x32_bf16 v[44:47], v[12:15], v[76:79], 0
  v_mfma_f32_16x16x32_bf16 v[44:47], v[16:19], v[80:83], v[44:47]
  s_add_u32 s32, s29, 274432
  buffer_load_dwordx4 v[76:79], v0, s[4:7], s32 offen offset:0 nt
  v_add_f32_dpp v27, v41, v40 row_ror:8 row_mask:0x1 bank_mask:0x3
  v_mfma_f32_16x16x32_bf16 v[40:43], v[12:15], a[72:75], 0
  v_mfma_f32_16x16x32_bf16 v[40:43], v[16:19], a[76:79], v[40:43]
  s_nop 2
  v_add_f32_dpp v20, v45, v44 row_ror:8 row_mask:0x2 bank_mask:0x3
  v_mfma_f32_16x16x32_bf16 v[44:47], v[12:15], a[80:83], 0
  v_mfma_f32_16x16x32_bf16 v[44:47], v[16:19], a[84:87], v[44:47]
  s_nop 1
  v_add_f32_dpp v27, v40, v41 row_ror:8 row_mask:0x1 bank_mask:0xc
  v_mfma_f32_16x16x32_bf16 v[40:43], v[12:15], a[88:91], 0
  v_mfma_f32_16x16x32_bf16 v[40:43], v[16:19], a[92:95], v[40:43]
  s_waitcnt vmcnt(8)
  buffer_load_dwordx4 v[80:83], v0, s[4:7], s32 offen offset:128 nt
  s_waitcnt vmcnt(6)
  v_add_f32_dpp v27, v45, v44 row_ror:8 row_mask:0x2 bank_mask:0x3
  v_mfma_f32_16x16x32_bf16 v[44:47], v[12:15], v[84:87], 0
  v_mfma_f32_16x16x32_bf16 v[44:47], v[16:19], v[88:91], v[44:47]
  buffer_load_dwordx4 v[84:87], v0, s[4:7], s32 offen offset:2048 nt
  s_nop 0
  v_add_f32_dpp v27, v40, v41 row_ror:8 row_mask:0x2 bank_mask:0xc
  v_mfma_f32_16x16x32_bf16 v[40:43], v[12:15], a[96:99], 0
  v_mfma_f32_16x16x32_bf16 v[40:43], v[16:19], a[100:103], v[40:43]
  s_nop 2
  v_add_f32_dpp v20, v44, v45 row_ror:8 row_mask:0x2 bank_mask:0xc
  v_mfma_f32_16x16x32_bf16 v[44:47], v[12:15], a[104:107], 0
  v_mfma_f32_16x16x32_bf16 v[44:47], v[16:19], a[108:111], v[44:47]
  s_nop 1
  v_add_f32_dpp v27, v41, v40 row_ror:8 row_mask:0x4 bank_mask:0x3
  v_mfma_f32_16x16x32_bf16 v[40:43], v[12:15], a[112:115], 0
  v_mfma_f32_16x16x32_bf16 v[40:43], v[16:19], a[116:119], v[40:43]
  s_waitcnt vmcnt(6)
  buffer_load_dwordx4 v[88:91], v0, s[4:7], s32 offen offset:2176 nt
  s_waitcnt vmcnt(6)
  v_add_f32_dpp v27, v44, v45 row_ror:8 row_mask:0x4 bank_mask:0xc
  v_mfma_f32_16x16x32_bf16 v[44:47], v[12:15], v[60:63], 0
  v_mfma_f32_16x16x32_bf16 v[44:47], v[16:19], v[64:67], v[44:47]
  s_add_u32 s32, s29, 327680
  buffer_load_dwordx4 v[60:63], v0, s[4:7], s32 offen offset:0 nt
  v_add_f32_dpp v27, v41, v40 row_ror:8 row_mask:0x8 bank_mask:0x3
  v_mfma_f32_16x16x32_bf16 v[40:43], v[12:15], a[120:123], 0
  v_mfma_f32_16x16x32_bf16 v[40:43], v[16:19], a[124:127], v[40:43]
  s_nop 2
  v_add_f32_dpp v20, v45, v44 row_ror:8 row_mask:0x4 bank_mask:0x3
  v_mfma_f32_16x16x32_bf16 v[44:47], v[12:15], a[128:131], 0
  v_mfma_f32_16x16x32_bf16 v[44:47], v[16:19], a[132:135], v[44:47]
  s_nop 1
  v_add_f32_dpp v27, v40, v41 row_ror:8 row_mask:0x8 bank_mask:0xc
  v_mfma_f32_16x16x32_bf16 v[40:43], v[12:15], a[136:139], 0
  v_mfma_f32_16x16x32_bf16 v[40:43], v[16:19], a[140:143], v[40:43]
  s_waitcnt vmcnt(6)
  buffer_load_dwordx4 v[64:67], v0, s[4:7], s32 offen offset:128 nt
  s_waitcnt vmcnt(6)
  v_add_f32_dpp v28, v45, v44 row_ror:8 row_mask:0x1 bank_mask:0x3
  v_mfma_f32_16x16x32_bf16 v[44:47], v[12:15], v[68:71], 0
  v_mfma_f32_16x16x32_bf16 v[44:47], v[16:19], v[72:75], v[44:47]
  buffer_load_dwordx4 v[68:71], v0, s[4:7], s32 offen offset:2048 nt
  s_nop 0
  v_add_f32_dpp v28, v40, v41 row_ror:8 row_mask:0x1 bank_mask:0xc
  v_mfma_f32_16x16x32_bf16 v[40:43], v[12:15], a[144:147], 0
  v_mfma_f32_16x16x32_bf16 v[40:43], v[16:19], a[148:151], v[40:43]
  s_nop 2
  v_add_f32_dpp v20, v44, v45 row_ror:8 row_mask:0x4 bank_mask:0xc
  v_mfma_f32_16x16x32_bf16 v[44:47], v[12:15], a[152:155], 0
  v_mfma_f32_16x16x32_bf16 v[44:47], v[16:19], a[156:159], v[44:47]
  s_nop 1
  v_add_f32_dpp v28, v41, v40 row_ror:8 row_mask:0x2 bank_mask:0x3
  v_mfma_f32_16x16x32_bf16 v[40:43], v[12:15], a[160:163], 0
  v_mfma_f32_16x16x32_bf16 v[40:43], v[16:19], a[164:167], v[40:43]
  s_waitcnt vmcnt(6)
  buffer_load_dwordx4 v[72:75], v0, s[4:7], s32 offen offset:2176 nt
  s_waitcnt vmcnt(6)
  v_add_f32_dpp v28, v44, v45 row_ror:8 row_mask:0x2 bank_mask:0xc
  v_mfma_f32_16x16x32_bf16 v[44:47], v[12:15], v[76:79], 0
  v_mfma_f32_16x16x32_bf16 v[44:47], v[16:19], v[80:83], v[44:47]
  s_add_u32 s32, s29, 331776
  buffer_load_dwordx4 v[76:79], v0, s[4:7], s32 offen offset:0 nt
  v_add_f32_dpp v28, v41, v40 row_ror:8 row_mask:0x4 bank_mask:0x3
  v_mfma_f32_16x16x32_bf16 v[40:43], v[12:15], a[168:171], 0
  v_mfma_f32_16x16x32_bf16 v[40:43], v[16:19], a[172:175], v[40:43]
  s_nop 2
  v_add_f32_dpp v20, v45, v44 row_ror:8 row_mask:0x8 bank_mask:0x3
  v_mfma_f32_16x16x32_bf16 v[44:47], v[12:15], a[176:179], 0
  v_mfma_f32_16x16x32_bf16 v[44:47], v[16:19], a[180:183], v[44:47]
  s_nop 1
  v_add_f32_dpp v28, v40, v41 row_ror:8 row_mask:0x4 bank_mask:0xc
  v_mfma_f32_16x16x32_bf16 v[40:43], v[12:15], a[184:187], 0
  v_mfma_f32_16x16x32_bf16 v[40:43], v[16:19], a[188:191], v[40:43]
  s_waitcnt vmcnt(6)
  buffer_load_dwordx4 v[80:83], v0, s[4:7], s32 offen offset:128 nt
  s_waitcnt vmcnt(6)
  v_add_f32_dpp v28, v45, v44 row_ror:8 row_mask:0x8 bank_mask:0x3
  v_mfma_f32_16x16x32_bf16 v[44:47], v[12:15], v[84:87], 0
  v_mfma_f32_16x16x32_bf16 v[44:47], v[16:19], v[88:91], v[44:47]
  buffer_load_dwordx4 v[84:87], v0, s[4:7], s32 offen offset:2048 nt
  s_nop 0
  v_add_f32_dpp v28, v40, v41 row_ror:8 row_mask:0x8 bank_mask:0xc
  v_mfma_f32_16x16x32_bf16 v[40:43], v[12:15], a[192:195], 0
  v_mfma_f32_16x16x32_bf16 v[40:43], v[16:19], a[196:199], v[40:43]
  s_nop 2
  v_add_f32_dpp v20, v44, v45 row_ror:8 row_mask:0x8 bank_mask:0xc
  v_mfma_f32_16x16x32_bf16 v[44:47], v[12:15], a[200:203], 0
  v_mfma_f32_16x16x32_bf16 v[44:47], v[16:19], a[204:207], v[44:47]
  s_nop 1
  v_add_f32_dpp v29, v41, v40 row_ror:8 row_mask:0x1 bank_mask:0x3
  v_mfma_f32_16x16x32_bf16 v[40:43], v[12:15], a[208:211], 0
  v_mfma_f32_16x16x32_bf16 v[40:43], v[16:19], a[212:215], v[40:43]
  s_waitcnt vmcnt(6)
  buffer_load_dwordx4 v[88:91], v0, s[4:7], s32 offen offset:2176 nt
  s_waitcnt vmcnt(6)
  v_add_f32_dpp v29, v44, v45 row_ror:8 row_mask:0x1 bank_mask:0xc
  v_mfma_f32_16x16x32_bf16 v[44:47], v[12:15], v[60:63], 0
  v_mfma_f32_16x16x32_bf16 v[44:47], v[16:19], v[64:67], v[44:47]
  s_add_u32 s32, s29, 335872
  buffer_load_dwordx4 v[60:63], v0, s[4:7], s32 offen offset:0 nt
  v_add_f32_dpp v29, v41, v40 row_ror:8 row_mask:0x2 bank_mask:0x3
  v_mfma_f32_16x16x32_bf16 v[40:43], v[12:15], a[216:219], 0
  v_mfma_f32_16x16x32_bf16 v[40:43], v[16:19], a[220:223], v[40:43]
  s_nop 2
  v_add_f32_dpp v21, v45, v44 row_ror:8 row_mask:0x1 bank_mask:0x3
  v_mfma_f32_16x16x32_bf16 v[44:47], v[12:15], a[224:227], 0
  v_mfma_f32_16x16x32_bf16 v[44:47], v[16:19], a[228:231], v[44:47]
  s_nop 1
  v_add_f32_dpp v29, v40, v41 row_ror:8 row_mask:0x2 bank_mask:0xc
  v_mfma_f32_16x16x32_bf16 v[40:43], v[12:15], a[232:235], 0
  v_mfma_f32_16x16x32_bf16 v[40:43], v[16:19], a[236:239], v[40:43]
  s_waitcnt vmcnt(6)
  buffer_load_dwordx4 v[64:67], v0, s[4:7], s32 offen offset:128 nt
  s_waitcnt vmcnt(6)
  v_add_f32_dpp v29, v45, v44 row_ror:8 row_mask:0x4 bank_mask:0x3
  v_mfma_f32_16x16x32_bf16 v[44:47], v[12:15], v[68:71], 0
  v_mfma_f32_16x16x32_bf16 v[44:47], v[16:19], v[72:75], v[44:47]
  buffer_load_dwordx4 v[68:71], v0, s[4:7], s32 offen offset:2048 nt
  s_nop 0
  v_add_f32_dpp v29, v40, v41 row_ror:8 row_mask:0x4 bank_mask:0xc
  v_mfma_f32_16x16x32_bf16 v[40:43], v[12:15], a[240:243], 0
  v_mfma_f32_16x16x32_bf16 v[40:43], v[16:19], a[244:247], v[40:43]
  s_nop 2
  v_add_f32_dpp v21, v44, v45 row_ror:8 row_mask:0x1 bank_mask:0xc
  v_mfma_f32_16x16x32_bf16 v[44:47], v[12:15], a[248:251], 0
  v_mfma_f32_16x16x32_bf16 v[44:47], v[16:19], a[252:255], v[44:47]
  v_mov_b32 v30, 0xff800000
  s_nop 0
  v_add_f32_dpp v29, v41, v40 row_ror:8 row_mask:0x8 bank_mask:0x3
  v_mfma_f32_16x16x32_bf16 v[40:43], v[12:15], v[92:95], 0
  v_mfma_f32_16x16x32_bf16 v[40:43], v[16:19], v[96:99], v[40:43]
  s_waitcnt vmcnt(6)
  buffer_load_dwordx4 v[72:75], v0, s[4:7], s32 offen offset:2176 nt
  s_waitcnt vmcnt(6)
  v_add_f32_dpp v29, v44, v45 row_ror:8 row_mask:0x8 bank_mask:0xc
  v_mfma_f32_16x16x32_bf16 v[44:47], v[12:15], v[76:79], 0
  v_mfma_f32_16x16x32_bf16 v[44:47], v[16:19], v[80:83], v[44:47]
  s_add_u32 s32, s29, 339968
  buffer_load_dwordx4 v[76:79], v0, s[4:7], s32 offen offset:0 nt
  v_add_f32_dpp v30, v41, v40 row_ror:8 row_mask:0x1 bank_mask:0x3
  v_mfma_f32_16x16x32_bf16 v[40:43], v[12:15], v[100:103], 0
  v_mfma_f32_16x16x32_bf16 v[40:43], v[16:19], v[104:107], v[40:43]
  s_nop 2
  v_add_f32_dpp v21, v45, v44 row_ror:8 row_mask:0x2 bank_mask:0x3
  v_mfma_f32_16x16x32_bf16 v[44:47], v[12:15], v[108:111], 0
  v_mfma_f32_16x16x32_bf16 v[44:47], v[16:19], v[112:115], v[44:47]
  s_nop 1
  v_add_f32_dpp v30, v41, v40 row_ror:8 row_mask:0x2 bank_mask:0x3
  v_mfma_f32_16x16x32_bf16 v[40:43], v[12:15], v[116:119], 0
  v_mfma_f32_16x16x32_bf16 v[40:43], v[16:19], v[120:123], v[40:43]
  s_waitcnt vmcnt(6)
  buffer_load_dwordx4 v[80:83], v0, s[4:7], s32 offen offset:128 nt
  s_waitcnt vmcnt(6)
  v_add_f32_dpp v30, v45, v44 row_ror:8 row_mask:0x4 bank_mask:0x3
  v_mfma_f32_16x16x32_bf16 v[44:47], v[12:15], v[84:87], 0
  v_mfma_f32_16x16x32_bf16 v[44:47], v[16:19], v[88:91], v[44:47]
  buffer_load_dwordx4 v[84:87], v0, s[4:7], s32 offen offset:2048 nt
  s_nop 0
  v_add_f32_dpp v30, v41, v40 row_ror:8 row_mask:0x8 bank_mask:0x3
  s_nop 4
  v_add_f32_dpp v21, v44, v45 row_ror:8 row_mask:0x2 bank_mask:0xc
  v_mul_f32 v26, 0x3e0293ee, v26
  v_mul_f32 v27, 0x3e0293ee, v27
  v_mul_f32 v28, 0x3e0293ee, v28
  v_mul_f32 v29, 0x3e0293ee, v29
  v_mul_f32 v30, 0x3e0293ee, v30
  v_max3_f32 v40, v26, v27, v28
  v_max3_f32 v40, v40, v29, v30
  s_nop 1
  v_max_f32_dpp v40, v40, v40 row_ror:8 row_mask:0xf bank_mask:0xf
  s_nop 1
  v_max_f32_dpp v40, v40, v40 row_ror:4 row_mask:0xf bank_mask:0xf
  s_nop 1
  v_max_f32_dpp v40, v40, v40 row_ror:2 row_mask:0xf bank_mask:0xf
  s_nop 1
  v_max_f32_dpp v40, v40, v40 row_ror:1 row_mask:0xf bank_mask:0xf
  s_nop 1
  v_max_f32_dpp v40, v40, v40 row_bcast:15 row_mask:0xa bank_mask:0xf
  s_nop 1
  v_max_f32_dpp v40, v40, v40 row_bcast:31 row_mask:0xc bank_mask:0xf
  s_nop 0
  v_readlane_b32 s46, v40, 63
  v_mov_b32 v36, 0
  v_mov_b32 v37, 0
  v_mov_b32 v38, 0
  v_mov_b32 v39, 0
  s_mov_b32 s37, s46
  v_subrev_f32 v26, s37, v26
  v_subrev_f32 v27, s37, v27
  v_subrev_f32 v28, s37, v28
  v_subrev_f32 v29, s37, v29
  v_subrev_f32 v30, s37, v30
  v_exp_f32 v26, v26
  v_exp_f32 v27, v27
  v_exp_f32 v28, v28
  v_exp_f32 v29, v29
  v_exp_f32 v30, v30
  v_add_f32 v42, v26, v27
  v_add_f32 v43, v28, v29
  v_add_f32 v42, v42, v30
  v_add_f32 v11, v42, v43
  v_cvt_pk_bf16_f32 v26, v26, v26
  v_cvt_pk_bf16_f32 v27, v27, v27
  v_cvt_pk_bf16_f32 v28, v28, v28
  v_cvt_pk_bf16_f32 v29, v29, v29
  v_cvt_pk_bf16_f32 v30, v30, v30
  v_and_b32_dpp v48, v26, v6 row_newbcast:0 row_mask:0xf bank_mask:0xf
  v_and_b32_dpp v49, v26, v7 row_newbcast:0 row_mask:0xf bank_mask:0xf
  v_and_b32_dpp v50, v26, v8 row_newbcast:0 row_mask:0xf bank_mask:0xf
  v_and_b32_dpp v51, v26, v9 row_newbcast:0 row_mask:0xf bank_mask:0xf
  s_nop 1
  v_mfma_f32_16x16x32_bf16 v[36:39], v[48:51], v[124:127], v[36:39]
  v_and_b32_dpp v52, v26, v6 row_newbcast:1 row_mask:0xf bank_mask:0xf
  v_and_b32_dpp v53, v26, v7 row_newbcast:1 row_mask:0xf bank_mask:0xf
  v_and_b32_dpp v54, v26, v8 row_newbcast:1 row_mask:0xf bank_mask:0xf
  v_and_b32_dpp v55, v26, v9 row_newbcast:1 row_mask:0xf bank_mask:0xf
  s_nop 1
  v_mfma_f32_16x16x32_bf16 v[36:39], v[52:55], v[128:131], v[36:39]
  s_waitcnt vmcnt(6)
  buffer_load_dwordx4 v[88:91], v0, s[4:7], s32 offen offset:2176 nt
  s_waitcnt vmcnt(6)
  v_mfma_f32_16x16x32_bf16 v[40:43], v[12:15], v[60:63], 0
  v_mfma_f32_16x16x32_bf16 v[40:43], v[16:19], v[64:67], v[40:43]
  s_add_u32 s32, s29, 393216
  buffer_load_dwordx4 v[60:63], v0, s[4:7], s32 offen offset:0 nt
  v_and_b32_dpp v48, v26, v6 row_newbcast:2 row_mask:0xf bank_mask:0xf
  v_and_b32_dpp v49, v26, v7 row_newbcast:2 row_mask:0xf bank_mask:0xf
  v_and_b32_dpp v50, v26, v8 row_newbcast:2 row_mask:0xf bank_mask:0xf
  v_and_b32_dpp v51, v26, v9 row_newbcast:2 row_mask:0xf bank_mask:0xf
  s_nop 1
  v_mfma_f32_16x16x32_bf16 v[36:39], v[48:51], v[132:135], v[36:39]
  v_and_b32_dpp v52, v26, v6 row_newbcast:3 row_mask:0xf bank_mask:0xf
  v_and_b32_dpp v53, v26, v7 row_newbcast:3 row_mask:0xf bank_mask:0xf
  v_and_b32_dpp v54, v26, v8 row_newbcast:3 row_mask:0xf bank_mask:0xf
  v_and_b32_dpp v55, v26, v9 row_newbcast:3 row_mask:0xf bank_mask:0xf
  s_nop 1
  v_mfma_f32_16x16x32_bf16 v[36:39], v[52:55], v[136:139], v[36:39]
  v_and_b32_dpp v48, v26, v6 row_newbcast:4 row_mask:0xf bank_mask:0xf
  v_and_b32_dpp v49, v26, v7 row_newbcast:4 row_mask:0xf bank_mask:0xf
  v_and_b32_dpp v50, v26, v8 row_newbcast:4 row_mask:0xf bank_mask:0xf
  v_and_b32_dpp v51, v26, v9 row_newbcast:4 row_mask:0xf bank_mask:0xf
  s_nop 1
  v_mfma_f32_16x16x32_bf16 v[36:39], v[48:51], v[140:143], v[36:39]
  s_waitcnt vmcnt(6)
  buffer_load_dwordx4 v[64:67], v0, s[4:7], s32 offen offset:128 nt
  s_waitcnt vmcnt(6)
  v_mfma_f32_16x16x32_bf16 v[44:47], v[12:15], v[68:71], 0
  v_mfma_f32_16x16x32_bf16 v[44:47], v[16:19], v[72:75], v[44:47]
  buffer_load_dwordx4 v[68:71], v0, s[4:7], s32 offen offset:2048 nt
  v_and_b32_dpp v52, v26, v6 row_newbcast:5 row_mask:0xf bank_mask:0xf
  v_and_b32_dpp v53, v26, v7 row_newbcast:5 row_mask:0xf bank_mask:0xf
  v_and_b32_dpp v54, v26, v8 row_newbcast:5 row_mask:0xf bank_mask:0xf
  v_and_b32_dpp v55, v26, v9 row_newbcast:5 row_mask:0xf bank_mask:0xf
  s_nop 1
  v_mfma_f32_16x16x32_bf16 v[36:39], v[52:55], v[144:147], v[36:39]
  v_and_b32_dpp v48, v26, v6 row_newbcast:6 row_mask:0xf bank_mask:0xf
  v_and_b32_dpp v49, v26, v7 row_newbcast:6 row_mask:0xf bank_mask:0xf
  v_and_b32_dpp v50, v26, v8 row_newbcast:6 row_mask:0xf bank_mask:0xf
  v_and_b32_dpp v51, v26, v9 row_newbcast:6 row_mask:0xf bank_mask:0xf
  s_nop 1
  v_mfma_f32_16x16x32_bf16 v[36:39], v[48:51], v[148:151], v[36:39]
  v_and_b32_dpp v52, v26, v6 row_newbcast:7 row_mask:0xf bank_mask:0xf
  v_and_b32_dpp v53, v26, v7 row_newbcast:7 row_mask:0xf bank_mask:0xf
  v_and_b32_dpp v54, v26, v8 row_newbcast:7 row_mask:0xf bank_mask:0xf
  v_and_b32_dpp v55, v26, v9 row_newbcast:7 row_mask:0xf bank_mask:0xf
  s_nop 1
  v_mfma_f32_16x16x32_bf16 v[36:39], v[52:55], v[152:155], v[36:39]
  s_waitcnt vmcnt(6)
  buffer_load_dwordx4 v[72:75], v0, s[4:7], s32 offen offset:2176 nt
  s_waitcnt vmcnt(6)
  v_add_f32_dpp v21, v41, v40 row_ror:8 row_mask:0x4 bank_mask:0x3
  v_mfma_f32_16x16x32_bf16 v[40:43], v[12:15], v[76:79], 0
  v_mfma_f32_16x16x32_bf16 v[40:43], v[16:19], v[80:83], v[40:43]
  s_add_u32 s32, s29, 397312
  buffer_load_dwordx4 v[76:79], v0, s[4:7], s32 offen offset:0 nt
  v_and_b32_dpp v48, v26, v6 row_newbcast:8 row_mask:0xf bank_mask:0xf
  v_and_b32_dpp v49, v26, v7 row_newbcast:8 row_mask:0xf bank_mask:0xf
  v_and_b32_dpp v50, v26, v8 row_newbcast:8 row_mask:0xf bank_mask:0xf
  v_and_b32_dpp v51, v26, v9 row_newbcast:8 row_mask:0xf bank_mask:0xf
  s_nop 1
  v_mfma_f32_16x16x32_bf16 v[36:39], v[48:51], v[156:159], v[36:39]
  v_and_b32_dpp v52, v26, v6 row_newbcast:9 row_mask:0xf bank_mask:0xf
  v_and_b32_dpp v53, v26, v7 row_newbcast:9 row_mask:0xf bank_mask:0xf
  v_and_b32_dpp v54, v26, v8 row_newbcast:9 row_mask:0xf bank_mask:0xf
  v_and_b32_dpp v55, v26, v9 row_newbcast:9 row_mask:0xf bank_mask:0xf
  s_nop 1
  v_mfma_f32_16x16x32_bf16 v[36:39], v[52:55], v[160:163], v[36:39]
  v_and_b32_dpp v48, v26, v6 row_newbcast:10 row_mask:0xf bank_mask:0xf
  v_and_b32_dpp v49, v26, v7 row_newbcast:10 row_mask:0xf bank_mask:0xf
  v_and_b32_dpp v50, v26, v8 row_newbcast:10 row_mask:0xf bank_mask:0xf
  v_and_b32_dpp v51, v26, v9 row_newbcast:10 row_mask:0xf bank_mask:0xf
  s_nop 1
  v_mfma_f32_16x16x32_bf16 v[36:39], v[48:51], v[164:167], v[36:39]
  s_waitcnt vmcnt(6)
  buffer_load_dwordx4 v[80:83], v0, s[4:7], s32 offen offset:128 nt
  s_waitcnt vmcnt(6)
  v_add_f32_dpp v21, v44, v45 row_ror:8 row_mask:0x4 bank_mask:0xc
  v_mfma_f32_16x16x32_bf16 v[44:47], v[12:15], v[84:87], 0
  v_mfma_f32_16x16x32_bf16 v[44:47], v[16:19], v[88:91], v[44:47]
  buffer_load_dwordx4 v[84:87], v0, s[4:7], s32 offen offset:2048 nt
  v_and_b32_dpp v52, v26, v6 row_newbcast:11 row_mask:0xf bank_mask:0xf
  v_and_b32_dpp v53, v26, v7 row_newbcast:11 row_mask:0xf bank_mask:0xf
  v_and_b32_dpp v54, v26, v8 row_newbcast:11 row_mask:0xf bank_mask:0xf
  v_and_b32_dpp v55, v26, v9 row_newbcast:11 row_mask:0xf bank_mask:0xf
  s_nop 1
  v_mfma_f32_16x16x32_bf16 v[36:39], v[52:55], v[168:171], v[36:39]
  v_and_b32_dpp v48, v26, v6 row_newbcast:12 row_mask:0xf bank_mask:0xf
  v_and_b32_dpp v49, v26, v7 row_newbcast:12 row_mask:0xf bank_mask:0xf
  v_and_b32_dpp v50, v26, v8 row_newbcast:12 row_mask:0xf bank_mask:0xf
  v_and_b32_dpp v51, v26, v9 row_newbcast:12 row_mask:0xf bank_mask:0xf
  s_nop 1
  v_mfma_f32_16x16x32_bf16 v[36:39], v[48:51], v[172:175], v[36:39]
  v_and_b32_dpp v52, v26, v6 row_newbcast:13 row_mask:0xf bank_mask:0xf
  v_and_b32_dpp v53, v26, v7 row_newbcast:13 row_mask:0xf bank_mask:0xf
  v_and_b32_dpp v54, v26, v8 row_newbcast:13 row_mask:0xf bank_mask:0xf
  v_and_b32_dpp v55, v26, v9 row_newbcast:13 row_mask:0xf bank_mask:0xf
  s_nop 1
  v_mfma_f32_16x16x32_bf16 v[36:39], v[52:55], v[176:179], v[36:39]
  s_waitcnt vmcnt(6)
  buffer_load_dwordx4 v[88:91], v0, s[4:7], s32 offen offset:2176 nt
  s_waitcnt vmcnt(6)
  v_add_f32_dpp v21, v41, v40 row_ror:8 row_mask:0x8 bank_mask:0x3
  v_mfma_f32_16x16x32_bf16 v[40:43], v[12:15], v[60:63], 0
  v_mfma_f32_16x16x32_bf16 v[40:43], v[16:19], v[64:67], v[40:43]
  s_add_u32 s32, s29, 401408
  buffer_load_dwordx4 v[60:63], v0, s[4:7], s32 offen offset:0 nt
  v_and_b32_dpp v48, v26, v6 row_newbcast:14 row_mask:0xf bank_mask:0xf
  v_and_b32_dpp v49, v26, v7 row_newbcast:14 row_mask:0xf bank_mask:0xf
  v_and_b32_dpp v50, v26, v8 row_newbcast:14 row_mask:0xf bank_mask:0xf
  v_and_b32_dpp v51, v26, v9 row_newbcast:14 row_mask:0xf bank_mask:0xf
  s_nop 1
  v_mfma_f32_16x16x32_bf16 v[36:39], v[48:51], v[180:183], v[36:39]
  v_and_b32_dpp v52, v26, v6 row_newbcast:15 row_mask:0xf bank_mask:0xf
  v_and_b32_dpp v53, v26, v7 row_newbcast:15 row_mask:0xf bank_mask:0xf
  v_and_b32_dpp v54, v26, v8 row_newbcast:15 row_mask:0xf bank_mask:0xf
  v_and_b32_dpp v55, v26, v9 row_newbcast:15 row_mask:0xf bank_mask:0xf
  s_nop 1
  v_mfma_f32_16x16x32_bf16 v[36:39], v[52:55], v[184:187], v[36:39]
  v_and_b32_dpp v48, v27, v6 row_newbcast:0 row_mask:0xf bank_mask:0xf
  v_and_b32_dpp v49, v27, v7 row_newbcast:0 row_mask:0xf bank_mask:0xf
  v_and_b32_dpp v50, v27, v8 row_newbcast:0 row_mask:0xf bank_mask:0xf
  v_and_b32_dpp v51, v27, v9 row_newbcast:0 row_mask:0xf bank_mask:0xf
  s_nop 1
  v_mfma_f32_16x16x32_bf16 v[36:39], v[48:51], v[188:191], v[36:39]
  s_waitcnt vmcnt(6)
  buffer_load_dwordx4 v[64:67], v0, s[4:7], s32 offen offset:128 nt
  s_waitcnt vmcnt(6)
  v_add_f32_dpp v21, v44, v45 row_ror:8 row_mask:0x8 bank_mask:0xc
  v_mfma_f32_16x16x32_bf16 v[44:47], v[12:15], v[68:71], 0
  v_mfma_f32_16x16x32_bf16 v[44:47], v[16:19], v[72:75], v[44:47]
  buffer_load_dwordx4 v[68:71], v0, s[4:7], s32 offen offset:2048 nt
  v_and_b32_dpp v52, v27, v6 row_newbcast:1 row_mask:0xf bank_mask:0xf
  v_and_b32_dpp v53, v27, v7 row_newbcast:1 row_mask:0xf bank_mask:0xf
  v_and_b32_dpp v54, v27, v8 row_newbcast:1 row_mask:0xf bank_mask:0xf
  v_and_b32_dpp v55, v27, v9 row_newbcast:1 row_mask:0xf bank_mask:0xf
  s_nop 1
  v_mfma_f32_16x16x32_bf16 v[36:39], v[52:55], v[192:195], v[36:39]
  v_and_b32_dpp v48, v27, v6 row_newbcast:2 row_mask:0xf bank_mask:0xf
  v_and_b32_dpp v49, v27, v7 row_newbcast:2 row_mask:0xf bank_mask:0xf
  v_and_b32_dpp v50, v27, v8 row_newbcast:2 row_mask:0xf bank_mask:0xf
  v_and_b32_dpp v51, v27, v9 row_newbcast:2 row_mask:0xf bank_mask:0xf
  s_nop 1
  v_mfma_f32_16x16x32_bf16 v[36:39], v[48:51], v[196:199], v[36:39]
  v_and_b32_dpp v52, v27, v6 row_newbcast:3 row_mask:0xf bank_mask:0xf
  v_and_b32_dpp v53, v27, v7 row_newbcast:3 row_mask:0xf bank_mask:0xf
  v_and_b32_dpp v54, v27, v8 row_newbcast:3 row_mask:0xf bank_mask:0xf
  v_and_b32_dpp v55, v27, v9 row_newbcast:3 row_mask:0xf bank_mask:0xf
  s_nop 1
  v_mfma_f32_16x16x32_bf16 v[36:39], v[52:55], v[200:203], v[36:39]
  s_waitcnt vmcnt(6)
  buffer_load_dwordx4 v[72:75], v0, s[4:7], s32 offen offset:2176 nt
  s_waitcnt vmcnt(6)
  v_add_f32_dpp v22, v41, v40 row_ror:8 row_mask:0x1 bank_mask:0x3
  v_mfma_f32_16x16x32_bf16 v[40:43], v[12:15], v[76:79], 0
  v_mfma_f32_16x16x32_bf16 v[40:43], v[16:19], v[80:83], v[40:43]
  s_add_u32 s32, s29, 405504
  buffer_load_dwordx4 v[76:79], v0, s[4:7], s32 offen offset:0 nt
  v_and_b32_dpp v48, v27, v6 row_newbcast:4 row_mask:0xf bank_mask:0xf
  v_and_b32_dpp v49, v27, v7 row_newbcast:4 row_mask:0xf bank_mask:0xf
  v_and_b32_dpp v50, v27, v8 row_newbcast:4 row_mask:0xf bank_mask:0xf
  v_and_b32_dpp v51, v27, v9 row_newbcast:4 row_mask:0xf bank_mask:0xf
  s_nop 1
  v_mfma_f32_16x16x32_bf16 v[36:39], v[48:51], v[204:207], v[36:39]
  v_and_b32_dpp v52, v27, v6 row_newbcast:5 row_mask:0xf bank_mask:0xf
  v_and_b32_dpp v53, v27, v7 row_newbcast:5 row_mask:0xf bank_mask:0xf
  v_and_b32_dpp v54, v27, v8 row_newbcast:5 row_mask:0xf bank_mask:0xf
  v_and_b32_dpp v55, v27, v9 row_newbcast:5 row_mask:0xf bank_mask:0xf
  s_nop 1
  v_mfma_f32_16x16x32_bf16 v[36:39], v[52:55], v[208:211], v[36:39]
  v_and_b32_dpp v48, v27, v6 row_newbcast:6 row_mask:0xf bank_mask:0xf
  v_and_b32_dpp v49, v27, v7 row_newbcast:6 row_mask:0xf bank_mask:0xf
  v_and_b32_dpp v50, v27, v8 row_newbcast:6 row_mask:0xf bank_mask:0xf
  v_and_b32_dpp v51, v27, v9 row_newbcast:6 row_mask:0xf bank_mask:0xf
  s_nop 1
  v_mfma_f32_16x16x32_bf16 v[36:39], v[48:51], v[212:215], v[36:39]
  s_waitcnt vmcnt(6)
  buffer_load_dwordx4 v[80:83], v0, s[4:7], s32 offen offset:128 nt
  s_waitcnt vmcnt(6)
  v_add_f32_dpp v22, v44, v45 row_ror:8 row_mask:0x1 bank_mask:0xc
  v_mfma_f32_16x16x32_bf16 v[44:47], v[12:15], v[84:87], 0
  v_mfma_f32_16x16x32_bf16 v[44:47], v[16:19], v[88:91], v[44:47]
  buffer_load_dwordx4 v[84:87], v0, s[4:7], s32 offen offset:2048 nt
  v_and_b32_dpp v52, v27, v6 row_newbcast:7 row_mask:0xf bank_mask:0xf
  v_and_b32_dpp v53, v27, v7 row_newbcast:7 row_mask:0xf bank_mask:0xf
  v_and_b32_dpp v54, v27, v8 row_newbcast:7 row_mask:0xf bank_mask:0xf
  v_and_b32_dpp v55, v27, v9 row_newbcast:7 row_mask:0xf bank_mask:0xf
  s_nop 1
  v_mfma_f32_16x16x32_bf16 v[36:39], v[52:55], v[216:219], v[36:39]
  v_and_b32_dpp v48, v27, v6 row_newbcast:8 row_mask:0xf bank_mask:0xf
  v_and_b32_dpp v49, v27, v7 row_newbcast:8 row_mask:0xf bank_mask:0xf
  v_and_b32_dpp v50, v27, v8 row_newbcast:8 row_mask:0xf bank_mask:0xf
  v_and_b32_dpp v51, v27, v9 row_newbcast:8 row_mask:0xf bank_mask:0xf
  s_nop 1
  v_mfma_f32_16x16x32_bf16 v[36:39], v[48:51], v[220:223], v[36:39]
  v_and_b32_dpp v52, v27, v6 row_newbcast:9 row_mask:0xf bank_mask:0xf
  v_and_b32_dpp v53, v27, v7 row_newbcast:9 row_mask:0xf bank_mask:0xf
  v_and_b32_dpp v54, v27, v8 row_newbcast:9 row_mask:0xf bank_mask:0xf
  v_and_b32_dpp v55, v27, v9 row_newbcast:9 row_mask:0xf bank_mask:0xf
  s_nop 1
  v_mfma_f32_16x16x32_bf16 v[36:39], v[52:55], v[224:227], v[36:39]
  s_waitcnt vmcnt(6)
  buffer_load_dwordx4 v[88:91], v0, s[4:7], s32 offen offset:2176 nt
  s_waitcnt vmcnt(6)
  v_add_f32_dpp v22, v41, v40 row_ror:8 row_mask:0x2 bank_mask:0x3
  v_mfma_f32_16x16x32_bf16 v[40:43], v[12:15], v[60:63], 0
  v_mfma_f32_16x16x32_bf16 v[40:43], v[16:19], v[64:67], v[40:43]
  s_add_u32 s32, s29, 458752
  buffer_load_dwordx4 v[60:63], v0, s[4:7], s32 offen offset:0 nt
  v_and_b32_dpp v48, v27, v6 row_newbcast:10 row_mask:0xf bank_mask:0xf
  v_and_b32_dpp v49, v27, v7 row_newbcast:10 row_mask:0xf bank_mask:0xf
  v_and_b32_dpp v50, v27, v8 row_newbcast:10 row_mask:0xf bank_mask:0xf
  v_and_b32_dpp v51, v27, v9 row_newbcast:10 row_mask:0xf bank_mask:0xf
  s_nop 1
  v_mfma_f32_16x16x32_bf16 v[36:39], v[48:51], v[228:231], v[36:39]
  v_and_b32_dpp v52, v27, v6 row_newbcast:11 row_mask:0xf bank_mask:0xf
  v_and_b32_dpp v53, v27, v7 row_newbcast:11 row_mask:0xf bank_mask:0xf
  v_and_b32_dpp v54, v27, v8 row_newbcast:11 row_mask:0xf bank_mask:0xf
  v_and_b32_dpp v55, v27, v9 row_newbcast:11 row_mask:0xf bank_mask:0xf
  s_nop 1
  v_mfma_f32_16x16x32_bf16 v[36:39], v[52:55], v[232:235], v[36:39]
  v_and_b32_dpp v48, v27, v6 row_newbcast:12 row_mask:0xf bank_mask:0xf
  v_and_b32_dpp v49, v27, v7 row_newbcast:12 row_mask:0xf bank_mask:0xf
  v_and_b32_dpp v50, v27, v8 row_newbcast:12 row_mask:0xf bank_mask:0xf
  v_and_b32_dpp v51, v27, v9 row_newbcast:12 row_mask:0xf bank_mask:0xf
  s_nop 1
  v_mfma_f32_16x16x32_bf16 v[36:39], v[48:51], v[236:239], v[36:39]
  s_waitcnt vmcnt(6)
  buffer_load_dwordx4 v[64:67], v0, s[4:7], s32 offen offset:128 nt
  s_waitcnt vmcnt(6)
  v_add_f32_dpp v22, v44, v45 row_ror:8 row_mask:0x2 bank_mask:0xc
  v_mfma_f32_16x16x32_bf16 v[44:47], v[12:15], v[68:71], 0
  v_mfma_f32_16x16x32_bf16 v[44:47], v[16:19], v[72:75], v[44:47]
  buffer_load_dwordx4 v[68:71], v0, s[4:7], s32 offen offset:2048 nt
  v_and_b32_dpp v52, v27, v6 row_newbcast:13 row_mask:0xf bank_mask:0xf
  v_and_b32_dpp v53, v27, v7 row_newbcast:13 row_mask:0xf bank_mask:0xf
  v_and_b32_dpp v54, v27, v8 row_newbcast:13 row_mask:0xf bank_mask:0xf
  v_and_b32_dpp v55, v27, v9 row_newbcast:13 row_mask:0xf bank_mask:0xf
  s_nop 1
  v_mfma_f32_16x16x32_bf16 v[36:39], v[52:55], v[240:243], v[36:39]
  v_and_b32_dpp v48, v27, v6 row_newbcast:14 row_mask:0xf bank_mask:0xf
  v_and_b32_dpp v49, v27, v7 row_newbcast:14 row_mask:0xf bank_mask:0xf
  v_and_b32_dpp v50, v27, v8 row_newbcast:14 row_mask:0xf bank_mask:0xf
  v_and_b32_dpp v51, v27, v9 row_newbcast:14 row_mask:0xf bank_mask:0xf
  s_nop 1
  v_mfma_f32_16x16x32_bf16 v[36:39], v[48:51], v[244:247], v[36:39]
  v_and_b32_dpp v52, v27, v6 row_newbcast:15 row_mask:0xf bank_mask:0xf
  v_and_b32_dpp v53, v27, v7 row_newbcast:15 row_mask:0xf bank_mask:0xf
  v_and_b32_dpp v54, v27, v8 row_newbcast:15 row_mask:0xf bank_mask:0xf
  v_and_b32_dpp v55, v27, v9 row_newbcast:15 row_mask:0xf bank_mask:0xf
  s_nop 1
  v_mfma_f32_16x16x32_bf16 v[36:39], v[52:55], v[248:251], v[36:39]
  s_waitcnt vmcnt(6)
  buffer_load_dwordx4 v[72:75], v0, s[4:7], s32 offen offset:2176 nt
  s_waitcnt vmcnt(6)
  v_add_f32_dpp v22, v41, v40 row_ror:8 row_mask:0x4 bank_mask:0x3
  v_mfma_f32_16x16x32_bf16 v[40:43], v[12:15], v[76:79], 0
  v_mfma_f32_16x16x32_bf16 v[40:43], v[16:19], v[80:83], v[40:43]
  s_add_u32 s32, s29, 462848
  buffer_load_dwordx4 v[76:79], v0, s[4:7], s32 offen offset:0 nt
  v_and_b32_dpp v48, v28, v6 row_newbcast:0 row_mask:0xf bank_mask:0xf
  v_and_b32_dpp v49, v28, v7 row_newbcast:0 row_mask:0xf bank_mask:0xf
  v_and_b32_dpp v50, v28, v8 row_newbcast:0 row_mask:0xf bank_mask:0xf
  v_and_b32_dpp v51, v28, v9 row_newbcast:0 row_mask:0xf bank_mask:0xf
  s_nop 1
  v_mfma_f32_16x16x32_bf16 v[36:39], v[48:51], v[252:255], v[36:39]
  ds_read_b128 v[56:59], v4 offset:0
  v_and_b32_dpp v52, v28, v6 row_newbcast:1 row_mask:0xf bank_mask:0xf
  v_and_b32_dpp v53, v28, v7 row_newbcast:1 row_mask:0xf bank_mask:0xf
  v_and_b32_dpp v54, v28, v8 row_newbcast:1 row_mask:0xf bank_mask:0xf
  v_and_b32_dpp v55, v28, v9 row_newbcast:1 row_mask:0xf bank_mask:0xf
  s_waitcnt lgkmcnt(0)
  s_nop 0
  v_mfma_f32_16x16x32_bf16 v[36:39], v[52:55], v[56:59], v[36:39]
  ds_read_b128 v[56:59], v4 offset:1024
  v_and_b32_dpp v48, v28, v6 row_newbcast:2 row_mask:0xf bank_mask:0xf
  v_and_b32_dpp v49, v28, v7 row_newbcast:2 row_mask:0xf bank_mask:0xf
  v_and_b32_dpp v50, v28, v8 row_newbcast:2 row_mask:0xf bank_mask:0xf
  v_and_b32_dpp v51, v28, v9 row_newbcast:2 row_mask:0xf bank_mask:0xf
  s_waitcnt lgkmcnt(0)
  s_nop 0
  v_mfma_f32_16x16x32_bf16 v[36:39], v[48:51], v[56:59], v[36:39]
  s_waitcnt vmcnt(6)
  buffer_load_dwordx4 v[80:83], v0, s[4:7], s32 offen offset:128 nt
  s_waitcnt vmcnt(6)
  v_add_f32_dpp v22, v44, v45 row_ror:8 row_mask:0x4 bank_mask:0xc
  v_mfma_f32_16x16x32_bf16 v[44:47], v[12:15], v[84:87], 0
  v_mfma_f32_16x16x32_bf16 v[44:47], v[16:19], v[88:91], v[44:47]
  buffer_load_dwordx4 v[84:87], v0, s[4:7], s32 offen offset:2048 nt
  ds_read_b128 v[56:59], v4 offset:2048
  v_and_b32_dpp v52, v28, v6 row_newbcast:3 row_mask:0xf bank_mask:0xf
  v_and_b32_dpp v53, v28, v7 row_newbcast:3 row_mask:0xf bank_mask:0xf
  v_and_b32_dpp v54, v28, v8 row_newbcast:3 row_mask:0xf bank_mask:0xf
  v_and_b32_dpp v55, v28, v9 row_newbcast:3 row_mask:0xf bank_mask:0xf
  s_waitcnt lgkmcnt(0)
  s_nop 0
  v_mfma_f32_16x16x32_bf16 v[36:39], v[52:55], v[56:59], v[36:39]
  ds_read_b128 v[56:59], v4 offset:3072
  v_and_b32_dpp v48, v28, v6 row_newbcast:4 row_mask:0xf bank_mask:0xf
  v_and_b32_dpp v49, v28, v7 row_newbcast:4 row_mask:0xf bank_mask:0xf
  v_and_b32_dpp v50, v28, v8 row_newbcast:4 row_mask:0xf bank_mask:0xf
  v_and_b32_dpp v51, v28, v9 row_newbcast:4 row_mask:0xf bank_mask:0xf
  s_waitcnt lgkmcnt(0)
  s_nop 0
  v_mfma_f32_16x16x32_bf16 v[36:39], v[48:51], v[56:59], v[36:39]
  ds_read_b128 v[56:59], v4 offset:4096
  v_and_b32_dpp v52, v28, v6 row_newbcast:5 row_mask:0xf bank_mask:0xf
  v_and_b32_dpp v53, v28, v7 row_newbcast:5 row_mask:0xf bank_mask:0xf
  v_and_b32_dpp v54, v28, v8 row_newbcast:5 row_mask:0xf bank_mask:0xf
  v_and_b32_dpp v55, v28, v9 row_newbcast:5 row_mask:0xf bank_mask:0xf
  s_waitcnt lgkmcnt(0)
  s_nop 0
  v_mfma_f32_16x16x32_bf16 v[36:39], v[52:55], v[56:59], v[36:39]
  s_waitcnt vmcnt(6)
  buffer_load_dwordx4 v[88:91], v0, s[4:7], s32 offen offset:2176 nt
  s_waitcnt vmcnt(6)
  v_add_f32_dpp v22, v41, v40 row_ror:8 row_mask:0x8 bank_mask:0x3
  v_mfma_f32_16x16x32_bf16 v[40:43], v[12:15], v[60:63], 0
  v_mfma_f32_16x16x32_bf16 v[40:43], v[16:19], v[64:67], v[40:43]
  s_add_u32 s32, s29, 466944
  buffer_load_dwordx4 v[60:63], v0, s[4:7], s32 offen offset:0 nt
  ds_read_b128 v[56:59], v4 offset:5120
  v_and_b32_dpp v48, v28, v6 row_newbcast:6 row_mask:0xf bank_mask:0xf
  v_and_b32_dpp v49, v28, v7 row_newbcast:6 row_mask:0xf bank_mask:0xf
  v_and_b32_dpp v50, v28, v8 row_newbcast:6 row_mask:0xf bank_mask:0xf
  v_and_b32_dpp v51, v28, v9 row_newbcast:6 row_mask:0xf bank_mask:0xf
  s_waitcnt lgkmcnt(0)
  s_nop 0
  v_mfma_f32_16x16x32_bf16 v[36:39], v[48:51], v[56:59], v[36:39]
  ds_read_b128 v[56:59], v4 offset:6144
  v_and_b32_dpp v52, v28, v6 row_newbcast:7 row_mask:0xf bank_mask:0xf
  v_and_b32_dpp v53, v28, v7 row_newbcast:7 row_mask:0xf bank_mask:0xf
  v_and_b32_dpp v54, v28, v8 row_newbcast:7 row_mask:0xf bank_mask:0xf
  v_and_b32_dpp v55, v28, v9 row_newbcast:7 row_mask:0xf bank_mask:0xf
  s_waitcnt lgkmcnt(0)
  s_nop 0
  v_mfma_f32_16x16x32_bf16 v[36:39], v[52:55], v[56:59], v[36:39]
  ds_read_b128 v[56:59], v4 offset:7168
  v_and_b32_dpp v48, v28, v6 row_newbcast:8 row_mask:0xf bank_mask:0xf
  v_and_b32_dpp v49, v28, v7 row_newbcast:8 row_mask:0xf bank_mask:0xf
  v_and_b32_dpp v50, v28, v8 row_newbcast:8 row_mask:0xf bank_mask:0xf
  v_and_b32_dpp v51, v28, v9 row_newbcast:8 row_mask:0xf bank_mask:0xf
  s_waitcnt lgkmcnt(0)
  s_nop 0
  v_mfma_f32_16x16x32_bf16 v[36:39], v[48:51], v[56:59], v[36:39]
  s_waitcnt vmcnt(6)
  buffer_load_dwordx4 v[64:67], v0, s[4:7], s32 offen offset:128 nt
  s_waitcnt vmcnt(6)
  v_add_f32_dpp v22, v44, v45 row_ror:8 row_mask:0x8 bank_mask:0xc
  v_mfma_f32_16x16x32_bf16 v[44:47], v[12:15], v[68:71], 0
  v_mfma_f32_16x16x32_bf16 v[44:47], v[16:19], v[72:75], v[44:47]
  buffer_load_dwordx4 v[68:71], v0, s[4:7], s32 offen offset:2048 nt
  ds_read_b128 v[56:59], v4 offset:8192
  v_and_b32_dpp v52, v28, v6 row_newbcast:9 row_mask:0xf bank_mask:0xf
  v_and_b32_dpp v53, v28, v7 row_newbcast:9 row_mask:0xf bank_mask:0xf
  v_and_b32_dpp v54, v28, v8 row_newbcast:9 row_mask:0xf bank_mask:0xf
  v_and_b32_dpp v55, v28, v9 row_newbcast:9 row_mask:0xf bank_mask:0xf
  s_waitcnt lgkmcnt(0)
  s_nop 0
  v_mfma_f32_16x16x32_bf16 v[36:39], v[52:55], v[56:59], v[36:39]
  ds_read_b128 v[56:59], v4 offset:9216
  v_and_b32_dpp v48, v28, v6 row_newbcast:10 row_mask:0xf bank_mask:0xf
  v_and_b32_dpp v49, v28, v7 row_newbcast:10 row_mask:0xf bank_mask:0xf
  v_and_b32_dpp v50, v28, v8 row_newbcast:10 row_mask:0xf bank_mask:0xf
  v_and_b32_dpp v51, v28, v9 row_newbcast:10 row_mask:0xf bank_mask:0xf
  s_waitcnt lgkmcnt(0)
  s_nop 0
  v_mfma_f32_16x16x32_bf16 v[36:39], v[48:51], v[56:59], v[36:39]
  ds_read_b128 v[56:59], v4 offset:10240
  v_and_b32_dpp v52, v28, v6 row_newbcast:11 row_mask:0xf bank_mask:0xf
  v_and_b32_dpp v53, v28, v7 row_newbcast:11 row_mask:0xf bank_mask:0xf
  v_and_b32_dpp v54, v28, v8 row_newbcast:11 row_mask:0xf bank_mask:0xf
  v_and_b32_dpp v55, v28, v9 row_newbcast:11 row_mask:0xf bank_mask:0xf
  s_waitcnt lgkmcnt(0)
  s_nop 0
  v_mfma_f32_16x16x32_bf16 v[36:39], v[52:55], v[56:59], v[36:39]
  s_waitcnt vmcnt(6)
  buffer_load_dwordx4 v[72:75], v0, s[4:7], s32 offen offset:2176 nt
  s_waitcnt vmcnt(6)
  v_add_f32_dpp v23, v41, v40 row_ror:8 row_mask:0x1 bank_mask:0x3
  v_mfma_f32_16x16x32_bf16 v[40:43], v[12:15], v[76:79], 0
  v_mfma_f32_16x16x32_bf16 v[40:43], v[16:19], v[80:83], v[40:43]
  s_add_u32 s32, s29, 471040
  buffer_load_dwordx4 v[76:79], v0, s[4:7], s32 offen offset:0 nt
  ds_read_b128 v[56:59], v4 offset:11264
  v_and_b32_dpp v48, v28, v6 row_newbcast:12 row_mask:0xf bank_mask:0xf
  v_and_b32_dpp v49, v28, v7 row_newbcast:12 row_mask:0xf bank_mask:0xf
  v_and_b32_dpp v50, v28, v8 row_newbcast:12 row_mask:0xf bank_mask:0xf
  v_and_b32_dpp v51, v28, v9 row_newbcast:12 row_mask:0xf bank_mask:0xf
  s_waitcnt lgkmcnt(0)
  s_nop 0
  v_mfma_f32_16x16x32_bf16 v[36:39], v[48:51], v[56:59], v[36:39]
  ds_read_b128 v[56:59], v4 offset:12288
  v_and_b32_dpp v52, v28, v6 row_newbcast:13 row_mask:0xf bank_mask:0xf
  v_and_b32_dpp v53, v28, v7 row_newbcast:13 row_mask:0xf bank_mask:0xf
  v_and_b32_dpp v54, v28, v8 row_newbcast:13 row_mask:0xf bank_mask:0xf
  v_and_b32_dpp v55, v28, v9 row_newbcast:13 row_mask:0xf bank_mask:0xf
  s_waitcnt lgkmcnt(0)
  s_nop 0
  v_mfma_f32_16x16x32_bf16 v[36:39], v[52:55], v[56:59], v[36:39]
  ds_read_b128 v[56:59], v4 offset:13312
  v_and_b32_dpp v48, v28, v6 row_newbcast:14 row_mask:0xf bank_mask:0xf
  v_and_b32_dpp v49, v28, v7 row_newbcast:14 row_mask:0xf bank_mask:0xf
  v_and_b32_dpp v50, v28, v8 row_newbcast:14 row_mask:0xf bank_mask:0xf
  v_and_b32_dpp v51, v28, v9 row_newbcast:14 row_mask:0xf bank_mask:0xf
  s_waitcnt lgkmcnt(0)
  s_nop 0
  v_mfma_f32_16x16x32_bf16 v[36:39], v[48:51], v[56:59], v[36:39]
  s_waitcnt vmcnt(6)
  buffer_load_dwordx4 v[80:83], v0, s[4:7], s32 offen offset:128 nt
  s_waitcnt vmcnt(6)
  v_add_f32_dpp v23, v44, v45 row_ror:8 row_mask:0x1 bank_mask:0xc
  v_mfma_f32_16x16x32_bf16 v[44:47], v[12:15], v[84:87], 0
  v_mfma_f32_16x16x32_bf16 v[44:47], v[16:19], v[88:91], v[44:47]
  buffer_load_dwordx4 v[84:87], v0, s[4:7], s32 offen offset:2048 nt
  ds_read_b128 v[56:59], v4 offset:14336
  v_and_b32_dpp v52, v28, v6 row_newbcast:15 row_mask:0xf bank_mask:0xf
  v_and_b32_dpp v53, v28, v7 row_newbcast:15 row_mask:0xf bank_mask:0xf
  v_and_b32_dpp v54, v28, v8 row_newbcast:15 row_mask:0xf bank_mask:0xf
  v_and_b32_dpp v55, v28, v9 row_newbcast:15 row_mask:0xf bank_mask:0xf
  s_waitcnt lgkmcnt(0)
  s_nop 0
  v_mfma_f32_16x16x32_bf16 v[36:39], v[52:55], v[56:59], v[36:39]
  ds_read_b128 v[56:59], v4 offset:15360
  v_and_b32_dpp v48, v29, v6 row_newbcast:0 row_mask:0xf bank_mask:0xf
  v_and_b32_dpp v49, v29, v7 row_newbcast:0 row_mask:0xf bank_mask:0xf
  v_and_b32_dpp v50, v29, v8 row_newbcast:0 row_mask:0xf bank_mask:0xf
  v_and_b32_dpp v51, v29, v9 row_newbcast:0 row_mask:0xf bank_mask:0xf
  s_waitcnt lgkmcnt(0)
  s_nop 0
  v_mfma_f32_16x16x32_bf16 v[36:39], v[48:51], v[56:59], v[36:39]
  ds_read_b128 v[56:59], v4 offset:16384
  v_and_b32_dpp v52, v29, v6 row_newbcast:1 row_mask:0xf bank_mask:0xf
  v_and_b32_dpp v53, v29, v7 row_newbcast:1 row_mask:0xf bank_mask:0xf
  v_and_b32_dpp v54, v29, v8 row_newbcast:1 row_mask:0xf bank_mask:0xf
  v_and_b32_dpp v55, v29, v9 row_newbcast:1 row_mask:0xf bank_mask:0xf
  s_waitcnt lgkmcnt(0)
  s_nop 0
  v_mfma_f32_16x16x32_bf16 v[36:39], v[52:55], v[56:59], v[36:39]
  s_waitcnt vmcnt(6)
  buffer_load_dwordx4 v[88:91], v0, s[4:7], s32 offen offset:2176 nt
  s_waitcnt vmcnt(6)
  v_add_f32_dpp v23, v41, v40 row_ror:8 row_mask:0x2 bank_mask:0x3
  v_mfma_f32_16x16x32_bf16 v[40:43], v[12:15], v[60:63], 0
  v_mfma_f32_16x16x32_bf16 v[40:43], v[16:19], v[64:67], v[40:43]
  s_add_u32 s32, s29, 532480
  buffer_load_dwordx4 v[60:63], v0, s[4:7], s32 offen offset:0 nt
  ds_read_b128 v[56:59], v4 offset:17408
  v_and_b32_dpp v48, v29, v6 row_newbcast:2 row_mask:0xf bank_mask:0xf
  v_and_b32_dpp v49, v29, v7 row_newbcast:2 row_mask:0xf bank_mask:0xf
  v_and_b32_dpp v50, v29, v8 row_newbcast:2 row_mask:0xf bank_mask:0xf
  v_and_b32_dpp v51, v29, v9 row_newbcast:2 row_mask:0xf bank_mask:0xf
  s_waitcnt lgkmcnt(0)
  s_nop 0
  v_mfma_f32_16x16x32_bf16 v[36:39], v[48:51], v[56:59], v[36:39]
  ds_read_b128 v[56:59], v4 offset:18432
  v_and_b32_dpp v52, v29, v6 row_newbcast:3 row_mask:0xf bank_mask:0xf
  v_and_b32_dpp v53, v29, v7 row_newbcast:3 row_mask:0xf bank_mask:0xf
  v_and_b32_dpp v54, v29, v8 row_newbcast:3 row_mask:0xf bank_mask:0xf
  v_and_b32_dpp v55, v29, v9 row_newbcast:3 row_mask:0xf bank_mask:0xf
  s_waitcnt lgkmcnt(0)
  s_nop 0
  v_mfma_f32_16x16x32_bf16 v[36:39], v[52:55], v[56:59], v[36:39]
  ds_read_b128 v[56:59], v4 offset:19456
  v_and_b32_dpp v48, v29, v6 row_newbcast:4 row_mask:0xf bank_mask:0xf
  v_and_b32_dpp v49, v29, v7 row_newbcast:4 row_mask:0xf bank_mask:0xf
  v_and_b32_dpp v50, v29, v8 row_newbcast:4 row_mask:0xf bank_mask:0xf
  v_and_b32_dpp v51, v29, v9 row_newbcast:4 row_mask:0xf bank_mask:0xf
  s_waitcnt lgkmcnt(0)
  s_nop 0
  v_mfma_f32_16x16x32_bf16 v[36:39], v[48:51], v[56:59], v[36:39]
  s_waitcnt vmcnt(6)
  buffer_load_dwordx4 v[64:67], v0, s[4:7], s32 offen offset:128 nt
  s_waitcnt vmcnt(6)
  v_add_f32_dpp v23, v44, v45 row_ror:8 row_mask:0x2 bank_mask:0xc
  v_mfma_f32_16x16x32_bf16 v[44:47], v[12:15], v[68:71], 0
  v_mfma_f32_16x16x32_bf16 v[44:47], v[16:19], v[72:75], v[44:47]
  buffer_load_dwordx4 v[68:71], v0, s[4:7], s32 offen offset:2048 nt
  ds_read_b128 v[56:59], v4 offset:20480
  v_and_b32_dpp v52, v29, v6 row_newbcast:5 row_mask:0xf bank_mask:0xf
  v_and_b32_dpp v53, v29, v7 row_newbcast:5 row_mask:0xf bank_mask:0xf
  v_and_b32_dpp v54, v29, v8 row_newbcast:5 row_mask:0xf bank_mask:0xf
  v_and_b32_dpp v55, v29, v9 row_newbcast:5 row_mask:0xf bank_mask:0xf
  s_waitcnt lgkmcnt(0)
  s_nop 0
  v_mfma_f32_16x16x32_bf16 v[36:39], v[52:55], v[56:59], v[36:39]
  ds_read_b128 v[56:59], v4 offset:21504
  v_and_b32_dpp v48, v29, v6 row_newbcast:6 row_mask:0xf bank_mask:0xf
  v_and_b32_dpp v49, v29, v7 row_newbcast:6 row_mask:0xf bank_mask:0xf
  v_and_b32_dpp v50, v29, v8 row_newbcast:6 row_mask:0xf bank_mask:0xf
  v_and_b32_dpp v51, v29, v9 row_newbcast:6 row_mask:0xf bank_mask:0xf
  s_waitcnt lgkmcnt(0)
  s_nop 0
  v_mfma_f32_16x16x32_bf16 v[36:39], v[48:51], v[56:59], v[36:39]
  ds_read_b128 v[56:59], v4 offset:22528
  v_and_b32_dpp v52, v29, v6 row_newbcast:7 row_mask:0xf bank_mask:0xf
  v_and_b32_dpp v53, v29, v7 row_newbcast:7 row_mask:0xf bank_mask:0xf
  v_and_b32_dpp v54, v29, v8 row_newbcast:7 row_mask:0xf bank_mask:0xf
  v_and_b32_dpp v55, v29, v9 row_newbcast:7 row_mask:0xf bank_mask:0xf
  s_waitcnt lgkmcnt(0)
  s_nop 0
  v_mfma_f32_16x16x32_bf16 v[36:39], v[52:55], v[56:59], v[36:39]
  s_waitcnt vmcnt(6)
  buffer_load_dwordx4 v[72:75], v0, s[4:7], s32 offen offset:2176 nt
  s_waitcnt vmcnt(6)
  v_add_f32_dpp v23, v41, v40 row_ror:8 row_mask:0x4 bank_mask:0x3
  v_mfma_f32_16x16x32_bf16 v[40:43], v[12:15], v[76:79], 0
  v_mfma_f32_16x16x32_bf16 v[40:43], v[16:19], v[80:83], v[40:43]
  s_add_u32 s32, s29, 536576
  buffer_load_dwordx4 v[76:79], v0, s[4:7], s32 offen offset:0 nt
  ds_read_b128 v[56:59], v4 offset:23552
  v_and_b32_dpp v48, v29, v6 row_newbcast:8 row_mask:0xf bank_mask:0xf
  v_and_b32_dpp v49, v29, v7 row_newbcast:8 row_mask:0xf bank_mask:0xf
  v_and_b32_dpp v50, v29, v8 row_newbcast:8 row_mask:0xf bank_mask:0xf
  v_and_b32_dpp v51, v29, v9 row_newbcast:8 row_mask:0xf bank_mask:0xf
  s_waitcnt lgkmcnt(0)
  s_nop 0
  v_mfma_f32_16x16x32_bf16 v[36:39], v[48:51], v[56:59], v[36:39]
  ds_read_b128 v[56:59], v4 offset:24576
  v_and_b32_dpp v52, v29, v6 row_newbcast:9 row_mask:0xf bank_mask:0xf
  v_and_b32_dpp v53, v29, v7 row_newbcast:9 row_mask:0xf bank_mask:0xf
  v_and_b32_dpp v54, v29, v8 row_newbcast:9 row_mask:0xf bank_mask:0xf
  v_and_b32_dpp v55, v29, v9 row_newbcast:9 row_mask:0xf bank_mask:0xf
  s_waitcnt lgkmcnt(0)
  s_nop 0
  v_mfma_f32_16x16x32_bf16 v[36:39], v[52:55], v[56:59], v[36:39]
  ds_read_b128 v[56:59], v4 offset:25600
  v_and_b32_dpp v48, v29, v6 row_newbcast:10 row_mask:0xf bank_mask:0xf
  v_and_b32_dpp v49, v29, v7 row_newbcast:10 row_mask:0xf bank_mask:0xf
  v_and_b32_dpp v50, v29, v8 row_newbcast:10 row_mask:0xf bank_mask:0xf
  v_and_b32_dpp v51, v29, v9 row_newbcast:10 row_mask:0xf bank_mask:0xf
  s_waitcnt lgkmcnt(0)
  s_nop 0
  v_mfma_f32_16x16x32_bf16 v[36:39], v[48:51], v[56:59], v[36:39]
  s_waitcnt vmcnt(6)
  buffer_load_dwordx4 v[80:83], v0, s[4:7], s32 offen offset:128 nt
  s_waitcnt vmcnt(6)
  v_add_f32_dpp v23, v44, v45 row_ror:8 row_mask:0x4 bank_mask:0xc
  v_mfma_f32_16x16x32_bf16 v[44:47], v[12:15], v[84:87], 0
  v_mfma_f32_16x16x32_bf16 v[44:47], v[16:19], v[88:91], v[44:47]
  buffer_load_dwordx4 v[84:87], v0, s[4:7], s32 offen offset:2048 nt
  ds_read_b128 v[56:59], v4 offset:26624
  v_and_b32_dpp v52, v29, v6 row_newbcast:11 row_mask:0xf bank_mask:0xf
  v_and_b32_dpp v53, v29, v7 row_newbcast:11 row_mask:0xf bank_mask:0xf
  v_and_b32_dpp v54, v29, v8 row_newbcast:11 row_mask:0xf bank_mask:0xf
  v_and_b32_dpp v55, v29, v9 row_newbcast:11 row_mask:0xf bank_mask:0xf
  s_waitcnt lgkmcnt(0)
  s_nop 0
  v_mfma_f32_16x16x32_bf16 v[36:39], v[52:55], v[56:59], v[36:39]
  ds_read_b128 v[56:59], v4 offset:27648
  v_and_b32_dpp v48, v29, v6 row_newbcast:12 row_mask:0xf bank_mask:0xf
  v_and_b32_dpp v49, v29, v7 row_newbcast:12 row_mask:0xf bank_mask:0xf
  v_and_b32_dpp v50, v29, v8 row_newbcast:12 row_mask:0xf bank_mask:0xf
  v_and_b32_dpp v51, v29, v9 row_newbcast:12 row_mask:0xf bank_mask:0xf
  s_waitcnt lgkmcnt(0)
  s_nop 0
  v_mfma_f32_16x16x32_bf16 v[36:39], v[48:51], v[56:59], v[36:39]
  ds_read_b128 v[56:59], v4 offset:28672
  v_and_b32_dpp v52, v29, v6 row_newbcast:13 row_mask:0xf bank_mask:0xf
  v_and_b32_dpp v53, v29, v7 row_newbcast:13 row_mask:0xf bank_mask:0xf
  v_and_b32_dpp v54, v29, v8 row_newbcast:13 row_mask:0xf bank_mask:0xf
  v_and_b32_dpp v55, v29, v9 row_newbcast:13 row_mask:0xf bank_mask:0xf
  s_waitcnt lgkmcnt(0)
  s_nop 0
  v_mfma_f32_16x16x32_bf16 v[36:39], v[52:55], v[56:59], v[36:39]
  s_waitcnt vmcnt(6)
  buffer_load_dwordx4 v[88:91], v0, s[4:7], s32 offen offset:2176 nt
  s_waitcnt vmcnt(6)
  v_mov_b32 v24, 0xff800000
  v_add_f32_dpp v23, v41, v40 row_ror:8 row_mask:0x8 bank_mask:0x3
  v_mfma_f32_16x16x32_bf16 v[40:43], v[12:15], v[60:63], 0
  v_mfma_f32_16x16x32_bf16 v[40:43], v[16:19], v[64:67], v[40:43]
  s_mov_b32 s32, s31
  s_mov_b64 exec, s[42:43]
  buffer_load_dwordx4 v[60:63], v0, s[4:7], s32 offen offset:0 nt
  s_mov_b64 exec, -1
  ds_read_b128 v[56:59], v4 offset:29696
  v_and_b32_dpp v48, v29, v6 row_newbcast:14 row_mask:0xf bank_mask:0xf
  v_and_b32_dpp v49, v29, v7 row_newbcast:14 row_mask:0xf bank_mask:0xf
  v_and_b32_dpp v50, v29, v8 row_newbcast:14 row_mask:0xf bank_mask:0xf
  v_and_b32_dpp v51, v29, v9 row_newbcast:14 row_mask:0xf bank_mask:0xf
  s_waitcnt lgkmcnt(0)
  s_nop 0
  v_mfma_f32_16x16x32_bf16 v[36:39], v[48:51], v[56:59], v[36:39]
  ds_read_b128 v[56:59], v4 offset:30720
  v_and_b32_dpp v52, v29, v6 row_newbcast:15 row_mask:0xf bank_mask:0xf
  v_and_b32_dpp v53, v29, v7 row_newbcast:15 row_mask:0xf bank_mask:0xf
  v_and_b32_dpp v54, v29, v8 row_newbcast:15 row_mask:0xf bank_mask:0xf
  v_and_b32_dpp v55, v29, v9 row_newbcast:15 row_mask:0xf bank_mask:0xf
  s_waitcnt lgkmcnt(0)
  s_nop 0
  v_mfma_f32_16x16x32_bf16 v[36:39], v[52:55], v[56:59], v[36:39]
  ds_read_b128 v[56:59], v4 offset:31744
  v_and_b32_dpp v48, v30, v6 row_newbcast:0 row_mask:0xf bank_mask:0xf
  v_and_b32_dpp v49, v30, v7 row_newbcast:0 row_mask:0xf bank_mask:0xf
  v_and_b32_dpp v50, v30, v8 row_newbcast:0 row_mask:0xf bank_mask:0xf
  v_and_b32_dpp v51, v30, v9 row_newbcast:0 row_mask:0xf bank_mask:0xf
  s_waitcnt lgkmcnt(0)
  s_nop 0
  v_mfma_f32_16x16x32_bf16 v[36:39], v[48:51], v[56:59], v[36:39]
  s_waitcnt vmcnt(6)
  s_mov_b64 exec, s[42:43]
  buffer_load_dwordx4 v[64:67], v0, s[4:7], s32 offen offset:128 nt
  s_mov_b64 exec, -1
  s_waitcnt vmcnt(6)
  v_add_f32_dpp v23, v44, v45 row_ror:8 row_mask:0x8 bank_mask:0xc
  v_mfma_f32_16x16x32_bf16 v[44:47], v[12:15], v[68:71], 0
  v_mfma_f32_16x16x32_bf16 v[44:47], v[16:19], v[72:75], v[44:47]
  s_mov_b64 exec, s[44:45]
  buffer_load_dwordx4 v[68:71], v0, s[4:7], s32 offen offset:2048 nt
  s_mov_b64 exec, -1
  ds_read_b128 v[56:59], v4 offset:32768
  v_and_b32_dpp v52, v30, v6 row_newbcast:1 row_mask:0xf bank_mask:0xf
  v_and_b32_dpp v53, v30, v7 row_newbcast:1 row_mask:0xf bank_mask:0xf
  v_and_b32_dpp v54, v30, v8 row_newbcast:1 row_mask:0xf bank_mask:0xf
  v_and_b32_dpp v55, v30, v9 row_newbcast:1 row_mask:0xf bank_mask:0xf
  s_waitcnt lgkmcnt(0)
  s_nop 0
  v_mfma_f32_16x16x32_bf16 v[36:39], v[52:55], v[56:59], v[36:39]
  ds_read_b128 v[56:59], v4 offset:33792
  v_and_b32_dpp v48, v30, v6 row_newbcast:2 row_mask:0xf bank_mask:0xf
  v_and_b32_dpp v49, v30, v7 row_newbcast:2 row_mask:0xf bank_mask:0xf
  v_and_b32_dpp v50, v30, v8 row_newbcast:2 row_mask:0xf bank_mask:0xf
  v_and_b32_dpp v51, v30, v9 row_newbcast:2 row_mask:0xf bank_mask:0xf
  s_waitcnt lgkmcnt(0)
  s_nop 0
  v_mfma_f32_16x16x32_bf16 v[36:39], v[48:51], v[56:59], v[36:39]
  ds_read_b128 v[56:59], v4 offset:34816
  v_and_b32_dpp v52, v30, v6 row_newbcast:3 row_mask:0xf bank_mask:0xf
  v_and_b32_dpp v53, v30, v7 row_newbcast:3 row_mask:0xf bank_mask:0xf
  v_and_b32_dpp v54, v30, v8 row_newbcast:3 row_mask:0xf bank_mask:0xf
  v_and_b32_dpp v55, v30, v9 row_newbcast:3 row_mask:0xf bank_mask:0xf
  s_waitcnt lgkmcnt(0)
  s_nop 0
  v_mfma_f32_16x16x32_bf16 v[36:39], v[52:55], v[56:59], v[36:39]
  s_waitcnt vmcnt(6)
  s_mov_b64 exec, s[44:45]
  buffer_load_dwordx4 v[72:75], v0, s[4:7], s32 offen offset:2176 nt
  s_mov_b64 exec, -1
  s_waitcnt vmcnt(6)
  v_add_f32_dpp v24, v41, v40 row_ror:8 row_mask:0x1 bank_mask:0x3
  v_mfma_f32_16x16x32_bf16 v[40:43], v[12:15], v[76:79], 0
  v_mfma_f32_16x16x32_bf16 v[40:43], v[16:19], v[80:83], v[40:43]
  s_add_u32 s33, s29, 262144
  buffer_load_dwordx4 v[76:79], v1, s[8:11], s33 offen offset:0 nt
  ds_read_b128 v[56:59], v4 offset:35840
  v_and_b32_dpp v48, v30, v6 row_newbcast:4 row_mask:0xf bank_mask:0xf
  v_and_b32_dpp v49, v30, v7 row_newbcast:4 row_mask:0xf bank_mask:0xf
  v_and_b32_dpp v50, v30, v8 row_newbcast:4 row_mask:0xf bank_mask:0xf
  v_and_b32_dpp v51, v30, v9 row_newbcast:4 row_mask:0xf bank_mask:0xf
  s_waitcnt lgkmcnt(0)
  s_nop 0
  v_mfma_f32_16x16x32_bf16 v[36:39], v[48:51], v[56:59], v[36:39]
  ds_read_b128 v[56:59], v4 offset:36864
  v_and_b32_dpp v52, v30, v6 row_newbcast:5 row_mask:0xf bank_mask:0xf
  v_and_b32_dpp v53, v30, v7 row_newbcast:5 row_mask:0xf bank_mask:0xf
  v_and_b32_dpp v54, v30, v8 row_newbcast:5 row_mask:0xf bank_mask:0xf
  v_and_b32_dpp v55, v30, v9 row_newbcast:5 row_mask:0xf bank_mask:0xf
  s_waitcnt lgkmcnt(0)
  s_nop 0
  v_mfma_f32_16x16x32_bf16 v[36:39], v[52:55], v[56:59], v[36:39]
  ds_read_b128 v[56:59], v4 offset:37888
  v_and_b32_dpp v48, v30, v6 row_newbcast:6 row_mask:0xf bank_mask:0xf
  v_and_b32_dpp v49, v30, v7 row_newbcast:6 row_mask:0xf bank_mask:0xf
  v_and_b32_dpp v50, v30, v8 row_newbcast:6 row_mask:0xf bank_mask:0xf
  v_and_b32_dpp v51, v30, v9 row_newbcast:6 row_mask:0xf bank_mask:0xf
  s_waitcnt lgkmcnt(0)
  s_nop 0
  v_mfma_f32_16x16x32_bf16 v[36:39], v[48:51], v[56:59], v[36:39]
  s_waitcnt vmcnt(6)
  buffer_load_dwordx4 v[80:83], v1, s[8:11], s33 offen offset:256 nt
  s_waitcnt vmcnt(6)
  v_add_f32_dpp v24, v45, v44 row_ror:8 row_mask:0x2 bank_mask:0x3
  v_mfma_f32_16x16x32_bf16 v[44:47], v[12:15], v[84:87], 0
  v_mfma_f32_16x16x32_bf16 v[44:47], v[16:19], v[88:91], v[44:47]
  buffer_load_dwordx4 v[84:87], v1, s[8:11], s33 offen offset:512 nt
  ds_read_b128 v[56:59], v4 offset:38912
  v_and_b32_dpp v52, v30, v6 row_newbcast:7 row_mask:0xf bank_mask:0xf
  v_and_b32_dpp v53, v30, v7 row_newbcast:7 row_mask:0xf bank_mask:0xf
  v_and_b32_dpp v54, v30, v8 row_newbcast:7 row_mask:0xf bank_mask:0xf
  v_and_b32_dpp v55, v30, v9 row_newbcast:7 row_mask:0xf bank_mask:0xf
  s_waitcnt lgkmcnt(0)
  s_nop 0
  v_mfma_f32_16x16x32_bf16 v[36:39], v[52:55], v[56:59], v[36:39]
  s_waitcnt vmcnt(6)
  buffer_load_dwordx4 v[88:91], v1, s[8:11], s33 offen offset:768 nt
  s_waitcnt vmcnt(6)
  v_mov_b32 v25, 0xff800000
  v_add_f32_dpp v24, v41, v40 row_ror:8 row_mask:0x4 bank_mask:0x3
  v_mfma_f32_16x16x32_bf16 v[40:43], v[12:15], v[60:63], 0
  v_mfma_f32_16x16x32_bf16 v[40:43], v[16:19], v[64:67], v[40:43]
  buffer_load_dwordx4 v[60:63], v1, s[8:11], s33 offen offset:1024 nt
  s_waitcnt vmcnt(6)
  buffer_load_dwordx4 v[64:67], v1, s[8:11], s33 offen offset:1280 nt
  s_waitcnt vmcnt(6)
  v_add_f32_dpp v24, v45, v44 row_ror:8 row_mask:0x8 bank_mask:0x3
  v_mfma_f32_16x16x32_bf16 v[44:47], v[12:15], v[68:71], 0
  v_mfma_f32_16x16x32_bf16 v[44:47], v[16:19], v[72:75], v[44:47]
  buffer_load_dwordx4 v[68:71], v1, s[8:11], s33 offen offset:1536 nt
  v_add_f32_dpp v25, v41, v40 row_ror:8 row_mask:0x1 bank_mask:0x3
  s_nop 5
  v_add_f32_dpp v25, v44, v45 row_ror:8 row_mask:0x1 bank_mask:0xc
  ds_bpermute_b32 v25, v5, v25
  s_waitcnt lgkmcnt(0)
  v_mul_f32 v20, 0x3e0293ee, v20
  v_mul_f32 v21, 0x3e0293ee, v21
  v_mul_f32 v22, 0x3e0293ee, v22
  v_mul_f32 v23, 0x3e0293ee, v23
  v_mul_f32 v24, 0x3e0293ee, v24
  v_mul_f32 v25, 0x3e0293ee, v25
  v_max3_f32 v40, v20, v21, v22
  v_max3_f32 v40, v40, v23, v24
  v_max_f32 v40, v40, v25
  v_max_f32 v40, s37, v40
  s_nop 1
  v_max_f32_dpp v40, v40, v40 row_ror:8 row_mask:0xf bank_mask:0xf
  s_nop 1
  v_max_f32_dpp v40, v40, v40 row_ror:4 row_mask:0xf bank_mask:0xf
  s_nop 1
  v_max_f32_dpp v40, v40, v40 row_ror:2 row_mask:0xf bank_mask:0xf
  s_nop 1
  v_max_f32_dpp v40, v40, v40 row_ror:1 row_mask:0xf bank_mask:0xf
  s_nop 1
  v_max_f32_dpp v40, v40, v40 row_bcast:15 row_mask:0xa bank_mask:0xf
  s_nop 1
  v_max_f32_dpp v40, v40, v40 row_bcast:31 row_mask:0xc bank_mask:0xf
  s_nop 0
  v_readlane_b32 s46, v40, 63
  s_nop 1
  v_mov_b32 v41, s46
  v_sub_f32 v41, s37, v41
  v_exp_f32 v41, v41
  s_nop 0
  v_mul_f32 v36, v36, v41
  v_mul_f32 v37, v37, v41
  v_mul_f32 v38, v38, v41
  v_mul_f32 v39, v39, v41
  v_mul_f32 v11, v11, v41
  s_mov_b32 s37, s46
  v_subrev_f32 v20, s37, v20
  v_subrev_f32 v21, s37, v21
  v_subrev_f32 v22, s37, v22
  v_subrev_f32 v23, s37, v23
  v_subrev_f32 v24, s37, v24
  v_subrev_f32 v25, s37, v25
  v_exp_f32 v20, v20
  v_exp_f32 v21, v21
  v_exp_f32 v22, v22
  v_exp_f32 v23, v23
  v_exp_f32 v24, v24
  v_exp_f32 v25, v25
  v_add_f32 v42, v20, v21
  v_add_f32 v43, v22, v23
  v_add_f32 v42, v42, v24
  v_add_f32 v43, v43, v25
  v_add_f32 v42, v42, v43
  v_add_f32 v11, v11, v42
  v_cvt_pk_bf16_f32 v20, v20, v20
  v_cvt_pk_bf16_f32 v21, v21, v21
  v_cvt_pk_bf16_f32 v22, v22, v22
  v_cvt_pk_bf16_f32 v23, v23, v23
  v_cvt_pk_bf16_f32 v24, v24, v24
  v_cvt_pk_bf16_f32 v25, v25, v25
  s_waitcnt vmcnt(6)
  buffer_load_dwordx4 v[72:75], v1, s[8:11], s33 offen offset:1792 nt
  v_and_b32_dpp v48, v20, v6 row_newbcast:0 row_mask:0xf bank_mask:0xf
  v_and_b32_dpp v49, v20, v7 row_newbcast:0 row_mask:0xf bank_mask:0xf
  v_and_b32_dpp v50, v20, v8 row_newbcast:0 row_mask:0xf bank_mask:0xf
  v_and_b32_dpp v51, v20, v9 row_newbcast:0 row_mask:0xf bank_mask:0xf
  s_nop 1
  v_mfma_f32_16x16x32_bf16 v[36:39], v[48:51], v[76:79], v[36:39]
  s_waitcnt vmcnt(6)
  buffer_load_dwordx4 v[76:79], v1, s[8:11], s33 offen offset:2048 nt
  v_and_b32_dpp v52, v20, v6 row_newbcast:1 row_mask:0xf bank_mask:0xf
  v_and_b32_dpp v53, v20, v7 row_newbcast:1 row_mask:0xf bank_mask:0xf
  v_and_b32_dpp v54, v20, v8 row_newbcast:1 row_mask:0xf bank_mask:0xf
  v_and_b32_dpp v55, v20, v9 row_newbcast:1 row_mask:0xf bank_mask:0xf
  s_nop 1
  v_mfma_f32_16x16x32_bf16 v[36:39], v[52:55], v[80:83], v[36:39]
  s_waitcnt vmcnt(6)
  buffer_load_dwordx4 v[80:83], v1, s[8:11], s33 offen offset:2304 nt
  v_and_b32_dpp v48, v20, v6 row_newbcast:2 row_mask:0xf bank_mask:0xf
  v_and_b32_dpp v49, v20, v7 row_newbcast:2 row_mask:0xf bank_mask:0xf
  v_and_b32_dpp v50, v20, v8 row_newbcast:2 row_mask:0xf bank_mask:0xf
  v_and_b32_dpp v51, v20, v9 row_newbcast:2 row_mask:0xf bank_mask:0xf
  s_nop 1
  v_mfma_f32_16x16x32_bf16 v[36:39], v[48:51], v[84:87], v[36:39]
  s_waitcnt vmcnt(6)
  buffer_load_dwordx4 v[84:87], v1, s[8:11], s33 offen offset:2560 nt
  v_and_b32_dpp v52, v20, v6 row_newbcast:3 row_mask:0xf bank_mask:0xf
  v_and_b32_dpp v53, v20, v7 row_newbcast:3 row_mask:0xf bank_mask:0xf
  v_and_b32_dpp v54, v20, v8 row_newbcast:3 row_mask:0xf bank_mask:0xf
  v_and_b32_dpp v55, v20, v9 row_newbcast:3 row_mask:0xf bank_mask:0xf
  s_nop 1
  v_mfma_f32_16x16x32_bf16 v[36:39], v[52:55], v[88:91], v[36:39]
  s_waitcnt vmcnt(6)
  buffer_load_dwordx4 v[88:91], v1, s[8:11], s33 offen offset:2816 nt
  v_and_b32_dpp v48, v20, v6 row_newbcast:4 row_mask:0xf bank_mask:0xf
  v_and_b32_dpp v49, v20, v7 row_newbcast:4 row_mask:0xf bank_mask:0xf
  v_and_b32_dpp v50, v20, v8 row_newbcast:4 row_mask:0xf bank_mask:0xf
  v_and_b32_dpp v51, v20, v9 row_newbcast:4 row_mask:0xf bank_mask:0xf
  s_nop 1
  v_mfma_f32_16x16x32_bf16 v[36:39], v[48:51], v[60:63], v[36:39]
  s_waitcnt vmcnt(6)
  buffer_load_dwordx4 v[60:63], v1, s[8:11], s33 offen offset:3072 nt
  v_and_b32_dpp v52, v20, v6 row_newbcast:5 row_mask:0xf bank_mask:0xf
  v_and_b32_dpp v53, v20, v7 row_newbcast:5 row_mask:0xf bank_mask:0xf
  v_and_b32_dpp v54, v20, v8 row_newbcast:5 row_mask:0xf bank_mask:0xf
  v_and_b32_dpp v55, v20, v9 row_newbcast:5 row_mask:0xf bank_mask:0xf
  s_nop 1
  v_mfma_f32_16x16x32_bf16 v[36:39], v[52:55], v[64:67], v[36:39]
  s_waitcnt vmcnt(6)
  buffer_load_dwordx4 v[64:67], v1, s[8:11], s33 offen offset:3328 nt
  v_and_b32_dpp v48, v20, v6 row_newbcast:6 row_mask:0xf bank_mask:0xf
  v_and_b32_dpp v49, v20, v7 row_newbcast:6 row_mask:0xf bank_mask:0xf
  v_and_b32_dpp v50, v20, v8 row_newbcast:6 row_mask:0xf bank_mask:0xf
  v_and_b32_dpp v51, v20, v9 row_newbcast:6 row_mask:0xf bank_mask:0xf
  s_nop 1
  v_mfma_f32_16x16x32_bf16 v[36:39], v[48:51], v[68:71], v[36:39]
  s_waitcnt vmcnt(6)
  buffer_load_dwordx4 v[68:71], v1, s[8:11], s33 offen offset:3584 nt
  v_and_b32_dpp v52, v20, v6 row_newbcast:7 row_mask:0xf bank_mask:0xf
  v_and_b32_dpp v53, v20, v7 row_newbcast:7 row_mask:0xf bank_mask:0xf
  v_and_b32_dpp v54, v20, v8 row_newbcast:7 row_mask:0xf bank_mask:0xf
  v_and_b32_dpp v55, v20, v9 row_newbcast:7 row_mask:0xf bank_mask:0xf
  s_nop 1
  v_mfma_f32_16x16x32_bf16 v[36:39], v[52:55], v[72:75], v[36:39]
  s_waitcnt vmcnt(6)
  buffer_load_dwordx4 v[72:75], v1, s[8:11], s33 offen offset:3840 nt
  v_and_b32_dpp v48, v20, v6 row_newbcast:8 row_mask:0xf bank_mask:0xf
  v_and_b32_dpp v49, v20, v7 row_newbcast:8 row_mask:0xf bank_mask:0xf
  v_and_b32_dpp v50, v20, v8 row_newbcast:8 row_mask:0xf bank_mask:0xf
  v_and_b32_dpp v51, v20, v9 row_newbcast:8 row_mask:0xf bank_mask:0xf
  s_nop 1
  v_mfma_f32_16x16x32_bf16 v[36:39], v[48:51], v[76:79], v[36:39]
  s_waitcnt vmcnt(6)
  s_add_u32 s33, s29, 327680
  buffer_load_dwordx4 v[76:79], v1, s[8:11], s33 offen offset:0 nt
  v_and_b32_dpp v52, v20, v6 row_newbcast:9 row_mask:0xf bank_mask:0xf
  v_and_b32_dpp v53, v20, v7 row_newbcast:9 row_mask:0xf bank_mask:0xf
  v_and_b32_dpp v54, v20, v8 row_newbcast:9 row_mask:0xf bank_mask:0xf
  v_and_b32_dpp v55, v20, v9 row_newbcast:9 row_mask:0xf bank_mask:0xf
  s_nop 1
  v_mfma_f32_16x16x32_bf16 v[36:39], v[52:55], v[80:83], v[36:39]
  s_waitcnt vmcnt(6)
  buffer_load_dwordx4 v[80:83], v1, s[8:11], s33 offen offset:256 nt
  v_and_b32_dpp v48, v20, v6 row_newbcast:10 row_mask:0xf bank_mask:0xf
  v_and_b32_dpp v49, v20, v7 row_newbcast:10 row_mask:0xf bank_mask:0xf
  v_and_b32_dpp v50, v20, v8 row_newbcast:10 row_mask:0xf bank_mask:0xf
  v_and_b32_dpp v51, v20, v9 row_newbcast:10 row_mask:0xf bank_mask:0xf
  s_nop 1
  v_mfma_f32_16x16x32_bf16 v[36:39], v[48:51], v[84:87], v[36:39]
  s_waitcnt vmcnt(6)
  buffer_load_dwordx4 v[84:87], v1, s[8:11], s33 offen offset:512 nt
  v_and_b32_dpp v52, v20, v6 row_newbcast:11 row_mask:0xf bank_mask:0xf
  v_and_b32_dpp v53, v20, v7 row_newbcast:11 row_mask:0xf bank_mask:0xf
  v_and_b32_dpp v54, v20, v8 row_newbcast:11 row_mask:0xf bank_mask:0xf
  v_and_b32_dpp v55, v20, v9 row_newbcast:11 row_mask:0xf bank_mask:0xf
  s_nop 1
  v_mfma_f32_16x16x32_bf16 v[36:39], v[52:55], v[88:91], v[36:39]
  s_waitcnt vmcnt(6)
  buffer_load_dwordx4 v[88:91], v1, s[8:11], s33 offen offset:768 nt
  v_and_b32_dpp v48, v20, v6 row_newbcast:12 row_mask:0xf bank_mask:0xf
  v_and_b32_dpp v49, v20, v7 row_newbcast:12 row_mask:0xf bank_mask:0xf
  v_and_b32_dpp v50, v20, v8 row_newbcast:12 row_mask:0xf bank_mask:0xf
  v_and_b32_dpp v51, v20, v9 row_newbcast:12 row_mask:0xf bank_mask:0xf
  s_nop 1
  v_mfma_f32_16x16x32_bf16 v[36:39], v[48:51], v[60:63], v[36:39]
  s_waitcnt vmcnt(6)
  buffer_load_dwordx4 v[60:63], v1, s[8:11], s33 offen offset:1024 nt
  v_and_b32_dpp v52, v20, v6 row_newbcast:13 row_mask:0xf bank_mask:0xf
  v_and_b32_dpp v53, v20, v7 row_newbcast:13 row_mask:0xf bank_mask:0xf
  v_and_b32_dpp v54, v20, v8 row_newbcast:13 row_mask:0xf bank_mask:0xf
  v_and_b32_dpp v55, v20, v9 row_newbcast:13 row_mask:0xf bank_mask:0xf
  s_nop 1
  v_mfma_f32_16x16x32_bf16 v[36:39], v[52:55], v[64:67], v[36:39]
  s_waitcnt vmcnt(6)
  buffer_load_dwordx4 v[64:67], v1, s[8:11], s33 offen offset:1280 nt
  v_and_b32_dpp v48, v20, v6 row_newbcast:14 row_mask:0xf bank_mask:0xf
  v_and_b32_dpp v49, v20, v7 row_newbcast:14 row_mask:0xf bank_mask:0xf
  v_and_b32_dpp v50, v20, v8 row_newbcast:14 row_mask:0xf bank_mask:0xf
  v_and_b32_dpp v51, v20, v9 row_newbcast:14 row_mask:0xf bank_mask:0xf
  s_nop 1
  v_mfma_f32_16x16x32_bf16 v[36:39], v[48:51], v[68:71], v[36:39]
  s_waitcnt vmcnt(6)
  buffer_load_dwordx4 v[68:71], v1, s[8:11], s33 offen offset:1536 nt
  v_and_b32_dpp v52, v20, v6 row_newbcast:15 row_mask:0xf bank_mask:0xf
  v_and_b32_dpp v53, v20, v7 row_newbcast:15 row_mask:0xf bank_mask:0xf
  v_and_b32_dpp v54, v20, v8 row_newbcast:15 row_mask:0xf bank_mask:0xf
  v_and_b32_dpp v55, v20, v9 row_newbcast:15 row_mask:0xf bank_mask:0xf
  s_nop 1
  v_mfma_f32_16x16x32_bf16 v[36:39], v[52:55], v[72:75], v[36:39]
  s_waitcnt vmcnt(6)
  buffer_load_dwordx4 v[72:75], v1, s[8:11], s33 offen offset:1792 nt
  v_and_b32_dpp v48, v21, v6 row_newbcast:0 row_mask:0xf bank_mask:0xf
  v_and_b32_dpp v49, v21, v7 row_newbcast:0 row_mask:0xf bank_mask:0xf
  v_and_b32_dpp v50, v21, v8 row_newbcast:0 row_mask:0xf bank_mask:0xf
  v_and_b32_dpp v51, v21, v9 row_newbcast:0 row_mask:0xf bank_mask:0xf
  s_nop 1
  v_mfma_f32_16x16x32_bf16 v[36:39], v[48:51], v[76:79], v[36:39]
  s_waitcnt vmcnt(6)
  buffer_load_dwordx4 v[76:79], v1, s[8:11], s33 offen offset:2048 nt
  v_and_b32_dpp v52, v21, v6 row_newbcast:1 row_mask:0xf bank_mask:0xf
  v_and_b32_dpp v53, v21, v7 row_newbcast:1 row_mask:0xf bank_mask:0xf
  v_and_b32_dpp v54, v21, v8 row_newbcast:1 row_mask:0xf bank_mask:0xf
  v_and_b32_dpp v55, v21, v9 row_newbcast:1 row_mask:0xf bank_mask:0xf
  s_nop 1
  v_mfma_f32_16x16x32_bf16 v[36:39], v[52:55], v[80:83], v[36:39]
  s_waitcnt vmcnt(6)
  buffer_load_dwordx4 v[80:83], v1, s[8:11], s33 offen offset:2304 nt
  v_and_b32_dpp v48, v21, v6 row_newbcast:2 row_mask:0xf bank_mask:0xf
  v_and_b32_dpp v49, v21, v7 row_newbcast:2 row_mask:0xf bank_mask:0xf
  v_and_b32_dpp v50, v21, v8 row_newbcast:2 row_mask:0xf bank_mask:0xf
  v_and_b32_dpp v51, v21, v9 row_newbcast:2 row_mask:0xf bank_mask:0xf
  s_nop 1
  v_mfma_f32_16x16x32_bf16 v[36:39], v[48:51], v[84:87], v[36:39]
  s_waitcnt vmcnt(6)
  buffer_load_dwordx4 v[84:87], v1, s[8:11], s33 offen offset:2560 nt
  v_and_b32_dpp v52, v21, v6 row_newbcast:3 row_mask:0xf bank_mask:0xf
  v_and_b32_dpp v53, v21, v7 row_newbcast:3 row_mask:0xf bank_mask:0xf
  v_and_b32_dpp v54, v21, v8 row_newbcast:3 row_mask:0xf bank_mask:0xf
  v_and_b32_dpp v55, v21, v9 row_newbcast:3 row_mask:0xf bank_mask:0xf
  s_nop 1
  v_mfma_f32_16x16x32_bf16 v[36:39], v[52:55], v[88:91], v[36:39]
  s_waitcnt vmcnt(6)
  buffer_load_dwordx4 v[88:91], v1, s[8:11], s33 offen offset:2816 nt
  v_and_b32_dpp v48, v21, v6 row_newbcast:4 row_mask:0xf bank_mask:0xf
  v_and_b32_dpp v49, v21, v7 row_newbcast:4 row_mask:0xf bank_mask:0xf
  v_and_b32_dpp v50, v21, v8 row_newbcast:4 row_mask:0xf bank_mask:0xf
  v_and_b32_dpp v51, v21, v9 row_newbcast:4 row_mask:0xf bank_mask:0xf
  s_nop 1
  v_mfma_f32_16x16x32_bf16 v[36:39], v[48:51], v[60:63], v[36:39]
  s_waitcnt vmcnt(6)
  buffer_load_dwordx4 v[60:63], v1, s[8:11], s33 offen offset:3072 nt
  v_and_b32_dpp v52, v21, v6 row_newbcast:5 row_mask:0xf bank_mask:0xf
  v_and_b32_dpp v53, v21, v7 row_newbcast:5 row_mask:0xf bank_mask:0xf
  v_and_b32_dpp v54, v21, v8 row_newbcast:5 row_mask:0xf bank_mask:0xf
  v_and_b32_dpp v55, v21, v9 row_newbcast:5 row_mask:0xf bank_mask:0xf
  s_nop 1
  v_mfma_f32_16x16x32_bf16 v[36:39], v[52:55], v[64:67], v[36:39]
  s_waitcnt vmcnt(6)
  buffer_load_dwordx4 v[64:67], v1, s[8:11], s33 offen offset:3328 nt
  v_and_b32_dpp v48, v21, v6 row_newbcast:6 row_mask:0xf bank_mask:0xf
  v_and_b32_dpp v49, v21, v7 row_newbcast:6 row_mask:0xf bank_mask:0xf
  v_and_b32_dpp v50, v21, v8 row_newbcast:6 row_mask:0xf bank_mask:0xf
  v_and_b32_dpp v51, v21, v9 row_newbcast:6 row_mask:0xf bank_mask:0xf
  s_nop 1
  v_mfma_f32_16x16x32_bf16 v[36:39], v[48:51], v[68:71], v[36:39]
  s_waitcnt vmcnt(6)
  buffer_load_dwordx4 v[68:71], v1, s[8:11], s33 offen offset:3584 nt
  v_and_b32_dpp v52, v21, v6 row_newbcast:7 row_mask:0xf bank_mask:0xf
  v_and_b32_dpp v53, v21, v7 row_newbcast:7 row_mask:0xf bank_mask:0xf
  v_and_b32_dpp v54, v21, v8 row_newbcast:7 row_mask:0xf bank_mask:0xf
  v_and_b32_dpp v55, v21, v9 row_newbcast:7 row_mask:0xf bank_mask:0xf
  s_nop 1
  v_mfma_f32_16x16x32_bf16 v[36:39], v[52:55], v[72:75], v[36:39]
  s_waitcnt vmcnt(6)
  buffer_load_dwordx4 v[72:75], v1, s[8:11], s33 offen offset:3840 nt
  v_and_b32_dpp v48, v21, v6 row_newbcast:8 row_mask:0xf bank_mask:0xf
  v_and_b32_dpp v49, v21, v7 row_newbcast:8 row_mask:0xf bank_mask:0xf
  v_and_b32_dpp v50, v21, v8 row_newbcast:8 row_mask:0xf bank_mask:0xf
  v_and_b32_dpp v51, v21, v9 row_newbcast:8 row_mask:0xf bank_mask:0xf
  s_nop 1
  v_mfma_f32_16x16x32_bf16 v[36:39], v[48:51], v[76:79], v[36:39]
  s_waitcnt vmcnt(6)
  s_add_u32 s33, s29, 393216
  buffer_load_dwordx4 v[76:79], v1, s[8:11], s33 offen offset:0 nt
  v_and_b32_dpp v52, v21, v6 row_newbcast:9 row_mask:0xf bank_mask:0xf
  v_and_b32_dpp v53, v21, v7 row_newbcast:9 row_mask:0xf bank_mask:0xf
  v_and_b32_dpp v54, v21, v8 row_newbcast:9 row_mask:0xf bank_mask:0xf
  v_and_b32_dpp v55, v21, v9 row_newbcast:9 row_mask:0xf bank_mask:0xf
  s_nop 1
  v_mfma_f32_16x16x32_bf16 v[36:39], v[52:55], v[80:83], v[36:39]
  s_waitcnt vmcnt(6)
  buffer_load_dwordx4 v[80:83], v1, s[8:11], s33 offen offset:256 nt
  v_and_b32_dpp v48, v21, v6 row_newbcast:10 row_mask:0xf bank_mask:0xf
  v_and_b32_dpp v49, v21, v7 row_newbcast:10 row_mask:0xf bank_mask:0xf
  v_and_b32_dpp v50, v21, v8 row_newbcast:10 row_mask:0xf bank_mask:0xf
  v_and_b32_dpp v51, v21, v9 row_newbcast:10 row_mask:0xf bank_mask:0xf
  s_nop 1
  v_mfma_f32_16x16x32_bf16 v[36:39], v[48:51], v[84:87], v[36:39]
  s_waitcnt vmcnt(6)
  buffer_load_dwordx4 v[84:87], v1, s[8:11], s33 offen offset:512 nt
  v_and_b32_dpp v52, v21, v6 row_newbcast:11 row_mask:0xf bank_mask:0xf
  v_and_b32_dpp v53, v21, v7 row_newbcast:11 row_mask:0xf bank_mask:0xf
  v_and_b32_dpp v54, v21, v8 row_newbcast:11 row_mask:0xf bank_mask:0xf
  v_and_b32_dpp v55, v21, v9 row_newbcast:11 row_mask:0xf bank_mask:0xf
  s_nop 1
  v_mfma_f32_16x16x32_bf16 v[36:39], v[52:55], v[88:91], v[36:39]
  s_waitcnt vmcnt(6)
  buffer_load_dwordx4 v[88:91], v1, s[8:11], s33 offen offset:768 nt
  v_and_b32_dpp v48, v21, v6 row_newbcast:12 row_mask:0xf bank_mask:0xf
  v_and_b32_dpp v49, v21, v7 row_newbcast:12 row_mask:0xf bank_mask:0xf
  v_and_b32_dpp v50, v21, v8 row_newbcast:12 row_mask:0xf bank_mask:0xf
  v_and_b32_dpp v51, v21, v9 row_newbcast:12 row_mask:0xf bank_mask:0xf
  s_nop 1
  v_mfma_f32_16x16x32_bf16 v[36:39], v[48:51], v[60:63], v[36:39]
  s_waitcnt vmcnt(6)
  buffer_load_dwordx4 v[60:63], v1, s[8:11], s33 offen offset:1024 nt
  v_and_b32_dpp v52, v21, v6 row_newbcast:13 row_mask:0xf bank_mask:0xf
  v_and_b32_dpp v53, v21, v7 row_newbcast:13 row_mask:0xf bank_mask:0xf
  v_and_b32_dpp v54, v21, v8 row_newbcast:13 row_mask:0xf bank_mask:0xf
  v_and_b32_dpp v55, v21, v9 row_newbcast:13 row_mask:0xf bank_mask:0xf
  s_nop 1
  v_mfma_f32_16x16x32_bf16 v[36:39], v[52:55], v[64:67], v[36:39]
  s_waitcnt vmcnt(6)
  buffer_load_dwordx4 v[64:67], v1, s[8:11], s33 offen offset:1280 nt
  v_and_b32_dpp v48, v21, v6 row_newbcast:14 row_mask:0xf bank_mask:0xf
  v_and_b32_dpp v49, v21, v7 row_newbcast:14 row_mask:0xf bank_mask:0xf
  v_and_b32_dpp v50, v21, v8 row_newbcast:14 row_mask:0xf bank_mask:0xf
  v_and_b32_dpp v51, v21, v9 row_newbcast:14 row_mask:0xf bank_mask:0xf
  s_nop 1
  v_mfma_f32_16x16x32_bf16 v[36:39], v[48:51], v[68:71], v[36:39]
  s_waitcnt vmcnt(6)
  buffer_load_dwordx4 v[68:71], v1, s[8:11], s33 offen offset:1536 nt
  v_and_b32_dpp v52, v21, v6 row_newbcast:15 row_mask:0xf bank_mask:0xf
  v_and_b32_dpp v53, v21, v7 row_newbcast:15 row_mask:0xf bank_mask:0xf
  v_and_b32_dpp v54, v21, v8 row_newbcast:15 row_mask:0xf bank_mask:0xf
  v_and_b32_dpp v55, v21, v9 row_newbcast:15 row_mask:0xf bank_mask:0xf
  s_nop 1
  v_mfma_f32_16x16x32_bf16 v[36:39], v[52:55], v[72:75], v[36:39]
  s_waitcnt vmcnt(6)
  buffer_load_dwordx4 v[72:75], v1, s[8:11], s33 offen offset:1792 nt
  v_and_b32_dpp v48, v22, v6 row_newbcast:0 row_mask:0xf bank_mask:0xf
  v_and_b32_dpp v49, v22, v7 row_newbcast:0 row_mask:0xf bank_mask:0xf
  v_and_b32_dpp v50, v22, v8 row_newbcast:0 row_mask:0xf bank_mask:0xf
  v_and_b32_dpp v51, v22, v9 row_newbcast:0 row_mask:0xf bank_mask:0xf
  s_nop 1
  v_mfma_f32_16x16x32_bf16 v[36:39], v[48:51], v[76:79], v[36:39]
  s_waitcnt vmcnt(6)
  buffer_load_dwordx4 v[76:79], v1, s[8:11], s33 offen offset:2048 nt
  v_and_b32_dpp v52, v22, v6 row_newbcast:1 row_mask:0xf bank_mask:0xf
  v_and_b32_dpp v53, v22, v7 row_newbcast:1 row_mask:0xf bank_mask:0xf
  v_and_b32_dpp v54, v22, v8 row_newbcast:1 row_mask:0xf bank_mask:0xf
  v_and_b32_dpp v55, v22, v9 row_newbcast:1 row_mask:0xf bank_mask:0xf
  s_nop 1
  v_mfma_f32_16x16x32_bf16 v[36:39], v[52:55], v[80:83], v[36:39]
  s_waitcnt vmcnt(6)
  buffer_load_dwordx4 v[80:83], v1, s[8:11], s33 offen offset:2304 nt
  v_and_b32_dpp v48, v22, v6 row_newbcast:2 row_mask:0xf bank_mask:0xf
  v_and_b32_dpp v49, v22, v7 row_newbcast:2 row_mask:0xf bank_mask:0xf
  v_and_b32_dpp v50, v22, v8 row_newbcast:2 row_mask:0xf bank_mask:0xf
  v_and_b32_dpp v51, v22, v9 row_newbcast:2 row_mask:0xf bank_mask:0xf
  s_nop 1
  v_mfma_f32_16x16x32_bf16 v[36:39], v[48:51], v[84:87], v[36:39]
  s_waitcnt vmcnt(6)
  buffer_load_dwordx4 v[84:87], v1, s[8:11], s33 offen offset:2560 nt
  v_and_b32_dpp v52, v22, v6 row_newbcast:3 row_mask:0xf bank_mask:0xf
  v_and_b32_dpp v53, v22, v7 row_newbcast:3 row_mask:0xf bank_mask:0xf
  v_and_b32_dpp v54, v22, v8 row_newbcast:3 row_mask:0xf bank_mask:0xf
  v_and_b32_dpp v55, v22, v9 row_newbcast:3 row_mask:0xf bank_mask:0xf
  s_nop 1
  v_mfma_f32_16x16x32_bf16 v[36:39], v[52:55], v[88:91], v[36:39]
  s_waitcnt vmcnt(6)
  buffer_load_dwordx4 v[88:91], v1, s[8:11], s33 offen offset:2816 nt
  v_and_b32_dpp v48, v22, v6 row_newbcast:4 row_mask:0xf bank_mask:0xf
  v_and_b32_dpp v49, v22, v7 row_newbcast:4 row_mask:0xf bank_mask:0xf
  v_and_b32_dpp v50, v22, v8 row_newbcast:4 row_mask:0xf bank_mask:0xf
  v_and_b32_dpp v51, v22, v9 row_newbcast:4 row_mask:0xf bank_mask:0xf
  s_nop 1
  v_mfma_f32_16x16x32_bf16 v[36:39], v[48:51], v[60:63], v[36:39]
  s_waitcnt vmcnt(6)
  buffer_load_dwordx4 v[60:63], v1, s[8:11], s33 offen offset:3072 nt
  v_and_b32_dpp v52, v22, v6 row_newbcast:5 row_mask:0xf bank_mask:0xf
  v_and_b32_dpp v53, v22, v7 row_newbcast:5 row_mask:0xf bank_mask:0xf
  v_and_b32_dpp v54, v22, v8 row_newbcast:5 row_mask:0xf bank_mask:0xf
  v_and_b32_dpp v55, v22, v9 row_newbcast:5 row_mask:0xf bank_mask:0xf
  s_nop 1
  v_mfma_f32_16x16x32_bf16 v[36:39], v[52:55], v[64:67], v[36:39]
  s_waitcnt vmcnt(6)
  buffer_load_dwordx4 v[64:67], v1, s[8:11], s33 offen offset:3328 nt
  v_and_b32_dpp v48, v22, v6 row_newbcast:6 row_mask:0xf bank_mask:0xf
  v_and_b32_dpp v49, v22, v7 row_newbcast:6 row_mask:0xf bank_mask:0xf
  v_and_b32_dpp v50, v22, v8 row_newbcast:6 row_mask:0xf bank_mask:0xf
  v_and_b32_dpp v51, v22, v9 row_newbcast:6 row_mask:0xf bank_mask:0xf
  s_nop 1
  v_mfma_f32_16x16x32_bf16 v[36:39], v[48:51], v[68:71], v[36:39]
  s_waitcnt vmcnt(6)
  buffer_load_dwordx4 v[68:71], v1, s[8:11], s33 offen offset:3584 nt
  v_and_b32_dpp v52, v22, v6 row_newbcast:7 row_mask:0xf bank_mask:0xf
  v_and_b32_dpp v53, v22, v7 row_newbcast:7 row_mask:0xf bank_mask:0xf
  v_and_b32_dpp v54, v22, v8 row_newbcast:7 row_mask:0xf bank_mask:0xf
  v_and_b32_dpp v55, v22, v9 row_newbcast:7 row_mask:0xf bank_mask:0xf
  s_nop 1
  v_mfma_f32_16x16x32_bf16 v[36:39], v[52:55], v[72:75], v[36:39]
  s_waitcnt vmcnt(6)
  buffer_load_dwordx4 v[72:75], v1, s[8:11], s33 offen offset:3840 nt
  v_and_b32_dpp v48, v22, v6 row_newbcast:8 row_mask:0xf bank_mask:0xf
  v_and_b32_dpp v49, v22, v7 row_newbcast:8 row_mask:0xf bank_mask:0xf
  v_and_b32_dpp v50, v22, v8 row_newbcast:8 row_mask:0xf bank_mask:0xf
  v_and_b32_dpp v51, v22, v9 row_newbcast:8 row_mask:0xf bank_mask:0xf
  s_nop 1
  v_mfma_f32_16x16x32_bf16 v[36:39], v[48:51], v[76:79], v[36:39]
  s_waitcnt vmcnt(6)
  s_add_u32 s33, s29, 458752
  buffer_load_dwordx4 v[76:79], v1, s[8:11], s33 offen offset:0 nt
  v_and_b32_dpp v52, v22, v6 row_newbcast:9 row_mask:0xf bank_mask:0xf
  v_and_b32_dpp v53, v22, v7 row_newbcast:9 row_mask:0xf bank_mask:0xf
  v_and_b32_dpp v54, v22, v8 row_newbcast:9 row_mask:0xf bank_mask:0xf
  v_and_b32_dpp v55, v22, v9 row_newbcast:9 row_mask:0xf bank_mask:0xf
  s_nop 1
  v_mfma_f32_16x16x32_bf16 v[36:39], v[52:55], v[80:83], v[36:39]
  s_waitcnt vmcnt(6)
  buffer_load_dwordx4 v[80:83], v1, s[8:11], s33 offen offset:256 nt
  v_and_b32_dpp v48, v22, v6 row_newbcast:10 row_mask:0xf bank_mask:0xf
  v_and_b32_dpp v49, v22, v7 row_newbcast:10 row_mask:0xf bank_mask:0xf
  v_and_b32_dpp v50, v22, v8 row_newbcast:10 row_mask:0xf bank_mask:0xf
  v_and_b32_dpp v51, v22, v9 row_newbcast:10 row_mask:0xf bank_mask:0xf
  s_nop 1
  v_mfma_f32_16x16x32_bf16 v[36:39], v[48:51], v[84:87], v[36:39]
  s_waitcnt vmcnt(6)
  buffer_load_dwordx4 v[84:87], v1, s[8:11], s33 offen offset:512 nt
  v_and_b32_dpp v52, v22, v6 row_newbcast:11 row_mask:0xf bank_mask:0xf
  v_and_b32_dpp v53, v22, v7 row_newbcast:11 row_mask:0xf bank_mask:0xf
  v_and_b32_dpp v54, v22, v8 row_newbcast:11 row_mask:0xf bank_mask:0xf
  v_and_b32_dpp v55, v22, v9 row_newbcast:11 row_mask:0xf bank_mask:0xf
  s_nop 1
  v_mfma_f32_16x16x32_bf16 v[36:39], v[52:55], v[88:91], v[36:39]
  s_waitcnt vmcnt(6)
  buffer_load_dwordx4 v[88:91], v1, s[8:11], s33 offen offset:768 nt
  v_and_b32_dpp v48, v22, v6 row_newbcast:12 row_mask:0xf bank_mask:0xf
  v_and_b32_dpp v49, v22, v7 row_newbcast:12 row_mask:0xf bank_mask:0xf
  v_and_b32_dpp v50, v22, v8 row_newbcast:12 row_mask:0xf bank_mask:0xf
  v_and_b32_dpp v51, v22, v9 row_newbcast:12 row_mask:0xf bank_mask:0xf
  s_nop 1
  v_mfma_f32_16x16x32_bf16 v[36:39], v[48:51], v[60:63], v[36:39]
  s_waitcnt vmcnt(6)
  buffer_load_dwordx4 v[60:63], v1, s[8:11], s33 offen offset:1024 nt
  v_and_b32_dpp v52, v22, v6 row_newbcast:13 row_mask:0xf bank_mask:0xf
  v_and_b32_dpp v53, v22, v7 row_newbcast:13 row_mask:0xf bank_mask:0xf
  v_and_b32_dpp v54, v22, v8 row_newbcast:13 row_mask:0xf bank_mask:0xf
  v_and_b32_dpp v55, v22, v9 row_newbcast:13 row_mask:0xf bank_mask:0xf
  s_nop 1
  v_mfma_f32_16x16x32_bf16 v[36:39], v[52:55], v[64:67], v[36:39]
  s_waitcnt vmcnt(6)
  buffer_load_dwordx4 v[64:67], v1, s[8:11], s33 offen offset:1280 nt
  v_and_b32_dpp v48, v22, v6 row_newbcast:14 row_mask:0xf bank_mask:0xf
  v_and_b32_dpp v49, v22, v7 row_newbcast:14 row_mask:0xf bank_mask:0xf
  v_and_b32_dpp v50, v22, v8 row_newbcast:14 row_mask:0xf bank_mask:0xf
  v_and_b32_dpp v51, v22, v9 row_newbcast:14 row_mask:0xf bank_mask:0xf
  s_nop 1
  v_mfma_f32_16x16x32_bf16 v[36:39], v[48:51], v[68:71], v[36:39]
  s_waitcnt vmcnt(6)
  buffer_load_dwordx4 v[68:71], v1, s[8:11], s33 offen offset:1536 nt
  v_and_b32_dpp v52, v22, v6 row_newbcast:15 row_mask:0xf bank_mask:0xf
  v_and_b32_dpp v53, v22, v7 row_newbcast:15 row_mask:0xf bank_mask:0xf
  v_and_b32_dpp v54, v22, v8 row_newbcast:15 row_mask:0xf bank_mask:0xf
  v_and_b32_dpp v55, v22, v9 row_newbcast:15 row_mask:0xf bank_mask:0xf
  s_nop 1
  v_mfma_f32_16x16x32_bf16 v[36:39], v[52:55], v[72:75], v[36:39]
  s_waitcnt vmcnt(6)
  buffer_load_dwordx4 v[72:75], v1, s[8:11], s33 offen offset:1792 nt
  v_and_b32_dpp v48, v23, v6 row_newbcast:0 row_mask:0xf bank_mask:0xf
  v_and_b32_dpp v49, v23, v7 row_newbcast:0 row_mask:0xf bank_mask:0xf
  v_and_b32_dpp v50, v23, v8 row_newbcast:0 row_mask:0xf bank_mask:0xf
  v_and_b32_dpp v51, v23, v9 row_newbcast:0 row_mask:0xf bank_mask:0xf
  s_nop 1
  v_mfma_f32_16x16x32_bf16 v[36:39], v[48:51], v[76:79], v[36:39]
  s_waitcnt vmcnt(6)
  buffer_load_dwordx4 v[76:79], v1, s[8:11], s33 offen offset:2048 nt
  v_and_b32_dpp v52, v23, v6 row_newbcast:1 row_mask:0xf bank_mask:0xf
  v_and_b32_dpp v53, v23, v7 row_newbcast:1 row_mask:0xf bank_mask:0xf
  v_and_b32_dpp v54, v23, v8 row_newbcast:1 row_mask:0xf bank_mask:0xf
  v_and_b32_dpp v55, v23, v9 row_newbcast:1 row_mask:0xf bank_mask:0xf
  s_nop 1
  v_mfma_f32_16x16x32_bf16 v[36:39], v[52:55], v[80:83], v[36:39]
  s_waitcnt vmcnt(6)
  buffer_load_dwordx4 v[80:83], v1, s[8:11], s33 offen offset:2304 nt
  v_and_b32_dpp v48, v23, v6 row_newbcast:2 row_mask:0xf bank_mask:0xf
  v_and_b32_dpp v49, v23, v7 row_newbcast:2 row_mask:0xf bank_mask:0xf
  v_and_b32_dpp v50, v23, v8 row_newbcast:2 row_mask:0xf bank_mask:0xf
  v_and_b32_dpp v51, v23, v9 row_newbcast:2 row_mask:0xf bank_mask:0xf
  s_nop 1
  v_mfma_f32_16x16x32_bf16 v[36:39], v[48:51], v[84:87], v[36:39]
  s_waitcnt vmcnt(6)
  buffer_load_dwordx4 v[84:87], v1, s[8:11], s33 offen offset:2560 nt
  v_and_b32_dpp v52, v23, v6 row_newbcast:3 row_mask:0xf bank_mask:0xf
  v_and_b32_dpp v53, v23, v7 row_newbcast:3 row_mask:0xf bank_mask:0xf
  v_and_b32_dpp v54, v23, v8 row_newbcast:3 row_mask:0xf bank_mask:0xf
  v_and_b32_dpp v55, v23, v9 row_newbcast:3 row_mask:0xf bank_mask:0xf
  s_nop 1
  v_mfma_f32_16x16x32_bf16 v[36:39], v[52:55], v[88:91], v[36:39]
  s_waitcnt vmcnt(6)
  buffer_load_dwordx4 v[88:91], v1, s[8:11], s33 offen offset:2816 nt
  v_and_b32_dpp v48, v23, v6 row_newbcast:4 row_mask:0xf bank_mask:0xf
  v_and_b32_dpp v49, v23, v7 row_newbcast:4 row_mask:0xf bank_mask:0xf
  v_and_b32_dpp v50, v23, v8 row_newbcast:4 row_mask:0xf bank_mask:0xf
  v_and_b32_dpp v51, v23, v9 row_newbcast:4 row_mask:0xf bank_mask:0xf
  s_nop 1
  v_mfma_f32_16x16x32_bf16 v[36:39], v[48:51], v[60:63], v[36:39]
  s_waitcnt vmcnt(6)
  buffer_load_dwordx4 v[60:63], v1, s[8:11], s33 offen offset:3072 nt
  v_and_b32_dpp v52, v23, v6 row_newbcast:5 row_mask:0xf bank_mask:0xf
  v_and_b32_dpp v53, v23, v7 row_newbcast:5 row_mask:0xf bank_mask:0xf
  v_and_b32_dpp v54, v23, v8 row_newbcast:5 row_mask:0xf bank_mask:0xf
  v_and_b32_dpp v55, v23, v9 row_newbcast:5 row_mask:0xf bank_mask:0xf
  s_nop 1
  v_mfma_f32_16x16x32_bf16 v[36:39], v[52:55], v[64:67], v[36:39]
  s_waitcnt vmcnt(6)
  buffer_load_dwordx4 v[64:67], v1, s[8:11], s33 offen offset:3328 nt
  v_and_b32_dpp v48, v23, v6 row_newbcast:6 row_mask:0xf bank_mask:0xf
  v_and_b32_dpp v49, v23, v7 row_newbcast:6 row_mask:0xf bank_mask:0xf
  v_and_b32_dpp v50, v23, v8 row_newbcast:6 row_mask:0xf bank_mask:0xf
  v_and_b32_dpp v51, v23, v9 row_newbcast:6 row_mask:0xf bank_mask:0xf
  s_nop 1
  v_mfma_f32_16x16x32_bf16 v[36:39], v[48:51], v[68:71], v[36:39]
  s_waitcnt vmcnt(6)
  buffer_load_dwordx4 v[68:71], v1, s[8:11], s33 offen offset:3584 nt
  v_and_b32_dpp v52, v23, v6 row_newbcast:7 row_mask:0xf bank_mask:0xf
  v_and_b32_dpp v53, v23, v7 row_newbcast:7 row_mask:0xf bank_mask:0xf
  v_and_b32_dpp v54, v23, v8 row_newbcast:7 row_mask:0xf bank_mask:0xf
  v_and_b32_dpp v55, v23, v9 row_newbcast:7 row_mask:0xf bank_mask:0xf
  s_nop 1
  v_mfma_f32_16x16x32_bf16 v[36:39], v[52:55], v[72:75], v[36:39]
  s_waitcnt vmcnt(6)
  buffer_load_dwordx4 v[72:75], v1, s[8:11], s33 offen offset:3840 nt
  v_and_b32_dpp v48, v23, v6 row_newbcast:8 row_mask:0xf bank_mask:0xf
  v_and_b32_dpp v49, v23, v7 row_newbcast:8 row_mask:0xf bank_mask:0xf
  v_and_b32_dpp v50, v23, v8 row_newbcast:8 row_mask:0xf bank_mask:0xf
  v_and_b32_dpp v51, v23, v9 row_newbcast:8 row_mask:0xf bank_mask:0xf
  s_nop 1
  v_mfma_f32_16x16x32_bf16 v[36:39], v[48:51], v[76:79], v[36:39]
  s_waitcnt vmcnt(6)
  s_add_u32 s33, s29, 532480
  buffer_load_dwordx4 v[76:79], v2, s[8:11], s33 offen offset:0 nt
  v_and_b32_dpp v52, v23, v6 row_newbcast:9 row_mask:0xf bank_mask:0xf
  v_and_b32_dpp v53, v23, v7 row_newbcast:9 row_mask:0xf bank_mask:0xf
  v_and_b32_dpp v54, v23, v8 row_newbcast:9 row_mask:0xf bank_mask:0xf
  v_and_b32_dpp v55, v23, v9 row_newbcast:9 row_mask:0xf bank_mask:0xf
  s_nop 1
  v_mfma_f32_16x16x32_bf16 v[36:39], v[52:55], v[80:83], v[36:39]
  s_waitcnt vmcnt(6)
  buffer_load_dwordx4 v[80:83], v2, s[8:11], s33 offen offset:256 nt
  v_and_b32_dpp v48, v23, v6 row_newbcast:10 row_mask:0xf bank_mask:0xf
  v_and_b32_dpp v49, v23, v7 row_newbcast:10 row_mask:0xf bank_mask:0xf
  v_and_b32_dpp v50, v23, v8 row_newbcast:10 row_mask:0xf bank_mask:0xf
  v_and_b32_dpp v51, v23, v9 row_newbcast:10 row_mask:0xf bank_mask:0xf
  s_nop 1
  v_mfma_f32_16x16x32_bf16 v[36:39], v[48:51], v[84:87], v[36:39]
  s_waitcnt vmcnt(6)
  buffer_load_dwordx4 v[84:87], v2, s[8:11], s33 offen offset:512 nt
  v_and_b32_dpp v52, v23, v6 row_newbcast:11 row_mask:0xf bank_mask:0xf
  v_and_b32_dpp v53, v23, v7 row_newbcast:11 row_mask:0xf bank_mask:0xf
  v_and_b32_dpp v54, v23, v8 row_newbcast:11 row_mask:0xf bank_mask:0xf
  v_and_b32_dpp v55, v23, v9 row_newbcast:11 row_mask:0xf bank_mask:0xf
  s_nop 1
  v_mfma_f32_16x16x32_bf16 v[36:39], v[52:55], v[88:91], v[36:39]
  s_waitcnt vmcnt(6)
  buffer_load_dwordx4 v[88:91], v2, s[8:11], s33 offen offset:768 nt
  v_and_b32_dpp v48, v23, v6 row_newbcast:12 row_mask:0xf bank_mask:0xf
  v_and_b32_dpp v49, v23, v7 row_newbcast:12 row_mask:0xf bank_mask:0xf
  v_and_b32_dpp v50, v23, v8 row_newbcast:12 row_mask:0xf bank_mask:0xf
  v_and_b32_dpp v51, v23, v9 row_newbcast:12 row_mask:0xf bank_mask:0xf
  s_nop 1
  v_mfma_f32_16x16x32_bf16 v[36:39], v[48:51], v[60:63], v[36:39]
  s_waitcnt vmcnt(6)
  buffer_load_dwordx4 v[60:63], v2, s[8:11], s33 offen offset:1024 nt
  v_and_b32_dpp v52, v23, v6 row_newbcast:13 row_mask:0xf bank_mask:0xf
  v_and_b32_dpp v53, v23, v7 row_newbcast:13 row_mask:0xf bank_mask:0xf
  v_and_b32_dpp v54, v23, v8 row_newbcast:13 row_mask:0xf bank_mask:0xf
  v_and_b32_dpp v55, v23, v9 row_newbcast:13 row_mask:0xf bank_mask:0xf
  s_nop 1
  v_mfma_f32_16x16x32_bf16 v[36:39], v[52:55], v[64:67], v[36:39]
  s_waitcnt vmcnt(6)
  buffer_load_dwordx4 v[64:67], v2, s[8:11], s33 offen offset:1280 nt
  v_and_b32_dpp v48, v23, v6 row_newbcast:14 row_mask:0xf bank_mask:0xf
  v_and_b32_dpp v49, v23, v7 row_newbcast:14 row_mask:0xf bank_mask:0xf
  v_and_b32_dpp v50, v23, v8 row_newbcast:14 row_mask:0xf bank_mask:0xf
  v_and_b32_dpp v51, v23, v9 row_newbcast:14 row_mask:0xf bank_mask:0xf
  s_nop 1
  v_mfma_f32_16x16x32_bf16 v[36:39], v[48:51], v[68:71], v[36:39]
  s_waitcnt vmcnt(6)
  buffer_load_dwordx4 v[68:71], v2, s[8:11], s33 offen offset:1536 nt
  v_and_b32_dpp v52, v23, v6 row_newbcast:15 row_mask:0xf bank_mask:0xf
  v_and_b32_dpp v53, v23, v7 row_newbcast:15 row_mask:0xf bank_mask:0xf
  v_and_b32_dpp v54, v23, v8 row_newbcast:15 row_mask:0xf bank_mask:0xf
  v_and_b32_dpp v55, v23, v9 row_newbcast:15 row_mask:0xf bank_mask:0xf
  s_nop 1
  v_mfma_f32_16x16x32_bf16 v[36:39], v[52:55], v[72:75], v[36:39]
  s_waitcnt vmcnt(6)
  buffer_load_dwordx4 v[72:75], v2, s[8:11], s33 offen offset:1792 nt
  v_and_b32_dpp v48, v24, v6 row_newbcast:0 row_mask:0xf bank_mask:0xf
  v_and_b32_dpp v49, v24, v7 row_newbcast:0 row_mask:0xf bank_mask:0xf
  v_and_b32_dpp v50, v24, v8 row_newbcast:0 row_mask:0xf bank_mask:0xf
  v_and_b32_dpp v51, v24, v9 row_newbcast:0 row_mask:0xf bank_mask:0xf
  s_nop 1
  v_mfma_f32_16x16x32_bf16 v[36:39], v[48:51], v[76:79], v[36:39]
  s_waitcnt vmcnt(6)
  s_mov_b32 s33, s31
  s_mov_b64 exec, s[42:43]
  buffer_load_dwordx4 v[76:79], v3, s[8:11], s33 offen offset:0 nt
  s_mov_b64 exec, -1
  v_and_b32_dpp v52, v24, v6 row_newbcast:1 row_mask:0xf bank_mask:0xf
  v_and_b32_dpp v53, v24, v7 row_newbcast:1 row_mask:0xf bank_mask:0xf
  v_and_b32_dpp v54, v24, v8 row_newbcast:1 row_mask:0xf bank_mask:0xf
  v_and_b32_dpp v55, v24, v9 row_newbcast:1 row_mask:0xf bank_mask:0xf
  s_nop 1
  v_mfma_f32_16x16x32_bf16 v[36:39], v[52:55], v[80:83], v[36:39]
  s_waitcnt vmcnt(6)
  s_mov_b64 exec, s[42:43]
  buffer_load_dwordx4 v[80:83], v3, s[8:11], s33 offen offset:1024 nt
  s_mov_b64 exec, -1
  v_and_b32_dpp v48, v24, v6 row_newbcast:2 row_mask:0xf bank_mask:0xf
  v_and_b32_dpp v49, v24, v7 row_newbcast:2 row_mask:0xf bank_mask:0xf
  v_and_b32_dpp v50, v24, v8 row_newbcast:2 row_mask:0xf bank_mask:0xf
  v_and_b32_dpp v51, v24, v9 row_newbcast:2 row_mask:0xf bank_mask:0xf
  s_nop 1
  v_mfma_f32_16x16x32_bf16 v[36:39], v[48:51], v[84:87], v[36:39]
  s_waitcnt vmcnt(6)
  s_mov_b64 exec, s[44:45]
  buffer_load_dwordx4 v[84:87], v3, s[8:11], s33 offen offset:2048 nt
  s_mov_b64 exec, -1
  v_and_b32_dpp v52, v24, v6 row_newbcast:3 row_mask:0xf bank_mask:0xf
  v_and_b32_dpp v53, v24, v7 row_newbcast:3 row_mask:0xf bank_mask:0xf
  v_and_b32_dpp v54, v24, v8 row_newbcast:3 row_mask:0xf bank_mask:0xf
  v_and_b32_dpp v55, v24, v9 row_newbcast:3 row_mask:0xf bank_mask:0xf
  s_nop 1
  v_mfma_f32_16x16x32_bf16 v[36:39], v[52:55], v[88:91], v[36:39]
  s_waitcnt vmcnt(6)
  s_mov_b64 exec, s[44:45]
  buffer_load_dwordx4 v[88:91], v3, s[8:11], s33 offen offset:3072 nt
  s_mov_b64 exec, -1
  v_and_b32_dpp v48, v24, v6 row_newbcast:4 row_mask:0xf bank_mask:0xf
  v_and_b32_dpp v49, v24, v7 row_newbcast:4 row_mask:0xf bank_mask:0xf
  v_and_b32_dpp v50, v24, v8 row_newbcast:4 row_mask:0xf bank_mask:0xf
  v_and_b32_dpp v51, v24, v9 row_newbcast:4 row_mask:0xf bank_mask:0xf
  s_nop 1
  v_mfma_f32_16x16x32_bf16 v[36:39], v[48:51], v[60:63], v[36:39]
  s_waitcnt vmcnt(6)
  v_and_b32_dpp v52, v24, v6 row_newbcast:5 row_mask:0xf bank_mask:0xf
  v_and_b32_dpp v53, v24, v7 row_newbcast:5 row_mask:0xf bank_mask:0xf
  v_and_b32_dpp v54, v24, v8 row_newbcast:5 row_mask:0xf bank_mask:0xf
  v_and_b32_dpp v55, v24, v9 row_newbcast:5 row_mask:0xf bank_mask:0xf
  s_nop 1
  v_mfma_f32_16x16x32_bf16 v[36:39], v[52:55], v[64:67], v[36:39]
  s_waitcnt vmcnt(5)
  v_and_b32_dpp v48, v24, v6 row_newbcast:6 row_mask:0xf bank_mask:0xf
  v_and_b32_dpp v49, v24, v7 row_newbcast:6 row_mask:0xf bank_mask:0xf
  v_and_b32_dpp v50, v24, v8 row_newbcast:6 row_mask:0xf bank_mask:0xf
  v_and_b32_dpp v51, v24, v9 row_newbcast:6 row_mask:0xf bank_mask:0xf
  s_nop 1
  v_mfma_f32_16x16x32_bf16 v[36:39], v[48:51], v[68:71], v[36:39]
  s_waitcnt vmcnt(4)
  v_and_b32_dpp v52, v24, v6 row_newbcast:7 row_mask:0xf bank_mask:0xf
  v_and_b32_dpp v53, v24, v7 row_newbcast:7 row_mask:0xf bank_mask:0xf
  v_and_b32_dpp v54, v24, v8 row_newbcast:7 row_mask:0xf bank_mask:0xf
  v_and_b32_dpp v55, v24, v9 row_newbcast:7 row_mask:0xf bank_mask:0xf
  s_nop 1
  v_mfma_f32_16x16x32_bf16 v[36:39], v[52:55], v[72:75], v[36:39]
  s_waitcnt vmcnt(3)
  v_and_b32_dpp v48, v25, v6 row_newbcast:0 row_mask:0xf bank_mask:0xf
  v_and_b32_dpp v49, v25, v7 row_newbcast:0 row_mask:0xf bank_mask:0xf
  v_and_b32_dpp v50, v25, v8 row_newbcast:0 row_mask:0xf bank_mask:0xf
  v_and_b32_dpp v51, v25, v9 row_newbcast:0 row_mask:0xf bank_mask:0xf
  s_nop 1
  v_mfma_f32_16x16x32_bf16 v[36:39], v[48:51], v[76:79], v[36:39]
  s_waitcnt vmcnt(2)
  v_and_b32_dpp v52, v25, v6 row_newbcast:1 row_mask:0xf bank_mask:0xf
  v_and_b32_dpp v53, v25, v7 row_newbcast:1 row_mask:0xf bank_mask:0xf
  v_and_b32_dpp v54, v25, v8 row_newbcast:1 row_mask:0xf bank_mask:0xf
  v_and_b32_dpp v55, v25, v9 row_newbcast:1 row_mask:0xf bank_mask:0xf
  s_nop 1
  v_mfma_f32_16x16x32_bf16 v[36:39], v[52:55], v[80:83], v[36:39]
  s_waitcnt vmcnt(1)
  v_and_b32_dpp v48, v25, v6 row_newbcast:2 row_mask:0xf bank_mask:0xf
  v_and_b32_dpp v49, v25, v7 row_newbcast:2 row_mask:0xf bank_mask:0xf
  v_and_b32_dpp v50, v25, v8 row_newbcast:2 row_mask:0xf bank_mask:0xf
  v_and_b32_dpp v51, v25, v9 row_newbcast:2 row_mask:0xf bank_mask:0xf
  s_nop 1
  v_mfma_f32_16x16x32_bf16 v[36:39], v[48:51], v[84:87], v[36:39]
  s_waitcnt vmcnt(0)
  v_and_b32_dpp v52, v25, v6 row_newbcast:3 row_mask:0xf bank_mask:0xf
  v_and_b32_dpp v53, v25, v7 row_newbcast:3 row_mask:0xf bank_mask:0xf
  v_and_b32_dpp v54, v25, v8 row_newbcast:3 row_mask:0xf bank_mask:0xf
  v_and_b32_dpp v55, v25, v9 row_newbcast:3 row_mask:0xf bank_mask:0xf
  s_nop 1
  v_mfma_f32_16x16x32_bf16 v[36:39], v[52:55], v[88:91], v[36:39]
  v_add_f32_dpp v11, v11, v11 row_ror:8 row_mask:0xf bank_mask:0xf
  s_nop 1
  v_add_f32_dpp v11, v11, v11 row_ror:4 row_mask:0xf bank_mask:0xf
  s_nop 1
  v_add_f32_dpp v11, v11, v11 row_ror:2 row_mask:0xf bank_mask:0xf
  s_nop 1
  v_add_f32_dpp v11, v11, v11 row_ror:1 row_mask:0xf bank_mask:0xf
  s_nop 1
  v_add_f32_dpp v11, v11, v11 row_bcast:15 row_mask:0xa bank_mask:0xf
  s_nop 1
  v_add_f32_dpp v11, v11, v11 row_bcast:31 row_mask:0xc bank_mask:0xf
  v_lshrrev_b32 v45, 4, v3
  v_and_b32 v40, 15, v45
  v_lshlrev_b32 v40, 5, v40
  v_lshrrev_b32 v41, 4, v45
  v_lshl_add_u32 v40, v41, 4, v40
  s_mul_i32 s46, s25, 28
  s_add_u32 s46, s46, s40
  s_lshl_b32 s46, s46, 9
  s_add_u32 s46, s46, 1376256
  s_mov_b32 exec_hi, 0
  buffer_store_dwordx4 v[36:39], v40, s[12:15], s46 offen sc1
  s_lshl_b32 s46, s25, 8
  s_lshl_b32 s47, s40, 3
  s_add_u32 s46, s46, s47
  s_add_u32 s46, s46, 1859584
  s_mov_b64 exec, -1
  v_mov_b32 v42, s37
  v_mov_b32 v43, v11
  v_mov_b32 v44, 0
  s_mov_b32 exec_lo, 0
  s_mov_b32 exec_hi, 0x80000000
  buffer_store_dwordx2 v[42:43], v44, s[12:15], s46 offen sc1
  s_mov_b64 exec, -1
  s_waitcnt vmcnt(0)
  s_endpgm
L_service:
  s_lshl_b32 s25, s46, 2
  s_add_u32 s25, s25, s47
  v_lshlrev_b32 v1, 4, v0
  v_lshlrev_b32 v2, 2, v0
  v_lshrrev_b32 v3, 4, v0
  v_and_b32 v4, 15, v0
  v_mov_b32 v10, 0
  s_lshl_b32 s42, s24, 10
  v_lshlrev_b32 v9, 4, v3
  v_add_u32 v9, s42, v9
  s_lshl_b32 s46, s25, 2
  s_add_u32 s46, s46, s24
  s_cmp_lt_u32 s46, 86
  s_cselect_b32 s41, 1, 0
  s_cmp_eq_u32 s41, 0
  s_cselect_b32 s46, 0, -1
  v_and_b32 v11, 3, v0
  v_cmp_eq_u32 vcc, v11, v3
  s_nop 1
  v_cndmask_b32 v11, 0, -1, vcc
  v_and_b32 v11, s46, v11
  s_cmp_lt_u32 s25, 22
  s_cselect_b32 s3, 1409024, 0
  s_mov_b32 s20, s70
  s_and_b32 s21, s71, 0xffff
  s_mov_b32 s22, 0x400000
  s_mov_b32 s23, 0x20000
  v_lshlrev_b32 v12, 13, v3
  v_lshl_add_u32 v12, v4, 4, v12
  s_lshl_b32 s50, s24, 20
  s_lshl_b32 s46, s25, 8
  s_add_u32 s50, s50, s46
  s_lshl_b32 s51, s24, 15
  s_mov_b32 m0, s51
  s_nop 0
  buffer_load_dwordx4 v12, s[20:23], s50 offen nt lds
  s_add_u32 s50, s50, 32768
  s_add_u32 s51, s51, 1024
  s_mov_b32 m0, s51
  s_nop 0
  buffer_load_dwordx4 v12, s[20:23], s50 offen nt lds
  s_add_u32 s50, s50, 32768
  s_add_u32 s51, s51, 1024
  s_mov_b32 m0, s51
  s_nop 0
  buffer_load_dwordx4 v12, s[20:23], s50 offen nt lds
  s_add_u32 s50, s50, 32768
  s_add_u32 s51, s51, 1024
  s_mov_b32 m0, s51
  s_nop 0
  buffer_load_dwordx4 v12, s[20:23], s50 offen nt lds
  s_add_u32 s50, s50, 32768
  s_add_u32 s51, s51, 1024
  s_mov_b32 m0, s51
  s_nop 0
  buffer_load_dwordx4 v12, s[20:23], s50 offen nt lds
  s_add_u32 s50, s50, 32768
  s_add_u32 s51, s51, 1024
  s_mov_b32 m0, s51
  s_nop 0
  buffer_load_dwordx4 v12, s[20:23], s50 offen nt lds
  s_add_u32 s50, s50, 32768
  s_add_u32 s51, s51, 1024
  s_mov_b32 m0, s51
  s_nop 0
  buffer_load_dwordx4 v12, s[20:23], s50 offen nt lds
  s_add_u32 s50, s50, 32768
  s_add_u32 s51, s51, 1024
  s_mov_b32 m0, s51
  s_nop 0
  buffer_load_dwordx4 v12, s[20:23], s50 offen nt lds
  s_add_u32 s50, s50, 32768
  s_add_u32 s51, s51, 1024
  s_mov_b32 m0, s51
  s_nop 0
  buffer_load_dwordx4 v12, s[20:23], s50 offen nt lds
  s_add_u32 s50, s50, 32768
  s_add_u32 s51, s51, 1024
  s_mov_b32 m0, s51
  s_nop 0
  buffer_load_dwordx4 v12, s[20:23], s50 offen nt lds
  s_add_u32 s50, s50, 32768
  s_add_u32 s51, s51, 1024
  s_mov_b32 m0, s51
  s_nop 0
  buffer_load_dwordx4 v12, s[20:23], s50 offen nt lds
  s_add_u32 s50, s50, 32768
  s_add_u32 s51, s51, 1024
  s_mov_b32 m0, s51
  s_nop 0
  buffer_load_dwordx4 v12, s[20:23], s50 offen nt lds
  s_add_u32 s50, s50, 32768
  s_add_u32 s51, s51, 1024
  s_mov_b32 m0, s51
  s_nop 0
  buffer_load_dwordx4 v12, s[20:23], s50 offen nt lds
  s_add_u32 s50, s50, 32768
  s_add_u32 s51, s51, 1024
  s_mov_b32 m0, s51
  s_nop 0
  buffer_load_dwordx4 v12, s[20:23], s50 offen nt lds
  s_add_u32 s50, s50, 32768
  s_add_u32 s51, s51, 1024
  s_mov_b32 m0, s51
  s_nop 0
  buffer_load_dwordx4 v12, s[20:23], s50 offen nt lds
  s_add_u32 s50, s50, 32768
  s_add_u32 s51, s51, 1024
  s_mov_b32 m0, s51
  s_nop 0
  buffer_load_dwordx4 v12, s[20:23], s50 offen nt lds
  s_add_u32 s50, s50, 32768
  s_add_u32 s51, s51, 1024
  s_mov_b32 m0, s51
  s_nop 0
  buffer_load_dwordx4 v12, s[20:23], s50 offen nt lds
  s_add_u32 s50, s50, 32768
  s_add_u32 s51, s51, 1024
  s_mov_b32 m0, s51
  s_nop 0
  buffer_load_dwordx4 v12, s[20:23], s50 offen nt lds
  s_add_u32 s50, s50, 32768
  s_add_u32 s51, s51, 1024
  s_mov_b32 m0, s51
  s_nop 0
  buffer_load_dwordx4 v12, s[20:23], s50 offen nt lds
  s_add_u32 s50, s50, 32768
  s_add_u32 s51, s51, 1024
  s_mov_b32 m0, s51
  s_nop 0
  buffer_load_dwordx4 v12, s[20:23], s50 offen nt lds
  s_add_u32 s50, s50, 32768
  s_add_u32 s51, s51, 1024
  s_mov_b32 m0, s51
  s_nop 0
  buffer_load_dwordx4 v12, s[20:23], s50 offen nt lds
  s_add_u32 s50, s50, 32768
  s_add_u32 s51, s51, 1024
  s_mov_b32 m0, s51
  s_nop 0
  buffer_load_dwordx4 v12, s[20:23], s50 offen nt lds
  s_add_u32 s50, s50, 32768
  s_add_u32 s51, s51, 1024
  s_mov_b32 m0, s51
  s_nop 0
  buffer_load_dwordx4 v12, s[20:23], s50 offen nt lds
  s_add_u32 s50, s50, 32768
  s_add_u32 s51, s51, 1024
  s_mov_b32 m0, s51
  s_nop 0
  buffer_load_dwordx4 v12, s[20:23], s50 offen nt lds
  s_add_u32 s50, s50, 32768
  s_add_u32 s51, s51, 1024
  s_mov_b32 m0, s51
  s_nop 0
  buffer_load_dwordx4 v12, s[20:23], s50 offen nt lds
  s_add_u32 s50, s50, 32768
  s_add_u32 s51, s51, 1024
  s_mov_b32 m0, s51
  s_nop 0
  buffer_load_dwordx4 v12, s[20:23], s50 offen nt lds
  s_add_u32 s50, s50, 32768
  s_add_u32 s51, s51, 1024
  s_mov_b32 m0, s51
  s_nop 0
  buffer_load_dwordx4 v12, s[20:23], s50 offen nt lds
  s_add_u32 s50, s50, 32768
  s_add_u32 s51, s51, 1024
  s_mov_b32 m0, s51
  s_nop 0
  buffer_load_dwordx4 v12, s[20:23], s50 offen nt lds
  s_add_u32 s50, s50, 32768
  s_add_u32 s51, s51, 1024
  s_mov_b32 m0, s51
  s_nop 0
  buffer_load_dwordx4 v12, s[20:23], s50 offen nt lds
  s_add_u32 s50, s50, 32768
  s_add_u32 s51, s51, 1024
  s_mov_b32 m0, s51
  s_nop 0
  buffer_load_dwordx4 v12, s[20:23], s50 offen nt lds
  s_add_u32 s50, s50, 32768
  s_add_u32 s51, s51, 1024
  s_mov_b32 m0, s51
  s_nop 0
  buffer_load_dwordx4 v12, s[20:23], s50 offen nt lds
  s_add_u32 s50, s50, 32768
  s_add_u32 s51, s51, 1024
  s_mov_b32 m0, s51
  s_nop 0
  buffer_load_dwordx4 v12, s[20:23], s50 offen nt lds
  s_waitcnt vmcnt(0) lgkmcnt(0)
  s_barrier
  v_bfe_u32 v14, v0, 2, 2
  v_lshl_add_u32 v14, v3, 3, v14
  v_and_b32 v15, 3, v0
  v_lshlrev_b32 v15, 3, v15
  v_lshl_add_u32 v16, v14, 8, v15
  s_lshl_b32 s46, s24, 6
  v_add_u32 v16, s46, v16
  v_add_u32 v17, 0x10000, v16
  ds_read_b64_tr_b16 a[0:1], v16 offset:0
  ds_read_b64_tr_b16 a[2:3], v16 offset:1024
  ds_read_b64_tr_b16 a[4:5], v16 offset:8192
  ds_read_b64_tr_b16 a[6:7], v16 offset:9216
  ds_read_b64_tr_b16 a[8:9], v16 offset:16384
  ds_read_b64_tr_b16 a[10:11], v16 offset:17408
  ds_read_b64_tr_b16 a[12:13], v16 offset:24576
  ds_read_b64_tr_b16 a[14:15], v16 offset:25600
  ds_read_b64_tr_b16 a[16:17], v16 offset:32768
  ds_read_b64_tr_b16 a[18:19], v16 offset:33792
  ds_read_b64_tr_b16 a[20:21], v16 offset:40960
  ds_read_b64_tr_b16 a[22:23], v16 offset:41984
  s_waitcnt lgkmcnt(8)
  ds_read_b64_tr_b16 a[24:25], v16 offset:49152
  ds_read_b64_tr_b16 a[26:27], v16 offset:50176
  ds_read_b64_tr_b16 a[28:29], v16 offset:57344
  ds_read_b64_tr_b16 a[30:31], v16 offset:58368
  s_waitcnt lgkmcnt(8)
  ds_read_b64_tr_b16 a[32:33], v17 offset:0
  ds_read_b64_tr_b16 a[34:35], v17 offset:1024
  ds_read_b64_tr_b16 a[36:37], v17 offset:8192
  ds_read_b64_tr_b16 a[38:39], v17 offset:9216
  s_waitcnt lgkmcnt(8)
  ds_read_b64_tr_b16 a[40:41], v17 offset:16384
  ds_read_b64_tr_b16 a[42:43], v17 offset:17408
  ds_read_b64_tr_b16 a[44:45], v17 offset:24576
  ds_read_b64_tr_b16 a[46:47], v17 offset:25600
  s_waitcnt lgkmcnt(8)
  ds_read_b64_tr_b16 a[48:49], v17 offset:32768
  ds_read_b64_tr_b16 a[50:51], v17 offset:33792
  ds_read_b64_tr_b16 a[52:53], v17 offset:40960
  ds_read_b64_tr_b16 a[54:55], v17 offset:41984
  s_waitcnt lgkmcnt(8)
  ds_read_b64_tr_b16 a[56:57], v17 offset:49152
  ds_read_b64_tr_b16 a[58:59], v17 offset:50176
  ds_read_b64_tr_b16 a[60:61], v17 offset:57344
  ds_read_b64_tr_b16 a[62:63], v17 offset:58368
  s_waitcnt lgkmcnt(8)
  ds_read_b64_tr_b16 a[64:65], v16 offset:32
  ds_read_b64_tr_b16 a[66:67], v16 offset:1056
  ds_read_b64_tr_b16 a[68:69], v16 offset:8224
  ds_read_b64_tr_b16 a[70:71], v16 offset:9248
  s_waitcnt lgkmcnt(8)
  ds_read_b64_tr_b16 a[72:73], v16 offset:16416
  ds_read_b64_tr_b16 a[74:75], v16 offset:17440
  ds_read_b64_tr_b16 a[76:77], v16 offset:24608
  ds_read_b64_tr_b16 a[78:79], v16 offset:25632
  s_waitcnt lgkmcnt(8)
  ds_read_b64_tr_b16 a[80:81], v16 offset:32800
  ds_read_b64_tr_b16 a[82:83], v16 offset:33824
  ds_read_b64_tr_b16 a[84:85], v16 offset:40992
  ds_read_b64_tr_b16 a[86:87], v16 offset:42016
  s_waitcnt lgkmcnt(8)
  ds_read_b64_tr_b16 a[88:89], v16 offset:49184
  ds_read_b64_tr_b16 a[90:91], v16 offset:50208
  ds_read_b64_tr_b16 a[92:93], v16 offset:57376
  ds_read_b64_tr_b16 a[94:95], v16 offset:58400
  s_waitcnt lgkmcnt(8)
  ds_read_b64_tr_b16 a[96:97], v17 offset:32
  ds_read_b64_tr_b16 a[98:99], v17 offset:1056
  ds_read_b64_tr_b16 a[100:101], v17 offset:8224
  ds_read_b64_tr_b16 a[102:103], v17 offset:9248
  s_waitcnt lgkmcnt(8)
  ds_read_b64_tr_b16 a[104:105], v17 offset:16416
  ds_read_b64_tr_b16 a[106:107], v17 offset:17440
  ds_read_b64_tr_b16 a[108:109], v17 offset:24608
  ds_read_b64_tr_b16 a[110:111], v17 offset:25632
  s_waitcnt lgkmcnt(8)
  ds_read_b64_tr_b16 a[112:113], v17 offset:32800
  ds_read_b64_tr_b16 a[114:115], v17 offset:33824
  ds_read_b64_tr_b16 a[116:117], v17 offset:40992
  ds_read_b64_tr_b16 a[118:119], v17 offset:42016
  s_waitcnt lgkmcnt(8)
  ds_read_b64_tr_b16 a[120:121], v17 offset:49184
  ds_read_b64_tr_b16 a[122:123], v17 offset:50208
  ds_read_b64_tr_b16 a[124:125], v17 offset:57376
  ds_read_b64_tr_b16 a[126:127], v17 offset:58400
  s_waitcnt lgkmcnt(8)
  s_waitcnt lgkmcnt(0)
  s_barrier
  s_mov_b32 s20, s72
  s_and_b32 s21, s73, 0xffff
  s_mov_b32 s22, 0x400000
  s_mov_b32 s23, 0x20000
  s_lshl_b32 s50, s25, 17
  s_lshl_b32 s46, s24, 15
  s_add_u32 s50, s50, s46
  s_lshl_b32 s51, s24, 15
  s_add_u32 s51, s51, 17408
  s_mov_b32 m0, s51
  s_nop 0
  buffer_load_dwordx4 v1, s[20:23], s50 offen nt lds
  s_add_u32 s50, s50, 1024
  s_add_u32 s51, s51, 1024
  s_mov_b32 m0, s51
  s_nop 0
  buffer_load_dwordx4 v1, s[20:23], s50 offen nt lds
  s_add_u32 s50, s50, 1024
  s_add_u32 s51, s51, 1024
  s_mov_b32 m0, s51
  s_nop 0
  buffer_load_dwordx4 v1, s[20:23], s50 offen nt lds
  s_add_u32 s50, s50, 1024
  s_add_u32 s51, s51, 1024
  s_mov_b32 m0, s51
  s_nop 0
  buffer_load_dwordx4 v1, s[20:23], s50 offen nt lds
  s_add_u32 s50, s50, 1024
  s_add_u32 s51, s51, 1024
  s_mov_b32 m0, s51
  s_nop 0
  buffer_load_dwordx4 v1, s[20:23], s50 offen nt lds
  s_add_u32 s50, s50, 1024
  s_add_u32 s51, s51, 1024
  s_mov_b32 m0, s51
  s_nop 0
  buffer_load_dwordx4 v1, s[20:23], s50 offen nt lds
  s_add_u32 s50, s50, 1024
  s_add_u32 s51, s51, 1024
  s_mov_b32 m0, s51
  s_nop 0
  buffer_load_dwordx4 v1, s[20:23], s50 offen nt lds
  s_add_u32 s50, s50, 1024
  s_add_u32 s51, s51, 1024
  s_mov_b32 m0, s51
  s_nop 0
  buffer_load_dwordx4 v1, s[20:23], s50 offen nt lds
  s_add_u32 s50, s50, 1024
  s_add_u32 s51, s51, 1024
  s_mov_b32 m0, s51
  s_nop 0
  buffer_load_dwordx4 v1, s[20:23], s50 offen nt lds
  s_add_u32 s50, s50, 1024
  s_add_u32 s51, s51, 1024
  s_mov_b32 m0, s51
  s_nop 0
  buffer_load_dwordx4 v1, s[20:23], s50 offen nt lds
  s_add_u32 s50, s50, 1024
  s_add_u32 s51, s51, 1024
  s_mov_b32 m0, s51
  s_nop 0
  buffer_load_dwordx4 v1, s[20:23], s50 offen nt lds
  s_add_u32 s50, s50, 1024
  s_add_u32 s51, s51, 1024
  s_mov_b32 m0, s51
  s_nop 0
  buffer_load_dwordx4 v1, s[20:23], s50 offen nt lds
  s_add_u32 s50, s50, 1024
  s_add_u32 s51, s51, 1024
  s_mov_b32 m0, s51
  s_nop 0
  buffer_load_dwordx4 v1, s[20:23], s50 offen nt lds
  s_add_u32 s50, s50, 1024
  s_add_u32 s51, s51, 1024
  s_mov_b32 m0, s51
  s_nop 0
  buffer_load_dwordx4 v1, s[20:23], s50 offen nt lds
  s_add_u32 s50, s50, 1024
  s_add_u32 s51, s51, 1024
  s_mov_b32 m0, s51
  s_nop 0
  buffer_load_dwordx4 v1, s[20:23], s50 offen nt lds
  s_add_u32 s50, s50, 1024
  s_add_u32 s51, s51, 1024
  s_mov_b32 m0, s51
  s_nop 0
  buffer_load_dwordx4 v1, s[20:23], s50 offen nt lds
  s_add_u32 s50, s50, 1024
  s_add_u32 s51, s51, 1024
  s_mov_b32 m0, s51
  s_nop 0
  buffer_load_dwordx4 v1, s[20:23], s50 offen nt lds
  s_add_u32 s50, s50, 1024
  s_add_u32 s51, s51, 1024
  s_mov_b32 m0, s51
  s_nop 0
  buffer_load_dwordx4 v1, s[20:23], s50 offen nt lds
  s_add_u32 s50, s50, 1024
  s_add_u32 s51, s51, 1024
  s_mov_b32 m0, s51
  s_nop 0
  buffer_load_dwordx4 v1, s[20:23], s50 offen nt lds
  s_add_u32 s50, s50, 1024
  s_add_u32 s51, s51, 1024
  s_mov_b32 m0, s51
  s_nop 0
  buffer_load_dwordx4 v1, s[20:23], s50 offen nt lds
  s_add_u32 s50, s50, 1024
  s_add_u32 s51, s51, 1024
  s_mov_b32 m0, s51
  s_nop 0
  buffer_load_dwordx4 v1, s[20:23], s50 offen nt lds
  s_add_u32 s50, s50, 1024
  s_add_u32 s51, s51, 1024
  s_mov_b32 m0, s51
  s_nop 0
  buffer_load_dwordx4 v1, s[20:23], s50 offen nt lds
  s_add_u32 s50, s50, 1024
  s_add_u32 s51, s51, 1024
  s_mov_b32 m0, s51
  s_nop 0
  buffer_load_dwordx4 v1, s[20:23], s50 offen nt lds
  s_add_u32 s50, s50, 1024
  s_add_u32 s51, s51, 1024
  s_mov_b32 m0, s51
  s_nop 0
  buffer_load_dwordx4 v1, s[20:23], s50 offen nt lds
  s_add_u32 s50, s50, 1024
  s_add_u32 s51, s51, 1024
  s_mov_b32 m0, s51
  s_nop 0
  buffer_load_dwordx4 v1, s[20:23], s50 offen nt lds
  s_add_u32 s50, s50, 1024
  s_add_u32 s51, s51, 1024
  s_mov_b32 m0, s51
  s_nop 0
  buffer_load_dwordx4 v1, s[20:23], s50 offen nt lds
  s_add_u32 s50, s50, 1024
  s_add_u32 s51, s51, 1024
  s_mov_b32 m0, s51
  s_nop 0
  buffer_load_dwordx4 v1, s[20:23], s50 offen nt lds
  s_add_u32 s50, s50, 1024
  s_add_u32 s51, s51, 1024
  s_mov_b32 m0, s51
  s_nop 0
  buffer_load_dwordx4 v1, s[20:23], s50 offen nt lds
  s_add_u32 s50, s50, 1024
  s_add_u32 s51, s51, 1024
  s_mov_b32 m0, s51
  s_nop 0
  buffer_load_dwordx4 v1, s[20:23], s50 offen nt lds
  s_add_u32 s50, s50, 1024
  s_add_u32 s51, s51, 1024
  s_mov_b32 m0, s51
  s_nop 0
  buffer_load_dwordx4 v1, s[20:23], s50 offen nt lds
  s_add_u32 s50, s50, 1024
  s_add_u32 s51, s51, 1024
  s_mov_b32 m0, s51
  s_nop 0
  buffer_load_dwordx4 v1, s[20:23], s50 offen nt lds
  s_add_u32 s50, s50, 1024
  s_add_u32 s51, s51, 1024
  s_mov_b32 m0, s51
  s_nop 0
  buffer_load_dwordx4 v1, s[20:23], s50 offen nt lds
  v_mov_b32 v16, 0x3f803f80
  v_mov_b32 v17, 0x3f803f80
  v_mov_b32 v18, 0x3f803f80
  v_mov_b32 v19, 0x3f803f80
  s_nop 1
  v_mfma_f32_16x16x32_bf16 v[20:23], v[16:19], a[0:3], 0
  v_mfma_f32_16x16x32_bf16 v[20:23], v[16:19], a[4:7], v[20:23]
  v_mfma_f32_16x16x32_bf16 v[20:23], v[16:19], a[8:11], v[20:23]
  v_mfma_f32_16x16x32_bf16 v[20:23], v[16:19], a[12:15], v[20:23]
  v_mfma_f32_16x16x32_bf16 v[20:23], v[16:19], a[16:19], v[20:23]
  v_mfma_f32_16x16x32_bf16 v[20:23], v[16:19], a[20:23], v[20:23]
  v_mfma_f32_16x16x32_bf16 v[20:23], v[16:19], a[24:27], v[20:23]
  v_mfma_f32_16x16x32_bf16 v[20:23], v[16:19], a[28:31], v[20:23]
  v_mfma_f32_16x16x32_bf16 v[20:23], v[16:19], a[32:35], v[20:23]
  v_mfma_f32_16x16x32_bf16 v[20:23], v[16:19], a[36:39], v[20:23]
  v_mfma_f32_16x16x32_bf16 v[20:23], v[16:19], a[40:43], v[20:23]
  v_mfma_f32_16x16x32_bf16 v[20:23], v[16:19], a[44:47], v[20:23]
  v_mfma_f32_16x16x32_bf16 v[20:23], v[16:19], a[48:51], v[20:23]
  v_mfma_f32_16x16x32_bf16 v[20:23], v[16:19], a[52:55], v[20:23]
  v_mfma_f32_16x16x32_bf16 v[20:23], v[16:19], a[56:59], v[20:23]
  v_mfma_f32_16x16x32_bf16 v[20:23], v[16:19], a[60:63], v[20:23]
  s_nop 7
  v_mov_b32 v5, v20
  v_mfma_f32_16x16x32_bf16 v[20:23], v[16:19], a[64:67], 0
  v_mfma_f32_16x16x32_bf16 v[20:23], v[16:19], a[68:71], v[20:23]
  v_mfma_f32_16x16x32_bf16 v[20:23], v[16:19], a[72:75], v[20:23]
  v_mfma_f32_16x16x32_bf16 v[20:23], v[16:19], a[76:79], v[20:23]
  v_mfma_f32_16x16x32_bf16 v[20:23], v[16:19], a[80:83], v[20:23]
  v_mfma_f32_16x16x32_bf16 v[20:23], v[16:19], a[84:87], v[20:23]
  v_mfma_f32_16x16x32_bf16 v[20:23], v[16:19], a[88:91], v[20:23]
  v_mfma_f32_16x16x32_bf16 v[20:23], v[16:19], a[92:95], v[20:23]
  v_mfma_f32_16x16x32_bf16 v[20:23], v[16:19], a[96:99], v[20:23]
  v_mfma_f32_16x16x32_bf16 v[20:23], v[16:19], a[100:103], v[20:23]
  v_mfma_f32_16x16x32_bf16 v[20:23], v[16:19], a[104:107], v[20:23]
  v_mfma_f32_16x16x32_bf16 v[20:23], v[16:19], a[108:111], v[20:23]
  v_mfma_f32_16x16x32_bf16 v[20:23], v[16:19], a[112:115], v[20:23]
  v_mfma_f32_16x16x32_bf16 v[20:23], v[16:19], a[116:119], v[20:23]
  v_mfma_f32_16x16x32_bf16 v[20:23], v[16:19], a[120:123], v[20:23]
  v_mfma_f32_16x16x32_bf16 v[20:23], v[16:19], a[124:127], v[20:23]
  s_nop 7
  v_mov_b32 v6, v20
sclp_100002:
  global_load_dword v20, v10, s[84:85] sc1
  s_waitcnt vmcnt(0)
  v_readfirstlane_b32 s46, v20
  s_nop 0
  s_cmp_ge_u32 s46, 224
  s_cbranch_scc1 sclok_100001
  s_sleep 4
  s_sub_u32 s39, s39, 1
  s_cmp_gt_i32 s39, 0
  s_cbranch_scc1 sclp_100002
sclok_100001:
  s_mov_b32 s46, 0
xa_100003:
  buffer_load_dwordx4 v[12:15], v1, s[64:67], s46 offen
  s_waitcnt vmcnt(0)
  v_add_u32 v16, s42, v1
  ds_write_b128 v16, v[12:15]
  ds_read_b128 v[28:31], v9 offset:0
  ds_read_b128 v[32:35], v9 offset:64
  ds_read_b128 v[36:39], v9 offset:128
  ds_read_b128 v[40:43], v9 offset:192
  s_waitcnt lgkmcnt(3)
  v_mfma_f32_16x16x32_bf16 v[20:23], v[28:31], a[0:3], 0
  v_mfma_f32_16x16x32_bf16 v[24:27], v[28:31], a[64:67], 0
  ds_read_b128 v[28:31], v9 offset:256
  v_lshlrev_b32 v50, 16, v12
  v_and_b32 v51, 0xffff0000, v12
  v_add_f32 v48, v50, v51
  s_waitcnt lgkmcnt(3)
  v_mfma_f32_16x16x32_bf16 v[20:23], v[32:35], a[4:7], v[20:23]
  v_mfma_f32_16x16x32_bf16 v[24:27], v[32:35], a[68:71], v[24:27]
  ds_read_b128 v[32:35], v9 offset:320
  v_mul_f32 v49, v50, v50
  v_fmac_f32 v49, v51, v51
  v_lshlrev_b32 v50, 16, v13
  v_and_b32 v51, 0xffff0000, v13
  s_waitcnt lgkmcnt(3)
  v_mfma_f32_16x16x32_bf16 v[20:23], v[36:39], a[8:11], v[20:23]
  v_mfma_f32_16x16x32_bf16 v[24:27], v[36:39], a[72:75], v[24:27]
  ds_read_b128 v[36:39], v9 offset:384
  v_add_f32 v48, v48, v50
  v_fmac_f32 v49, v50, v50
  v_add_f32 v48, v48, v51
  s_waitcnt lgkmcnt(3)
  v_mfma_f32_16x16x32_bf16 v[20:23], v[40:43], a[12:15], v[20:23]
  v_mfma_f32_16x16x32_bf16 v[24:27], v[40:43], a[76:79], v[24:27]
  ds_read_b128 v[40:43], v9 offset:448
  v_fmac_f32 v49, v51, v51
  v_lshlrev_b32 v50, 16, v14
  v_and_b32 v51, 0xffff0000, v14
  v_add_f32 v48, v48, v50
  s_waitcnt lgkmcnt(3)
  v_mfma_f32_16x16x32_bf16 v[20:23], v[28:31], a[16:19], v[20:23]
  v_mfma_f32_16x16x32_bf16 v[24:27], v[28:31], a[80:83], v[24:27]
  ds_read_b128 v[28:31], v9 offset:512
  v_fmac_f32 v49, v50, v50
  v_add_f32 v48, v48, v51
  v_fmac_f32 v49, v51, v51
  s_waitcnt lgkmcnt(3)
  v_mfma_f32_16x16x32_bf16 v[20:23], v[32:35], a[20:23], v[20:23]
  v_mfma_f32_16x16x32_bf16 v[24:27], v[32:35], a[84:87], v[24:27]
  ds_read_b128 v[32:35], v9 offset:576
  v_lshlrev_b32 v50, 16, v15
  v_and_b32 v51, 0xffff0000, v15
  v_add_f32 v48, v48, v50
  v_fmac_f32 v49, v50, v50
  s_waitcnt lgkmcnt(3)
  v_mfma_f32_16x16x32_bf16 v[20:23], v[36:39], a[24:27], v[20:23]
  v_mfma_f32_16x16x32_bf16 v[24:27], v[36:39], a[88:91], v[24:27]
  ds_read_b128 v[36:39], v9 offset:640
  v_add_f32 v48, v48, v51
  v_fmac_f32 v49, v51, v51
  s_nop 0
  v_add_f32_dpp v48, v48, v48 row_ror:8 row_mask:0xf bank_mask:0xf
  s_waitcnt lgkmcnt(3)
  v_mfma_f32_16x16x32_bf16 v[20:23], v[40:43], a[28:31], v[20:23]
  v_mfma_f32_16x16x32_bf16 v[24:27], v[40:43], a[92:95], v[24:27]
  ds_read_b128 v[40:43], v9 offset:704
  v_add_f32_dpp v49, v49, v49 row_ror:8 row_mask:0xf bank_mask:0xf
  v_add_f32_dpp v48, v48, v48 row_ror:4 row_mask:0xf bank_mask:0xf
  s_nop 0
  v_add_f32_dpp v49, v49, v49 row_ror:4 row_mask:0xf bank_mask:0xf
  v_add_f32_dpp v48, v48, v48 row_ror:2 row_mask:0xf bank_mask:0xf
  s_waitcnt lgkmcnt(3)
  v_mfma_f32_16x16x32_bf16 v[20:23], v[28:31], a[32:35], v[20:23]
  v_mfma_f32_16x16x32_bf16 v[24:27], v[28:31], a[96:99], v[24:27]
  ds_read_b128 v[28:31], v9 offset:768
  v_add_f32_dpp v49, v49, v49 row_ror:2 row_mask:0xf bank_mask:0xf
  v_add_f32_dpp v48, v48, v48 row_ror:1 row_mask:0xf bank_mask:0xf
  s_nop 0
  v_add_f32_dpp v49, v49, v49 row_ror:1 row_mask:0xf bank_mask:0xf
  s_waitcnt lgkmcnt(3)
  v_mfma_f32_16x16x32_bf16 v[20:23], v[32:35], a[36:39], v[20:23]
  v_mfma_f32_16x16x32_bf16 v[24:27], v[32:35], a[100:103], v[24:27]
  ds_read_b128 v[32:35], v9 offset:832
  v_add_f32_dpp v48, v48, v48 row_bcast:15 row_mask:0xa bank_mask:0xf
  v_add_f32_dpp v49, v49, v49 row_bcast:15 row_mask:0xa bank_mask:0xf
  s_nop 0
  v_add_f32_dpp v48, v48, v48 row_bcast:31 row_mask:0xc bank_mask:0xf
  v_add_f32_dpp v49, v49, v49 row_bcast:31 row_mask:0xc bank_mask:0xf
  s_waitcnt lgkmcnt(3)
  v_mfma_f32_16x16x32_bf16 v[20:23], v[36:39], a[40:43], v[20:23]
  v_mfma_f32_16x16x32_bf16 v[24:27], v[36:39], a[104:107], v[24:27]
  ds_read_b128 v[36:39], v9 offset:896
  v_readlane_b32 s54, v48, 63
  v_readlane_b32 s55, v49, 63
  s_nop 0
  v_mov_b32 v44, s54
  s_waitcnt lgkmcnt(3)
  v_mfma_f32_16x16x32_bf16 v[20:23], v[40:43], a[44:47], v[20:23]
  v_mfma_f32_16x16x32_bf16 v[24:27], v[40:43], a[108:111], v[24:27]
  ds_read_b128 v[40:43], v9 offset:960
  v_mov_b32 v45, s55
  v_mul_f32 v44, 0x3b000000, v44
  v_mul_f32 v45, 0x3b000000, v45
  v_fma_f32 v45, -v44, v44, v45
  s_waitcnt lgkmcnt(3)
  v_mfma_f32_16x16x32_bf16 v[20:23], v[28:31], a[48:51], v[20:23]
  v_mfma_f32_16x16x32_bf16 v[24:27], v[28:31], a[112:115], v[24:27]
  v_max_f32 v45, 0, v45
  v_cvt_pk_bf16_f32 v44, v44, v44
  v_cvt_pk_bf16_f32 v45, v45, v45
  s_waitcnt lgkmcnt(2)
  v_mfma_f32_16x16x32_bf16 v[20:23], v[32:35], a[52:55], v[20:23]
  v_mfma_f32_16x16x32_bf16 v[24:27], v[32:35], a[116:119], v[24:27]
  v_and_b32 v44, 0xffff0000, v44
  v_and_b32 v45, 0xffff0000, v45
  v_add_f32 v45, 0x3727c5ac, v45
  v_cvt_pk_bf16_f32 v45, v45, v45
  s_waitcnt lgkmcnt(1)
  v_mfma_f32_16x16x32_bf16 v[20:23], v[36:39], a[56:59], v[20:23]
  v_mfma_f32_16x16x32_bf16 v[24:27], v[36:39], a[120:123], v[24:27]
  v_and_b32 v45, 0xffff0000, v45
  v_sqrt_f32 v45, v45
  s_nop 0
  v_cvt_pk_bf16_f32 v45, v45, v45
  s_waitcnt lgkmcnt(0)
  v_mfma_f32_16x16x32_bf16 v[20:23], v[40:43], a[60:63], v[20:23]
  v_mfma_f32_16x16x32_bf16 v[24:27], v[40:43], a[124:127], v[24:27]
  v_and_b32 v45, 0xffff0000, v45
  v_rcp_f32 v45, v45
  v_mul_f32 v46, v44, v5
  v_mul_f32 v47, v44, v6
  s_nop 2
  v_sub_f32 v20, v20, v46
  v_sub_f32 v24, v24, v47
  v_mul_f32 v20, v20, v45
  v_mul_f32 v24, v24, v45
  s_nop 1
  v_mov_b32_dpp v20, v24 quad_perm:[0,1,2,3] row_mask:0x2 bank_mask:0xf
  s_nop 1
  v_mov_b32_dpp v12, v20 quad_perm:[1,1,3,3] row_mask:0xf bank_mask:0xf
  v_cvt_pk_bf16_f32 v12, v20, v12
  v_lshlrev_b32 v13, 1, v0
  s_lshl_b32 s46, s25, 8
  s_lshl_b32 s47, s24, 6
  s_add_u32 s46, s46, s47
  s_add_u32 s46, s46, 2400256
  s_mov_b32 exec_lo, 0x55555555
  s_mov_b32 exec_hi, 0
  buffer_store_dword v12, v13, s[12:15], s46 offen sc1
  s_mov_b64 exec, -1
  s_mov_b32 s46, 1024
xa_100005:
  buffer_load_dwordx4 v[12:15], v1, s[64:67], s46 offen
  s_waitcnt vmcnt(0)
  v_add_u32 v16, s42, v1
  ds_write_b128 v16, v[12:15]
  ds_read_b128 v[28:31], v9 offset:0
  ds_read_b128 v[32:35], v9 offset:64
  ds_read_b128 v[36:39], v9 offset:128
  ds_read_b128 v[40:43], v9 offset:192
  s_waitcnt lgkmcnt(3)
  v_mfma_f32_16x16x32_bf16 v[20:23], v[28:31], a[0:3], 0
  v_mfma_f32_16x16x32_bf16 v[24:27], v[28:31], a[64:67], 0
  ds_read_b128 v[28:31], v9 offset:256
  v_lshlrev_b32 v50, 16, v12
  v_and_b32 v51, 0xffff0000, v12
  v_add_f32 v48, v50, v51
  s_waitcnt lgkmcnt(3)
  v_mfma_f32_16x16x32_bf16 v[20:23], v[32:35], a[4:7], v[20:23]
  v_mfma_f32_16x16x32_bf16 v[24:27], v[32:35], a[68:71], v[24:27]
  ds_read_b128 v[32:35], v9 offset:320
  v_mul_f32 v49, v50, v50
  v_fmac_f32 v49, v51, v51
  v_lshlrev_b32 v50, 16, v13
  v_and_b32 v51, 0xffff0000, v13
  s_waitcnt lgkmcnt(3)
  v_mfma_f32_16x16x32_bf16 v[20:23], v[36:39], a[8:11], v[20:23]
  v_mfma_f32_16x16x32_bf16 v[24:27], v[36:39], a[72:75], v[24:27]
  ds_read_b128 v[36:39], v9 offset:384
  v_add_f32 v48, v48, v50
  v_fmac_f32 v49, v50, v50
  v_add_f32 v48, v48, v51
  s_waitcnt lgkmcnt(3)
  v_mfma_f32_16x16x32_bf16 v[20:23], v[40:43], a[12:15], v[20:23]
  v_mfma_f32_16x16x32_bf16 v[24:27], v[40:43], a[76:79], v[24:27]
  ds_read_b128 v[40:43], v9 offset:448
  v_fmac_f32 v49, v51, v51
  v_lshlrev_b32 v50, 16, v14
  v_and_b32 v51, 0xffff0000, v14
  v_add_f32 v48, v48, v50
  s_waitcnt lgkmcnt(3)
  v_mfma_f32_16x16x32_bf16 v[20:23], v[28:31], a[16:19], v[20:23]
  v_mfma_f32_16x16x32_bf16 v[24:27], v[28:31], a[80:83], v[24:27]
  ds_read_b128 v[28:31], v9 offset:512
  v_fmac_f32 v49, v50, v50
  v_add_f32 v48, v48, v51
  v_fmac_f32 v49, v51, v51
  s_waitcnt lgkmcnt(3)
  v_mfma_f32_16x16x32_bf16 v[20:23], v[32:35], a[20:23], v[20:23]
  v_mfma_f32_16x16x32_bf16 v[24:27], v[32:35], a[84:87], v[24:27]
  ds_read_b128 v[32:35], v9 offset:576
  v_lshlrev_b32 v50, 16, v15
  v_and_b32 v51, 0xffff0000, v15
  v_add_f32 v48, v48, v50
  v_fmac_f32 v49, v50, v50
  s_waitcnt lgkmcnt(3)
  v_mfma_f32_16x16x32_bf16 v[20:23], v[36:39], a[24:27], v[20:23]
  v_mfma_f32_16x16x32_bf16 v[24:27], v[36:39], a[88:91], v[24:27]
  ds_read_b128 v[36:39], v9 offset:640
  v_add_f32 v48, v48, v51
  v_fmac_f32 v49, v51, v51
  s_nop 0
  v_add_f32_dpp v48, v48, v48 row_ror:8 row_mask:0xf bank_mask:0xf
  s_waitcnt lgkmcnt(3)
  v_mfma_f32_16x16x32_bf16 v[20:23], v[40:43], a[28:31], v[20:23]
  v_mfma_f32_16x16x32_bf16 v[24:27], v[40:43], a[92:95], v[24:27]
  ds_read_b128 v[40:43], v9 offset:704
  v_add_f32_dpp v49, v49, v49 row_ror:8 row_mask:0xf bank_mask:0xf
  v_add_f32_dpp v48, v48, v48 row_ror:4 row_mask:0xf bank_mask:0xf
  s_nop 0
  v_add_f32_dpp v49, v49, v49 row_ror:4 row_mask:0xf bank_mask:0xf
  v_add_f32_dpp v48, v48, v48 row_ror:2 row_mask:0xf bank_mask:0xf
  s_waitcnt lgkmcnt(3)
  v_mfma_f32_16x16x32_bf16 v[20:23], v[28:31], a[32:35], v[20:23]
  v_mfma_f32_16x16x32_bf16 v[24:27], v[28:31], a[96:99], v[24:27]
  ds_read_b128 v[28:31], v9 offset:768
  v_add_f32_dpp v49, v49, v49 row_ror:2 row_mask:0xf bank_mask:0xf
  v_add_f32_dpp v48, v48, v48 row_ror:1 row_mask:0xf bank_mask:0xf
  s_nop 0
  v_add_f32_dpp v49, v49, v49 row_ror:1 row_mask:0xf bank_mask:0xf
  s_waitcnt lgkmcnt(3)
  v_mfma_f32_16x16x32_bf16 v[20:23], v[32:35], a[36:39], v[20:23]
  v_mfma_f32_16x16x32_bf16 v[24:27], v[32:35], a[100:103], v[24:27]
  ds_read_b128 v[32:35], v9 offset:832
  v_add_f32_dpp v48, v48, v48 row_bcast:15 row_mask:0xa bank_mask:0xf
  v_add_f32_dpp v49, v49, v49 row_bcast:15 row_mask:0xa bank_mask:0xf
  s_nop 0
  v_add_f32_dpp v48, v48, v48 row_bcast:31 row_mask:0xc bank_mask:0xf
  v_add_f32_dpp v49, v49, v49 row_bcast:31 row_mask:0xc bank_mask:0xf
  s_waitcnt lgkmcnt(3)
  v_mfma_f32_16x16x32_bf16 v[20:23], v[36:39], a[40:43], v[20:23]
  v_mfma_f32_16x16x32_bf16 v[24:27], v[36:39], a[104:107], v[24:27]
  ds_read_b128 v[36:39], v9 offset:896
  v_readlane_b32 s54, v48, 63
  v_readlane_b32 s55, v49, 63
  s_nop 0
  v_mov_b32 v44, s54
  s_waitcnt lgkmcnt(3)
  v_mfma_f32_16x16x32_bf16 v[20:23], v[40:43], a[44:47], v[20:23]
  v_mfma_f32_16x16x32_bf16 v[24:27], v[40:43], a[108:111], v[24:27]
  ds_read_b128 v[40:43], v9 offset:960
  v_mov_b32 v45, s55
  v_mul_f32 v44, 0x3b000000, v44
  v_mul_f32 v45, 0x3b000000, v45
  v_fma_f32 v45, -v44, v44, v45
  s_waitcnt lgkmcnt(3)
  v_mfma_f32_16x16x32_bf16 v[20:23], v[28:31], a[48:51], v[20:23]
  v_mfma_f32_16x16x32_bf16 v[24:27], v[28:31], a[112:115], v[24:27]
  v_max_f32 v45, 0, v45
  v_cvt_pk_bf16_f32 v44, v44, v44
  v_cvt_pk_bf16_f32 v45, v45, v45
  s_waitcnt lgkmcnt(2)
  v_mfma_f32_16x16x32_bf16 v[20:23], v[32:35], a[52:55], v[20:23]
  v_mfma_f32_16x16x32_bf16 v[24:27], v[32:35], a[116:119], v[24:27]
  v_and_b32 v44, 0xffff0000, v44
  v_and_b32 v45, 0xffff0000, v45
  v_add_f32 v45, 0x3727c5ac, v45
  v_cvt_pk_bf16_f32 v45, v45, v45
  s_waitcnt lgkmcnt(1)
  v_mfma_f32_16x16x32_bf16 v[20:23], v[36:39], a[56:59], v[20:23]
  v_mfma_f32_16x16x32_bf16 v[24:27], v[36:39], a[120:123], v[24:27]
  v_and_b32 v45, 0xffff0000, v45
  v_sqrt_f32 v45, v45
  s_nop 0
  v_cvt_pk_bf16_f32 v45, v45, v45
  s_waitcnt lgkmcnt(0)
  v_mfma_f32_16x16x32_bf16 v[20:23], v[40:43], a[60:63], v[20:23]
  v_mfma_f32_16x16x32_bf16 v[24:27], v[40:43], a[124:127], v[24:27]
  v_and_b32 v45, 0xffff0000, v45
  v_rcp_f32 v45, v45
  v_mul_f32 v46, v44, v5
  v_mul_f32 v47, v44, v6
  s_nop 2
  v_sub_f32 v20, v20, v46
  v_sub_f32 v24, v24, v47
  v_mul_f32 v20, v20, v45
  v_mul_f32 v24, v24, v45
  s_nop 1
  v_mov_b32_dpp v20, v24 quad_perm:[0,1,2,3] row_mask:0x2 bank_mask:0xf
  s_nop 1
  v_mov_b32_dpp v12, v20 quad_perm:[1,1,3,3] row_mask:0xf bank_mask:0xf
  v_cvt_pk_bf16_f32 v12, v20, v12
  v_lshlrev_b32 v13, 1, v0
  s_lshl_b32 s46, s25, 8
  s_lshl_b32 s47, s24, 6
  s_add_u32 s46, s46, s47
  s_add_u32 s46, s46, 2408448
  s_mov_b32 exec_lo, 0x55555555
  s_mov_b32 exec_hi, 0
  buffer_store_dword v12, v13, s[12:15], s46 offen sc1
  s_mov_b64 exec, -1
  s_waitcnt vmcnt(0) lgkmcnt(0)
  s_barrier
  v_bfe_u32 v14, v0, 2, 2
  v_lshl_add_u32 v14, v3, 3, v14
  v_and_b32 v15, 3, v0
  v_lshlrev_b32 v15, 3, v15
  v_lshl_add_u32 v16, v14, 10, v15
  s_lshl_b32 s46, s24, 8
  s_add_u32 s46, s46, 17408
  v_add_u32 v16, s46, v16
  v_add_u32 v17, 0x10000, v16
  ds_read_b64_tr_b16 a[128:129], v16 offset:0
  ds_read_b64_tr_b16 a[130:131], v16 offset:4096
  ds_read_b64_tr_b16 a[132:133], v16 offset:32768
  ds_read_b64_tr_b16 a[134:135], v16 offset:36864
  ds_read_b64_tr_b16 a[136:137], v17 offset:0
  ds_read_b64_tr_b16 a[138:139], v17 offset:4096
  ds_read_b64_tr_b16 a[140:141], v17 offset:32768
  ds_read_b64_tr_b16 a[142:143], v17 offset:36864
  ds_read_b64_tr_b16 a[144:145], v16 offset:32
  ds_read_b64_tr_b16 a[146:147], v16 offset:4128
  ds_read_b64_tr_b16 a[148:149], v16 offset:32800
  ds_read_b64_tr_b16 a[150:151], v16 offset:36896
  s_waitcnt lgkmcnt(8)
  ds_read_b64_tr_b16 a[152:153], v17 offset:32
  ds_read_b64_tr_b16 a[154:155], v17 offset:4128
  ds_read_b64_tr_b16 a[156:157], v17 offset:32800
  ds_read_b64_tr_b16 a[158:159], v17 offset:36896
  s_waitcnt lgkmcnt(8)
  ds_read_b64_tr_b16 a[160:161], v16 offset:64
  ds_read_b64_tr_b16 a[162:163], v16 offset:4160
  ds_read_b64_tr_b16 a[164:165], v16 offset:32832
  ds_read_b64_tr_b16 a[166:167], v16 offset:36928
  s_waitcnt lgkmcnt(8)
  ds_read_b64_tr_b16 a[168:169], v17 offset:64
  ds_read_b64_tr_b16 a[170:171], v17 offset:4160
  ds_read_b64_tr_b16 a[172:173], v17 offset:32832
  ds_read_b64_tr_b16 a[174:175], v17 offset:36928
  s_waitcnt lgkmcnt(8)
  ds_read_b64_tr_b16 a[176:177], v16 offset:96
  ds_read_b64_tr_b16 a[178:179], v16 offset:4192
  ds_read_b64_tr_b16 a[180:181], v16 offset:32864
  ds_read_b64_tr_b16 a[182:183], v16 offset:36960
  s_waitcnt lgkmcnt(8)
  ds_read_b64_tr_b16 a[184:185], v17 offset:96
  ds_read_b64_tr_b16 a[186:187], v17 offset:4192
  ds_read_b64_tr_b16 a[188:189], v17 offset:32864
  ds_read_b64_tr_b16 a[190:191], v17 offset:36960
  s_waitcnt lgkmcnt(8)
  ds_read_b64_tr_b16 a[192:193], v16 offset:128
  ds_read_b64_tr_b16 a[194:195], v16 offset:4224
  ds_read_b64_tr_b16 a[196:197], v16 offset:32896
  ds_read_b64_tr_b16 a[198:199], v16 offset:36992
  s_waitcnt lgkmcnt(8)
  ds_read_b64_tr_b16 a[200:201], v17 offset:128
  ds_read_b64_tr_b16 a[202:203], v17 offset:4224
  ds_read_b64_tr_b16 a[204:205], v17 offset:32896
  ds_read_b64_tr_b16 a[206:207], v17 offset:36992
  s_waitcnt lgkmcnt(8)
  ds_read_b64_tr_b16 a[208:209], v16 offset:160
  ds_read_b64_tr_b16 a[210:211], v16 offset:4256
  ds_read_b64_tr_b16 a[212:213], v16 offset:32928
  ds_read_b64_tr_b16 a[214:215], v16 offset:37024
  s_waitcnt lgkmcnt(8)
  ds_read_b64_tr_b16 a[216:217], v17 offset:160
  ds_read_b64_tr_b16 a[218:219], v17 offset:4256
  ds_read_b64_tr_b16 a[220:221], v17 offset:32928
  ds_read_b64_tr_b16 a[222:223], v17 offset:37024
  s_waitcnt lgkmcnt(8)
  ds_read_b64_tr_b16 a[224:225], v16 offset:192
  ds_read_b64_tr_b16 a[226:227], v16 offset:4288
  ds_read_b64_tr_b16 a[228:229], v16 offset:32960
  ds_read_b64_tr_b16 a[230:231], v16 offset:37056
  s_waitcnt lgkmcnt(8)
  ds_read_b64_tr_b16 a[232:233], v17 offset:192
  ds_read_b64_tr_b16 a[234:235], v17 offset:4288
  ds_read_b64_tr_b16 a[236:237], v17 offset:32960
  ds_read_b64_tr_b16 a[238:239], v17 offset:37056
  s_waitcnt lgkmcnt(8)
  ds_read_b64_tr_b16 a[240:241], v16 offset:224
  ds_read_b64_tr_b16 a[242:243], v16 offset:4320
  ds_read_b64_tr_b16 a[244:245], v16 offset:32992
  ds_read_b64_tr_b16 a[246:247], v16 offset:37088
  s_waitcnt lgkmcnt(8)
  ds_read_b64_tr_b16 a[248:249], v17 offset:224
  ds_read_b64_tr_b16 a[250:251], v17 offset:4320
  ds_read_b64_tr_b16 a[252:253], v17 offset:32992
  ds_read_b64_tr_b16 a[254:255], v17 offset:37088
  s_waitcnt lgkmcnt(8)
  s_waitcnt lgkmcnt(0)
  s_barrier
  v_lshrrev_b32 v12, 3, v0
  s_mov_b32 s46, 2752
  v_mul_lo_u32 v12, v12, s46
  v_and_b32 v13, 7, v0
  v_lshl_add_u32 v12, v13, 4, v12
  s_mov_b32 s20, s76
  s_and_b32 s21, s77, 0xffff
  s_mov_b32 s22, s3
  s_mov_b32 s23, 0x20000
  s_mul_i32 s50, s24, 352256
  s_lshl_b32 s46, s25, 7
  s_add_u32 s50, s50, s46
  s_lshl_b32 s51, s24, 14
  s_add_u32 s51, s51, 17408
  s_mov_b32 m0, s51
  s_nop 0
  buffer_load_dwordx4 v12, s[20:23], s50 offen nt lds
  s_add_u32 s50, s50, 22016
  s_add_u32 s51, s51, 1024
  s_mov_b32 m0, s51
  s_nop 0
  buffer_load_dwordx4 v12, s[20:23], s50 offen nt lds
  s_add_u32 s50, s50, 22016
  s_add_u32 s51, s51, 1024
  s_mov_b32 m0, s51
  s_nop 0
  buffer_load_dwordx4 v12, s[20:23], s50 offen nt lds
  s_add_u32 s50, s50, 22016
  s_add_u32 s51, s51, 1024
  s_mov_b32 m0, s51
  s_nop 0
  buffer_load_dwordx4 v12, s[20:23], s50 offen nt lds
  s_add_u32 s50, s50, 22016
  s_add_u32 s51, s51, 1024
  s_mov_b32 m0, s51
  s_nop 0
  buffer_load_dwordx4 v12, s[20:23], s50 offen nt lds
  s_add_u32 s50, s50, 22016
  s_add_u32 s51, s51, 1024
  s_mov_b32 m0, s51
  s_nop 0
  buffer_load_dwordx4 v12, s[20:23], s50 offen nt lds
  s_add_u32 s50, s50, 22016
  s_add_u32 s51, s51, 1024
  s_mov_b32 m0, s51
  s_nop 0
  buffer_load_dwordx4 v12, s[20:23], s50 offen nt lds
  s_add_u32 s50, s50, 22016
  s_add_u32 s51, s51, 1024
  s_mov_b32 m0, s51
  s_nop 0
  buffer_load_dwordx4 v12, s[20:23], s50 offen nt lds
  s_add_u32 s50, s50, 22016
  s_add_u32 s51, s51, 1024
  s_mov_b32 m0, s51
  s_nop 0
  buffer_load_dwordx4 v12, s[20:23], s50 offen nt lds
  s_add_u32 s50, s50, 22016
  s_add_u32 s51, s51, 1024
  s_mov_b32 m0, s51
  s_nop 0
  buffer_load_dwordx4 v12, s[20:23], s50 offen nt lds
  s_add_u32 s50, s50, 22016
  s_add_u32 s51, s51, 1024
  s_mov_b32 m0, s51
  s_nop 0
  buffer_load_dwordx4 v12, s[20:23], s50 offen nt lds
  s_add_u32 s50, s50, 22016
  s_add_u32 s51, s51, 1024
  s_mov_b32 m0, s51
  s_nop 0
  buffer_load_dwordx4 v12, s[20:23], s50 offen nt lds
  s_add_u32 s50, s50, 22016
  s_add_u32 s51, s51, 1024
  s_mov_b32 m0, s51
  s_nop 0
  buffer_load_dwordx4 v12, s[20:23], s50 offen nt lds
  s_add_u32 s50, s50, 22016
  s_add_u32 s51, s51, 1024
  s_mov_b32 m0, s51
  s_nop 0
  buffer_load_dwordx4 v12, s[20:23], s50 offen nt lds
  s_add_u32 s50, s50, 22016
  s_add_u32 s51, s51, 1024
  s_mov_b32 m0, s51
  s_nop 0
  buffer_load_dwordx4 v12, s[20:23], s50 offen nt lds
  s_add_u32 s50, s50, 22016
  s_add_u32 s51, s51, 1024
  s_mov_b32 m0, s51
  s_nop 0
  buffer_load_dwordx4 v12, s[20:23], s50 offen nt lds
  s_mov_b32 s20, s78
  s_and_b32 s21, s79, 0xffff
  s_mov_b32 s22, s3
  s_mov_b32 s23, 0x20000
  s_mul_i32 s50, s24, 352256
  s_lshl_b32 s46, s25, 7
  s_add_u32 s50, s50, s46
  s_lshl_b32 s51, s24, 14
  s_add_u32 s51, s51, 82944
  s_mov_b32 m0, s51
  s_nop 0
  buffer_load_dwordx4 v12, s[20:23], s50 offen nt lds
  s_add_u32 s50, s50, 22016
  s_add_u32 s51, s51, 1024
  s_mov_b32 m0, s51
  s_nop 0
  buffer_load_dwordx4 v12, s[20:23], s50 offen nt lds
  s_add_u32 s50, s50, 22016
  s_add_u32 s51, s51, 1024
  s_mov_b32 m0, s51
  s_nop 0
  buffer_load_dwordx4 v12, s[20:23], s50 offen nt lds
  s_add_u32 s50, s50, 22016
  s_add_u32 s51, s51, 1024
  s_mov_b32 m0, s51
  s_nop 0
  buffer_load_dwordx4 v12, s[20:23], s50 offen nt lds
  s_add_u32 s50, s50, 22016
  s_add_u32 s51, s51, 1024
  s_mov_b32 m0, s51
  s_nop 0
  buffer_load_dwordx4 v12, s[20:23], s50 offen nt lds
  s_add_u32 s50, s50, 22016
  s_add_u32 s51, s51, 1024
  s_mov_b32 m0, s51
  s_nop 0
  buffer_load_dwordx4 v12, s[20:23], s50 offen nt lds
  s_add_u32 s50, s50, 22016
  s_add_u32 s51, s51, 1024
  s_mov_b32 m0, s51
  s_nop 0
  buffer_load_dwordx4 v12, s[20:23], s50 offen nt lds
  s_add_u32 s50, s50, 22016
  s_add_u32 s51, s51, 1024
  s_mov_b32 m0, s51
  s_nop 0
  buffer_load_dwordx4 v12, s[20:23], s50 offen nt lds
  s_add_u32 s50, s50, 22016
  s_add_u32 s51, s51, 1024
  s_mov_b32 m0, s51
  s_nop 0
  buffer_load_dwordx4 v12, s[20:23], s50 offen nt lds
  s_add_u32 s50, s50, 22016
  s_add_u32 s51, s51, 1024
  s_mov_b32 m0, s51
  s_nop 0
  buffer_load_dwordx4 v12, s[20:23], s50 offen nt lds
  s_add_u32 s50, s50, 22016
  s_add_u32 s51, s51, 1024
  s_mov_b32 m0, s51
  s_nop 0
  buffer_load_dwordx4 v12, s[20:23], s50 offen nt lds
  s_add_u32 s50, s50, 22016
  s_add_u32 s51, s51, 1024
  s_mov_b32 m0, s51
  s_nop 0
  buffer_load_dwordx4 v12, s[20:23], s50 offen nt lds
  s_add_u32 s50, s50, 22016
  s_add_u32 s51, s51, 1024
  s_mov_b32 m0, s51
  s_nop 0
  buffer_load_dwordx4 v12, s[20:23], s50 offen nt lds
  s_add_u32 s50, s50, 22016
  s_add_u32 s51, s51, 1024
  s_mov_b32 m0, s51
  s_nop 0
  buffer_load_dwordx4 v12, s[20:23], s50 offen nt lds
  s_add_u32 s50, s50, 22016
  s_add_u32 s51, s51, 1024
  s_mov_b32 m0, s51
  s_nop 0
  buffer_load_dwordx4 v12, s[20:23], s50 offen nt lds
  s_add_u32 s50, s50, 22016
  s_add_u32 s51, s51, 1024
  s_mov_b32 m0, s51
  s_nop 0
  buffer_load_dwordx4 v12, s[20:23], s50 offen nt lds
  s_waitcnt vmcnt(0) lgkmcnt(0)
  s_barrier
  v_lshl_add_u32 v16, v14, 7, v15
  s_lshl_b32 s46, s24, 5
  s_add_u32 s46, s46, 17408
  v_add_u32 v16, s46, v16
  v_add_u32 v17, 0x10000, v16
  ds_read_b64_tr_b16 v[64:65], v16 offset:0
  ds_read_b64_tr_b16 v[66:67], v16 offset:512
  ds_read_b64_tr_b16 v[68:69], v16 offset:4096
  ds_read_b64_tr_b16 v[70:71], v16 offset:4608
  ds_read_b64_tr_b16 v[72:73], v16 offset:8192
  ds_read_b64_tr_b16 v[74:75], v16 offset:8704
  ds_read_b64_tr_b16 v[76:77], v16 offset:12288
  ds_read_b64_tr_b16 v[78:79], v16 offset:12800
  ds_read_b64_tr_b16 v[80:81], v16 offset:16384
  ds_read_b64_tr_b16 v[82:83], v16 offset:16896
  ds_read_b64_tr_b16 v[84:85], v16 offset:20480
  ds_read_b64_tr_b16 v[86:87], v16 offset:20992
  s_waitcnt lgkmcnt(8)
  ds_read_b64_tr_b16 v[88:89], v16 offset:24576
  ds_read_b64_tr_b16 v[90:91], v16 offset:25088
  ds_read_b64_tr_b16 v[92:93], v16 offset:28672
  ds_read_b64_tr_b16 v[94:95], v16 offset:29184
  s_waitcnt lgkmcnt(8)
  ds_read_b64_tr_b16 v[96:97], v16 offset:32768
  ds_read_b64_tr_b16 v[98:99], v16 offset:33280
  ds_read_b64_tr_b16 v[100:101], v16 offset:36864
  ds_read_b64_tr_b16 v[102:103], v16 offset:37376
  s_waitcnt lgkmcnt(8)
  ds_read_b64_tr_b16 v[104:105], v16 offset:40960
  ds_read_b64_tr_b16 v[106:107], v16 offset:41472
  ds_read_b64_tr_b16 v[108:109], v16 offset:45056
  ds_read_b64_tr_b16 v[110:111], v16 offset:45568
  s_waitcnt lgkmcnt(8)
  ds_read_b64_tr_b16 v[112:113], v16 offset:49152
  ds_read_b64_tr_b16 v[114:115], v16 offset:49664
  ds_read_b64_tr_b16 v[116:117], v16 offset:53248
  ds_read_b64_tr_b16 v[118:119], v16 offset:53760
  s_waitcnt lgkmcnt(8)
  ds_read_b64_tr_b16 v[120:121], v16 offset:57344
  ds_read_b64_tr_b16 v[122:123], v16 offset:57856
  ds_read_b64_tr_b16 v[124:125], v16 offset:61440
  ds_read_b64_tr_b16 v[126:127], v16 offset:61952
  s_waitcnt lgkmcnt(8)
  ds_read_b64_tr_b16 v[128:129], v17 offset:0
  ds_read_b64_tr_b16 v[130:131], v17 offset:512
  ds_read_b64_tr_b16 v[132:133], v17 offset:4096
  ds_read_b64_tr_b16 v[134:135], v17 offset:4608
  s_waitcnt lgkmcnt(8)
  ds_read_b64_tr_b16 v[136:137], v17 offset:8192
  ds_read_b64_tr_b16 v[138:139], v17 offset:8704
  ds_read_b64_tr_b16 v[140:141], v17 offset:12288
  ds_read_b64_tr_b16 v[142:143], v17 offset:12800
  s_waitcnt lgkmcnt(8)
  ds_read_b64_tr_b16 v[144:145], v17 offset:16384
  ds_read_b64_tr_b16 v[146:147], v17 offset:16896
  ds_read_b64_tr_b16 v[148:149], v17 offset:20480
  ds_read_b64_tr_b16 v[150:151], v17 offset:20992
  s_waitcnt lgkmcnt(8)
  ds_read_b64_tr_b16 v[152:153], v17 offset:24576
  ds_read_b64_tr_b16 v[154:155], v17 offset:25088
  ds_read_b64_tr_b16 v[156:157], v17 offset:28672
  ds_read_b64_tr_b16 v[158:159], v17 offset:29184
  s_waitcnt lgkmcnt(8)
  ds_read_b64_tr_b16 v[160:161], v17 offset:32768
  ds_read_b64_tr_b16 v[162:163], v17 offset:33280
  ds_read_b64_tr_b16 v[164:165], v17 offset:36864
  ds_read_b64_tr_b16 v[166:167], v17 offset:37376
  s_waitcnt lgkmcnt(8)
  ds_read_b64_tr_b16 v[168:169], v17 offset:40960
  ds_read_b64_tr_b16 v[170:171], v17 offset:41472
  ds_read_b64_tr_b16 v[172:173], v17 offset:45056
  ds_read_b64_tr_b16 v[174:175], v17 offset:45568
  s_waitcnt lgkmcnt(8)
  ds_read_b64_tr_b16 v[176:177], v17 offset:49152
  ds_read_b64_tr_b16 v[178:179], v17 offset:49664
  ds_read_b64_tr_b16 v[180:181], v17 offset:53248
  ds_read_b64_tr_b16 v[182:183], v17 offset:53760
  s_waitcnt lgkmcnt(8)
  ds_read_b64_tr_b16 v[184:185], v17 offset:57344
  ds_read_b64_tr_b16 v[186:187], v17 offset:57856
  ds_read_b64_tr_b16 v[188:189], v17 offset:61440
  ds_read_b64_tr_b16 v[190:191], v17 offset:61952
  s_waitcnt lgkmcnt(8)
  s_waitcnt lgkmcnt(0)
  s_barrier
  s_mov_b32 s20, s80
  s_and_b32 s21, s81, 0xffff
  s_mov_b32 s22, s3
  s_mov_b32 s23, 0x20000
  s_lshl_b32 s50, s25, 16
  s_lshl_b32 s46, s24, 14
  s_add_u32 s50, s50, s46
  s_lshl_b32 s51, s24, 14
  s_add_u32 s51, s51, 17408
  s_mov_b32 m0, s51
  s_nop 0
  buffer_load_dwordx4 v1, s[20:23], s50 offen nt lds
  s_add_u32 s50, s50, 1024
  s_add_u32 s51, s51, 1024
  s_mov_b32 m0, s51
  s_nop 0
  buffer_load_dwordx4 v1, s[20:23], s50 offen nt lds
  s_add_u32 s50, s50, 1024
  s_add_u32 s51, s51, 1024
  s_mov_b32 m0, s51
  s_nop 0
  buffer_load_dwordx4 v1, s[20:23], s50 offen nt lds
  s_add_u32 s50, s50, 1024
  s_add_u32 s51, s51, 1024
  s_mov_b32 m0, s51
  s_nop 0
  buffer_load_dwordx4 v1, s[20:23], s50 offen nt lds
  s_add_u32 s50, s50, 1024
  s_add_u32 s51, s51, 1024
  s_mov_b32 m0, s51
  s_nop 0
  buffer_load_dwordx4 v1, s[20:23], s50 offen nt lds
  s_add_u32 s50, s50, 1024
  s_add_u32 s51, s51, 1024
  s_mov_b32 m0, s51
  s_nop 0
  buffer_load_dwordx4 v1, s[20:23], s50 offen nt lds
  s_add_u32 s50, s50, 1024
  s_add_u32 s51, s51, 1024
  s_mov_b32 m0, s51
  s_nop 0
  buffer_load_dwordx4 v1, s[20:23], s50 offen nt lds
  s_add_u32 s50, s50, 1024
  s_add_u32 s51, s51, 1024
  s_mov_b32 m0, s51
  s_nop 0
  buffer_load_dwordx4 v1, s[20:23], s50 offen nt lds
  s_add_u32 s50, s50, 1024
  s_add_u32 s51, s51, 1024
  s_mov_b32 m0, s51
  s_nop 0
  buffer_load_dwordx4 v1, s[20:23], s50 offen nt lds
  s_add_u32 s50, s50, 1024
  s_add_u32 s51, s51, 1024
  s_mov_b32 m0, s51
  s_nop 0
  buffer_load_dwordx4 v1, s[20:23], s50 offen nt lds
  s_add_u32 s50, s50, 1024
  s_add_u32 s51, s51, 1024
  s_mov_b32 m0, s51
  s_nop 0
  buffer_load_dwordx4 v1, s[20:23], s50 offen nt lds
  s_add_u32 s50, s50, 1024
  s_add_u32 s51, s51, 1024
  s_mov_b32 m0, s51
  s_nop 0
  buffer_load_dwordx4 v1, s[20:23], s50 offen nt lds
  s_add_u32 s50, s50, 1024
  s_add_u32 s51, s51, 1024
  s_mov_b32 m0, s51
  s_nop 0
  buffer_load_dwordx4 v1, s[20:23], s50 offen nt lds
  s_add_u32 s50, s50, 1024
  s_add_u32 s51, s51, 1024
  s_mov_b32 m0, s51
  s_nop 0
  buffer_load_dwordx4 v1, s[20:23], s50 offen nt lds
  s_add_u32 s50, s50, 1024
  s_add_u32 s51, s51, 1024
  s_mov_b32 m0, s51
  s_nop 0
  buffer_load_dwordx4 v1, s[20:23], s50 offen nt lds
  s_add_u32 s50, s50, 1024
  s_add_u32 s51, s51, 1024
  s_mov_b32 m0, s51
  s_nop 0
  buffer_load_dwordx4 v1, s[20:23], s50 offen nt lds
  v_mov_b32 v16, 0x3f803f80
  v_mov_b32 v17, 0x3f803f80
  v_mov_b32 v18, 0x3f803f80
  v_mov_b32 v19, 0x3f803f80
  s_nop 1
  v_mfma_f32_16x16x32_bf16 v[20:23], v[16:19], v[64:67], 0
  v_mfma_f32_16x16x32_bf16 v[20:23], v[16:19], v[68:71], v[20:23]
  v_mfma_f32_16x16x32_bf16 v[20:23], v[16:19], v[72:75], v[20:23]
  v_mfma_f32_16x16x32_bf16 v[20:23], v[16:19], v[76:79], v[20:23]
  v_mfma_f32_16x16x32_bf16 v[20:23], v[16:19], v[80:83], v[20:23]
  v_mfma_f32_16x16x32_bf16 v[20:23], v[16:19], v[84:87], v[20:23]
  v_mfma_f32_16x16x32_bf16 v[20:23], v[16:19], v[88:91], v[20:23]
  v_mfma_f32_16x16x32_bf16 v[20:23], v[16:19], v[92:95], v[20:23]
  v_mfma_f32_16x16x32_bf16 v[20:23], v[16:19], v[96:99], v[20:23]
  v_mfma_f32_16x16x32_bf16 v[20:23], v[16:19], v[100:103], v[20:23]
  v_mfma_f32_16x16x32_bf16 v[20:23], v[16:19], v[104:107], v[20:23]
  v_mfma_f32_16x16x32_bf16 v[20:23], v[16:19], v[108:111], v[20:23]
  v_mfma_f32_16x16x32_bf16 v[20:23], v[16:19], v[112:115], v[20:23]
  v_mfma_f32_16x16x32_bf16 v[20:23], v[16:19], v[116:119], v[20:23]
  v_mfma_f32_16x16x32_bf16 v[20:23], v[16:19], v[120:123], v[20:23]
  v_mfma_f32_16x16x32_bf16 v[20:23], v[16:19], v[124:127], v[20:23]
  s_nop 7
  v_mov_b32 v7, v20
  v_mfma_f32_16x16x32_bf16 v[20:23], v[16:19], v[128:131], 0
  v_mfma_f32_16x16x32_bf16 v[20:23], v[16:19], v[132:135], v[20:23]
  v_mfma_f32_16x16x32_bf16 v[20:23], v[16:19], v[136:139], v[20:23]
  v_mfma_f32_16x16x32_bf16 v[20:23], v[16:19], v[140:143], v[20:23]
  v_mfma_f32_16x16x32_bf16 v[20:23], v[16:19], v[144:147], v[20:23]
  v_mfma_f32_16x16x32_bf16 v[20:23], v[16:19], v[148:151], v[20:23]
  v_mfma_f32_16x16x32_bf16 v[20:23], v[16:19], v[152:155], v[20:23]
  v_mfma_f32_16x16x32_bf16 v[20:23], v[16:19], v[156:159], v[20:23]
  v_mfma_f32_16x16x32_bf16 v[20:23], v[16:19], v[160:163], v[20:23]
  v_mfma_f32_16x16x32_bf16 v[20:23], v[16:19], v[164:167], v[20:23]
  v_mfma_f32_16x16x32_bf16 v[20:23], v[16:19], v[168:171], v[20:23]
  v_mfma_f32_16x16x32_bf16 v[20:23], v[16:19], v[172:175], v[20:23]
  v_mfma_f32_16x16x32_bf16 v[20:23], v[16:19], v[176:179], v[20:23]
  v_mfma_f32_16x16x32_bf16 v[20:23], v[16:19], v[180:183], v[20:23]
  v_mfma_f32_16x16x32_bf16 v[20:23], v[16:19], v[184:187], v[20:23]
  v_mfma_f32_16x16x32_bf16 v[20:23], v[16:19], v[188:191], v[20:23]
  s_nop 7
  v_mov_b32 v8, v20
  s_waitcnt vmcnt(0) lgkmcnt(0)
  v_bfe_u32 v12, v0, 2, 2
  v_lshlrev_b32 v12, 10, v12
  v_lshl_add_u32 v12, v3, 5, v12
  v_add_u32 v12, v12, v15
  s_lshl_b32 s46, s24, 14
  s_add_u32 s46, s46, 17408
  v_add_u32 v12, s46, v12
  ds_read_b64_tr_b16 v[192:193], v12 offset:0
  ds_read_b64_tr_b16 v[194:195], v12 offset:4096
  ds_read_b64_tr_b16 v[196:197], v12 offset:8192
  ds_read_b64_tr_b16 v[198:199], v12 offset:12288
  ds_read_b64_tr_b16 v[200:201], v12 offset:128
  ds_read_b64_tr_b16 v[202:203], v12 offset:4224
  ds_read_b64_tr_b16 v[204:205], v12 offset:8320
  ds_read_b64_tr_b16 v[206:207], v12 offset:12416
  ds_read_b64_tr_b16 v[208:209], v12 offset:256
  ds_read_b64_tr_b16 v[210:211], v12 offset:4352
  ds_read_b64_tr_b16 v[212:213], v12 offset:8448
  ds_read_b64_tr_b16 v[214:215], v12 offset:12544
  s_waitcnt lgkmcnt(8)
  ds_read_b64_tr_b16 v[216:217], v12 offset:384
  ds_read_b64_tr_b16 v[218:219], v12 offset:4480
  ds_read_b64_tr_b16 v[220:221], v12 offset:8576
  ds_read_b64_tr_b16 v[222:223], v12 offset:12672
  s_waitcnt lgkmcnt(8)
  ds_read_b64_tr_b16 v[224:225], v12 offset:512
  ds_read_b64_tr_b16 v[226:227], v12 offset:4608
  ds_read_b64_tr_b16 v[228:229], v12 offset:8704
  ds_read_b64_tr_b16 v[230:231], v12 offset:12800
  s_waitcnt lgkmcnt(8)
  ds_read_b64_tr_b16 v[232:233], v12 offset:640
  ds_read_b64_tr_b16 v[234:235], v12 offset:4736
  ds_read_b64_tr_b16 v[236:237], v12 offset:8832
  ds_read_b64_tr_b16 v[238:239], v12 offset:12928
  s_waitcnt lgkmcnt(8)
  ds_read_b64_tr_b16 v[240:241], v12 offset:768
  ds_read_b64_tr_b16 v[242:243], v12 offset:4864
  ds_read_b64_tr_b16 v[244:245], v12 offset:8960
  ds_read_b64_tr_b16 v[246:247], v12 offset:13056
  s_waitcnt lgkmcnt(8)
  ds_read_b64_tr_b16 v[248:249], v12 offset:896
  ds_read_b64_tr_b16 v[250:251], v12 offset:4992
  ds_read_b64_tr_b16 v[252:253], v12 offset:9088
  ds_read_b64_tr_b16 v[254:255], v12 offset:13184
  s_waitcnt lgkmcnt(8)
  s_waitcnt lgkmcnt(0)
  s_lshl_b32 s46, s24, 14
  s_add_u32 s46, s46, 17408
  v_add_u32 v13, s46, v1
  ds_write_b128 v13, v[192:195] offset:0
  ds_write_b128 v13, v[196:199] offset:1024
  ds_write_b128 v13, v[200:203] offset:2048
  ds_write_b128 v13, v[204:207] offset:3072
  ds_write_b128 v13, v[208:211] offset:4096
  ds_write_b128 v13, v[212:215] offset:5120
  ds_write_b128 v13, v[216:219] offset:6144
  ds_write_b128 v13, v[220:223] offset:7168
  ds_write_b128 v13, v[224:227] offset:8192
  ds_write_b128 v13, v[228:231] offset:9216
  ds_write_b128 v13, v[232:235] offset:10240
  ds_write_b128 v13, v[236:239] offset:11264
  s_waitcnt lgkmcnt(8)
  ds_write_b128 v13, v[240:243] offset:12288
  ds_write_b128 v13, v[244:247] offset:13312
  ds_write_b128 v13, v[248:251] offset:14336
  ds_write_b128 v13, v[252:255] offset:15360
  s_waitcnt lgkmcnt(8)
  s_waitcnt lgkmcnt(0)
  v_lshlrev_b32 v14, 6, v4
  v_lshl_add_u32 v14, v3, 4, v14
  v_add_u32 v14, s46, v14
  ds_read_b128 v[192:195], v14 offset:0
  ds_read_b128 v[196:199], v14 offset:1024
  ds_read_b128 v[200:203], v14 offset:2048
  ds_read_b128 v[204:207], v14 offset:3072
  ds_read_b128 v[208:211], v14 offset:4096
  ds_read_b128 v[212:215], v14 offset:5120
  ds_read_b128 v[216:219], v14 offset:6144
  ds_read_b128 v[220:223], v14 offset:7168
  ds_read_b128 v[224:227], v14 offset:8192
  ds_read_b128 v[228:231], v14 offset:9216
  ds_read_b128 v[232:235], v14 offset:10240
  ds_read_b128 v[236:239], v14 offset:11264
  s_waitcnt lgkmcnt(8)
  ds_read_b128 v[240:243], v14 offset:12288
  ds_read_b128 v[244:247], v14 offset:13312
  ds_read_b128 v[248:251], v14 offset:14336
  ds_read_b128 v[252:255], v14 offset:15360
  s_waitcnt lgkmcnt(8)
  s_waitcnt lgkmcnt(0)
  s_barrier
  s_lshl_b32 s46, s25, 8
  s_add_u32 s46, s46, 1835008
  v_lshlrev_b32 v14, 3, v0
  v_cmp_gt_u32 vcc, 28, v0
  s_nop 0
  s_mov_b64 s[48:49], vcc
  s_cmp_eq_u32 s24, 0
  s_nop 1
  s_cbranch_scc0 s1wok_100010
s1w_100009:
  v_mov_b32 v12, -1
  s_mov_b64 exec, s[48:49]
  buffer_load_dword v12, v14, s[12:15], s46 offen sc1
  s_mov_b64 exec, -1
  s_waitcnt vmcnt(0)
  v_cmp_ne_u32 vcc, -1, v12
  s_nop 0
  s_bcnt1_i32_b64 s50, vcc
  s_cmp_ge_u32 s50, 20
  s_cbranch_scc1 s1wok_100010
  s_sleep 8
  s_sub_u32 s39, s39, 1
  s_cmp_gt_i32 s39, 0
  s_cbranch_scc1 s1w_100009
s1wok_100010:
  s_barrier
  s_mul_i32 s62, s25, 28
  s_mul_i32 s47, s24, 7
  s_add_u32 s62, s62, s47
  s_lshl_b32 s62, s62, 9
  s_add_u32 s62, s62, 0
s1_100007:
  v_mov_b32 v12, 0
  v_mov_b32 v13, 0
  s_mov_b64 exec, s[48:49]
  buffer_load_dwordx2 v[12:13], v14, s[12:15], s46 offen sc1
  s_mov_b64 exec, -1
  buffer_load_dwordx2 v[20:21], v14, s[12:15], s62 offen offset:0 sc1
  buffer_load_dwordx2 v[22:23], v14, s[12:15], s62 offen offset:512 sc1
  buffer_load_dwordx2 v[24:25], v14, s[12:15], s62 offen offset:1024 sc1
  buffer_load_dwordx2 v[26:27], v14, s[12:15], s62 offen offset:1536 sc1
  buffer_load_dwordx2 v[28:29], v14, s[12:15], s62 offen offset:2048 sc1
  buffer_load_dwordx2 v[30:31], v14, s[12:15], s62 offen offset:2560 sc1
  buffer_load_dwordx2 v[32:33], v14, s[12:15], s62 offen offset:3072 sc1
  s_waitcnt vmcnt(7)
  v_mov_b32 v15, 0xff800000
  v_cndmask_b32 v16, v15, v12, s[48:49]
  v_mov_b32 v17, v16
  s_nop 1
  v_max_f32_dpp v17, v17, v17 row_ror:8 row_mask:0xf bank_mask:0xf
  s_nop 1
  v_max_f32_dpp v17, v17, v17 row_ror:4 row_mask:0xf bank_mask:0xf
  s_nop 1
  v_max_f32_dpp v17, v17, v17 row_ror:2 row_mask:0xf bank_mask:0xf
  s_nop 1
  v_max_f32_dpp v17, v17, v17 row_ror:1 row_mask:0xf bank_mask:0xf
  s_nop 1
  v_max_f32_dpp v17, v17, v17 row_bcast:15 row_mask:0xa bank_mask:0xf
  s_nop 1
  v_max_f32_dpp v17, v17, v17 row_bcast:31 row_mask:0xc bank_mask:0xf
  s_nop 0
  v_readlane_b32 s50, v17, 63
  s_nop 1
  v_subrev_f32 v16, s50, v16
  v_exp_f32 v16, v16
  s_nop 0
  v_mul_f32 v17, v16, v13
  s_nop 1
  v_add_f32_dpp v17, v17, v17 row_ror:8 row_mask:0xf bank_mask:0xf
  s_nop 1
  v_add_f32_dpp v17, v17, v17 row_ror:4 row_mask:0xf bank_mask:0xf
  s_nop 1
  v_add_f32_dpp v17, v17, v17 row_ror:2 row_mask:0xf bank_mask:0xf
  s_nop 1
  v_add_f32_dpp v17, v17, v17 row_ror:1 row_mask:0xf bank_mask:0xf
  s_nop 1
  v_add_f32_dpp v17, v17, v17 row_bcast:15 row_mask:0xa bank_mask:0xf
  s_nop 1
  v_add_f32_dpp v17, v17, v17 row_bcast:31 row_mask:0xc bank_mask:0xf
  s_nop 0
  v_readlane_b32 s50, v17, 63
  s_nop 1
  v_mov_b32 v17, s50
  v_rcp_f32 v17, v17
  s_nop 0
  v_mul_f32 v16, v16, v17
  s_mul_i32 s51, s24, 7
  s_add_u32 s52, s51, 0
  v_readlane_b32 s54, v16, s52
  s_add_u32 s52, s51, 1
  v_readlane_b32 s55, v16, s52
  s_add_u32 s52, s51, 2
  v_readlane_b32 s56, v16, s52
  s_add_u32 s52, s51, 3
  v_readlane_b32 s57, v16, s52
  s_add_u32 s52, s51, 4
  v_readlane_b32 s58, v16, s52
  s_add_u32 s52, s51, 5
  v_readlane_b32 s59, v16, s52
  s_add_u32 s52, s51, 6
  v_readlane_b32 s60, v16, s52
  s_waitcnt vmcnt(0)
  v_max_u32 v18, v12, v13
  v_max3_u32 v18, v18, v20, v21
  v_max3_u32 v18, v18, v22, v23
  v_max3_u32 v18, v18, v24, v25
  v_max3_u32 v18, v18, v26, v27
  v_max3_u32 v18, v18, v28, v29
  v_max3_u32 v18, v18, v30, v31
  v_max3_u32 v18, v18, v32, v33
  v_cmp_eq_u32 vcc, -1, v18
  s_nop 0
  s_cmp_lg_u64 vcc, 0
  s_cbranch_scc0 s1ok_100008
  s_sub_u32 s39, s39, 1
  s_cmp_gt_i32 s39, 0
  s_cbranch_scc1 s1_100007
s1ok_100008:
  v_mul_f32 v18, s54, v20
  v_mul_f32 v19, s54, v21
  v_fmac_f32 v18, s55, v22
  v_fmac_f32 v19, s55, v23
  v_fmac_f32 v18, s56, v24
  v_fmac_f32 v19, s56, v25
  v_fmac_f32 v18, s57, v26
  v_fmac_f32 v19, s57, v27
  v_fmac_f32 v18, s58, v28
  v_fmac_f32 v19, s58, v29
  v_fmac_f32 v18, s59, v30
  v_fmac_f32 v19, s59, v31
  v_fmac_f32 v18, s60, v32
  v_fmac_f32 v19, s60, v33
  s_lshl_b32 s46, s24, 9
  s_add_u32 s46, s46, 4096
  v_add_u32 v15, s46, v14
  ds_write_b64 v15, v[18:19]
  s_waitcnt lgkmcnt(0)
  s_barrier
  v_add_u32 v15, 4096, v14
  ds_read_b64 v[20:21], v15 offset:0
  ds_read_b64 v[22:23], v15 offset:512
  ds_read_b64 v[24:25], v15 offset:1024
  ds_read_b64 v[26:27], v15 offset:1536
  s_waitcnt lgkmcnt(0)
  v_add_f32 v20, v20, v22
  v_add_f32 v21, v21, v23
  v_add_f32 v24, v24, v26
  v_add_f32 v25, v25, v27
  v_add_f32 v20, v20, v24
  v_add_f32 v21, v21, v25
  v_cvt_pk_bf16_f32 v20, v20, v21
  s_lshl_b32 s46, s24, 8
  s_add_u32 s46, s46, 8192
  v_add_u32 v15, s46, v2
  ds_write_b32 v15, v20
  v_lshlrev_b32 v15, 4, v3
  v_add_u32 v15, s46, v15
  ds_read_b128 v[20:23], v15 offset:0
  ds_read_b128 v[24:27], v15 offset:64
  ds_read_b128 v[28:31], v15 offset:128
  ds_read_b128 v[32:35], v15 offset:192
  s_waitcnt lgkmcnt(0)
  v_mfma_f32_16x16x32_bf16 v[36:39], v[20:23], a[128:131], 0
  v_mfma_f32_16x16x32_bf16 v[36:39], v[24:27], a[132:135], v[36:39]
  v_mfma_f32_16x16x32_bf16 v[36:39], v[28:31], a[136:139], v[36:39]
  v_mfma_f32_16x16x32_bf16 v[36:39], v[32:35], a[140:143], v[36:39]
  v_mfma_f32_16x16x32_bf16 v[40:43], v[20:23], a[144:147], 0
  v_mfma_f32_16x16x32_bf16 v[40:43], v[24:27], a[148:151], v[40:43]
  v_mfma_f32_16x16x32_bf16 v[40:43], v[28:31], a[152:155], v[40:43]
  v_mfma_f32_16x16x32_bf16 v[40:43], v[32:35], a[156:159], v[40:43]
  v_mfma_f32_16x16x32_bf16 v[44:47], v[20:23], a[160:163], 0
  v_mfma_f32_16x16x32_bf16 v[44:47], v[24:27], a[164:167], v[44:47]
  v_mfma_f32_16x16x32_bf16 v[44:47], v[28:31], a[168:171], v[44:47]
  v_mfma_f32_16x16x32_bf16 v[44:47], v[32:35], a[172:175], v[44:47]
  v_mov_b32_dpp v52, v36 quad_perm:[0,1,2,3] row_mask:0x1 bank_mask:0xf
  v_mfma_f32_16x16x32_bf16 v[48:51], v[20:23], a[176:179], 0
  v_mfma_f32_16x16x32_bf16 v[48:51], v[24:27], a[180:183], v[48:51]
  v_mfma_f32_16x16x32_bf16 v[48:51], v[28:31], a[184:187], v[48:51]
  v_mfma_f32_16x16x32_bf16 v[48:51], v[32:35], a[188:191], v[48:51]
  v_mov_b32_dpp v52, v40 quad_perm:[0,1,2,3] row_mask:0x2 bank_mask:0xf
  v_mfma_f32_16x16x32_bf16 v[36:39], v[20:23], a[192:195], 0
  v_mfma_f32_16x16x32_bf16 v[36:39], v[24:27], a[196:199], v[36:39]
  v_mfma_f32_16x16x32_bf16 v[36:39], v[28:31], a[200:203], v[36:39]
  v_mfma_f32_16x16x32_bf16 v[36:39], v[32:35], a[204:207], v[36:39]
  v_mov_b32_dpp v52, v44 quad_perm:[0,1,2,3] row_mask:0x4 bank_mask:0xf
  v_mfma_f32_16x16x32_bf16 v[40:43], v[20:23], a[208:211], 0
  v_mfma_f32_16x16x32_bf16 v[40:43], v[24:27], a[212:215], v[40:43]
  v_mfma_f32_16x16x32_bf16 v[40:43], v[28:31], a[216:219], v[40:43]
  v_mfma_f32_16x16x32_bf16 v[40:43], v[32:35], a[220:223], v[40:43]
  v_mov_b32_dpp v52, v48 quad_perm:[0,1,2,3] row_mask:0x8 bank_mask:0xf
  v_mfma_f32_16x16x32_bf16 v[44:47], v[20:23], a[224:227], 0
  v_mfma_f32_16x16x32_bf16 v[44:47], v[24:27], a[228:231], v[44:47]
  v_mfma_f32_16x16x32_bf16 v[44:47], v[28:31], a[232:235], v[44:47]
  v_mfma_f32_16x16x32_bf16 v[44:47], v[32:35], a[236:239], v[44:47]
  v_mov_b32_dpp v53, v36 quad_perm:[0,1,2,3] row_mask:0x1 bank_mask:0xf
  v_mfma_f32_16x16x32_bf16 v[48:51], v[20:23], a[240:243], 0
  v_mfma_f32_16x16x32_bf16 v[48:51], v[24:27], a[244:247], v[48:51]
  v_mfma_f32_16x16x32_bf16 v[48:51], v[28:31], a[248:251], v[48:51]
  v_mfma_f32_16x16x32_bf16 v[48:51], v[32:35], a[252:255], v[48:51]
  v_mov_b32_dpp v53, v40 quad_perm:[0,1,2,3] row_mask:0x2 bank_mask:0xf
  s_nop 1
  v_mov_b32_dpp v53, v44 quad_perm:[0,1,2,3] row_mask:0x4 bank_mask:0xf
  s_nop 3
  v_mov_b32_dpp v53, v48 quad_perm:[0,1,2,3] row_mask:0x8 bank_mask:0xf
  v_lshlrev_b32 v15, 11, v3
  v_lshl_add_u32 v15, v4, 2, v15
  s_lshl_b32 s46, s24, 14
  s_lshl_b32 s47, s25, 6
  s_add_u32 s46, s46, s47
  s_add_u32 s46, s46, 1867776
  buffer_store_dword v52, v15, s[12:15], s46 offen sc1
  s_add_u32 s46, s46, 8192
  buffer_store_dword v53, v15, s[12:15], s46 offen sc1
  s_cmp_eq_u32 s24, 0
  s_cbranch_scc0 w0_100011
  s_lshl_b32 s46, s25, 11
  s_add_u32 s46, s46, 1867776
  s_lshl_b32 s47, s25, 5
  s_add_u32 s47, s47, 0
  v_and_b32 v24, 3, v0
  v_lshlrev_b32 v24, 3, v24
  s_nop 1
r16_100012:
  buffer_load_dwordx4 v[12:15], v1, s[12:15], s46 offen sc1
  buffer_load_dwordx4 v[16:19], v1, s[12:15], s46 offen offset:1024 sc1
  s_mov_b64 exec, -1
  buffer_load_dwordx2 v[20:21], v24, s[64:67], s47 offen
  s_waitcnt vmcnt(0)
  v_max_u32 v25, v12, v13
  v_max3_u32 v25, v25, v14, v15
  v_max3_u32 v25, v25, v16, v17
  v_max3_u32 v25, v25, v18, v19
  v_cmp_eq_u32 vcc, -1, v25
  s_nop 0
  s_cmp_lg_u64 vcc, 0
  s_cbranch_scc0 r16ok_100013
  s_sub_u32 s39, s39, 1
  s_cmp_gt_i32 s39, 0
  s_cbranch_scc1 r16_100012
r16ok_100013:
  v_add_f32 v12, v12, v16
  v_add_f32 v13, v13, v17
  v_add_f32 v14, v14, v18
  v_add_f32 v15, v15, v19
  v_add_f32_dpp v12, v12, v12 row_ror:4 row_mask:0xf bank_mask:0xf
  v_add_f32_dpp v13, v13, v13 row_ror:4 row_mask:0xf bank_mask:0xf
  v_add_f32_dpp v14, v14, v14 row_ror:4 row_mask:0xf bank_mask:0xf
  v_add_f32_dpp v15, v15, v15 row_ror:4 row_mask:0xf bank_mask:0xf
  v_add_f32_dpp v12, v12, v12 row_ror:8 row_mask:0xf bank_mask:0xf
  v_add_f32_dpp v13, v13, v13 row_ror:8 row_mask:0xf bank_mask:0xf
  v_add_f32_dpp v14, v14, v14 row_ror:8 row_mask:0xf bank_mask:0xf
  v_add_f32_dpp v15, v15, v15 row_ror:8 row_mask:0xf bank_mask:0xf
  v_mov_b32 v16, v12
  v_mov_b32 v17, v13
  v_mov_b32 v18, v14
  v_mov_b32 v19, v15
  v_permlane32_swap_b32 v12, v16
  v_permlane32_swap_b32 v13, v17
  v_permlane32_swap_b32 v14, v18
  v_permlane32_swap_b32 v15, v19
  v_add_f32 v12, v12, v16
  v_add_f32 v13, v13, v17
  v_add_f32 v14, v14, v18
  v_add_f32 v15, v15, v19
  v_mov_b32 v16, v12
  v_mov_b32 v17, v13
  v_mov_b32 v18, v14
  v_mov_b32 v19, v15
  v_permlane16_swap_b32 v12, v16
  v_permlane16_swap_b32 v13, v17
  v_permlane16_swap_b32 v14, v18
  v_permlane16_swap_b32 v15, v19
  v_add_f32 v12, v12, v16
  v_add_f32 v13, v13, v17
  v_add_f32 v14, v14, v18
  v_add_f32 v15, v15, v19
  v_lshlrev_b32 v16, 16, v20
  v_and_b32 v17, 0xffff0000, v20
  v_lshlrev_b32 v18, 16, v21
  v_and_b32 v19, 0xffff0000, v21
  v_cvt_pk_bf16_f32 v12, v12, v12
  v_and_b32 v12, 0xffff0000, v12
  v_cvt_pk_bf16_f32 v13, v13, v13
  v_and_b32 v13, 0xffff0000, v13
  v_cvt_pk_bf16_f32 v14, v14, v14
  v_and_b32 v14, 0xffff0000, v14
  v_cvt_pk_bf16_f32 v15, v15, v15
  v_and_b32 v15, 0xffff0000, v15
  v_add_f32 v12, v12, v16
  v_add_f32 v13, v13, v17
  v_add_f32 v14, v14, v18
  v_add_f32 v15, v15, v19
  v_cvt_pk_bf16_f32 v20, v12, v13
  v_cvt_pk_bf16_f32 v21, v14, v15
  s_lshl_b32 s46, s25, 5
  s_add_u32 s46, s46, 2129920
  s_mov_b64 exec, 0xf
  buffer_store_dwordx2 v[20:21], v24, s[12:15], s46 offen sc1
  s_mov_b64 exec, -1
w0_100011:
  s_cmp_lt_u32 s25, 22
  s_cbranch_scc0 f3_100014
  s_mov_b32 s46, 2129920
xa_100015:
  buffer_load_dwordx4 v[12:15], v1, s[12:15], s46 offen sc1
  s_waitcnt vmcnt(0)
  v_max_u32 v16, v12, v13
  v_max3_u32 v16, v16, v14, v15
  v_cmp_eq_u32 vcc, -1, v16
  s_nop 0
  s_cmp_lg_u64 vcc, 0
  s_cbranch_scc0 xaok_100016
  s_sub_u32 s39, s39, 1
  s_cmp_gt_i32 s39, 0
  s_cbranch_scc1 xa_100015
xaok_100016:
  v_add_u32 v16, s42, v1
  ds_write_b128 v16, v[12:15]
  ds_read_b128 v[28:31], v9 offset:0
  ds_read_b128 v[32:35], v9 offset:64
  ds_read_b128 v[36:39], v9 offset:128
  ds_read_b128 v[40:43], v9 offset:192
  s_waitcnt lgkmcnt(3)
  v_mfma_f32_16x16x32_bf16 v[20:23], v[28:31], v[64:67], 0
  v_mfma_f32_16x16x32_bf16 v[24:27], v[28:31], v[128:131], 0
  ds_read_b128 v[28:31], v9 offset:256
  v_lshlrev_b32 v50, 16, v12
  v_and_b32 v51, 0xffff0000, v12
  v_add_f32 v48, v50, v51
  s_waitcnt lgkmcnt(3)
  v_mfma_f32_16x16x32_bf16 v[20:23], v[32:35], v[68:71], v[20:23]
  v_mfma_f32_16x16x32_bf16 v[24:27], v[32:35], v[132:135], v[24:27]
  ds_read_b128 v[32:35], v9 offset:320
  v_mul_f32 v49, v50, v50
  v_fmac_f32 v49, v51, v51
  v_lshlrev_b32 v50, 16, v13
  v_and_b32 v51, 0xffff0000, v13
  s_waitcnt lgkmcnt(3)
  v_mfma_f32_16x16x32_bf16 v[20:23], v[36:39], v[72:75], v[20:23]
  v_mfma_f32_16x16x32_bf16 v[24:27], v[36:39], v[136:139], v[24:27]
  ds_read_b128 v[36:39], v9 offset:384
  v_add_f32 v48, v48, v50
  v_fmac_f32 v49, v50, v50
  v_add_f32 v48, v48, v51
  s_waitcnt lgkmcnt(3)
  v_mfma_f32_16x16x32_bf16 v[20:23], v[40:43], v[76:79], v[20:23]
  v_mfma_f32_16x16x32_bf16 v[24:27], v[40:43], v[140:143], v[24:27]
  ds_read_b128 v[40:43], v9 offset:448
  v_fmac_f32 v49, v51, v51
  v_lshlrev_b32 v50, 16, v14
  v_and_b32 v51, 0xffff0000, v14
  v_add_f32 v48, v48, v50
  s_waitcnt lgkmcnt(3)
  v_mfma_f32_16x16x32_bf16 v[20:23], v[28:31], v[80:83], v[20:23]
  v_mfma_f32_16x16x32_bf16 v[24:27], v[28:31], v[144:147], v[24:27]
  ds_read_b128 v[28:31], v9 offset:512
  v_fmac_f32 v49, v50, v50
  v_add_f32 v48, v48, v51
  v_fmac_f32 v49, v51, v51
  s_waitcnt lgkmcnt(3)
  v_mfma_f32_16x16x32_bf16 v[20:23], v[32:35], v[84:87], v[20:23]
  v_mfma_f32_16x16x32_bf16 v[24:27], v[32:35], v[148:151], v[24:27]
  ds_read_b128 v[32:35], v9 offset:576
  v_lshlrev_b32 v50, 16, v15
  v_and_b32 v51, 0xffff0000, v15
  v_add_f32 v48, v48, v50
  v_fmac_f32 v49, v50, v50
  s_waitcnt lgkmcnt(3)
  v_mfma_f32_16x16x32_bf16 v[20:23], v[36:39], v[88:91], v[20:23]
  v_mfma_f32_16x16x32_bf16 v[24:27], v[36:39], v[152:155], v[24:27]
  ds_read_b128 v[36:39], v9 offset:640
  v_add_f32 v48, v48, v51
  v_fmac_f32 v49, v51, v51
  s_nop 0
  v_add_f32_dpp v48, v48, v48 row_ror:8 row_mask:0xf bank_mask:0xf
  s_waitcnt lgkmcnt(3)
  v_mfma_f32_16x16x32_bf16 v[20:23], v[40:43], v[92:95], v[20:23]
  v_mfma_f32_16x16x32_bf16 v[24:27], v[40:43], v[156:159], v[24:27]
  ds_read_b128 v[40:43], v9 offset:704
  v_add_f32_dpp v49, v49, v49 row_ror:8 row_mask:0xf bank_mask:0xf
  v_add_f32_dpp v48, v48, v48 row_ror:4 row_mask:0xf bank_mask:0xf
  s_nop 0
  v_add_f32_dpp v49, v49, v49 row_ror:4 row_mask:0xf bank_mask:0xf
  v_add_f32_dpp v48, v48, v48 row_ror:2 row_mask:0xf bank_mask:0xf
  s_waitcnt lgkmcnt(3)
  v_mfma_f32_16x16x32_bf16 v[20:23], v[28:31], v[96:99], v[20:23]
  v_mfma_f32_16x16x32_bf16 v[24:27], v[28:31], v[160:163], v[24:27]
  ds_read_b128 v[28:31], v9 offset:768
  v_add_f32_dpp v49, v49, v49 row_ror:2 row_mask:0xf bank_mask:0xf
  v_add_f32_dpp v48, v48, v48 row_ror:1 row_mask:0xf bank_mask:0xf
  s_nop 0
  v_add_f32_dpp v49, v49, v49 row_ror:1 row_mask:0xf bank_mask:0xf
  s_waitcnt lgkmcnt(3)
  v_mfma_f32_16x16x32_bf16 v[20:23], v[32:35], v[100:103], v[20:23]
  v_mfma_f32_16x16x32_bf16 v[24:27], v[32:35], v[164:167], v[24:27]
  ds_read_b128 v[32:35], v9 offset:832
  v_add_f32_dpp v48, v48, v48 row_bcast:15 row_mask:0xa bank_mask:0xf
  v_add_f32_dpp v49, v49, v49 row_bcast:15 row_mask:0xa bank_mask:0xf
  s_nop 0
  v_add_f32_dpp v48, v48, v48 row_bcast:31 row_mask:0xc bank_mask:0xf
  v_add_f32_dpp v49, v49, v49 row_bcast:31 row_mask:0xc bank_mask:0xf
  s_waitcnt lgkmcnt(3)
  v_mfma_f32_16x16x32_bf16 v[20:23], v[36:39], v[104:107], v[20:23]
  v_mfma_f32_16x16x32_bf16 v[24:27], v[36:39], v[168:171], v[24:27]
  ds_read_b128 v[36:39], v9 offset:896
  v_readlane_b32 s54, v48, 63
  v_readlane_b32 s55, v49, 63
  s_nop 0
  v_mov_b32 v44, s54
  s_waitcnt lgkmcnt(3)
  v_mfma_f32_16x16x32_bf16 v[20:23], v[40:43], v[108:111], v[20:23]
  v_mfma_f32_16x16x32_bf16 v[24:27], v[40:43], v[172:175], v[24:27]
  ds_read_b128 v[40:43], v9 offset:960
  v_mov_b32 v45, s55
  v_mul_f32 v44, 0x3b000000, v44
  v_mul_f32 v45, 0x3b000000, v45
  v_fma_f32 v45, -v44, v44, v45
  s_waitcnt lgkmcnt(3)
  v_mfma_f32_16x16x32_bf16 v[20:23], v[28:31], v[112:115], v[20:23]
  v_mfma_f32_16x16x32_bf16 v[24:27], v[28:31], v[176:179], v[24:27]
  v_max_f32 v45, 0, v45
  v_cvt_pk_bf16_f32 v44, v44, v44
  v_cvt_pk_bf16_f32 v45, v45, v45
  s_waitcnt lgkmcnt(2)
  v_mfma_f32_16x16x32_bf16 v[20:23], v[32:35], v[116:119], v[20:23]
  v_mfma_f32_16x16x32_bf16 v[24:27], v[32:35], v[180:183], v[24:27]
  v_and_b32 v44, 0xffff0000, v44
  v_and_b32 v45, 0xffff0000, v45
  v_add_f32 v45, 0x3727c5ac, v45
  v_cvt_pk_bf16_f32 v45, v45, v45
  s_waitcnt lgkmcnt(1)
  v_mfma_f32_16x16x32_bf16 v[20:23], v[36:39], v[120:123], v[20:23]
  v_mfma_f32_16x16x32_bf16 v[24:27], v[36:39], v[184:187], v[24:27]
  v_and_b32 v45, 0xffff0000, v45
  v_sqrt_f32 v45, v45
  s_nop 0
  v_cvt_pk_bf16_f32 v45, v45, v45
  s_waitcnt lgkmcnt(0)
  v_mfma_f32_16x16x32_bf16 v[20:23], v[40:43], v[124:127], v[20:23]
  v_mfma_f32_16x16x32_bf16 v[24:27], v[40:43], v[188:191], v[24:27]
  v_and_b32 v45, 0xffff0000, v45
  v_rcp_f32 v45, v45
  v_mul_f32 v46, v44, v7
  v_mul_f32 v47, v44, v8
  s_nop 2
  v_sub_f32 v20, v20, v46
  v_sub_f32 v24, v24, v47
  v_mul_f32 v20, v20, v45
  v_mul_f32 v24, v24, v45
  v_cvt_pk_bf16_f32 v20, v20, v20
  v_and_b32 v20, 0xffff0000, v20
  v_cvt_pk_bf16_f32 v24, v24, v24
  v_and_b32 v24, 0xffff0000, v24
  v_mul_f32 v12, v20, v24
  s_nop 1
  v_mov_b32_dpp v13, v12 quad_perm:[1,1,3,3] row_mask:0xf bank_mask:0xf
  v_cvt_pk_bf16_f32 v12, v12, v13
  s_nop 1
  v_and_b32_dpp v28, v12, v11 row_newbcast:0 row_mask:0xf bank_mask:0xf
  v_and_b32_dpp v29, v12, v11 row_newbcast:2 row_mask:0xf bank_mask:0xf
  v_and_b32_dpp v30, v12, v11 row_newbcast:4 row_mask:0xf bank_mask:0xf
  v_and_b32_dpp v31, v12, v11 row_newbcast:6 row_mask:0xf bank_mask:0xf
  v_and_b32_dpp v32, v12, v11 row_newbcast:8 row_mask:0xf bank_mask:0xf
  v_and_b32_dpp v33, v12, v11 row_newbcast:10 row_mask:0xf bank_mask:0xf
  v_and_b32_dpp v34, v12, v11 row_newbcast:12 row_mask:0xf bank_mask:0xf
  v_and_b32_dpp v35, v12, v11 row_newbcast:14 row_mask:0xf bank_mask:0xf
  s_lshl_b32 s46, s24, 11
  s_add_u32 s46, s46, 9216
  v_lshlrev_b32 v14, 4, v4
  v_add_u32 v14, s46, v14
  v_mfma_f32_16x16x32_bf16 v[36:39], v[28:31], v[192:195], 0
  v_mfma_f32_16x16x32_bf16 v[36:39], v[32:35], v[196:199], v[36:39]
  v_mfma_f32_16x16x32_bf16 v[40:43], v[28:31], v[200:203], 0
  v_mfma_f32_16x16x32_bf16 v[40:43], v[32:35], v[204:207], v[40:43]
  v_mfma_f32_16x16x32_bf16 v[44:47], v[28:31], v[208:211], 0
  v_mfma_f32_16x16x32_bf16 v[44:47], v[32:35], v[212:215], v[44:47]
  s_mov_b64 exec, 0xffff
  s_nop 2
  ds_write_b128 v14, v[36:39] offset:0
  s_mov_b64 exec, -1
  v_mfma_f32_16x16x32_bf16 v[48:51], v[28:31], v[216:219], 0
  v_mfma_f32_16x16x32_bf16 v[48:51], v[32:35], v[220:223], v[48:51]
  s_mov_b64 exec, 0xffff
  ds_write_b128 v14, v[40:43] offset:256
  s_mov_b64 exec, -1
  v_mfma_f32_16x16x32_bf16 v[36:39], v[28:31], v[224:227], 0
  v_mfma_f32_16x16x32_bf16 v[36:39], v[32:35], v[228:231], v[36:39]
  s_mov_b64 exec, 0xffff
  ds_write_b128 v14, v[44:47] offset:512
  s_mov_b64 exec, -1
  v_mfma_f32_16x16x32_bf16 v[40:43], v[28:31], v[232:235], 0
  v_mfma_f32_16x16x32_bf16 v[40:43], v[32:35], v[236:239], v[40:43]
  s_mov_b64 exec, 0xffff
  ds_write_b128 v14, v[48:51] offset:768
  s_mov_b64 exec, -1
  v_mfma_f32_16x16x32_bf16 v[44:47], v[28:31], v[240:243], 0
  v_mfma_f32_16x16x32_bf16 v[44:47], v[32:35], v[244:247], v[44:47]
  s_mov_b64 exec, 0xffff
  ds_write_b128 v14, v[36:39] offset:1024
  s_mov_b64 exec, -1
  v_mfma_f32_16x16x32_bf16 v[48:51], v[28:31], v[248:251], 0
  v_mfma_f32_16x16x32_bf16 v[48:51], v[32:35], v[252:255], v[48:51]
  s_mov_b64 exec, 0xffff
  ds_write_b128 v14, v[40:43] offset:1280
  s_mov_b64 exec, -1
  s_mov_b64 exec, 0xffff
  ds_write_b128 v14, v[44:47] offset:1536
  s_mov_b64 exec, -1
  s_mov_b64 exec, 0xffff
  s_nop 0
  ds_write_b128 v14, v[48:51] offset:1792
  s_mov_b64 exec, -1
  s_waitcnt lgkmcnt(0)
  s_barrier
  s_lshl_b32 s46, s24, 9
  s_add_u32 s46, s46, 9216
  v_lshlrev_b32 v14, 3, v0
  v_add_u32 v15, s46, v14
  ds_read_b64 v[20:21], v15 offset:0
  ds_read_b64 v[22:23], v15 offset:2048
  ds_read_b64 v[24:25], v15 offset:4096
  ds_read_b64 v[26:27], v15 offset:6144
  s_waitcnt lgkmcnt(0)
  v_add_f32 v20, v20, v22
  v_add_f32 v21, v21, v23
  v_add_f32 v24, v24, v26
  v_add_f32 v25, v25, v27
  v_add_f32 v20, v20, v24
  v_add_f32 v21, v21, v25
  v_lshrrev_b32 v14, 3, v0
  v_lshlrev_b32 v14, 11, v14
  v_and_b32 v15, 7, v0
  v_lshl_add_u32 v14, v15, 3, v14
  s_lshl_b32 s46, s24, 14
  s_lshl_b32 s47, s25, 6
  s_add_u32 s46, s46, s47
  s_add_u32 s46, s46, 2138112
  buffer_store_dwordx2 v[20:21], v14, s[12:15], s46 offen sc1
  s_barrier
f3_100014:
  s_cmp_eq_u32 s24, 1
  s_cbranch_scc0 w1_100017
  s_lshl_b32 s46, s25, 11
  s_add_u32 s46, s46, 2138112
  s_lshl_b32 s47, s25, 5
  s_add_u32 s47, s47, 2129920
  v_and_b32 v24, 3, v0
  v_lshlrev_b32 v24, 3, v24
  v_cmp_gt_u32 vcc, 24, v0
  s_nop 0
  s_mov_b64 s[48:49], vcc
  s_nop 2
r16_100018:
  buffer_load_dwordx4 v[12:15], v1, s[12:15], s46 offen sc1
  v_mov_b32 v16, 0
  v_mov_b32 v17, 0
  v_mov_b32 v18, 0
  v_mov_b32 v19, 0
  s_mov_b64 exec, s[48:49]
  buffer_load_dwordx4 v[16:19], v1, s[12:15], s46 offen offset:1024 sc1
  s_mov_b64 exec, -1
  buffer_load_dwordx2 v[20:21], v24, s[12:15], s47 offen sc1
  s_waitcnt vmcnt(0)
  v_max_u32 v25, v12, v13
  v_max3_u32 v25, v25, v14, v15
  v_max3_u32 v25, v25, v16, v17
  v_max3_u32 v25, v25, v18, v19
  v_max3_u32 v25, v25, v20, v21
  v_cmp_eq_u32 vcc, -1, v25
  s_nop 0
  s_cmp_lg_u64 vcc, 0
  s_cbranch_scc0 r16ok_100019
  s_sub_u32 s39, s39, 1
  s_cmp_gt_i32 s39, 0
  s_cbranch_scc1 r16_100018
r16ok_100019:
  v_add_f32 v12, v12, v16
  v_add_f32 v13, v13, v17
  v_add_f32 v14, v14, v18
  v_add_f32 v15, v15, v19
  v_add_f32_dpp v12, v12, v12 row_ror:4 row_mask:0xf bank_mask:0xf
  v_add_f32_dpp v13, v13, v13 row_ror:4 row_mask:0xf bank_mask:0xf
  v_add_f32_dpp v14, v14, v14 row_ror:4 row_mask:0xf bank_mask:0xf
  v_add_f32_dpp v15, v15, v15 row_ror:4 row_mask:0xf bank_mask:0xf
  v_add_f32_dpp v12, v12, v12 row_ror:8 row_mask:0xf bank_mask:0xf
  v_add_f32_dpp v13, v13, v13 row_ror:8 row_mask:0xf bank_mask:0xf
  v_add_f32_dpp v14, v14, v14 row_ror:8 row_mask:0xf bank_mask:0xf
  v_add_f32_dpp v15, v15, v15 row_ror:8 row_mask:0xf bank_mask:0xf
  v_mov_b32 v16, v12
  v_mov_b32 v17, v13
  v_mov_b32 v18, v14
  v_mov_b32 v19, v15
  v_permlane32_swap_b32 v12, v16
  v_permlane32_swap_b32 v13, v17
  v_permlane32_swap_b32 v14, v18
  v_permlane32_swap_b32 v15, v19
  v_add_f32 v12, v12, v16
  v_add_f32 v13, v13, v17
  v_add_f32 v14, v14, v18
  v_add_f32 v15, v15, v19
  v_mov_b32 v16, v12
  v_mov_b32 v17, v13
  v_mov_b32 v18, v14
  v_mov_b32 v19, v15
  v_permlane16_swap_b32 v12, v16
  v_permlane16_swap_b32 v13, v17
  v_permlane16_swap_b32 v14, v18
  v_permlane16_swap_b32 v15, v19
  v_add_f32 v12, v12, v16
  v_add_f32 v13, v13, v17
  v_add_f32 v14, v14, v18
  v_add_f32 v15, v15, v19
  v_lshlrev_b32 v16, 16, v20
  v_and_b32 v17, 0xffff0000, v20
  v_lshlrev_b32 v18, 16, v21
  v_and_b32 v19, 0xffff0000, v21
  v_cvt_pk_bf16_f32 v12, v12, v12
  v_and_b32 v12, 0xffff0000, v12
  v_cvt_pk_bf16_f32 v13, v13, v13
  v_and_b32 v13, 0xffff0000, v13
  v_cvt_pk_bf16_f32 v14, v14, v14
  v_and_b32 v14, 0xffff0000, v14
  v_cvt_pk_bf16_f32 v15, v15, v15
  v_and_b32 v15, 0xffff0000, v15
  v_add_f32 v12, v12, v16
  v_add_f32 v13, v13, v17
  v_add_f32 v14, v14, v18
  v_add_f32 v15, v15, v19
  v_cvt_pk_bf16_f32 v20, v12, v13
  v_cvt_pk_bf16_f32 v21, v14, v15
  s_lshl_b32 s46, s25, 5
  s_add_u32 s46, s46, 2134016
  s_mov_b64 exec, 0xf
  buffer_store_dwordx2 v[20:21], v24, s[12:15], s46 offen sc1
  s_mov_b64 exec, -1
w1_100017:
  s_mov_b32 s46, 2134016
xa_100020:
  buffer_load_dwordx4 v[12:15], v1, s[12:15], s46 offen sc1
  s_waitcnt vmcnt(0)
  v_max_u32 v16, v12, v13
  v_max3_u32 v16, v16, v14, v15
  v_cmp_eq_u32 vcc, -1, v16
  s_nop 0
  s_cmp_lg_u64 vcc, 0
  s_cbranch_scc0 xaok_100021
  s_sub_u32 s39, s39, 1
  s_cmp_gt_i32 s39, 0
  s_cbranch_scc1 xa_100020
xaok_100021:
  v_add_u32 v16, s42, v1
  ds_write_b128 v16, v[12:15]
  ds_read_b128 v[28:31], v9 offset:0
  ds_read_b128 v[32:35], v9 offset:64
  ds_read_b128 v[36:39], v9 offset:128
  ds_read_b128 v[40:43], v9 offset:192
  s_waitcnt lgkmcnt(3)
  v_mfma_f32_16x16x32_bf16 v[20:23], v[28:31], a[0:3], 0
  v_mfma_f32_16x16x32_bf16 v[24:27], v[28:31], a[64:67], 0
  ds_read_b128 v[28:31], v9 offset:256
  v_lshlrev_b32 v50, 16, v12
  v_and_b32 v51, 0xffff0000, v12
  v_add_f32 v48, v50, v51
  s_waitcnt lgkmcnt(3)
  v_mfma_f32_16x16x32_bf16 v[20:23], v[32:35], a[4:7], v[20:23]
  v_mfma_f32_16x16x32_bf16 v[24:27], v[32:35], a[68:71], v[24:27]
  ds_read_b128 v[32:35], v9 offset:320
  v_mul_f32 v49, v50, v50
  v_fmac_f32 v49, v51, v51
  v_lshlrev_b32 v50, 16, v13
  v_and_b32 v51, 0xffff0000, v13
  s_waitcnt lgkmcnt(3)
  v_mfma_f32_16x16x32_bf16 v[20:23], v[36:39], a[8:11], v[20:23]
  v_mfma_f32_16x16x32_bf16 v[24:27], v[36:39], a[72:75], v[24:27]
  ds_read_b128 v[36:39], v9 offset:384
  v_add_f32 v48, v48, v50
  v_fmac_f32 v49, v50, v50
  v_add_f32 v48, v48, v51
  s_waitcnt lgkmcnt(3)
  v_mfma_f32_16x16x32_bf16 v[20:23], v[40:43], a[12:15], v[20:23]
  v_mfma_f32_16x16x32_bf16 v[24:27], v[40:43], a[76:79], v[24:27]
  ds_read_b128 v[40:43], v9 offset:448
  v_fmac_f32 v49, v51, v51
  v_lshlrev_b32 v50, 16, v14
  v_and_b32 v51, 0xffff0000, v14
  v_add_f32 v48, v48, v50
  s_waitcnt lgkmcnt(3)
  v_mfma_f32_16x16x32_bf16 v[20:23], v[28:31], a[16:19], v[20:23]
  v_mfma_f32_16x16x32_bf16 v[24:27], v[28:31], a[80:83], v[24:27]
  ds_read_b128 v[28:31], v9 offset:512
  v_fmac_f32 v49, v50, v50
  v_add_f32 v48, v48, v51
  v_fmac_f32 v49, v51, v51
  s_waitcnt lgkmcnt(3)
  v_mfma_f32_16x16x32_bf16 v[20:23], v[32:35], a[20:23], v[20:23]
  v_mfma_f32_16x16x32_bf16 v[24:27], v[32:35], a[84:87], v[24:27]
  ds_read_b128 v[32:35], v9 offset:576
  v_lshlrev_b32 v50, 16, v15
  v_and_b32 v51, 0xffff0000, v15
  v_add_f32 v48, v48, v50
  v_fmac_f32 v49, v50, v50
  s_waitcnt lgkmcnt(3)
  v_mfma_f32_16x16x32_bf16 v[20:23], v[36:39], a[24:27], v[20:23]
  v_mfma_f32_16x16x32_bf16 v[24:27], v[36:39], a[88:91], v[24:27]
  ds_read_b128 v[36:39], v9 offset:640
  v_add_f32 v48, v48, v51
  v_fmac_f32 v49, v51, v51
  s_nop 0
  v_add_f32_dpp v48, v48, v48 row_ror:8 row_mask:0xf bank_mask:0xf
  s_waitcnt lgkmcnt(3)
  v_mfma_f32_16x16x32_bf16 v[20:23], v[40:43], a[28:31], v[20:23]
  v_mfma_f32_16x16x32_bf16 v[24:27], v[40:43], a[92:95], v[24:27]
  ds_read_b128 v[40:43], v9 offset:704
  v_add_f32_dpp v49, v49, v49 row_ror:8 row_mask:0xf bank_mask:0xf
  v_add_f32_dpp v48, v48, v48 row_ror:4 row_mask:0xf bank_mask:0xf
  s_nop 0
  v_add_f32_dpp v49, v49, v49 row_ror:4 row_mask:0xf bank_mask:0xf
  v_add_f32_dpp v48, v48, v48 row_ror:2 row_mask:0xf bank_mask:0xf
  s_waitcnt lgkmcnt(3)
  v_mfma_f32_16x16x32_bf16 v[20:23], v[28:31], a[32:35], v[20:23]
  v_mfma_f32_16x16x32_bf16 v[24:27], v[28:31], a[96:99], v[24:27]
  ds_read_b128 v[28:31], v9 offset:768
  v_add_f32_dpp v49, v49, v49 row_ror:2 row_mask:0xf bank_mask:0xf
  v_add_f32_dpp v48, v48, v48 row_ror:1 row_mask:0xf bank_mask:0xf
  s_nop 0
  v_add_f32_dpp v49, v49, v49 row_ror:1 row_mask:0xf bank_mask:0xf
  s_waitcnt lgkmcnt(3)
  v_mfma_f32_16x16x32_bf16 v[20:23], v[32:35], a[36:39], v[20:23]
  v_mfma_f32_16x16x32_bf16 v[24:27], v[32:35], a[100:103], v[24:27]
  ds_read_b128 v[32:35], v9 offset:832
  v_add_f32_dpp v48, v48, v48 row_bcast:15 row_mask:0xa bank_mask:0xf
  v_add_f32_dpp v49, v49, v49 row_bcast:15 row_mask:0xa bank_mask:0xf
  s_nop 0
  v_add_f32_dpp v48, v48, v48 row_bcast:31 row_mask:0xc bank_mask:0xf
  v_add_f32_dpp v49, v49, v49 row_bcast:31 row_mask:0xc bank_mask:0xf
  s_waitcnt lgkmcnt(3)
  v_mfma_f32_16x16x32_bf16 v[20:23], v[36:39], a[40:43], v[20:23]
  v_mfma_f32_16x16x32_bf16 v[24:27], v[36:39], a[104:107], v[24:27]
  ds_read_b128 v[36:39], v9 offset:896
  v_readlane_b32 s54, v48, 63
  v_readlane_b32 s55, v49, 63
  s_nop 0
  v_mov_b32 v44, s54
  s_waitcnt lgkmcnt(3)
  v_mfma_f32_16x16x32_bf16 v[20:23], v[40:43], a[44:47], v[20:23]
  v_mfma_f32_16x16x32_bf16 v[24:27], v[40:43], a[108:111], v[24:27]
  ds_read_b128 v[40:43], v9 offset:960
  v_mov_b32 v45, s55
  v_mul_f32 v44, 0x3b000000, v44
  v_mul_f32 v45, 0x3b000000, v45
  v_fma_f32 v45, -v44, v44, v45
  s_waitcnt lgkmcnt(3)
  v_mfma_f32_16x16x32_bf16 v[20:23], v[28:31], a[48:51], v[20:23]
  v_mfma_f32_16x16x32_bf16 v[24:27], v[28:31], a[112:115], v[24:27]
  v_max_f32 v45, 0, v45
  v_cvt_pk_bf16_f32 v44, v44, v44
  v_cvt_pk_bf16_f32 v45, v45, v45
  s_waitcnt lgkmcnt(2)
  v_mfma_f32_16x16x32_bf16 v[20:23], v[32:35], a[52:55], v[20:23]
  v_mfma_f32_16x16x32_bf16 v[24:27], v[32:35], a[116:119], v[24:27]
  v_and_b32 v44, 0xffff0000, v44
  v_and_b32 v45, 0xffff0000, v45
  v_add_f32 v45, 0x3727c5ac, v45
  v_cvt_pk_bf16_f32 v45, v45, v45
  s_waitcnt lgkmcnt(1)
  v_mfma_f32_16x16x32_bf16 v[20:23], v[36:39], a[56:59], v[20:23]
  v_mfma_f32_16x16x32_bf16 v[24:27], v[36:39], a[120:123], v[24:27]
  v_and_b32 v45, 0xffff0000, v45
  v_sqrt_f32 v45, v45
  s_nop 0
  v_cvt_pk_bf16_f32 v45, v45, v45
  s_waitcnt lgkmcnt(0)
  v_mfma_f32_16x16x32_bf16 v[20:23], v[40:43], a[60:63], v[20:23]
  v_mfma_f32_16x16x32_bf16 v[24:27], v[40:43], a[124:127], v[24:27]
  v_and_b32 v45, 0xffff0000, v45
  v_rcp_f32 v45, v45
  v_mul_f32 v46, v44, v5
  v_mul_f32 v47, v44, v6
  s_nop 2
  v_sub_f32 v20, v20, v46
  v_sub_f32 v24, v24, v47
  v_mul_f32 v20, v20, v45
  v_mul_f32 v24, v24, v45
  s_nop 1
  v_mov_b32_dpp v20, v24 quad_perm:[0,1,2,3] row_mask:0x2 bank_mask:0xf
  s_nop 1
  v_mov_b32_dpp v12, v20 quad_perm:[1,1,3,3] row_mask:0xf bank_mask:0xf
  v_cvt_pk_bf16_f32 v12, v20, v12
  v_lshlrev_b32 v13, 1, v0
  s_lshl_b32 s46, s25, 8
  s_lshl_b32 s47, s24, 6
  s_add_u32 s46, s46, s47
  s_add_u32 s46, s46, 2416640
  s_mov_b32 exec_lo, 0x55555555
  s_mov_b32 exec_hi, 0
  buffer_store_dword v12, v13, s[12:15], s46 offen sc1
  s_mov_b64 exec, -1
  s_lshl_b32 s46, s25, 8
  s_add_u32 s46, s46, 1843200
  v_lshlrev_b32 v14, 3, v0
  v_cmp_gt_u32 vcc, 28, v0
  s_nop 0
  s_mov_b64 s[48:49], vcc
  s_cmp_eq_u32 s24, 0
  s_nop 1
  s_cbranch_scc0 s1wok_100025
s1w_100024:
  v_mov_b32 v12, -1
  s_mov_b64 exec, s[48:49]
  buffer_load_dword v12, v14, s[12:15], s46 offen sc1
  s_mov_b64 exec, -1
  s_waitcnt vmcnt(0)
  v_cmp_ne_u32 vcc, -1, v12
  s_nop 0
  s_bcnt1_i32_b64 s50, vcc
  s_cmp_ge_u32 s50, 20
  s_cbranch_scc1 s1wok_100025
  s_sleep 8
  s_sub_u32 s39, s39, 1
  s_cmp_gt_i32 s39, 0
  s_cbranch_scc1 s1w_100024
s1wok_100025:
  s_barrier
  s_mul_i32 s62, s25, 28
  s_mul_i32 s47, s24, 7
  s_add_u32 s62, s62, s47
  s_lshl_b32 s62, s62, 9
  s_add_u32 s62, s62, 458752
s1_100022:
  v_mov_b32 v12, 0
  v_mov_b32 v13, 0
  s_mov_b64 exec, s[48:49]
  buffer_load_dwordx2 v[12:13], v14, s[12:15], s46 offen sc1
  s_mov_b64 exec, -1
  buffer_load_dwordx2 v[20:21], v14, s[12:15], s62 offen offset:0 sc1
  buffer_load_dwordx2 v[22:23], v14, s[12:15], s62 offen offset:512 sc1
  buffer_load_dwordx2 v[24:25], v14, s[12:15], s62 offen offset:1024 sc1
  buffer_load_dwordx2 v[26:27], v14, s[12:15], s62 offen offset:1536 sc1
  buffer_load_dwordx2 v[28:29], v14, s[12:15], s62 offen offset:2048 sc1
  buffer_load_dwordx2 v[30:31], v14, s[12:15], s62 offen offset:2560 sc1
  buffer_load_dwordx2 v[32:33], v14, s[12:15], s62 offen offset:3072 sc1
  s_waitcnt vmcnt(7)
  v_mov_b32 v15, 0xff800000
  v_cndmask_b32 v16, v15, v12, s[48:49]
  v_mov_b32 v17, v16
  s_nop 1
  v_max_f32_dpp v17, v17, v17 row_ror:8 row_mask:0xf bank_mask:0xf
  s_nop 1
  v_max_f32_dpp v17, v17, v17 row_ror:4 row_mask:0xf bank_mask:0xf
  s_nop 1
  v_max_f32_dpp v17, v17, v17 row_ror:2 row_mask:0xf bank_mask:0xf
  s_nop 1
  v_max_f32_dpp v17, v17, v17 row_ror:1 row_mask:0xf bank_mask:0xf
  s_nop 1
  v_max_f32_dpp v17, v17, v17 row_bcast:15 row_mask:0xa bank_mask:0xf
  s_nop 1
  v_max_f32_dpp v17, v17, v17 row_bcast:31 row_mask:0xc bank_mask:0xf
  s_nop 0
  v_readlane_b32 s50, v17, 63
  s_nop 1
  v_subrev_f32 v16, s50, v16
  v_exp_f32 v16, v16
  s_nop 0
  v_mul_f32 v17, v16, v13
  s_nop 1
  v_add_f32_dpp v17, v17, v17 row_ror:8 row_mask:0xf bank_mask:0xf
  s_nop 1
  v_add_f32_dpp v17, v17, v17 row_ror:4 row_mask:0xf bank_mask:0xf
  s_nop 1
  v_add_f32_dpp v17, v17, v17 row_ror:2 row_mask:0xf bank_mask:0xf
  s_nop 1
  v_add_f32_dpp v17, v17, v17 row_ror:1 row_mask:0xf bank_mask:0xf
  s_nop 1
  v_add_f32_dpp v17, v17, v17 row_bcast:15 row_mask:0xa bank_mask:0xf
  s_nop 1
  v_add_f32_dpp v17, v17, v17 row_bcast:31 row_mask:0xc bank_mask:0xf
  s_nop 0
  v_readlane_b32 s50, v17, 63
  s_nop 1
  v_mov_b32 v17, s50
  v_rcp_f32 v17, v17
  s_nop 0
  v_mul_f32 v16, v16, v17
  s_mul_i32 s51, s24, 7
  s_add_u32 s52, s51, 0
  v_readlane_b32 s54, v16, s52
  s_add_u32 s52, s51, 1
  v_readlane_b32 s55, v16, s52
  s_add_u32 s52, s51, 2
  v_readlane_b32 s56, v16, s52
  s_add_u32 s52, s51, 3
  v_readlane_b32 s57, v16, s52
  s_add_u32 s52, s51, 4
  v_readlane_b32 s58, v16, s52
  s_add_u32 s52, s51, 5
  v_readlane_b32 s59, v16, s52
  s_add_u32 s52, s51, 6
  v_readlane_b32 s60, v16, s52
  s_waitcnt vmcnt(0)
  v_max_u32 v18, v12, v13
  v_max3_u32 v18, v18, v20, v21
  v_max3_u32 v18, v18, v22, v23
  v_max3_u32 v18, v18, v24, v25
  v_max3_u32 v18, v18, v26, v27
  v_max3_u32 v18, v18, v28, v29
  v_max3_u32 v18, v18, v30, v31
  v_max3_u32 v18, v18, v32, v33
  v_cmp_eq_u32 vcc, -1, v18
  s_nop 0
  s_cmp_lg_u64 vcc, 0
  s_cbranch_scc0 s1ok_100023
  s_sub_u32 s39, s39, 1
  s_cmp_gt_i32 s39, 0
  s_cbranch_scc1 s1_100022
s1ok_100023:
  v_mul_f32 v18, s54, v20
  v_mul_f32 v19, s54, v21
  v_fmac_f32 v18, s55, v22
  v_fmac_f32 v19, s55, v23
  v_fmac_f32 v18, s56, v24
  v_fmac_f32 v19, s56, v25
  v_fmac_f32 v18, s57, v26
  v_fmac_f32 v19, s57, v27
  v_fmac_f32 v18, s58, v28
  v_fmac_f32 v19, s58, v29
  v_fmac_f32 v18, s59, v30
  v_fmac_f32 v19, s59, v31
  v_fmac_f32 v18, s60, v32
  v_fmac_f32 v19, s60, v33
  s_lshl_b32 s46, s24, 9
  s_add_u32 s46, s46, 6144
  v_add_u32 v15, s46, v14
  ds_write_b64 v15, v[18:19]
  s_waitcnt lgkmcnt(0)
  s_barrier
  v_add_u32 v15, 6144, v14
  ds_read_b64 v[20:21], v15 offset:0
  ds_read_b64 v[22:23], v15 offset:512
  ds_read_b64 v[24:25], v15 offset:1024
  ds_read_b64 v[26:27], v15 offset:1536
  s_waitcnt lgkmcnt(0)
  v_add_f32 v20, v20, v22
  v_add_f32 v21, v21, v23
  v_add_f32 v24, v24, v26
  v_add_f32 v25, v25, v27
  v_add_f32 v20, v20, v24
  v_add_f32 v21, v21, v25
  v_cvt_pk_bf16_f32 v20, v20, v21
  s_lshl_b32 s46, s24, 8
  s_add_u32 s46, s46, 8192
  v_add_u32 v15, s46, v2
  ds_write_b32 v15, v20
  v_lshlrev_b32 v15, 4, v3
  v_add_u32 v15, s46, v15
  ds_read_b128 v[20:23], v15 offset:0
  ds_read_b128 v[24:27], v15 offset:64
  ds_read_b128 v[28:31], v15 offset:128
  ds_read_b128 v[32:35], v15 offset:192
  s_waitcnt lgkmcnt(0)
  v_mfma_f32_16x16x32_bf16 v[36:39], v[20:23], a[128:131], 0
  v_mfma_f32_16x16x32_bf16 v[36:39], v[24:27], a[132:135], v[36:39]
  v_mfma_f32_16x16x32_bf16 v[36:39], v[28:31], a[136:139], v[36:39]
  v_mfma_f32_16x16x32_bf16 v[36:39], v[32:35], a[140:143], v[36:39]
  v_mfma_f32_16x16x32_bf16 v[40:43], v[20:23], a[144:147], 0
  v_mfma_f32_16x16x32_bf16 v[40:43], v[24:27], a[148:151], v[40:43]
  v_mfma_f32_16x16x32_bf16 v[40:43], v[28:31], a[152:155], v[40:43]
  v_mfma_f32_16x16x32_bf16 v[40:43], v[32:35], a[156:159], v[40:43]
  v_mfma_f32_16x16x32_bf16 v[44:47], v[20:23], a[160:163], 0
  v_mfma_f32_16x16x32_bf16 v[44:47], v[24:27], a[164:167], v[44:47]
  v_mfma_f32_16x16x32_bf16 v[44:47], v[28:31], a[168:171], v[44:47]
  v_mfma_f32_16x16x32_bf16 v[44:47], v[32:35], a[172:175], v[44:47]
  v_mov_b32_dpp v52, v36 quad_perm:[0,1,2,3] row_mask:0x1 bank_mask:0xf
  v_mfma_f32_16x16x32_bf16 v[48:51], v[20:23], a[176:179], 0
  v_mfma_f32_16x16x32_bf16 v[48:51], v[24:27], a[180:183], v[48:51]
  v_mfma_f32_16x16x32_bf16 v[48:51], v[28:31], a[184:187], v[48:51]
  v_mfma_f32_16x16x32_bf16 v[48:51], v[32:35], a[188:191], v[48:51]
  v_mov_b32_dpp v52, v40 quad_perm:[0,1,2,3] row_mask:0x2 bank_mask:0xf
  v_mfma_f32_16x16x32_bf16 v[36:39], v[20:23], a[192:195], 0
  v_mfma_f32_16x16x32_bf16 v[36:39], v[24:27], a[196:199], v[36:39]
  v_mfma_f32_16x16x32_bf16 v[36:39], v[28:31], a[200:203], v[36:39]
  v_mfma_f32_16x16x32_bf16 v[36:39], v[32:35], a[204:207], v[36:39]
  v_mov_b32_dpp v52, v44 quad_perm:[0,1,2,3] row_mask:0x4 bank_mask:0xf
  v_mfma_f32_16x16x32_bf16 v[40:43], v[20:23], a[208:211], 0
  v_mfma_f32_16x16x32_bf16 v[40:43], v[24:27], a[212:215], v[40:43]
  v_mfma_f32_16x16x32_bf16 v[40:43], v[28:31], a[216:219], v[40:43]
  v_mfma_f32_16x16x32_bf16 v[40:43], v[32:35], a[220:223], v[40:43]
  v_mov_b32_dpp v52, v48 quad_perm:[0,1,2,3] row_mask:0x8 bank_mask:0xf
  v_mfma_f32_16x16x32_bf16 v[44:47], v[20:23], a[224:227], 0
  v_mfma_f32_16x16x32_bf16 v[44:47], v[24:27], a[228:231], v[44:47]
  v_mfma_f32_16x16x32_bf16 v[44:47], v[28:31], a[232:235], v[44:47]
  v_mfma_f32_16x16x32_bf16 v[44:47], v[32:35], a[236:239], v[44:47]
  v_mov_b32_dpp v53, v36 quad_perm:[0,1,2,3] row_mask:0x1 bank_mask:0xf
  v_mfma_f32_16x16x32_bf16 v[48:51], v[20:23], a[240:243], 0
  v_mfma_f32_16x16x32_bf16 v[48:51], v[24:27], a[244:247], v[48:51]
  v_mfma_f32_16x16x32_bf16 v[48:51], v[28:31], a[248:251], v[48:51]
  v_mfma_f32_16x16x32_bf16 v[48:51], v[32:35], a[252:255], v[48:51]
  v_mov_b32_dpp v53, v40 quad_perm:[0,1,2,3] row_mask:0x2 bank_mask:0xf
  s_nop 1
  v_mov_b32_dpp v53, v44 quad_perm:[0,1,2,3] row_mask:0x4 bank_mask:0xf
  s_nop 3
  v_mov_b32_dpp v53, v48 quad_perm:[0,1,2,3] row_mask:0x8 bank_mask:0xf
  v_lshlrev_b32 v15, 11, v3
  v_lshl_add_u32 v15, v4, 2, v15
  s_lshl_b32 s46, s24, 14
  s_lshl_b32 s47, s25, 6
  s_add_u32 s46, s46, s47
  s_add_u32 s46, s46, 1933312
  buffer_store_dword v52, v15, s[12:15], s46 offen sc1
  s_add_u32 s46, s46, 8192
  buffer_store_dword v53, v15, s[12:15], s46 offen sc1
  s_cmp_eq_u32 s24, 0
  s_cbranch_scc0 w0_100026
  s_lshl_b32 s46, s25, 11
  s_add_u32 s46, s46, 1933312
  s_lshl_b32 s47, s25, 5
  s_add_u32 s47, s47, 1024
  v_and_b32 v24, 3, v0
  v_lshlrev_b32 v24, 3, v24
  s_nop 1
r16_100027:
  buffer_load_dwordx4 v[12:15], v1, s[12:15], s46 offen sc1
  buffer_load_dwordx4 v[16:19], v1, s[12:15], s46 offen offset:1024 sc1
  s_mov_b64 exec, -1
  buffer_load_dwordx2 v[20:21], v24, s[64:67], s47 offen
  s_waitcnt vmcnt(0)
  v_max_u32 v25, v12, v13
  v_max3_u32 v25, v25, v14, v15
  v_max3_u32 v25, v25, v16, v17
  v_max3_u32 v25, v25, v18, v19
  v_cmp_eq_u32 vcc, -1, v25
  s_nop 0
  s_cmp_lg_u64 vcc, 0
  s_cbranch_scc0 r16ok_100028
  s_sub_u32 s39, s39, 1
  s_cmp_gt_i32 s39, 0
  s_cbranch_scc1 r16_100027
r16ok_100028:
  v_add_f32 v12, v12, v16
  v_add_f32 v13, v13, v17
  v_add_f32 v14, v14, v18
  v_add_f32 v15, v15, v19
  v_add_f32_dpp v12, v12, v12 row_ror:4 row_mask:0xf bank_mask:0xf
  v_add_f32_dpp v13, v13, v13 row_ror:4 row_mask:0xf bank_mask:0xf
  v_add_f32_dpp v14, v14, v14 row_ror:4 row_mask:0xf bank_mask:0xf
  v_add_f32_dpp v15, v15, v15 row_ror:4 row_mask:0xf bank_mask:0xf
  v_add_f32_dpp v12, v12, v12 row_ror:8 row_mask:0xf bank_mask:0xf
  v_add_f32_dpp v13, v13, v13 row_ror:8 row_mask:0xf bank_mask:0xf
  v_add_f32_dpp v14, v14, v14 row_ror:8 row_mask:0xf bank_mask:0xf
  v_add_f32_dpp v15, v15, v15 row_ror:8 row_mask:0xf bank_mask:0xf
  v_mov_b32 v16, v12
  v_mov_b32 v17, v13
  v_mov_b32 v18, v14
  v_mov_b32 v19, v15
  v_permlane32_swap_b32 v12, v16
  v_permlane32_swap_b32 v13, v17
  v_permlane32_swap_b32 v14, v18
  v_permlane32_swap_b32 v15, v19
  v_add_f32 v12, v12, v16
  v_add_f32 v13, v13, v17
  v_add_f32 v14, v14, v18
  v_add_f32 v15, v15, v19
  v_mov_b32 v16, v12
  v_mov_b32 v17, v13
  v_mov_b32 v18, v14
  v_mov_b32 v19, v15
  v_permlane16_swap_b32 v12, v16
  v_permlane16_swap_b32 v13, v17
  v_permlane16_swap_b32 v14, v18
  v_permlane16_swap_b32 v15, v19
  v_add_f32 v12, v12, v16
  v_add_f32 v13, v13, v17
  v_add_f32 v14, v14, v18
  v_add_f32 v15, v15, v19
  v_lshlrev_b32 v16, 16, v20
  v_and_b32 v17, 0xffff0000, v20
  v_lshlrev_b32 v18, 16, v21
  v_and_b32 v19, 0xffff0000, v21
  v_cvt_pk_bf16_f32 v12, v12, v12
  v_and_b32 v12, 0xffff0000, v12
  v_cvt_pk_bf16_f32 v13, v13, v13
  v_and_b32 v13, 0xffff0000, v13
  v_cvt_pk_bf16_f32 v14, v14, v14
  v_and_b32 v14, 0xffff0000, v14
  v_cvt_pk_bf16_f32 v15, v15, v15
  v_and_b32 v15, 0xffff0000, v15
  v_add_f32 v12, v12, v16
  v_add_f32 v13, v13, v17
  v_add_f32 v14, v14, v18
  v_add_f32 v15, v15, v19
  v_cvt_pk_bf16_f32 v20, v12, v13
  v_cvt_pk_bf16_f32 v21, v14, v15
  s_lshl_b32 s46, s25, 5
  s_add_u32 s46, s46, 2130944
  s_mov_b64 exec, 0xf
  buffer_store_dwordx2 v[20:21], v24, s[12:15], s46 offen sc1
  s_mov_b64 exec, -1
w0_100026:
  s_cmp_lt_u32 s25, 22
  s_cbranch_scc0 f3_100029
  s_mov_b32 s46, 2130944
xa_100030:
  buffer_load_dwordx4 v[12:15], v1, s[12:15], s46 offen sc1
  s_waitcnt vmcnt(0)
  v_max_u32 v16, v12, v13
  v_max3_u32 v16, v16, v14, v15
  v_cmp_eq_u32 vcc, -1, v16
  s_nop 0
  s_cmp_lg_u64 vcc, 0
  s_cbranch_scc0 xaok_100031
  s_sub_u32 s39, s39, 1
  s_cmp_gt_i32 s39, 0
  s_cbranch_scc1 xa_100030
xaok_100031:
  v_add_u32 v16, s42, v1
  ds_write_b128 v16, v[12:15]
  ds_read_b128 v[28:31], v9 offset:0
  ds_read_b128 v[32:35], v9 offset:64
  ds_read_b128 v[36:39], v9 offset:128
  ds_read_b128 v[40:43], v9 offset:192
  s_waitcnt lgkmcnt(3)
  v_mfma_f32_16x16x32_bf16 v[20:23], v[28:31], v[64:67], 0
  v_mfma_f32_16x16x32_bf16 v[24:27], v[28:31], v[128:131], 0
  ds_read_b128 v[28:31], v9 offset:256
  v_lshlrev_b32 v50, 16, v12
  v_and_b32 v51, 0xffff0000, v12
  v_add_f32 v48, v50, v51
  s_waitcnt lgkmcnt(3)
  v_mfma_f32_16x16x32_bf16 v[20:23], v[32:35], v[68:71], v[20:23]
  v_mfma_f32_16x16x32_bf16 v[24:27], v[32:35], v[132:135], v[24:27]
  ds_read_b128 v[32:35], v9 offset:320
  v_mul_f32 v49, v50, v50
  v_fmac_f32 v49, v51, v51
  v_lshlrev_b32 v50, 16, v13
  v_and_b32 v51, 0xffff0000, v13
  s_waitcnt lgkmcnt(3)
  v_mfma_f32_16x16x32_bf16 v[20:23], v[36:39], v[72:75], v[20:23]
  v_mfma_f32_16x16x32_bf16 v[24:27], v[36:39], v[136:139], v[24:27]
  ds_read_b128 v[36:39], v9 offset:384
  v_add_f32 v48, v48, v50
  v_fmac_f32 v49, v50, v50
  v_add_f32 v48, v48, v51
  s_waitcnt lgkmcnt(3)
  v_mfma_f32_16x16x32_bf16 v[20:23], v[40:43], v[76:79], v[20:23]
  v_mfma_f32_16x16x32_bf16 v[24:27], v[40:43], v[140:143], v[24:27]
  ds_read_b128 v[40:43], v9 offset:448
  v_fmac_f32 v49, v51, v51
  v_lshlrev_b32 v50, 16, v14
  v_and_b32 v51, 0xffff0000, v14
  v_add_f32 v48, v48, v50
  s_waitcnt lgkmcnt(3)
  v_mfma_f32_16x16x32_bf16 v[20:23], v[28:31], v[80:83], v[20:23]
  v_mfma_f32_16x16x32_bf16 v[24:27], v[28:31], v[144:147], v[24:27]
  ds_read_b128 v[28:31], v9 offset:512
  v_fmac_f32 v49, v50, v50
  v_add_f32 v48, v48, v51
  v_fmac_f32 v49, v51, v51
  s_waitcnt lgkmcnt(3)
  v_mfma_f32_16x16x32_bf16 v[20:23], v[32:35], v[84:87], v[20:23]
  v_mfma_f32_16x16x32_bf16 v[24:27], v[32:35], v[148:151], v[24:27]
  ds_read_b128 v[32:35], v9 offset:576
  v_lshlrev_b32 v50, 16, v15
  v_and_b32 v51, 0xffff0000, v15
  v_add_f32 v48, v48, v50
  v_fmac_f32 v49, v50, v50
  s_waitcnt lgkmcnt(3)
  v_mfma_f32_16x16x32_bf16 v[20:23], v[36:39], v[88:91], v[20:23]
  v_mfma_f32_16x16x32_bf16 v[24:27], v[36:39], v[152:155], v[24:27]
  ds_read_b128 v[36:39], v9 offset:640
  v_add_f32 v48, v48, v51
  v_fmac_f32 v49, v51, v51
  s_nop 0
  v_add_f32_dpp v48, v48, v48 row_ror:8 row_mask:0xf bank_mask:0xf
  s_waitcnt lgkmcnt(3)
  v_mfma_f32_16x16x32_bf16 v[20:23], v[40:43], v[92:95], v[20:23]
  v_mfma_f32_16x16x32_bf16 v[24:27], v[40:43], v[156:159], v[24:27]
  ds_read_b128 v[40:43], v9 offset:704
  v_add_f32_dpp v49, v49, v49 row_ror:8 row_mask:0xf bank_mask:0xf
  v_add_f32_dpp v48, v48, v48 row_ror:4 row_mask:0xf bank_mask:0xf
  s_nop 0
  v_add_f32_dpp v49, v49, v49 row_ror:4 row_mask:0xf bank_mask:0xf
  v_add_f32_dpp v48, v48, v48 row_ror:2 row_mask:0xf bank_mask:0xf
  s_waitcnt lgkmcnt(3)
  v_mfma_f32_16x16x32_bf16 v[20:23], v[28:31], v[96:99], v[20:23]
  v_mfma_f32_16x16x32_bf16 v[24:27], v[28:31], v[160:163], v[24:27]
  ds_read_b128 v[28:31], v9 offset:768
  v_add_f32_dpp v49, v49, v49 row_ror:2 row_mask:0xf bank_mask:0xf
  v_add_f32_dpp v48, v48, v48 row_ror:1 row_mask:0xf bank_mask:0xf
  s_nop 0
  v_add_f32_dpp v49, v49, v49 row_ror:1 row_mask:0xf bank_mask:0xf
  s_waitcnt lgkmcnt(3)
  v_mfma_f32_16x16x32_bf16 v[20:23], v[32:35], v[100:103], v[20:23]
  v_mfma_f32_16x16x32_bf16 v[24:27], v[32:35], v[164:167], v[24:27]
  ds_read_b128 v[32:35], v9 offset:832
  v_add_f32_dpp v48, v48, v48 row_bcast:15 row_mask:0xa bank_mask:0xf
  v_add_f32_dpp v49, v49, v49 row_bcast:15 row_mask:0xa bank_mask:0xf
  s_nop 0
  v_add_f32_dpp v48, v48, v48 row_bcast:31 row_mask:0xc bank_mask:0xf
  v_add_f32_dpp v49, v49, v49 row_bcast:31 row_mask:0xc bank_mask:0xf
  s_waitcnt lgkmcnt(3)
  v_mfma_f32_16x16x32_bf16 v[20:23], v[36:39], v[104:107], v[20:23]
  v_mfma_f32_16x16x32_bf16 v[24:27], v[36:39], v[168:171], v[24:27]
  ds_read_b128 v[36:39], v9 offset:896
  v_readlane_b32 s54, v48, 63
  v_readlane_b32 s55, v49, 63
  s_nop 0
  v_mov_b32 v44, s54
  s_waitcnt lgkmcnt(3)
  v_mfma_f32_16x16x32_bf16 v[20:23], v[40:43], v[108:111], v[20:23]
  v_mfma_f32_16x16x32_bf16 v[24:27], v[40:43], v[172:175], v[24:27]
  ds_read_b128 v[40:43], v9 offset:960
  v_mov_b32 v45, s55
  v_mul_f32 v44, 0x3b000000, v44
  v_mul_f32 v45, 0x3b000000, v45
  v_fma_f32 v45, -v44, v44, v45
  s_waitcnt lgkmcnt(3)
  v_mfma_f32_16x16x32_bf16 v[20:23], v[28:31], v[112:115], v[20:23]
  v_mfma_f32_16x16x32_bf16 v[24:27], v[28:31], v[176:179], v[24:27]
  v_max_f32 v45, 0, v45
  v_cvt_pk_bf16_f32 v44, v44, v44
  v_cvt_pk_bf16_f32 v45, v45, v45
  s_waitcnt lgkmcnt(2)
  v_mfma_f32_16x16x32_bf16 v[20:23], v[32:35], v[116:119], v[20:23]
  v_mfma_f32_16x16x32_bf16 v[24:27], v[32:35], v[180:183], v[24:27]
  v_and_b32 v44, 0xffff0000, v44
  v_and_b32 v45, 0xffff0000, v45
  v_add_f32 v45, 0x3727c5ac, v45
  v_cvt_pk_bf16_f32 v45, v45, v45
  s_waitcnt lgkmcnt(1)
  v_mfma_f32_16x16x32_bf16 v[20:23], v[36:39], v[120:123], v[20:23]
  v_mfma_f32_16x16x32_bf16 v[24:27], v[36:39], v[184:187], v[24:27]
  v_and_b32 v45, 0xffff0000, v45
  v_sqrt_f32 v45, v45
  s_nop 0
  v_cvt_pk_bf16_f32 v45, v45, v45
  s_waitcnt lgkmcnt(0)
  v_mfma_f32_16x16x32_bf16 v[20:23], v[40:43], v[124:127], v[20:23]
  v_mfma_f32_16x16x32_bf16 v[24:27], v[40:43], v[188:191], v[24:27]
  v_and_b32 v45, 0xffff0000, v45
  v_rcp_f32 v45, v45
  v_mul_f32 v46, v44, v7
  v_mul_f32 v47, v44, v8
  s_nop 2
  v_sub_f32 v20, v20, v46
  v_sub_f32 v24, v24, v47
  v_mul_f32 v20, v20, v45
  v_mul_f32 v24, v24, v45
  v_cvt_pk_bf16_f32 v20, v20, v20
  v_and_b32 v20, 0xffff0000, v20
  v_cvt_pk_bf16_f32 v24, v24, v24
  v_and_b32 v24, 0xffff0000, v24
  v_mul_f32 v12, v20, v24
  s_nop 1
  v_mov_b32_dpp v13, v12 quad_perm:[1,1,3,3] row_mask:0xf bank_mask:0xf
  v_cvt_pk_bf16_f32 v12, v12, v13
  s_nop 1
  v_and_b32_dpp v28, v12, v11 row_newbcast:0 row_mask:0xf bank_mask:0xf
  v_and_b32_dpp v29, v12, v11 row_newbcast:2 row_mask:0xf bank_mask:0xf
  v_and_b32_dpp v30, v12, v11 row_newbcast:4 row_mask:0xf bank_mask:0xf
  v_and_b32_dpp v31, v12, v11 row_newbcast:6 row_mask:0xf bank_mask:0xf
  v_and_b32_dpp v32, v12, v11 row_newbcast:8 row_mask:0xf bank_mask:0xf
  v_and_b32_dpp v33, v12, v11 row_newbcast:10 row_mask:0xf bank_mask:0xf
  v_and_b32_dpp v34, v12, v11 row_newbcast:12 row_mask:0xf bank_mask:0xf
  v_and_b32_dpp v35, v12, v11 row_newbcast:14 row_mask:0xf bank_mask:0xf
  s_lshl_b32 s46, s24, 11
  s_add_u32 s46, s46, 9216
  v_lshlrev_b32 v14, 4, v4
  v_add_u32 v14, s46, v14
  v_mfma_f32_16x16x32_bf16 v[36:39], v[28:31], v[192:195], 0
  v_mfma_f32_16x16x32_bf16 v[36:39], v[32:35], v[196:199], v[36:39]
  v_mfma_f32_16x16x32_bf16 v[40:43], v[28:31], v[200:203], 0
  v_mfma_f32_16x16x32_bf16 v[40:43], v[32:35], v[204:207], v[40:43]
  v_mfma_f32_16x16x32_bf16 v[44:47], v[28:31], v[208:211], 0
  v_mfma_f32_16x16x32_bf16 v[44:47], v[32:35], v[212:215], v[44:47]
  s_mov_b64 exec, 0xffff
  s_nop 2
  ds_write_b128 v14, v[36:39] offset:0
  s_mov_b64 exec, -1
  v_mfma_f32_16x16x32_bf16 v[48:51], v[28:31], v[216:219], 0
  v_mfma_f32_16x16x32_bf16 v[48:51], v[32:35], v[220:223], v[48:51]
  s_mov_b64 exec, 0xffff
  ds_write_b128 v14, v[40:43] offset:256
  s_mov_b64 exec, -1
  v_mfma_f32_16x16x32_bf16 v[36:39], v[28:31], v[224:227], 0
  v_mfma_f32_16x16x32_bf16 v[36:39], v[32:35], v[228:231], v[36:39]
  s_mov_b64 exec, 0xffff
  ds_write_b128 v14, v[44:47] offset:512
  s_mov_b64 exec, -1
  v_mfma_f32_16x16x32_bf16 v[40:43], v[28:31], v[232:235], 0
  v_mfma_f32_16x16x32_bf16 v[40:43], v[32:35], v[236:239], v[40:43]
  s_mov_b64 exec, 0xffff
  ds_write_b128 v14, v[48:51] offset:768
  s_mov_b64 exec, -1
  v_mfma_f32_16x16x32_bf16 v[44:47], v[28:31], v[240:243], 0
  v_mfma_f32_16x16x32_bf16 v[44:47], v[32:35], v[244:247], v[44:47]
  s_mov_b64 exec, 0xffff
  ds_write_b128 v14, v[36:39] offset:1024
  s_mov_b64 exec, -1
  v_mfma_f32_16x16x32_bf16 v[48:51], v[28:31], v[248:251], 0
  v_mfma_f32_16x16x32_bf16 v[48:51], v[32:35], v[252:255], v[48:51]
  s_mov_b64 exec, 0xffff
  ds_write_b128 v14, v[40:43] offset:1280
  s_mov_b64 exec, -1
  s_mov_b64 exec, 0xffff
  ds_write_b128 v14, v[44:47] offset:1536
  s_mov_b64 exec, -1
  s_mov_b64 exec, 0xffff
  s_nop 0
  ds_write_b128 v14, v[48:51] offset:1792
  s_mov_b64 exec, -1
  s_waitcnt lgkmcnt(0)
  s_barrier
  s_lshl_b32 s46, s24, 9
  s_add_u32 s46, s46, 9216
  v_lshlrev_b32 v14, 3, v0
  v_add_u32 v15, s46, v14
  ds_read_b64 v[20:21], v15 offset:0
  ds_read_b64 v[22:23], v15 offset:2048
  ds_read_b64 v[24:25], v15 offset:4096
  ds_read_b64 v[26:27], v15 offset:6144
  s_waitcnt lgkmcnt(0)
  v_add_f32 v20, v20, v22
  v_add_f32 v21, v21, v23
  v_add_f32 v24, v24, v26
  v_add_f32 v25, v25, v27
  v_add_f32 v20, v20, v24
  v_add_f32 v21, v21, v25
  v_lshrrev_b32 v14, 3, v0
  v_lshlrev_b32 v14, 11, v14
  v_and_b32 v15, 7, v0
  v_lshl_add_u32 v14, v15, 3, v14
  s_lshl_b32 s46, s24, 14
  s_lshl_b32 s47, s25, 6
  s_add_u32 s46, s46, s47
  s_add_u32 s46, s46, 2203648
  buffer_store_dwordx2 v[20:21], v14, s[12:15], s46 offen sc1
  s_barrier
f3_100029:
  s_cmp_eq_u32 s24, 1
  s_cbranch_scc0 w1_100032
  s_lshl_b32 s46, s25, 11
  s_add_u32 s46, s46, 2203648
  s_lshl_b32 s47, s25, 5
  s_add_u32 s47, s47, 2130944
  v_and_b32 v24, 3, v0
  v_lshlrev_b32 v24, 3, v24
  v_cmp_gt_u32 vcc, 24, v0
  s_nop 0
  s_mov_b64 s[48:49], vcc
  s_nop 2
r16_100033:
  buffer_load_dwordx4 v[12:15], v1, s[12:15], s46 offen sc1
  v_mov_b32 v16, 0
  v_mov_b32 v17, 0
  v_mov_b32 v18, 0
  v_mov_b32 v19, 0
  s_mov_b64 exec, s[48:49]
  buffer_load_dwordx4 v[16:19], v1, s[12:15], s46 offen offset:1024 sc1
  s_mov_b64 exec, -1
  buffer_load_dwordx2 v[20:21], v24, s[12:15], s47 offen sc1
  s_waitcnt vmcnt(0)
  v_max_u32 v25, v12, v13
  v_max3_u32 v25, v25, v14, v15
  v_max3_u32 v25, v25, v16, v17
  v_max3_u32 v25, v25, v18, v19
  v_max3_u32 v25, v25, v20, v21
  v_cmp_eq_u32 vcc, -1, v25
  s_nop 0
  s_cmp_lg_u64 vcc, 0
  s_cbranch_scc0 r16ok_100034
  s_sub_u32 s39, s39, 1
  s_cmp_gt_i32 s39, 0
  s_cbranch_scc1 r16_100033
r16ok_100034:
  v_add_f32 v12, v12, v16
  v_add_f32 v13, v13, v17
  v_add_f32 v14, v14, v18
  v_add_f32 v15, v15, v19
  v_add_f32_dpp v12, v12, v12 row_ror:4 row_mask:0xf bank_mask:0xf
  v_add_f32_dpp v13, v13, v13 row_ror:4 row_mask:0xf bank_mask:0xf
  v_add_f32_dpp v14, v14, v14 row_ror:4 row_mask:0xf bank_mask:0xf
  v_add_f32_dpp v15, v15, v15 row_ror:4 row_mask:0xf bank_mask:0xf
  v_add_f32_dpp v12, v12, v12 row_ror:8 row_mask:0xf bank_mask:0xf
  v_add_f32_dpp v13, v13, v13 row_ror:8 row_mask:0xf bank_mask:0xf
  v_add_f32_dpp v14, v14, v14 row_ror:8 row_mask:0xf bank_mask:0xf
  v_add_f32_dpp v15, v15, v15 row_ror:8 row_mask:0xf bank_mask:0xf
  v_mov_b32 v16, v12
  v_mov_b32 v17, v13
  v_mov_b32 v18, v14
  v_mov_b32 v19, v15
  v_permlane32_swap_b32 v12, v16
  v_permlane32_swap_b32 v13, v17
  v_permlane32_swap_b32 v14, v18
  v_permlane32_swap_b32 v15, v19
  v_add_f32 v12, v12, v16
  v_add_f32 v13, v13, v17
  v_add_f32 v14, v14, v18
  v_add_f32 v15, v15, v19
  v_mov_b32 v16, v12
  v_mov_b32 v17, v13
  v_mov_b32 v18, v14
  v_mov_b32 v19, v15
  v_permlane16_swap_b32 v12, v16
  v_permlane16_swap_b32 v13, v17
  v_permlane16_swap_b32 v14, v18
  v_permlane16_swap_b32 v15, v19
  v_add_f32 v12, v12, v16
  v_add_f32 v13, v13, v17
  v_add_f32 v14, v14, v18
  v_add_f32 v15, v15, v19
  v_lshlrev_b32 v16, 16, v20
  v_and_b32 v17, 0xffff0000, v20
  v_lshlrev_b32 v18, 16, v21
  v_and_b32 v19, 0xffff0000, v21
  v_cvt_pk_bf16_f32 v12, v12, v12
  v_and_b32 v12, 0xffff0000, v12
  v_cvt_pk_bf16_f32 v13, v13, v13
  v_and_b32 v13, 0xffff0000, v13
  v_cvt_pk_bf16_f32 v14, v14, v14
  v_and_b32 v14, 0xffff0000, v14
  v_cvt_pk_bf16_f32 v15, v15, v15
  v_and_b32 v15, 0xffff0000, v15
  v_add_f32 v12, v12, v16
  v_add_f32 v13, v13, v17
  v_add_f32 v14, v14, v18
  v_add_f32 v15, v15, v19
  v_cvt_pk_bf16_f32 v20, v12, v13
  v_cvt_pk_bf16_f32 v21, v14, v15
  s_lshl_b32 s46, s25, 5
  s_add_u32 s46, s46, 2135040
  s_mov_b64 exec, 0xf
  buffer_store_dwordx2 v[20:21], v24, s[12:15], s46 offen sc1
  s_mov_b64 exec, -1
w1_100032:
  s_mov_b32 s46, 2135040
xa_100035:
  buffer_load_dwordx4 v[12:15], v1, s[12:15], s46 offen sc1
  s_waitcnt vmcnt(0)
  v_max_u32 v16, v12, v13
  v_max3_u32 v16, v16, v14, v15
  v_cmp_eq_u32 vcc, -1, v16
  s_nop 0
  s_cmp_lg_u64 vcc, 0
  s_cbranch_scc0 xaok_100036
  s_sub_u32 s39, s39, 1
  s_cmp_gt_i32 s39, 0
  s_cbranch_scc1 xa_100035
xaok_100036:
  v_add_u32 v16, s42, v1
  ds_write_b128 v16, v[12:15]
  ds_read_b128 v[28:31], v9 offset:0
  ds_read_b128 v[32:35], v9 offset:64
  ds_read_b128 v[36:39], v9 offset:128
  ds_read_b128 v[40:43], v9 offset:192
  s_waitcnt lgkmcnt(3)
  v_mfma_f32_16x16x32_bf16 v[20:23], v[28:31], a[0:3], 0
  v_mfma_f32_16x16x32_bf16 v[24:27], v[28:31], a[64:67], 0
  ds_read_b128 v[28:31], v9 offset:256
  v_lshlrev_b32 v50, 16, v12
  v_and_b32 v51, 0xffff0000, v12
  v_add_f32 v48, v50, v51
  s_waitcnt lgkmcnt(3)
  v_mfma_f32_16x16x32_bf16 v[20:23], v[32:35], a[4:7], v[20:23]
  v_mfma_f32_16x16x32_bf16 v[24:27], v[32:35], a[68:71], v[24:27]
  ds_read_b128 v[32:35], v9 offset:320
  v_mul_f32 v49, v50, v50
  v_fmac_f32 v49, v51, v51
  v_lshlrev_b32 v50, 16, v13
  v_and_b32 v51, 0xffff0000, v13
  s_waitcnt lgkmcnt(3)
  v_mfma_f32_16x16x32_bf16 v[20:23], v[36:39], a[8:11], v[20:23]
  v_mfma_f32_16x16x32_bf16 v[24:27], v[36:39], a[72:75], v[24:27]
  ds_read_b128 v[36:39], v9 offset:384
  v_add_f32 v48, v48, v50
  v_fmac_f32 v49, v50, v50
  v_add_f32 v48, v48, v51
  s_waitcnt lgkmcnt(3)
  v_mfma_f32_16x16x32_bf16 v[20:23], v[40:43], a[12:15], v[20:23]
  v_mfma_f32_16x16x32_bf16 v[24:27], v[40:43], a[76:79], v[24:27]
  ds_read_b128 v[40:43], v9 offset:448
  v_fmac_f32 v49, v51, v51
  v_lshlrev_b32 v50, 16, v14
  v_and_b32 v51, 0xffff0000, v14
  v_add_f32 v48, v48, v50
  s_waitcnt lgkmcnt(3)
  v_mfma_f32_16x16x32_bf16 v[20:23], v[28:31], a[16:19], v[20:23]
  v_mfma_f32_16x16x32_bf16 v[24:27], v[28:31], a[80:83], v[24:27]
  ds_read_b128 v[28:31], v9 offset:512
  v_fmac_f32 v49, v50, v50
  v_add_f32 v48, v48, v51
  v_fmac_f32 v49, v51, v51
  s_waitcnt lgkmcnt(3)
  v_mfma_f32_16x16x32_bf16 v[20:23], v[32:35], a[20:23], v[20:23]
  v_mfma_f32_16x16x32_bf16 v[24:27], v[32:35], a[84:87], v[24:27]
  ds_read_b128 v[32:35], v9 offset:576
  v_lshlrev_b32 v50, 16, v15
  v_and_b32 v51, 0xffff0000, v15
  v_add_f32 v48, v48, v50
  v_fmac_f32 v49, v50, v50
  s_waitcnt lgkmcnt(3)
  v_mfma_f32_16x16x32_bf16 v[20:23], v[36:39], a[24:27], v[20:23]
  v_mfma_f32_16x16x32_bf16 v[24:27], v[36:39], a[88:91], v[24:27]
  ds_read_b128 v[36:39], v9 offset:640
  v_add_f32 v48, v48, v51
  v_fmac_f32 v49, v51, v51
  s_nop 0
  v_add_f32_dpp v48, v48, v48 row_ror:8 row_mask:0xf bank_mask:0xf
  s_waitcnt lgkmcnt(3)
  v_mfma_f32_16x16x32_bf16 v[20:23], v[40:43], a[28:31], v[20:23]
  v_mfma_f32_16x16x32_bf16 v[24:27], v[40:43], a[92:95], v[24:27]
  ds_read_b128 v[40:43], v9 offset:704
  v_add_f32_dpp v49, v49, v49 row_ror:8 row_mask:0xf bank_mask:0xf
  v_add_f32_dpp v48, v48, v48 row_ror:4 row_mask:0xf bank_mask:0xf
  s_nop 0
  v_add_f32_dpp v49, v49, v49 row_ror:4 row_mask:0xf bank_mask:0xf
  v_add_f32_dpp v48, v48, v48 row_ror:2 row_mask:0xf bank_mask:0xf
  s_waitcnt lgkmcnt(3)
  v_mfma_f32_16x16x32_bf16 v[20:23], v[28:31], a[32:35], v[20:23]
  v_mfma_f32_16x16x32_bf16 v[24:27], v[28:31], a[96:99], v[24:27]
  ds_read_b128 v[28:31], v9 offset:768
  v_add_f32_dpp v49, v49, v49 row_ror:2 row_mask:0xf bank_mask:0xf
  v_add_f32_dpp v48, v48, v48 row_ror:1 row_mask:0xf bank_mask:0xf
  s_nop 0
  v_add_f32_dpp v49, v49, v49 row_ror:1 row_mask:0xf bank_mask:0xf
  s_waitcnt lgkmcnt(3)
  v_mfma_f32_16x16x32_bf16 v[20:23], v[32:35], a[36:39], v[20:23]
  v_mfma_f32_16x16x32_bf16 v[24:27], v[32:35], a[100:103], v[24:27]
  ds_read_b128 v[32:35], v9 offset:832
  v_add_f32_dpp v48, v48, v48 row_bcast:15 row_mask:0xa bank_mask:0xf
  v_add_f32_dpp v49, v49, v49 row_bcast:15 row_mask:0xa bank_mask:0xf
  s_nop 0
  v_add_f32_dpp v48, v48, v48 row_bcast:31 row_mask:0xc bank_mask:0xf
  v_add_f32_dpp v49, v49, v49 row_bcast:31 row_mask:0xc bank_mask:0xf
  s_waitcnt lgkmcnt(3)
  v_mfma_f32_16x16x32_bf16 v[20:23], v[36:39], a[40:43], v[20:23]
  v_mfma_f32_16x16x32_bf16 v[24:27], v[36:39], a[104:107], v[24:27]
  ds_read_b128 v[36:39], v9 offset:896
  v_readlane_b32 s54, v48, 63
  v_readlane_b32 s55, v49, 63
  s_nop 0
  v_mov_b32 v44, s54
  s_waitcnt lgkmcnt(3)
  v_mfma_f32_16x16x32_bf16 v[20:23], v[40:43], a[44:47], v[20:23]
  v_mfma_f32_16x16x32_bf16 v[24:27], v[40:43], a[108:111], v[24:27]
  ds_read_b128 v[40:43], v9 offset:960
  v_mov_b32 v45, s55
  v_mul_f32 v44, 0x3b000000, v44
  v_mul_f32 v45, 0x3b000000, v45
  v_fma_f32 v45, -v44, v44, v45
  s_waitcnt lgkmcnt(3)
  v_mfma_f32_16x16x32_bf16 v[20:23], v[28:31], a[48:51], v[20:23]
  v_mfma_f32_16x16x32_bf16 v[24:27], v[28:31], a[112:115], v[24:27]
  v_max_f32 v45, 0, v45
  v_cvt_pk_bf16_f32 v44, v44, v44
  v_cvt_pk_bf16_f32 v45, v45, v45
  s_waitcnt lgkmcnt(2)
  v_mfma_f32_16x16x32_bf16 v[20:23], v[32:35], a[52:55], v[20:23]
  v_mfma_f32_16x16x32_bf16 v[24:27], v[32:35], a[116:119], v[24:27]
  v_and_b32 v44, 0xffff0000, v44
  v_and_b32 v45, 0xffff0000, v45
  v_add_f32 v45, 0x3727c5ac, v45
  v_cvt_pk_bf16_f32 v45, v45, v45
  s_waitcnt lgkmcnt(1)
  v_mfma_f32_16x16x32_bf16 v[20:23], v[36:39], a[56:59], v[20:23]
  v_mfma_f32_16x16x32_bf16 v[24:27], v[36:39], a[120:123], v[24:27]
  v_and_b32 v45, 0xffff0000, v45
  v_sqrt_f32 v45, v45
  s_nop 0
  v_cvt_pk_bf16_f32 v45, v45, v45
  s_waitcnt lgkmcnt(0)
  v_mfma_f32_16x16x32_bf16 v[20:23], v[40:43], a[60:63], v[20:23]
  v_mfma_f32_16x16x32_bf16 v[24:27], v[40:43], a[124:127], v[24:27]
  v_and_b32 v45, 0xffff0000, v45
  v_rcp_f32 v45, v45
  v_mul_f32 v46, v44, v5
  v_mul_f32 v47, v44, v6
  s_nop 2
  v_sub_f32 v20, v20, v46
  v_sub_f32 v24, v24, v47
  v_mul_f32 v20, v20, v45
  v_mul_f32 v24, v24, v45
  s_nop 1
  v_mov_b32_dpp v20, v24 quad_perm:[0,1,2,3] row_mask:0x2 bank_mask:0xf
  s_nop 1
  v_mov_b32_dpp v12, v20 quad_perm:[1,1,3,3] row_mask:0xf bank_mask:0xf
  v_cvt_pk_bf16_f32 v12, v20, v12
  v_lshlrev_b32 v13, 1, v0
  s_lshl_b32 s46, s25, 8
  s_lshl_b32 s47, s24, 6
  s_add_u32 s46, s46, s47
  s_add_u32 s46, s46, 2424832
  s_mov_b32 exec_lo, 0x55555555
  s_mov_b32 exec_hi, 0
  buffer_store_dword v12, v13, s[12:15], s46 offen sc1
  s_mov_b64 exec, -1
  s_lshl_b32 s46, s25, 8
  s_add_u32 s46, s46, 1851392
  v_lshlrev_b32 v14, 3, v0
  v_cmp_gt_u32 vcc, 28, v0
  s_nop 0
  s_mov_b64 s[48:49], vcc
  s_cmp_eq_u32 s24, 0
  s_nop 1
  s_cbranch_scc0 s1wok_100040
s1w_100039:
  v_mov_b32 v12, -1
  s_mov_b64 exec, s[48:49]
  buffer_load_dword v12, v14, s[12:15], s46 offen sc1
  s_mov_b64 exec, -1
  s_waitcnt vmcnt(0)
  v_cmp_ne_u32 vcc, -1, v12
  s_nop 0
  s_bcnt1_i32_b64 s50, vcc
  s_cmp_ge_u32 s50, 20
  s_cbranch_scc1 s1wok_100040
  s_sleep 8
  s_sub_u32 s39, s39, 1
  s_cmp_gt_i32 s39, 0
  s_cbranch_scc1 s1w_100039
s1wok_100040:
  s_barrier
  s_mul_i32 s62, s25, 28
  s_mul_i32 s47, s24, 7
  s_add_u32 s62, s62, s47
  s_lshl_b32 s62, s62, 9
  s_add_u32 s62, s62, 917504
s1_100037:
  v_mov_b32 v12, 0
  v_mov_b32 v13, 0
  s_mov_b64 exec, s[48:49]
  buffer_load_dwordx2 v[12:13], v14, s[12:15], s46 offen sc1
  s_mov_b64 exec, -1
  buffer_load_dwordx2 v[20:21], v14, s[12:15], s62 offen offset:0 sc1
  buffer_load_dwordx2 v[22:23], v14, s[12:15], s62 offen offset:512 sc1
  buffer_load_dwordx2 v[24:25], v14, s[12:15], s62 offen offset:1024 sc1
  buffer_load_dwordx2 v[26:27], v14, s[12:15], s62 offen offset:1536 sc1
  buffer_load_dwordx2 v[28:29], v14, s[12:15], s62 offen offset:2048 sc1
  buffer_load_dwordx2 v[30:31], v14, s[12:15], s62 offen offset:2560 sc1
  buffer_load_dwordx2 v[32:33], v14, s[12:15], s62 offen offset:3072 sc1
  s_waitcnt vmcnt(7)
  v_mov_b32 v15, 0xff800000
  v_cndmask_b32 v16, v15, v12, s[48:49]
  v_mov_b32 v17, v16
  s_nop 1
  v_max_f32_dpp v17, v17, v17 row_ror:8 row_mask:0xf bank_mask:0xf
  s_nop 1
  v_max_f32_dpp v17, v17, v17 row_ror:4 row_mask:0xf bank_mask:0xf
  s_nop 1
  v_max_f32_dpp v17, v17, v17 row_ror:2 row_mask:0xf bank_mask:0xf
  s_nop 1
  v_max_f32_dpp v17, v17, v17 row_ror:1 row_mask:0xf bank_mask:0xf
  s_nop 1
  v_max_f32_dpp v17, v17, v17 row_bcast:15 row_mask:0xa bank_mask:0xf
  s_nop 1
  v_max_f32_dpp v17, v17, v17 row_bcast:31 row_mask:0xc bank_mask:0xf
  s_nop 0
  v_readlane_b32 s50, v17, 63
  s_nop 1
  v_subrev_f32 v16, s50, v16
  v_exp_f32 v16, v16
  s_nop 0
  v_mul_f32 v17, v16, v13
  s_nop 1
  v_add_f32_dpp v17, v17, v17 row_ror:8 row_mask:0xf bank_mask:0xf
  s_nop 1
  v_add_f32_dpp v17, v17, v17 row_ror:4 row_mask:0xf bank_mask:0xf
  s_nop 1
  v_add_f32_dpp v17, v17, v17 row_ror:2 row_mask:0xf bank_mask:0xf
  s_nop 1
  v_add_f32_dpp v17, v17, v17 row_ror:1 row_mask:0xf bank_mask:0xf
  s_nop 1
  v_add_f32_dpp v17, v17, v17 row_bcast:15 row_mask:0xa bank_mask:0xf
  s_nop 1
  v_add_f32_dpp v17, v17, v17 row_bcast:31 row_mask:0xc bank_mask:0xf
  s_nop 0
  v_readlane_b32 s50, v17, 63
  s_nop 1
  v_mov_b32 v17, s50
  v_rcp_f32 v17, v17
  s_nop 0
  v_mul_f32 v16, v16, v17
  s_mul_i32 s51, s24, 7
  s_add_u32 s52, s51, 0
  v_readlane_b32 s54, v16, s52
  s_add_u32 s52, s51, 1
  v_readlane_b32 s55, v16, s52
  s_add_u32 s52, s51, 2
  v_readlane_b32 s56, v16, s52
  s_add_u32 s52, s51, 3
  v_readlane_b32 s57, v16, s52
  s_add_u32 s52, s51, 4
  v_readlane_b32 s58, v16, s52
  s_add_u32 s52, s51, 5
  v_readlane_b32 s59, v16, s52
  s_add_u32 s52, s51, 6
  v_readlane_b32 s60, v16, s52
  s_waitcnt vmcnt(0)
  v_max_u32 v18, v12, v13
  v_max3_u32 v18, v18, v20, v21
  v_max3_u32 v18, v18, v22, v23
  v_max3_u32 v18, v18, v24, v25
  v_max3_u32 v18, v18, v26, v27
  v_max3_u32 v18, v18, v28, v29
  v_max3_u32 v18, v18, v30, v31
  v_max3_u32 v18, v18, v32, v33
  v_cmp_eq_u32 vcc, -1, v18
  s_nop 0
  s_cmp_lg_u64 vcc, 0
  s_cbranch_scc0 s1ok_100038
  s_sub_u32 s39, s39, 1
  s_cmp_gt_i32 s39, 0
  s_cbranch_scc1 s1_100037
s1ok_100038:
  v_mul_f32 v18, s54, v20
  v_mul_f32 v19, s54, v21
  v_fmac_f32 v18, s55, v22
  v_fmac_f32 v19, s55, v23
  v_fmac_f32 v18, s56, v24
  v_fmac_f32 v19, s56, v25
  v_fmac_f32 v18, s57, v26
  v_fmac_f32 v19, s57, v27
  v_fmac_f32 v18, s58, v28
  v_fmac_f32 v19, s58, v29
  v_fmac_f32 v18, s59, v30
  v_fmac_f32 v19, s59, v31
  v_fmac_f32 v18, s60, v32
  v_fmac_f32 v19, s60, v33
  s_lshl_b32 s46, s24, 9
  s_add_u32 s46, s46, 4096
  v_add_u32 v15, s46, v14
  ds_write_b64 v15, v[18:19]
  s_waitcnt lgkmcnt(0)
  s_barrier
  v_add_u32 v15, 4096, v14
  ds_read_b64 v[20:21], v15 offset:0
  ds_read_b64 v[22:23], v15 offset:512
  ds_read_b64 v[24:25], v15 offset:1024
  ds_read_b64 v[26:27], v15 offset:1536
  s_waitcnt lgkmcnt(0)
  v_add_f32 v20, v20, v22
  v_add_f32 v21, v21, v23
  v_add_f32 v24, v24, v26
  v_add_f32 v25, v25, v27
  v_add_f32 v20, v20, v24
  v_add_f32 v21, v21, v25
  v_cvt_pk_bf16_f32 v20, v20, v21
  s_lshl_b32 s46, s24, 8
  s_add_u32 s46, s46, 8192
  v_add_u32 v15, s46, v2
  ds_write_b32 v15, v20
  v_lshlrev_b32 v15, 4, v3
  v_add_u32 v15, s46, v15
  ds_read_b128 v[20:23], v15 offset:0
  ds_read_b128 v[24:27], v15 offset:64
  ds_read_b128 v[28:31], v15 offset:128
  ds_read_b128 v[32:35], v15 offset:192
  s_waitcnt lgkmcnt(0)
  v_mfma_f32_16x16x32_bf16 v[36:39], v[20:23], a[128:131], 0
  v_mfma_f32_16x16x32_bf16 v[36:39], v[24:27], a[132:135], v[36:39]
  v_mfma_f32_16x16x32_bf16 v[36:39], v[28:31], a[136:139], v[36:39]
  v_mfma_f32_16x16x32_bf16 v[36:39], v[32:35], a[140:143], v[36:39]
  v_mfma_f32_16x16x32_bf16 v[40:43], v[20:23], a[144:147], 0
  v_mfma_f32_16x16x32_bf16 v[40:43], v[24:27], a[148:151], v[40:43]
  v_mfma_f32_16x16x32_bf16 v[40:43], v[28:31], a[152:155], v[40:43]
  v_mfma_f32_16x16x32_bf16 v[40:43], v[32:35], a[156:159], v[40:43]
  v_mfma_f32_16x16x32_bf16 v[44:47], v[20:23], a[160:163], 0
  v_mfma_f32_16x16x32_bf16 v[44:47], v[24:27], a[164:167], v[44:47]
  v_mfma_f32_16x16x32_bf16 v[44:47], v[28:31], a[168:171], v[44:47]
  v_mfma_f32_16x16x32_bf16 v[44:47], v[32:35], a[172:175], v[44:47]
  v_mov_b32_dpp v52, v36 quad_perm:[0,1,2,3] row_mask:0x1 bank_mask:0xf
  v_mfma_f32_16x16x32_bf16 v[48:51], v[20:23], a[176:179], 0
  v_mfma_f32_16x16x32_bf16 v[48:51], v[24:27], a[180:183], v[48:51]
  v_mfma_f32_16x16x32_bf16 v[48:51], v[28:31], a[184:187], v[48:51]
  v_mfma_f32_16x16x32_bf16 v[48:51], v[32:35], a[188:191], v[48:51]
  v_mov_b32_dpp v52, v40 quad_perm:[0,1,2,3] row_mask:0x2 bank_mask:0xf
  v_mfma_f32_16x16x32_bf16 v[36:39], v[20:23], a[192:195], 0
  v_mfma_f32_16x16x32_bf16 v[36:39], v[24:27], a[196:199], v[36:39]
  v_mfma_f32_16x16x32_bf16 v[36:39], v[28:31], a[200:203], v[36:39]
  v_mfma_f32_16x16x32_bf16 v[36:39], v[32:35], a[204:207], v[36:39]
  v_mov_b32_dpp v52, v44 quad_perm:[0,1,2,3] row_mask:0x4 bank_mask:0xf
  v_mfma_f32_16x16x32_bf16 v[40:43], v[20:23], a[208:211], 0
  v_mfma_f32_16x16x32_bf16 v[40:43], v[24:27], a[212:215], v[40:43]
  v_mfma_f32_16x16x32_bf16 v[40:43], v[28:31], a[216:219], v[40:43]
  v_mfma_f32_16x16x32_bf16 v[40:43], v[32:35], a[220:223], v[40:43]
  v_mov_b32_dpp v52, v48 quad_perm:[0,1,2,3] row_mask:0x8 bank_mask:0xf
  v_mfma_f32_16x16x32_bf16 v[44:47], v[20:23], a[224:227], 0
  v_mfma_f32_16x16x32_bf16 v[44:47], v[24:27], a[228:231], v[44:47]
  v_mfma_f32_16x16x32_bf16 v[44:47], v[28:31], a[232:235], v[44:47]
  v_mfma_f32_16x16x32_bf16 v[44:47], v[32:35], a[236:239], v[44:47]
  v_mov_b32_dpp v53, v36 quad_perm:[0,1,2,3] row_mask:0x1 bank_mask:0xf
  v_mfma_f32_16x16x32_bf16 v[48:51], v[20:23], a[240:243], 0
  v_mfma_f32_16x16x32_bf16 v[48:51], v[24:27], a[244:247], v[48:51]
  v_mfma_f32_16x16x32_bf16 v[48:51], v[28:31], a[248:251], v[48:51]
  v_mfma_f32_16x16x32_bf16 v[48:51], v[32:35], a[252:255], v[48:51]
  v_mov_b32_dpp v53, v40 quad_perm:[0,1,2,3] row_mask:0x2 bank_mask:0xf
  s_nop 1
  v_mov_b32_dpp v53, v44 quad_perm:[0,1,2,3] row_mask:0x4 bank_mask:0xf
  s_nop 3
  v_mov_b32_dpp v53, v48 quad_perm:[0,1,2,3] row_mask:0x8 bank_mask:0xf
  v_lshlrev_b32 v15, 11, v3
  v_lshl_add_u32 v15, v4, 2, v15
  s_lshl_b32 s46, s24, 14
  s_lshl_b32 s47, s25, 6
  s_add_u32 s46, s46, s47
  s_add_u32 s46, s46, 1998848
  buffer_store_dword v52, v15, s[12:15], s46 offen sc1
  s_add_u32 s46, s46, 8192
  buffer_store_dword v53, v15, s[12:15], s46 offen sc1
  s_cmp_eq_u32 s24, 0
  s_cbranch_scc0 w0_100041
  s_lshl_b32 s46, s25, 11
  s_add_u32 s46, s46, 1998848
  s_lshl_b32 s47, s25, 5
  s_add_u32 s47, s47, 2134016
  v_and_b32 v24, 3, v0
  v_lshlrev_b32 v24, 3, v24
  s_nop 1
r16_100042:
  buffer_load_dwordx4 v[12:15], v1, s[12:15], s46 offen sc1
  buffer_load_dwordx4 v[16:19], v1, s[12:15], s46 offen offset:1024 sc1
  s_mov_b64 exec, -1
  buffer_load_dwordx2 v[20:21], v24, s[12:15], s47 offen sc1
  s_waitcnt vmcnt(0)
  v_max_u32 v25, v12, v13
  v_max3_u32 v25, v25, v14, v15
  v_max3_u32 v25, v25, v16, v17
  v_max3_u32 v25, v25, v18, v19
  v_max3_u32 v25, v25, v20, v21
  v_cmp_eq_u32 vcc, -1, v25
  s_nop 0
  s_cmp_lg_u64 vcc, 0
  s_cbranch_scc0 r16ok_100043
  s_sub_u32 s39, s39, 1
  s_cmp_gt_i32 s39, 0
  s_cbranch_scc1 r16_100042
r16ok_100043:
  v_add_f32 v12, v12, v16
  v_add_f32 v13, v13, v17
  v_add_f32 v14, v14, v18
  v_add_f32 v15, v15, v19
  v_add_f32_dpp v12, v12, v12 row_ror:4 row_mask:0xf bank_mask:0xf
  v_add_f32_dpp v13, v13, v13 row_ror:4 row_mask:0xf bank_mask:0xf
  v_add_f32_dpp v14, v14, v14 row_ror:4 row_mask:0xf bank_mask:0xf
  v_add_f32_dpp v15, v15, v15 row_ror:4 row_mask:0xf bank_mask:0xf
  v_add_f32_dpp v12, v12, v12 row_ror:8 row_mask:0xf bank_mask:0xf
  v_add_f32_dpp v13, v13, v13 row_ror:8 row_mask:0xf bank_mask:0xf
  v_add_f32_dpp v14, v14, v14 row_ror:8 row_mask:0xf bank_mask:0xf
  v_add_f32_dpp v15, v15, v15 row_ror:8 row_mask:0xf bank_mask:0xf
  v_mov_b32 v16, v12
  v_mov_b32 v17, v13
  v_mov_b32 v18, v14
  v_mov_b32 v19, v15
  v_permlane32_swap_b32 v12, v16
  v_permlane32_swap_b32 v13, v17
  v_permlane32_swap_b32 v14, v18
  v_permlane32_swap_b32 v15, v19
  v_add_f32 v12, v12, v16
  v_add_f32 v13, v13, v17
  v_add_f32 v14, v14, v18
  v_add_f32 v15, v15, v19
  v_mov_b32 v16, v12
  v_mov_b32 v17, v13
  v_mov_b32 v18, v14
  v_mov_b32 v19, v15
  v_permlane16_swap_b32 v12, v16
  v_permlane16_swap_b32 v13, v17
  v_permlane16_swap_b32 v14, v18
  v_permlane16_swap_b32 v15, v19
  v_add_f32 v12, v12, v16
  v_add_f32 v13, v13, v17
  v_add_f32 v14, v14, v18
  v_add_f32 v15, v15, v19
  v_lshlrev_b32 v16, 16, v20
  v_and_b32 v17, 0xffff0000, v20
  v_lshlrev_b32 v18, 16, v21
  v_and_b32 v19, 0xffff0000, v21
  v_cvt_pk_bf16_f32 v12, v12, v12
  v_and_b32 v12, 0xffff0000, v12
  v_cvt_pk_bf16_f32 v13, v13, v13
  v_and_b32 v13, 0xffff0000, v13
  v_cvt_pk_bf16_f32 v14, v14, v14
  v_and_b32 v14, 0xffff0000, v14
  v_cvt_pk_bf16_f32 v15, v15, v15
  v_and_b32 v15, 0xffff0000, v15
  v_add_f32 v12, v12, v16
  v_add_f32 v13, v13, v17
  v_add_f32 v14, v14, v18
  v_add_f32 v15, v15, v19
  v_cvt_pk_bf16_f32 v20, v12, v13
  v_cvt_pk_bf16_f32 v21, v14, v15
  s_lshl_b32 s46, s25, 5
  s_add_u32 s46, s46, 2131968
  s_mov_b64 exec, 0xf
  buffer_store_dwordx2 v[20:21], v24, s[12:15], s46 offen sc1
  s_mov_b64 exec, -1
w0_100041:
  s_cmp_lt_u32 s25, 22
  s_cbranch_scc0 f3_100044
  s_mov_b32 s46, 2131968
xa_100045:
  buffer_load_dwordx4 v[12:15], v1, s[12:15], s46 offen sc1
  s_waitcnt vmcnt(0)
  v_max_u32 v16, v12, v13
  v_max3_u32 v16, v16, v14, v15
  v_cmp_eq_u32 vcc, -1, v16
  s_nop 0
  s_cmp_lg_u64 vcc, 0
  s_cbranch_scc0 xaok_100046
  s_sub_u32 s39, s39, 1
  s_cmp_gt_i32 s39, 0
  s_cbranch_scc1 xa_100045
xaok_100046:
  v_add_u32 v16, s42, v1
  ds_write_b128 v16, v[12:15]
  ds_read_b128 v[28:31], v9 offset:0
  ds_read_b128 v[32:35], v9 offset:64
  ds_read_b128 v[36:39], v9 offset:128
  ds_read_b128 v[40:43], v9 offset:192
  s_waitcnt lgkmcnt(3)
  v_mfma_f32_16x16x32_bf16 v[20:23], v[28:31], v[64:67], 0
  v_mfma_f32_16x16x32_bf16 v[24:27], v[28:31], v[128:131], 0
  ds_read_b128 v[28:31], v9 offset:256
  v_lshlrev_b32 v50, 16, v12
  v_and_b32 v51, 0xffff0000, v12
  v_add_f32 v48, v50, v51
  s_waitcnt lgkmcnt(3)
  v_mfma_f32_16x16x32_bf16 v[20:23], v[32:35], v[68:71], v[20:23]
  v_mfma_f32_16x16x32_bf16 v[24:27], v[32:35], v[132:135], v[24:27]
  ds_read_b128 v[32:35], v9 offset:320
  v_mul_f32 v49, v50, v50
  v_fmac_f32 v49, v51, v51
  v_lshlrev_b32 v50, 16, v13
  v_and_b32 v51, 0xffff0000, v13
  s_waitcnt lgkmcnt(3)
  v_mfma_f32_16x16x32_bf16 v[20:23], v[36:39], v[72:75], v[20:23]
  v_mfma_f32_16x16x32_bf16 v[24:27], v[36:39], v[136:139], v[24:27]
  ds_read_b128 v[36:39], v9 offset:384
  v_add_f32 v48, v48, v50
  v_fmac_f32 v49, v50, v50
  v_add_f32 v48, v48, v51
  s_waitcnt lgkmcnt(3)
  v_mfma_f32_16x16x32_bf16 v[20:23], v[40:43], v[76:79], v[20:23]
  v_mfma_f32_16x16x32_bf16 v[24:27], v[40:43], v[140:143], v[24:27]
  ds_read_b128 v[40:43], v9 offset:448
  v_fmac_f32 v49, v51, v51
  v_lshlrev_b32 v50, 16, v14
  v_and_b32 v51, 0xffff0000, v14
  v_add_f32 v48, v48, v50
  s_waitcnt lgkmcnt(3)
  v_mfma_f32_16x16x32_bf16 v[20:23], v[28:31], v[80:83], v[20:23]
  v_mfma_f32_16x16x32_bf16 v[24:27], v[28:31], v[144:147], v[24:27]
  ds_read_b128 v[28:31], v9 offset:512
  v_fmac_f32 v49, v50, v50
  v_add_f32 v48, v48, v51
  v_fmac_f32 v49, v51, v51
  s_waitcnt lgkmcnt(3)
  v_mfma_f32_16x16x32_bf16 v[20:23], v[32:35], v[84:87], v[20:23]
  v_mfma_f32_16x16x32_bf16 v[24:27], v[32:35], v[148:151], v[24:27]
  ds_read_b128 v[32:35], v9 offset:576
  v_lshlrev_b32 v50, 16, v15
  v_and_b32 v51, 0xffff0000, v15
  v_add_f32 v48, v48, v50
  v_fmac_f32 v49, v50, v50
  s_waitcnt lgkmcnt(3)
  v_mfma_f32_16x16x32_bf16 v[20:23], v[36:39], v[88:91], v[20:23]
  v_mfma_f32_16x16x32_bf16 v[24:27], v[36:39], v[152:155], v[24:27]
  ds_read_b128 v[36:39], v9 offset:640
  v_add_f32 v48, v48, v51
  v_fmac_f32 v49, v51, v51
  s_nop 0
  v_add_f32_dpp v48, v48, v48 row_ror:8 row_mask:0xf bank_mask:0xf
  s_waitcnt lgkmcnt(3)
  v_mfma_f32_16x16x32_bf16 v[20:23], v[40:43], v[92:95], v[20:23]
  v_mfma_f32_16x16x32_bf16 v[24:27], v[40:43], v[156:159], v[24:27]
  ds_read_b128 v[40:43], v9 offset:704
  v_add_f32_dpp v49, v49, v49 row_ror:8 row_mask:0xf bank_mask:0xf
  v_add_f32_dpp v48, v48, v48 row_ror:4 row_mask:0xf bank_mask:0xf
  s_nop 0
  v_add_f32_dpp v49, v49, v49 row_ror:4 row_mask:0xf bank_mask:0xf
  v_add_f32_dpp v48, v48, v48 row_ror:2 row_mask:0xf bank_mask:0xf
  s_waitcnt lgkmcnt(3)
  v_mfma_f32_16x16x32_bf16 v[20:23], v[28:31], v[96:99], v[20:23]
  v_mfma_f32_16x16x32_bf16 v[24:27], v[28:31], v[160:163], v[24:27]
  ds_read_b128 v[28:31], v9 offset:768
  v_add_f32_dpp v49, v49, v49 row_ror:2 row_mask:0xf bank_mask:0xf
  v_add_f32_dpp v48, v48, v48 row_ror:1 row_mask:0xf bank_mask:0xf
  s_nop 0
  v_add_f32_dpp v49, v49, v49 row_ror:1 row_mask:0xf bank_mask:0xf
  s_waitcnt lgkmcnt(3)
  v_mfma_f32_16x16x32_bf16 v[20:23], v[32:35], v[100:103], v[20:23]
  v_mfma_f32_16x16x32_bf16 v[24:27], v[32:35], v[164:167], v[24:27]
  ds_read_b128 v[32:35], v9 offset:832
  v_add_f32_dpp v48, v48, v48 row_bcast:15 row_mask:0xa bank_mask:0xf
  v_add_f32_dpp v49, v49, v49 row_bcast:15 row_mask:0xa bank_mask:0xf
  s_nop 0
  v_add_f32_dpp v48, v48, v48 row_bcast:31 row_mask:0xc bank_mask:0xf
  v_add_f32_dpp v49, v49, v49 row_bcast:31 row_mask:0xc bank_mask:0xf
  s_waitcnt lgkmcnt(3)
  v_mfma_f32_16x16x32_bf16 v[20:23], v[36:39], v[104:107], v[20:23]
  v_mfma_f32_16x16x32_bf16 v[24:27], v[36:39], v[168:171], v[24:27]
  ds_read_b128 v[36:39], v9 offset:896
  v_readlane_b32 s54, v48, 63
  v_readlane_b32 s55, v49, 63
  s_nop 0
  v_mov_b32 v44, s54
  s_waitcnt lgkmcnt(3)
  v_mfma_f32_16x16x32_bf16 v[20:23], v[40:43], v[108:111], v[20:23]
  v_mfma_f32_16x16x32_bf16 v[24:27], v[40:43], v[172:175], v[24:27]
  ds_read_b128 v[40:43], v9 offset:960
  v_mov_b32 v45, s55
  v_mul_f32 v44, 0x3b000000, v44
  v_mul_f32 v45, 0x3b000000, v45
  v_fma_f32 v45, -v44, v44, v45
  s_waitcnt lgkmcnt(3)
  v_mfma_f32_16x16x32_bf16 v[20:23], v[28:31], v[112:115], v[20:23]
  v_mfma_f32_16x16x32_bf16 v[24:27], v[28:31], v[176:179], v[24:27]
  v_max_f32 v45, 0, v45
  v_cvt_pk_bf16_f32 v44, v44, v44
  v_cvt_pk_bf16_f32 v45, v45, v45
  s_waitcnt lgkmcnt(2)
  v_mfma_f32_16x16x32_bf16 v[20:23], v[32:35], v[116:119], v[20:23]
  v_mfma_f32_16x16x32_bf16 v[24:27], v[32:35], v[180:183], v[24:27]
  v_and_b32 v44, 0xffff0000, v44
  v_and_b32 v45, 0xffff0000, v45
  v_add_f32 v45, 0x3727c5ac, v45
  v_cvt_pk_bf16_f32 v45, v45, v45
  s_waitcnt lgkmcnt(1)
  v_mfma_f32_16x16x32_bf16 v[20:23], v[36:39], v[120:123], v[20:23]
  v_mfma_f32_16x16x32_bf16 v[24:27], v[36:39], v[184:187], v[24:27]
  v_and_b32 v45, 0xffff0000, v45
  v_sqrt_f32 v45, v45
  s_nop 0
  v_cvt_pk_bf16_f32 v45, v45, v45
  s_waitcnt lgkmcnt(0)
  v_mfma_f32_16x16x32_bf16 v[20:23], v[40:43], v[124:127], v[20:23]
  v_mfma_f32_16x16x32_bf16 v[24:27], v[40:43], v[188:191], v[24:27]
  v_and_b32 v45, 0xffff0000, v45
  v_rcp_f32 v45, v45
  v_mul_f32 v46, v44, v7
  v_mul_f32 v47, v44, v8
  s_nop 2
  v_sub_f32 v20, v20, v46
  v_sub_f32 v24, v24, v47
  v_mul_f32 v20, v20, v45
  v_mul_f32 v24, v24, v45
  v_cvt_pk_bf16_f32 v20, v20, v20
  v_and_b32 v20, 0xffff0000, v20
  v_cvt_pk_bf16_f32 v24, v24, v24
  v_and_b32 v24, 0xffff0000, v24
  v_mul_f32 v12, v20, v24
  s_nop 1
  v_mov_b32_dpp v13, v12 quad_perm:[1,1,3,3] row_mask:0xf bank_mask:0xf
  v_cvt_pk_bf16_f32 v12, v12, v13
  s_nop 1
  v_and_b32_dpp v28, v12, v11 row_newbcast:0 row_mask:0xf bank_mask:0xf
  v_and_b32_dpp v29, v12, v11 row_newbcast:2 row_mask:0xf bank_mask:0xf
  v_and_b32_dpp v30, v12, v11 row_newbcast:4 row_mask:0xf bank_mask:0xf
  v_and_b32_dpp v31, v12, v11 row_newbcast:6 row_mask:0xf bank_mask:0xf
  v_and_b32_dpp v32, v12, v11 row_newbcast:8 row_mask:0xf bank_mask:0xf
  v_and_b32_dpp v33, v12, v11 row_newbcast:10 row_mask:0xf bank_mask:0xf
  v_and_b32_dpp v34, v12, v11 row_newbcast:12 row_mask:0xf bank_mask:0xf
  v_and_b32_dpp v35, v12, v11 row_newbcast:14 row_mask:0xf bank_mask:0xf
  s_lshl_b32 s46, s24, 11
  s_add_u32 s46, s46, 9216
  v_lshlrev_b32 v14, 4, v4
  v_add_u32 v14, s46, v14
  v_mfma_f32_16x16x32_bf16 v[36:39], v[28:31], v[192:195], 0
  v_mfma_f32_16x16x32_bf16 v[36:39], v[32:35], v[196:199], v[36:39]
  v_mfma_f32_16x16x32_bf16 v[40:43], v[28:31], v[200:203], 0
  v_mfma_f32_16x16x32_bf16 v[40:43], v[32:35], v[204:207], v[40:43]
  v_mfma_f32_16x16x32_bf16 v[44:47], v[28:31], v[208:211], 0
  v_mfma_f32_16x16x32_bf16 v[44:47], v[32:35], v[212:215], v[44:47]
  s_mov_b64 exec, 0xffff
  s_nop 2
  ds_write_b128 v14, v[36:39] offset:0
  s_mov_b64 exec, -1
  v_mfma_f32_16x16x32_bf16 v[48:51], v[28:31], v[216:219], 0
  v_mfma_f32_16x16x32_bf16 v[48:51], v[32:35], v[220:223], v[48:51]
  s_mov_b64 exec, 0xffff
  ds_write_b128 v14, v[40:43] offset:256
  s_mov_b64 exec, -1
  v_mfma_f32_16x16x32_bf16 v[36:39], v[28:31], v[224:227], 0
  v_mfma_f32_16x16x32_bf16 v[36:39], v[32:35], v[228:231], v[36:39]
  s_mov_b64 exec, 0xffff
  ds_write_b128 v14, v[44:47] offset:512
  s_mov_b64 exec, -1
  v_mfma_f32_16x16x32_bf16 v[40:43], v[28:31], v[232:235], 0
  v_mfma_f32_16x16x32_bf16 v[40:43], v[32:35], v[236:239], v[40:43]
  s_mov_b64 exec, 0xffff
  ds_write_b128 v14, v[48:51] offset:768
  s_mov_b64 exec, -1
  v_mfma_f32_16x16x32_bf16 v[44:47], v[28:31], v[240:243], 0
  v_mfma_f32_16x16x32_bf16 v[44:47], v[32:35], v[244:247], v[44:47]
  s_mov_b64 exec, 0xffff
  ds_write_b128 v14, v[36:39] offset:1024
  s_mov_b64 exec, -1
  v_mfma_f32_16x16x32_bf16 v[48:51], v[28:31], v[248:251], 0
  v_mfma_f32_16x16x32_bf16 v[48:51], v[32:35], v[252:255], v[48:51]
  s_mov_b64 exec, 0xffff
  ds_write_b128 v14, v[40:43] offset:1280
  s_mov_b64 exec, -1
  s_mov_b64 exec, 0xffff
  ds_write_b128 v14, v[44:47] offset:1536
  s_mov_b64 exec, -1
  s_mov_b64 exec, 0xffff
  s_nop 0
  ds_write_b128 v14, v[48:51] offset:1792
  s_mov_b64 exec, -1
  s_waitcnt lgkmcnt(0)
  s_barrier
  s_lshl_b32 s46, s24, 9
  s_add_u32 s46, s46, 9216
  v_lshlrev_b32 v14, 3, v0
  v_add_u32 v15, s46, v14
  ds_read_b64 v[20:21], v15 offset:0
  ds_read_b64 v[22:23], v15 offset:2048
  ds_read_b64 v[24:25], v15 offset:4096
  ds_read_b64 v[26:27], v15 offset:6144
  s_waitcnt lgkmcnt(0)
  v_add_f32 v20, v20, v22
  v_add_f32 v21, v21, v23
  v_add_f32 v24, v24, v26
  v_add_f32 v25, v25, v27
  v_add_f32 v20, v20, v24
  v_add_f32 v21, v21, v25
  v_lshrrev_b32 v14, 3, v0
  v_lshlrev_b32 v14, 11, v14
  v_and_b32 v15, 7, v0
  v_lshl_add_u32 v14, v15, 3, v14
  s_lshl_b32 s46, s24, 14
  s_lshl_b32 s47, s25, 6
  s_add_u32 s46, s46, s47
  s_add_u32 s46, s46, 2269184
  buffer_store_dwordx2 v[20:21], v14, s[12:15], s46 offen sc1
  s_barrier
f3_100044:
  s_cmp_eq_u32 s24, 1
  s_cbranch_scc0 w1_100047
  s_lshl_b32 s46, s25, 11
  s_add_u32 s46, s46, 2269184
  s_lshl_b32 s47, s25, 5
  s_add_u32 s47, s47, 2131968
  v_and_b32 v24, 3, v0
  v_lshlrev_b32 v24, 3, v24
  v_cmp_gt_u32 vcc, 24, v0
  s_nop 0
  s_mov_b64 s[48:49], vcc
  s_nop 2
r16_100048:
  buffer_load_dwordx4 v[12:15], v1, s[12:15], s46 offen sc1
  v_mov_b32 v16, 0
  v_mov_b32 v17, 0
  v_mov_b32 v18, 0
  v_mov_b32 v19, 0
  s_mov_b64 exec, s[48:49]
  buffer_load_dwordx4 v[16:19], v1, s[12:15], s46 offen offset:1024 sc1
  s_mov_b64 exec, -1
  buffer_load_dwordx2 v[20:21], v24, s[12:15], s47 offen sc1
  s_waitcnt vmcnt(0)
  v_max_u32 v25, v12, v13
  v_max3_u32 v25, v25, v14, v15
  v_max3_u32 v25, v25, v16, v17
  v_max3_u32 v25, v25, v18, v19
  v_max3_u32 v25, v25, v20, v21
  v_cmp_eq_u32 vcc, -1, v25
  s_nop 0
  s_cmp_lg_u64 vcc, 0
  s_cbranch_scc0 r16ok_100049
  s_sub_u32 s39, s39, 1
  s_cmp_gt_i32 s39, 0
  s_cbranch_scc1 r16_100048
r16ok_100049:
  v_add_f32 v12, v12, v16
  v_add_f32 v13, v13, v17
  v_add_f32 v14, v14, v18
  v_add_f32 v15, v15, v19
  v_add_f32_dpp v12, v12, v12 row_ror:4 row_mask:0xf bank_mask:0xf
  v_add_f32_dpp v13, v13, v13 row_ror:4 row_mask:0xf bank_mask:0xf
  v_add_f32_dpp v14, v14, v14 row_ror:4 row_mask:0xf bank_mask:0xf
  v_add_f32_dpp v15, v15, v15 row_ror:4 row_mask:0xf bank_mask:0xf
  v_add_f32_dpp v12, v12, v12 row_ror:8 row_mask:0xf bank_mask:0xf
  v_add_f32_dpp v13, v13, v13 row_ror:8 row_mask:0xf bank_mask:0xf
  v_add_f32_dpp v14, v14, v14 row_ror:8 row_mask:0xf bank_mask:0xf
  v_add_f32_dpp v15, v15, v15 row_ror:8 row_mask:0xf bank_mask:0xf
  v_mov_b32 v16, v12
  v_mov_b32 v17, v13
  v_mov_b32 v18, v14
  v_mov_b32 v19, v15
  v_permlane32_swap_b32 v12, v16
  v_permlane32_swap_b32 v13, v17
  v_permlane32_swap_b32 v14, v18
  v_permlane32_swap_b32 v15, v19
  v_add_f32 v12, v12, v16
  v_add_f32 v13, v13, v17
  v_add_f32 v14, v14, v18
  v_add_f32 v15, v15, v19
  v_mov_b32 v16, v12
  v_mov_b32 v17, v13
  v_mov_b32 v18, v14
  v_mov_b32 v19, v15
  v_permlane16_swap_b32 v12, v16
  v_permlane16_swap_b32 v13, v17
  v_permlane16_swap_b32 v14, v18
  v_permlane16_swap_b32 v15, v19
  v_add_f32 v12, v12, v16
  v_add_f32 v13, v13, v17
  v_add_f32 v14, v14, v18
  v_add_f32 v15, v15, v19
  v_lshlrev_b32 v16, 16, v20
  v_and_b32 v17, 0xffff0000, v20
  v_lshlrev_b32 v18, 16, v21
  v_and_b32 v19, 0xffff0000, v21
  v_cvt_pk_bf16_f32 v12, v12, v12
  v_and_b32 v12, 0xffff0000, v12
  v_cvt_pk_bf16_f32 v13, v13, v13
  v_and_b32 v13, 0xffff0000, v13
  v_cvt_pk_bf16_f32 v14, v14, v14
  v_and_b32 v14, 0xffff0000, v14
  v_cvt_pk_bf16_f32 v15, v15, v15
  v_and_b32 v15, 0xffff0000, v15
  v_add_f32 v12, v12, v16
  v_add_f32 v13, v13, v17
  v_add_f32 v14, v14, v18
  v_add_f32 v15, v15, v19
  v_cvt_pk_bf16_f32 v20, v12, v13
  v_cvt_pk_bf16_f32 v21, v14, v15
  s_lshl_b32 s46, s25, 5
  s_add_u32 s46, s46, 0
  s_mov_b64 exec, 0xf
  buffer_store_dwordx2 v[20:21], v24, s[16:19], s46 offen
  s_mov_b64 exec, -1
w1_100047:
  s_lshl_b32 s46, s25, 8
  s_add_u32 s46, s46, 1859584
  v_lshlrev_b32 v14, 3, v0
  v_cmp_gt_u32 vcc, 28, v0
  s_nop 0
  s_mov_b64 s[48:49], vcc
  s_cmp_eq_u32 s24, 0
  s_nop 1
  s_cbranch_scc0 s1wok_100053
s1w_100052:
  v_mov_b32 v12, -1
  s_mov_b64 exec, s[48:49]
  buffer_load_dword v12, v14, s[12:15], s46 offen sc1
  s_mov_b64 exec, -1
  s_waitcnt vmcnt(0)
  v_cmp_ne_u32 vcc, -1, v12
  s_nop 0
  s_bcnt1_i32_b64 s50, vcc
  s_cmp_ge_u32 s50, 20
  s_cbranch_scc1 s1wok_100053
  s_sleep 8
  s_sub_u32 s39, s39, 1
  s_cmp_gt_i32 s39, 0
  s_cbranch_scc1 s1w_100052
s1wok_100053:
  s_barrier
  s_mul_i32 s62, s25, 28
  s_mul_i32 s47, s24, 7
  s_add_u32 s62, s62, s47
  s_lshl_b32 s62, s62, 9
  s_add_u32 s62, s62, 1376256
s1_100050:
  v_mov_b32 v12, 0
  v_mov_b32 v13, 0
  s_mov_b64 exec, s[48:49]
  buffer_load_dwordx2 v[12:13], v14, s[12:15], s46 offen sc1
  s_mov_b64 exec, -1
  buffer_load_dwordx2 v[20:21], v14, s[12:15], s62 offen offset:0 sc1
  buffer_load_dwordx2 v[22:23], v14, s[12:15], s62 offen offset:512 sc1
  buffer_load_dwordx2 v[24:25], v14, s[12:15], s62 offen offset:1024 sc1
  buffer_load_dwordx2 v[26:27], v14, s[12:15], s62 offen offset:1536 sc1
  buffer_load_dwordx2 v[28:29], v14, s[12:15], s62 offen offset:2048 sc1
  buffer_load_dwordx2 v[30:31], v14, s[12:15], s62 offen offset:2560 sc1
  buffer_load_dwordx2 v[32:33], v14, s[12:15], s62 offen offset:3072 sc1
  s_waitcnt vmcnt(7)
  v_mov_b32 v15, 0xff800000
  v_cndmask_b32 v16, v15, v12, s[48:49]
  v_mov_b32 v17, v16
  s_nop 1
  v_max_f32_dpp v17, v17, v17 row_ror:8 row_mask:0xf bank_mask:0xf
  s_nop 1
  v_max_f32_dpp v17, v17, v17 row_ror:4 row_mask:0xf bank_mask:0xf
  s_nop 1
  v_max_f32_dpp v17, v17, v17 row_ror:2 row_mask:0xf bank_mask:0xf
  s_nop 1
  v_max_f32_dpp v17, v17, v17 row_ror:1 row_mask:0xf bank_mask:0xf
  s_nop 1
  v_max_f32_dpp v17, v17, v17 row_bcast:15 row_mask:0xa bank_mask:0xf
  s_nop 1
  v_max_f32_dpp v17, v17, v17 row_bcast:31 row_mask:0xc bank_mask:0xf
  s_nop 0
  v_readlane_b32 s50, v17, 63
  s_nop 1
  v_subrev_f32 v16, s50, v16
  v_exp_f32 v16, v16
  s_nop 0
  v_mul_f32 v17, v16, v13
  s_nop 1
  v_add_f32_dpp v17, v17, v17 row_ror:8 row_mask:0xf bank_mask:0xf
  s_nop 1
  v_add_f32_dpp v17, v17, v17 row_ror:4 row_mask:0xf bank_mask:0xf
  s_nop 1
  v_add_f32_dpp v17, v17, v17 row_ror:2 row_mask:0xf bank_mask:0xf
  s_nop 1
  v_add_f32_dpp v17, v17, v17 row_ror:1 row_mask:0xf bank_mask:0xf
  s_nop 1
  v_add_f32_dpp v17, v17, v17 row_bcast:15 row_mask:0xa bank_mask:0xf
  s_nop 1
  v_add_f32_dpp v17, v17, v17 row_bcast:31 row_mask:0xc bank_mask:0xf
  s_nop 0
  v_readlane_b32 s50, v17, 63
  s_nop 1
  v_mov_b32 v17, s50
  v_rcp_f32 v17, v17
  s_nop 0
  v_mul_f32 v16, v16, v17
  s_mul_i32 s51, s24, 7
  s_add_u32 s52, s51, 0
  v_readlane_b32 s54, v16, s52
  s_add_u32 s52, s51, 1
  v_readlane_b32 s55, v16, s52
  s_add_u32 s52, s51, 2
  v_readlane_b32 s56, v16, s52
  s_add_u32 s52, s51, 3
  v_readlane_b32 s57, v16, s52
  s_add_u32 s52, s51, 4
  v_readlane_b32 s58, v16, s52
  s_add_u32 s52, s51, 5
  v_readlane_b32 s59, v16, s52
  s_add_u32 s52, s51, 6
  v_readlane_b32 s60, v16, s52
  s_waitcnt vmcnt(0)
  v_max_u32 v18, v12, v13
  v_max3_u32 v18, v18, v20, v21
  v_max3_u32 v18, v18, v22, v23
  v_max3_u32 v18, v18, v24, v25
  v_max3_u32 v18, v18, v26, v27
  v_max3_u32 v18, v18, v28, v29
  v_max3_u32 v18, v18, v30, v31
  v_max3_u32 v18, v18, v32, v33
  v_cmp_eq_u32 vcc, -1, v18
  s_nop 0
  s_cmp_lg_u64 vcc, 0
  s_cbranch_scc0 s1ok_100051
  s_sub_u32 s39, s39, 1
  s_cmp_gt_i32 s39, 0
  s_cbranch_scc1 s1_100050
s1ok_100051:
  v_mul_f32 v18, s54, v20
  v_mul_f32 v19, s54, v21
  v_fmac_f32 v18, s55, v22
  v_fmac_f32 v19, s55, v23
  v_fmac_f32 v18, s56, v24
  v_fmac_f32 v19, s56, v25
  v_fmac_f32 v18, s57, v26
  v_fmac_f32 v19, s57, v27
  v_fmac_f32 v18, s58, v28
  v_fmac_f32 v19, s58, v29
  v_fmac_f32 v18, s59, v30
  v_fmac_f32 v19, s59, v31
  v_fmac_f32 v18, s60, v32
  v_fmac_f32 v19, s60, v33
  s_lshl_b32 s46, s24, 9
  s_add_u32 s46, s46, 6144
  v_add_u32 v15, s46, v14
  ds_write_b64 v15, v[18:19]
  s_waitcnt lgkmcnt(0)
  s_barrier
  v_add_u32 v15, 6144, v14
  ds_read_b64 v[20:21], v15 offset:0
  ds_read_b64 v[22:23], v15 offset:512
  ds_read_b64 v[24:25], v15 offset:1024
  ds_read_b64 v[26:27], v15 offset:1536
  s_waitcnt lgkmcnt(0)
  v_add_f32 v20, v20, v22
  v_add_f32 v21, v21, v23
  v_add_f32 v24, v24, v26
  v_add_f32 v25, v25, v27
  v_add_f32 v20, v20, v24
  v_add_f32 v21, v21, v25
  v_cvt_pk_bf16_f32 v20, v20, v21
  s_lshl_b32 s46, s24, 8
  s_add_u32 s46, s46, 8192
  v_add_u32 v15, s46, v2
  ds_write_b32 v15, v20
  v_lshlrev_b32 v15, 4, v3
  v_add_u32 v15, s46, v15
  ds_read_b128 v[20:23], v15 offset:0
  ds_read_b128 v[24:27], v15 offset:64
  ds_read_b128 v[28:31], v15 offset:128
  ds_read_b128 v[32:35], v15 offset:192
  s_waitcnt lgkmcnt(0)
  v_mfma_f32_16x16x32_bf16 v[36:39], v[20:23], a[128:131], 0
  v_mfma_f32_16x16x32_bf16 v[36:39], v[24:27], a[132:135], v[36:39]
  v_mfma_f32_16x16x32_bf16 v[36:39], v[28:31], a[136:139], v[36:39]
  v_mfma_f32_16x16x32_bf16 v[36:39], v[32:35], a[140:143], v[36:39]
  v_mfma_f32_16x16x32_bf16 v[40:43], v[20:23], a[144:147], 0
  v_mfma_f32_16x16x32_bf16 v[40:43], v[24:27], a[148:151], v[40:43]
  v_mfma_f32_16x16x32_bf16 v[40:43], v[28:31], a[152:155], v[40:43]
  v_mfma_f32_16x16x32_bf16 v[40:43], v[32:35], a[156:159], v[40:43]
  v_mfma_f32_16x16x32_bf16 v[44:47], v[20:23], a[160:163], 0
  v_mfma_f32_16x16x32_bf16 v[44:47], v[24:27], a[164:167], v[44:47]
  v_mfma_f32_16x16x32_bf16 v[44:47], v[28:31], a[168:171], v[44:47]
  v_mfma_f32_16x16x32_bf16 v[44:47], v[32:35], a[172:175], v[44:47]
  v_mov_b32_dpp v52, v36 quad_perm:[0,1,2,3] row_mask:0x1 bank_mask:0xf
  v_mfma_f32_16x16x32_bf16 v[48:51], v[20:23], a[176:179], 0
  v_mfma_f32_16x16x32_bf16 v[48:51], v[24:27], a[180:183], v[48:51]
  v_mfma_f32_16x16x32_bf16 v[48:51], v[28:31], a[184:187], v[48:51]
  v_mfma_f32_16x16x32_bf16 v[48:51], v[32:35], a[188:191], v[48:51]
  v_mov_b32_dpp v52, v40 quad_perm:[0,1,2,3] row_mask:0x2 bank_mask:0xf
  v_mfma_f32_16x16x32_bf16 v[36:39], v[20:23], a[192:195], 0
  v_mfma_f32_16x16x32_bf16 v[36:39], v[24:27], a[196:199], v[36:39]
  v_mfma_f32_16x16x32_bf16 v[36:39], v[28:31], a[200:203], v[36:39]
  v_mfma_f32_16x16x32_bf16 v[36:39], v[32:35], a[204:207], v[36:39]
  v_mov_b32_dpp v52, v44 quad_perm:[0,1,2,3] row_mask:0x4 bank_mask:0xf
  v_mfma_f32_16x16x32_bf16 v[40:43], v[20:23], a[208:211], 0
  v_mfma_f32_16x16x32_bf16 v[40:43], v[24:27], a[212:215], v[40:43]
  v_mfma_f32_16x16x32_bf16 v[40:43], v[28:31], a[216:219], v[40:43]
  v_mfma_f32_16x16x32_bf16 v[40:43], v[32:35], a[220:223], v[40:43]
  v_mov_b32_dpp v52, v48 quad_perm:[0,1,2,3] row_mask:0x8 bank_mask:0xf
  v_mfma_f32_16x16x32_bf16 v[44:47], v[20:23], a[224:227], 0
  v_mfma_f32_16x16x32_bf16 v[44:47], v[24:27], a[228:231], v[44:47]
  v_mfma_f32_16x16x32_bf16 v[44:47], v[28:31], a[232:235], v[44:47]
  v_mfma_f32_16x16x32_bf16 v[44:47], v[32:35], a[236:239], v[44:47]
  v_mov_b32_dpp v53, v36 quad_perm:[0,1,2,3] row_mask:0x1 bank_mask:0xf
  v_mfma_f32_16x16x32_bf16 v[48:51], v[20:23], a[240:243], 0
  v_mfma_f32_16x16x32_bf16 v[48:51], v[24:27], a[244:247], v[48:51]
  v_mfma_f32_16x16x32_bf16 v[48:51], v[28:31], a[248:251], v[48:51]
  v_mfma_f32_16x16x32_bf16 v[48:51], v[32:35], a[252:255], v[48:51]
  v_mov_b32_dpp v53, v40 quad_perm:[0,1,2,3] row_mask:0x2 bank_mask:0xf
  s_nop 1
  v_mov_b32_dpp v53, v44 quad_perm:[0,1,2,3] row_mask:0x4 bank_mask:0xf
  s_nop 3
  v_mov_b32_dpp v53, v48 quad_perm:[0,1,2,3] row_mask:0x8 bank_mask:0xf
  v_lshlrev_b32 v15, 11, v3
  v_lshl_add_u32 v15, v4, 2, v15
  s_lshl_b32 s46, s24, 14
  s_lshl_b32 s47, s25, 6
  s_add_u32 s46, s46, s47
  s_add_u32 s46, s46, 2064384
  buffer_store_dword v52, v15, s[12:15], s46 offen sc1
  s_add_u32 s46, s46, 8192
  buffer_store_dword v53, v15, s[12:15], s46 offen sc1
  s_cmp_eq_u32 s24, 0
  s_cbranch_scc0 w0_100054
  s_lshl_b32 s46, s25, 11
  s_add_u32 s46, s46, 2064384
  s_lshl_b32 s47, s25, 5
  s_add_u32 s47, s47, 2135040
  v_and_b32 v24, 3, v0
  v_lshlrev_b32 v24, 3, v24
  s_nop 1
r16_100055:
  buffer_load_dwordx4 v[12:15], v1, s[12:15], s46 offen sc1
  buffer_load_dwordx4 v[16:19], v1, s[12:15], s46 offen offset:1024 sc1
  s_mov_b64 exec, -1
  buffer_load_dwordx2 v[20:21], v24, s[12:15], s47 offen sc1
  s_waitcnt vmcnt(0)
  v_max_u32 v25, v12, v13
  v_max3_u32 v25, v25, v14, v15
  v_max3_u32 v25, v25, v16, v17
  v_max3_u32 v25, v25, v18, v19
  v_max3_u32 v25, v25, v20, v21
  v_cmp_eq_u32 vcc, -1, v25
  s_nop 0
  s_cmp_lg_u64 vcc, 0
  s_cbranch_scc0 r16ok_100056
  s_sub_u32 s39, s39, 1
  s_cmp_gt_i32 s39, 0
  s_cbranch_scc1 r16_100055
r16ok_100056:
  v_add_f32 v12, v12, v16
  v_add_f32 v13, v13, v17
  v_add_f32 v14, v14, v18
  v_add_f32 v15, v15, v19
  v_add_f32_dpp v12, v12, v12 row_ror:4 row_mask:0xf bank_mask:0xf
  v_add_f32_dpp v13, v13, v13 row_ror:4 row_mask:0xf bank_mask:0xf
  v_add_f32_dpp v14, v14, v14 row_ror:4 row_mask:0xf bank_mask:0xf
  v_add_f32_dpp v15, v15, v15 row_ror:4 row_mask:0xf bank_mask:0xf
  v_add_f32_dpp v12, v12, v12 row_ror:8 row_mask:0xf bank_mask:0xf
  v_add_f32_dpp v13, v13, v13 row_ror:8 row_mask:0xf bank_mask:0xf
  v_add_f32_dpp v14, v14, v14 row_ror:8 row_mask:0xf bank_mask:0xf
  v_add_f32_dpp v15, v15, v15 row_ror:8 row_mask:0xf bank_mask:0xf
  v_mov_b32 v16, v12
  v_mov_b32 v17, v13
  v_mov_b32 v18, v14
  v_mov_b32 v19, v15
  v_permlane32_swap_b32 v12, v16
  v_permlane32_swap_b32 v13, v17
  v_permlane32_swap_b32 v14, v18
  v_permlane32_swap_b32 v15, v19
  v_add_f32 v12, v12, v16
  v_add_f32 v13, v13, v17
  v_add_f32 v14, v14, v18
  v_add_f32 v15, v15, v19
  v_mov_b32 v16, v12
  v_mov_b32 v17, v13
  v_mov_b32 v18, v14
  v_mov_b32 v19, v15
  v_permlane16_swap_b32 v12, v16
  v_permlane16_swap_b32 v13, v17
  v_permlane16_swap_b32 v14, v18
  v_permlane16_swap_b32 v15, v19
  v_add_f32 v12, v12, v16
  v_add_f32 v13, v13, v17
  v_add_f32 v14, v14, v18
  v_add_f32 v15, v15, v19
  v_lshlrev_b32 v16, 16, v20
  v_and_b32 v17, 0xffff0000, v20
  v_lshlrev_b32 v18, 16, v21
  v_and_b32 v19, 0xffff0000, v21
  v_cvt_pk_bf16_f32 v12, v12, v12
  v_and_b32 v12, 0xffff0000, v12
  v_cvt_pk_bf16_f32 v13, v13, v13
  v_and_b32 v13, 0xffff0000, v13
  v_cvt_pk_bf16_f32 v14, v14, v14
  v_and_b32 v14, 0xffff0000, v14
  v_cvt_pk_bf16_f32 v15, v15, v15
  v_and_b32 v15, 0xffff0000, v15
  v_add_f32 v12, v12, v16
  v_add_f32 v13, v13, v17
  v_add_f32 v14, v14, v18
  v_add_f32 v15, v15, v19
  v_cvt_pk_bf16_f32 v20, v12, v13
  v_cvt_pk_bf16_f32 v21, v14, v15
  s_lshl_b32 s46, s25, 5
  s_add_u32 s46, s46, 2132992
  s_mov_b64 exec, 0xf
  buffer_store_dwordx2 v[20:21], v24, s[12:15], s46 offen sc1
  s_mov_b64 exec, -1
w0_100054:
  s_cmp_lt_u32 s25, 22
  s_cbranch_scc0 f3_100057
  s_mov_b32 s46, 2132992
xa_100058:
  buffer_load_dwordx4 v[12:15], v1, s[12:15], s46 offen sc1
  s_waitcnt vmcnt(0)
  v_max_u32 v16, v12, v13
  v_max3_u32 v16, v16, v14, v15
  v_cmp_eq_u32 vcc, -1, v16
  s_nop 0
  s_cmp_lg_u64 vcc, 0
  s_cbranch_scc0 xaok_100059
  s_sub_u32 s39, s39, 1
  s_cmp_gt_i32 s39, 0
  s_cbranch_scc1 xa_100058
xaok_100059:
  v_add_u32 v16, s42, v1
  ds_write_b128 v16, v[12:15]
  ds_read_b128 v[28:31], v9 offset:0
  ds_read_b128 v[32:35], v9 offset:64
  ds_read_b128 v[36:39], v9 offset:128
  ds_read_b128 v[40:43], v9 offset:192
  s_waitcnt lgkmcnt(3)
  v_mfma_f32_16x16x32_bf16 v[20:23], v[28:31], v[64:67], 0
  v_mfma_f32_16x16x32_bf16 v[24:27], v[28:31], v[128:131], 0
  ds_read_b128 v[28:31], v9 offset:256
  v_lshlrev_b32 v50, 16, v12
  v_and_b32 v51, 0xffff0000, v12
  v_add_f32 v48, v50, v51
  s_waitcnt lgkmcnt(3)
  v_mfma_f32_16x16x32_bf16 v[20:23], v[32:35], v[68:71], v[20:23]
  v_mfma_f32_16x16x32_bf16 v[24:27], v[32:35], v[132:135], v[24:27]
  ds_read_b128 v[32:35], v9 offset:320
  v_mul_f32 v49, v50, v50
  v_fmac_f32 v49, v51, v51
  v_lshlrev_b32 v50, 16, v13
  v_and_b32 v51, 0xffff0000, v13
  s_waitcnt lgkmcnt(3)
  v_mfma_f32_16x16x32_bf16 v[20:23], v[36:39], v[72:75], v[20:23]
  v_mfma_f32_16x16x32_bf16 v[24:27], v[36:39], v[136:139], v[24:27]
  ds_read_b128 v[36:39], v9 offset:384
  v_add_f32 v48, v48, v50
  v_fmac_f32 v49, v50, v50
  v_add_f32 v48, v48, v51
  s_waitcnt lgkmcnt(3)
  v_mfma_f32_16x16x32_bf16 v[20:23], v[40:43], v[76:79], v[20:23]
  v_mfma_f32_16x16x32_bf16 v[24:27], v[40:43], v[140:143], v[24:27]
  ds_read_b128 v[40:43], v9 offset:448
  v_fmac_f32 v49, v51, v51
  v_lshlrev_b32 v50, 16, v14
  v_and_b32 v51, 0xffff0000, v14
  v_add_f32 v48, v48, v50
  s_waitcnt lgkmcnt(3)
  v_mfma_f32_16x16x32_bf16 v[20:23], v[28:31], v[80:83], v[20:23]
  v_mfma_f32_16x16x32_bf16 v[24:27], v[28:31], v[144:147], v[24:27]
  ds_read_b128 v[28:31], v9 offset:512
  v_fmac_f32 v49, v50, v50
  v_add_f32 v48, v48, v51
  v_fmac_f32 v49, v51, v51
  s_waitcnt lgkmcnt(3)
  v_mfma_f32_16x16x32_bf16 v[20:23], v[32:35], v[84:87], v[20:23]
  v_mfma_f32_16x16x32_bf16 v[24:27], v[32:35], v[148:151], v[24:27]
  ds_read_b128 v[32:35], v9 offset:576
  v_lshlrev_b32 v50, 16, v15
  v_and_b32 v51, 0xffff0000, v15
  v_add_f32 v48, v48, v50
  v_fmac_f32 v49, v50, v50
  s_waitcnt lgkmcnt(3)
  v_mfma_f32_16x16x32_bf16 v[20:23], v[36:39], v[88:91], v[20:23]
  v_mfma_f32_16x16x32_bf16 v[24:27], v[36:39], v[152:155], v[24:27]
  ds_read_b128 v[36:39], v9 offset:640
  v_add_f32 v48, v48, v51
  v_fmac_f32 v49, v51, v51
  s_nop 0
  v_add_f32_dpp v48, v48, v48 row_ror:8 row_mask:0xf bank_mask:0xf
  s_waitcnt lgkmcnt(3)
  v_mfma_f32_16x16x32_bf16 v[20:23], v[40:43], v[92:95], v[20:23]
  v_mfma_f32_16x16x32_bf16 v[24:27], v[40:43], v[156:159], v[24:27]
  ds_read_b128 v[40:43], v9 offset:704
  v_add_f32_dpp v49, v49, v49 row_ror:8 row_mask:0xf bank_mask:0xf
  v_add_f32_dpp v48, v48, v48 row_ror:4 row_mask:0xf bank_mask:0xf
  s_nop 0
  v_add_f32_dpp v49, v49, v49 row_ror:4 row_mask:0xf bank_mask:0xf
  v_add_f32_dpp v48, v48, v48 row_ror:2 row_mask:0xf bank_mask:0xf
  s_waitcnt lgkmcnt(3)
  v_mfma_f32_16x16x32_bf16 v[20:23], v[28:31], v[96:99], v[20:23]
  v_mfma_f32_16x16x32_bf16 v[24:27], v[28:31], v[160:163], v[24:27]
  ds_read_b128 v[28:31], v9 offset:768
  v_add_f32_dpp v49, v49, v49 row_ror:2 row_mask:0xf bank_mask:0xf
  v_add_f32_dpp v48, v48, v48 row_ror:1 row_mask:0xf bank_mask:0xf
  s_nop 0
  v_add_f32_dpp v49, v49, v49 row_ror:1 row_mask:0xf bank_mask:0xf
  s_waitcnt lgkmcnt(3)
  v_mfma_f32_16x16x32_bf16 v[20:23], v[32:35], v[100:103], v[20:23]
  v_mfma_f32_16x16x32_bf16 v[24:27], v[32:35], v[164:167], v[24:27]
  ds_read_b128 v[32:35], v9 offset:832
  v_add_f32_dpp v48, v48, v48 row_bcast:15 row_mask:0xa bank_mask:0xf
  v_add_f32_dpp v49, v49, v49 row_bcast:15 row_mask:0xa bank_mask:0xf
  s_nop 0
  v_add_f32_dpp v48, v48, v48 row_bcast:31 row_mask:0xc bank_mask:0xf
  v_add_f32_dpp v49, v49, v49 row_bcast:31 row_mask:0xc bank_mask:0xf
  s_waitcnt lgkmcnt(3)
  v_mfma_f32_16x16x32_bf16 v[20:23], v[36:39], v[104:107], v[20:23]
  v_mfma_f32_16x16x32_bf16 v[24:27], v[36:39], v[168:171], v[24:27]
  ds_read_b128 v[36:39], v9 offset:896
  v_readlane_b32 s54, v48, 63
  v_readlane_b32 s55, v49, 63
  s_nop 0
  v_mov_b32 v44, s54
  s_waitcnt lgkmcnt(3)
  v_mfma_f32_16x16x32_bf16 v[20:23], v[40:43], v[108:111], v[20:23]
  v_mfma_f32_16x16x32_bf16 v[24:27], v[40:43], v[172:175], v[24:27]
  ds_read_b128 v[40:43], v9 offset:960
  v_mov_b32 v45, s55
  v_mul_f32 v44, 0x3b000000, v44
  v_mul_f32 v45, 0x3b000000, v45
  v_fma_f32 v45, -v44, v44, v45
  s_waitcnt lgkmcnt(3)
  v_mfma_f32_16x16x32_bf16 v[20:23], v[28:31], v[112:115], v[20:23]
  v_mfma_f32_16x16x32_bf16 v[24:27], v[28:31], v[176:179], v[24:27]
  v_max_f32 v45, 0, v45
  v_cvt_pk_bf16_f32 v44, v44, v44
  v_cvt_pk_bf16_f32 v45, v45, v45
  s_waitcnt lgkmcnt(2)
  v_mfma_f32_16x16x32_bf16 v[20:23], v[32:35], v[116:119], v[20:23]
  v_mfma_f32_16x16x32_bf16 v[24:27], v[32:35], v[180:183], v[24:27]
  v_and_b32 v44, 0xffff0000, v44
  v_and_b32 v45, 0xffff0000, v45
  v_add_f32 v45, 0x3727c5ac, v45
  v_cvt_pk_bf16_f32 v45, v45, v45
  s_waitcnt lgkmcnt(1)
  v_mfma_f32_16x16x32_bf16 v[20:23], v[36:39], v[120:123], v[20:23]
  v_mfma_f32_16x16x32_bf16 v[24:27], v[36:39], v[184:187], v[24:27]
  v_and_b32 v45, 0xffff0000, v45
  v_sqrt_f32 v45, v45
  s_nop 0
  v_cvt_pk_bf16_f32 v45, v45, v45
  s_waitcnt lgkmcnt(0)
  v_mfma_f32_16x16x32_bf16 v[20:23], v[40:43], v[124:127], v[20:23]
  v_mfma_f32_16x16x32_bf16 v[24:27], v[40:43], v[188:191], v[24:27]
  v_and_b32 v45, 0xffff0000, v45
  v_rcp_f32 v45, v45
  v_mul_f32 v46, v44, v7
  v_mul_f32 v47, v44, v8
  s_nop 2
  v_sub_f32 v20, v20, v46
  v_sub_f32 v24, v24, v47
  v_mul_f32 v20, v20, v45
  v_mul_f32 v24, v24, v45
  v_cvt_pk_bf16_f32 v20, v20, v20
  v_and_b32 v20, 0xffff0000, v20
  v_cvt_pk_bf16_f32 v24, v24, v24
  v_and_b32 v24, 0xffff0000, v24
  v_mul_f32 v12, v20, v24
  s_nop 1
  v_mov_b32_dpp v13, v12 quad_perm:[1,1,3,3] row_mask:0xf bank_mask:0xf
  v_cvt_pk_bf16_f32 v12, v12, v13
  s_nop 1
  v_and_b32_dpp v28, v12, v11 row_newbcast:0 row_mask:0xf bank_mask:0xf
  v_and_b32_dpp v29, v12, v11 row_newbcast:2 row_mask:0xf bank_mask:0xf
  v_and_b32_dpp v30, v12, v11 row_newbcast:4 row_mask:0xf bank_mask:0xf
  v_and_b32_dpp v31, v12, v11 row_newbcast:6 row_mask:0xf bank_mask:0xf
  v_and_b32_dpp v32, v12, v11 row_newbcast:8 row_mask:0xf bank_mask:0xf
  v_and_b32_dpp v33, v12, v11 row_newbcast:10 row_mask:0xf bank_mask:0xf
  v_and_b32_dpp v34, v12, v11 row_newbcast:12 row_mask:0xf bank_mask:0xf
  v_and_b32_dpp v35, v12, v11 row_newbcast:14 row_mask:0xf bank_mask:0xf
  s_lshl_b32 s46, s24, 11
  s_add_u32 s46, s46, 9216
  v_lshlrev_b32 v14, 4, v4
  v_add_u32 v14, s46, v14
  v_mfma_f32_16x16x32_bf16 v[36:39], v[28:31], v[192:195], 0
  v_mfma_f32_16x16x32_bf16 v[36:39], v[32:35], v[196:199], v[36:39]
  v_mfma_f32_16x16x32_bf16 v[40:43], v[28:31], v[200:203], 0
  v_mfma_f32_16x16x32_bf16 v[40:43], v[32:35], v[204:207], v[40:43]
  v_mfma_f32_16x16x32_bf16 v[44:47], v[28:31], v[208:211], 0
  v_mfma_f32_16x16x32_bf16 v[44:47], v[32:35], v[212:215], v[44:47]
  s_mov_b64 exec, 0xffff
  s_nop 2
  ds_write_b128 v14, v[36:39] offset:0
  s_mov_b64 exec, -1
  v_mfma_f32_16x16x32_bf16 v[48:51], v[28:31], v[216:219], 0
  v_mfma_f32_16x16x32_bf16 v[48:51], v[32:35], v[220:223], v[48:51]
  s_mov_b64 exec, 0xffff
  ds_write_b128 v14, v[40:43] offset:256
  s_mov_b64 exec, -1
  v_mfma_f32_16x16x32_bf16 v[36:39], v[28:31], v[224:227], 0
  v_mfma_f32_16x16x32_bf16 v[36:39], v[32:35], v[228:231], v[36:39]
  s_mov_b64 exec, 0xffff
  ds_write_b128 v14, v[44:47] offset:512
  s_mov_b64 exec, -1
  v_mfma_f32_16x16x32_bf16 v[40:43], v[28:31], v[232:235], 0
  v_mfma_f32_16x16x32_bf16 v[40:43], v[32:35], v[236:239], v[40:43]
  s_mov_b64 exec, 0xffff
  ds_write_b128 v14, v[48:51] offset:768
  s_mov_b64 exec, -1
  v_mfma_f32_16x16x32_bf16 v[44:47], v[28:31], v[240:243], 0
  v_mfma_f32_16x16x32_bf16 v[44:47], v[32:35], v[244:247], v[44:47]
  s_mov_b64 exec, 0xffff
  ds_write_b128 v14, v[36:39] offset:1024
  s_mov_b64 exec, -1
  v_mfma_f32_16x16x32_bf16 v[48:51], v[28:31], v[248:251], 0
  v_mfma_f32_16x16x32_bf16 v[48:51], v[32:35], v[252:255], v[48:51]
  s_mov_b64 exec, 0xffff
  ds_write_b128 v14, v[40:43] offset:1280
  s_mov_b64 exec, -1
  s_mov_b64 exec, 0xffff
  ds_write_b128 v14, v[44:47] offset:1536
  s_mov_b64 exec, -1
  s_mov_b64 exec, 0xffff
  s_nop 0
  ds_write_b128 v14, v[48:51] offset:1792
  s_mov_b64 exec, -1
  s_waitcnt lgkmcnt(0)
  s_barrier
  s_lshl_b32 s46, s24, 9
  s_add_u32 s46, s46, 9216
  v_lshlrev_b32 v14, 3, v0
  v_add_u32 v15, s46, v14
  ds_read_b64 v[20:21], v15 offset:0
  ds_read_b64 v[22:23], v15 offset:2048
  ds_read_b64 v[24:25], v15 offset:4096
  ds_read_b64 v[26:27], v15 offset:6144
  s_waitcnt lgkmcnt(0)
  v_add_f32 v20, v20, v22
  v_add_f32 v21, v21, v23
  v_add_f32 v24, v24, v26
  v_add_f32 v25, v25, v27
  v_add_f32 v20, v20, v24
  v_add_f32 v21, v21, v25
  v_lshrrev_b32 v14, 3, v0
  v_lshlrev_b32 v14, 11, v14
  v_and_b32 v15, 7, v0
  v_lshl_add_u32 v14, v15, 3, v14
  s_lshl_b32 s46, s24, 14
  s_lshl_b32 s47, s25, 6
  s_add_u32 s46, s46, s47
  s_add_u32 s46, s46, 2334720
  buffer_store_dwordx2 v[20:21], v14, s[12:15], s46 offen sc1
  s_barrier
f3_100057:
  s_cmp_eq_u32 s24, 1
  s_cbranch_scc0 w1_100060
  s_lshl_b32 s46, s25, 11
  s_add_u32 s46, s46, 2334720
  s_lshl_b32 s47, s25, 5
  s_add_u32 s47, s47, 2132992
  v_and_b32 v24, 3, v0
  v_lshlrev_b32 v24, 3, v24
  v_cmp_gt_u32 vcc, 24, v0
  s_nop 0
  s_mov_b64 s[48:49], vcc
  s_nop 2
r16_100061:
  buffer_load_dwordx4 v[12:15], v1, s[12:15], s46 offen sc1
  v_mov_b32 v16, 0
  v_mov_b32 v17, 0
  v_mov_b32 v18, 0
  v_mov_b32 v19, 0
  s_mov_b64 exec, s[48:49]
  buffer_load_dwordx4 v[16:19], v1, s[12:15], s46 offen offset:1024 sc1
  s_mov_b64 exec, -1
  buffer_load_dwordx2 v[20:21], v24, s[12:15], s47 offen sc1
  s_waitcnt vmcnt(0)
  v_max_u32 v25, v12, v13
  v_max3_u32 v25, v25, v14, v15
  v_max3_u32 v25, v25, v16, v17
  v_max3_u32 v25, v25, v18, v19
  v_max3_u32 v25, v25, v20, v21
  v_cmp_eq_u32 vcc, -1, v25
  s_nop 0
  s_cmp_lg_u64 vcc, 0
  s_cbranch_scc0 r16ok_100062
  s_sub_u32 s39, s39, 1
  s_cmp_gt_i32 s39, 0
  s_cbranch_scc1 r16_100061
r16ok_100062:
  v_add_f32 v12, v12, v16
  v_add_f32 v13, v13, v17
  v_add_f32 v14, v14, v18
  v_add_f32 v15, v15, v19
  v_add_f32_dpp v12, v12, v12 row_ror:4 row_mask:0xf bank_mask:0xf
  v_add_f32_dpp v13, v13, v13 row_ror:4 row_mask:0xf bank_mask:0xf
  v_add_f32_dpp v14, v14, v14 row_ror:4 row_mask:0xf bank_mask:0xf
  v_add_f32_dpp v15, v15, v15 row_ror:4 row_mask:0xf bank_mask:0xf
  v_add_f32_dpp v12, v12, v12 row_ror:8 row_mask:0xf bank_mask:0xf
  v_add_f32_dpp v13, v13, v13 row_ror:8 row_mask:0xf bank_mask:0xf
  v_add_f32_dpp v14, v14, v14 row_ror:8 row_mask:0xf bank_mask:0xf
  v_add_f32_dpp v15, v15, v15 row_ror:8 row_mask:0xf bank_mask:0xf
  v_mov_b32 v16, v12
  v_mov_b32 v17, v13
  v_mov_b32 v18, v14
  v_mov_b32 v19, v15
  v_permlane32_swap_b32 v12, v16
  v_permlane32_swap_b32 v13, v17
  v_permlane32_swap_b32 v14, v18
  v_permlane32_swap_b32 v15, v19
  v_add_f32 v12, v12, v16
  v_add_f32 v13, v13, v17
  v_add_f32 v14, v14, v18
  v_add_f32 v15, v15, v19
  v_mov_b32 v16, v12
  v_mov_b32 v17, v13
  v_mov_b32 v18, v14
  v_mov_b32 v19, v15
  v_permlane16_swap_b32 v12, v16
  v_permlane16_swap_b32 v13, v17
  v_permlane16_swap_b32 v14, v18
  v_permlane16_swap_b32 v15, v19
  v_add_f32 v12, v12, v16
  v_add_f32 v13, v13, v17
  v_add_f32 v14, v14, v18
  v_add_f32 v15, v15, v19
  v_lshlrev_b32 v16, 16, v20
  v_and_b32 v17, 0xffff0000, v20
  v_lshlrev_b32 v18, 16, v21
  v_and_b32 v19, 0xffff0000, v21
  v_cvt_pk_bf16_f32 v12, v12, v12
  v_and_b32 v12, 0xffff0000, v12
  v_cvt_pk_bf16_f32 v13, v13, v13
  v_and_b32 v13, 0xffff0000, v13
  v_cvt_pk_bf16_f32 v14, v14, v14
  v_and_b32 v14, 0xffff0000, v14
  v_cvt_pk_bf16_f32 v15, v15, v15
  v_and_b32 v15, 0xffff0000, v15
  v_add_f32 v12, v12, v16
  v_add_f32 v13, v13, v17
  v_add_f32 v14, v14, v18
  v_add_f32 v15, v15, v19
  v_cvt_pk_bf16_f32 v20, v12, v13
  v_cvt_pk_bf16_f32 v21, v14, v15
  s_lshl_b32 s46, s25, 5
  s_add_u32 s46, s46, 1024
  s_mov_b64 exec, 0xf
  buffer_store_dwordx2 v[20:21], v24, s[16:19], s46 offen
  s_mov_b64 exec, -1
w1_100060:
  s_waitcnt vmcnt(0)
L_end:
  s_endpgm
.section .rodata,"a"
.p2align 6
.amdhsa_kernel interleave_layers__gqa_block_cached__glu_gated_bilinear__decode_kernel
  .amdhsa_next_free_vgpr 512
  .amdhsa_next_free_sgpr 102
  .amdhsa_accum_offset 256
  .amdhsa_group_segment_fixed_size 0
  .amdhsa_kernarg_size 96
  .amdhsa_user_sgpr_count 2
  .amdhsa_user_sgpr_kernarg_segment_ptr 1
  .amdhsa_system_sgpr_workgroup_id_x 1
.end_amdhsa_kernel
```
